```python
import torch

def _softmax(x, axis=-1):
    return torch.softmax(x, dim=axis)
def _gelu(x):
    return torch.nn.functional.gelu(x, approximate="tanh")
def _silu(x):
    return torch.nn.functional.silu(x)
def _sigmoid(x):
    return torch.sigmoid(x)
def _layernorm(x, axis=-1, eps=1e-5):
    m = x.mean(dim=axis, keepdim=True)
    v = x.var(dim=axis, keepdim=True, unbiased=False)
    return (x - m) / torch.sqrt(v + eps)
def _scatter_add(tgt, idx, src, axis=0):
    return tgt.clone().index_add_(axis, idx, src)
def _segment_sum(src, seg, n):
    out = torch.zeros((n,) + src.shape[1:], dtype=src.dtype)
    return out.index_add_(0, seg, src)
def _pad(x, pw):
    flat = tuple(v for pair in reversed(pw) for v in pair)
    return torch.nn.functional.pad(x, flat)

kernel_name = 'standalone__gqa_softmax__near_ridge'

def setup_inputs():

    _w = (lambda a: (lambda t: t.to(torch.bfloat16) if t.is_floating_point() else t)(torch.as_tensor(a)))
    B, Hq, Hkv, Sq, Sk, D = 16, 32, 32, 256, 1024, 128
    return {
        "q": _w((lambda *s: torch.randn(*s, dtype=torch.bfloat16) * 0.8)(B, Hq, Sq, D)),
        "k": _w((lambda *s: torch.randn(*s, dtype=torch.bfloat16) * 0.8)(B, Hkv, Sk, D)),
        "v": _w((lambda *s: torch.randn(*s, dtype=torch.bfloat16) * 0.05)(B, Hkv, Sk, D)),
    }

def reference(q, k, v):
    B, Hq, Sq, D = q.shape
    Hkv = k.shape[1]
    rep = Hq // Hkv
    k = (lambda x, n, axis: torch.repeat_interleave(x, n, dim=axis))(k, rep, axis=1)
    v = (lambda x, n, axis: torch.repeat_interleave(x, n, dim=axis))(v, rep, axis=1)
    scale = D ** -0.5
    scores = torch.einsum("bhqd,bhkd->bhqk", q, k) * scale
    p = _softmax(scores, axis=-1)
    return torch.einsum("bhqk,bhkd->bhqd", p, v)
```

```asm
; @launch grid=(256,1,1) block=(256,1,1) lds=163840
.amdgcn_target "amdgcn-amd-amdhsa--gfx950"
.text
.globl standalone__gqa_softmax__near_ridge_kernel
.p2align 8
.type standalone__gqa_softmax__near_ridge_kernel,@function
standalone__gqa_softmax__near_ridge_kernel:
    s_cmp_lt_u32 s2, 256
    s_cbranch_scc1 L_go
    s_endpgm
L_go:
    s_load_dwordx4 s[4:7], s[0:1], 0
    s_load_dwordx4 s[8:11], s[0:1], 16
    v_lshrrev_b32 v226, 6, v0
    v_and_b32 v204, 63, v0
    v_readfirstlane_b32 s3, v226
    v_lshrrev_b32 v227, 4, v204
    v_and_b32 v228, 15, v204
    v_lshl_add_u32 v229, v226, 4, v227
    v_lshlrev_b32 v229, 8, v229
    v_add_u32 v230, 0, v227
    v_xor_b32 v230, v230, v228
    v_lshl_add_u32 v196, v230, 4, v229
    v_add_u32 v230, 4, v227
    v_xor_b32 v230, v230, v228
    v_lshl_add_u32 v197, v230, 4, v229
    v_add_u32 v230, 8, v227
    v_xor_b32 v230, v230, v228
    v_lshl_add_u32 v198, v230, 4, v229
    v_add_u32 v230, 12, v227
    v_xor_b32 v230, v230, v228
    v_lshl_add_u32 v199, v230, 4, v229
    s_waitcnt lgkmcnt(0)
    s_lshl_b32 s38, s2, 17
    s_add_u32 s12, s4, s38
    s_addc_u32 s13, s5, 0
    s_and_b32 s13, s13, 0xffff
    s_mov_b32 s14, 131072
    s_mov_b32 s15, 0x20000
    s_mul_i32 s51, s3, 12288
    s_add_u32 s38, s51, 0
    buffer_load_dwordx4 v[0:3], v196, s[12:15], s38 offen offset:0 nt
    s_add_u32 s38, s51, 0
    buffer_load_dwordx4 v[4:7], v197, s[12:15], s38 offen offset:1024 nt
    s_add_u32 s38, s51, 0
    buffer_load_dwordx4 v[8:11], v198, s[12:15], s38 offen offset:2048 nt
    s_add_u32 s38, s51, 0
    buffer_load_dwordx4 v[12:15], v199, s[12:15], s38 offen offset:3072 nt
    s_add_u32 s38, s51, 4096
    buffer_load_dwordx4 v[16:19], v196, s[12:15], s38 offen offset:0 nt
    s_add_u32 s38, s51, 4096
    buffer_load_dwordx4 v[20:23], v197, s[12:15], s38 offen offset:1024 nt
    s_add_u32 s38, s51, 4096
    buffer_load_dwordx4 v[24:27], v198, s[12:15], s38 offen offset:2048 nt
    s_add_u32 s38, s51, 4096
    buffer_load_dwordx4 v[28:31], v199, s[12:15], s38 offen offset:3072 nt
L_pc:
    s_getpc_b64 s[42:43]
    s_lshr_b32 s39, s2, 3
    s_and_b32 s39, s39, 7
    s_lshl_b32 s39, s39, 2
    s_add_u32 s39, s39, s3
    s_lshl_b32 s39, s39, 12
    v_lshl_add_u32 v230, v204, 6, s39
    s_mov_b32 s39, L_codeend-L_pc-8
    v_min_u32 v230, s39, v230
    global_load_dword v246, v230, s[42:43]
    s_lshl_b32 s38, s2, 19
    s_add_u32 s16, s6, s38
    s_addc_u32 s17, s7, 0
    s_and_b32 s17, s17, 0xffff
    s_mov_b32 s18, 524288
    s_mov_b32 s19, 0x20000
    s_lshl_b32 s30, s3, 12
    s_mov_b32 s28, 0
    s_add_u32 m0, s30, 0
    s_nop 0
    buffer_load_dwordx4 v196, s[16:19], s28 offen offset:0 nt lds
    buffer_load_dwordx4 v197, s[16:19], s28 offen offset:1024 nt lds
    buffer_load_dwordx4 v198, s[16:19], s28 offen offset:2048 nt lds
    buffer_load_dwordx4 v199, s[16:19], s28 offen offset:3072 nt lds
    s_add_u32 s28, s28, 16384
    s_add_u32 s38, s51, 8192
    buffer_load_dwordx4 v[32:35], v196, s[12:15], s38 offen offset:0 nt
    s_add_u32 s38, s51, 8192
    buffer_load_dwordx4 v[36:39], v197, s[12:15], s38 offen offset:1024 nt
    s_add_u32 s38, s51, 8192
    buffer_load_dwordx4 v[40:43], v198, s[12:15], s38 offen offset:2048 nt
    s_add_u32 s38, s51, 8192
    buffer_load_dwordx4 v[44:47], v199, s[12:15], s38 offen offset:3072 nt
    s_add_u32 s38, s51, 12288
    buffer_load_dwordx4 v[48:51], v196, s[12:15], s38 offen offset:0 nt
    s_add_u32 s38, s51, 12288
    buffer_load_dwordx4 v[52:55], v197, s[12:15], s38 offen offset:1024 nt
    s_add_u32 s38, s51, 12288
    buffer_load_dwordx4 v[56:59], v198, s[12:15], s38 offen offset:2048 nt
    s_add_u32 s38, s51, 12288
    buffer_load_dwordx4 v[60:63], v199, s[12:15], s38 offen offset:3072 nt
    s_lshl_b32 s38, s2, 19
    s_add_u32 s20, s8, s38
    s_addc_u32 s21, s9, 0
    s_and_b32 s21, s21, 0xffff
    s_mov_b32 s22, 524288
    s_mov_b32 s23, 0x20000
    s_lshl_b32 s38, s2, 17
    s_add_u32 s24, s10, s38
    s_addc_u32 s25, s11, 0
    s_and_b32 s25, s25, 0xffff
    s_mov_b32 s26, 131072
    s_mov_b32 s27, 0x20000
    s_lshl_b32 s36, s3, 13
    s_add_u32 s36, s36, 131072
    s_lshl_b32 s52, s3, 14
    s_mov_b32 s29, 0
    s_mov_b32 s34, 0x3e0293ee
    s_mov_b32 s35, 0x3e0293ee
    s_mov_b32 s37, 0xffff0000
    s_mov_b32 s48, 0x30800000
    s_mov_b32 s49, 0x5d800000
    s_mov_b32 s50, 0
    s_add_u32 s51, s51, 65536
    v_add_u32 v230, 0, v227
    v_lshlrev_b32 v230, 1, v230
    v_xor_b32 v230, v230, v228
    v_lshl_add_u32 v200, v230, 4, v229
    v_add_u32 v230, 4, v227
    v_lshlrev_b32 v230, 1, v230
    v_xor_b32 v230, v230, v228
    v_lshl_add_u32 v201, v230, 4, v229
    v_lshlrev_b32 v229, 8, v228
    v_add_u32 v226, 0, v227
    v_xor_b32 v226, v226, v228
    v_lshl_add_u32 v180, v226, 4, v229
    v_add_u32 v214, s36, v180
    v_add_u32 v226, 4, v227
    v_xor_b32 v226, v226, v228
    v_lshl_add_u32 v181, v226, 4, v229
    v_add_u32 v215, s36, v181
    v_add_u32 v226, 8, v227
    v_xor_b32 v226, v226, v228
    v_lshl_add_u32 v182, v226, 4, v229
    v_add_u32 v216, s36, v182
    v_add_u32 v226, 12, v227
    v_xor_b32 v226, v226, v228
    v_lshl_add_u32 v183, v226, 4, v229
    v_add_u32 v217, s36, v183
    v_lshrrev_b32 v231, 2, v228
    v_and_b32 v232, 3, v204
    v_lshl_add_u32 v233, v227, 2, v231
    v_lshlrev_b32 v229, 8, v233
    v_lshl_add_u32 v229, v232, 3, v229
    v_add_u32 v229, 0x10000, v229
    v_and_b32 v233, 7, v233
    v_xor_b32 v226, 0, v233
    v_lshl_add_u32 v188, v226, 5, v229
    v_xor_b32 v226, 1, v233
    v_lshl_add_u32 v189, v226, 5, v229
    v_xor_b32 v226, 2, v233
    v_lshl_add_u32 v190, v226, 5, v229
    v_xor_b32 v226, 3, v233
    v_lshl_add_u32 v191, v226, 5, v229
    v_xor_b32 v226, 4, v233
    v_lshl_add_u32 v192, v226, 5, v229
    v_xor_b32 v226, 5, v233
    v_lshl_add_u32 v193, v226, 5, v229
    v_xor_b32 v226, 6, v233
    v_lshl_add_u32 v194, v226, 5, v229
    v_xor_b32 v226, 7, v233
    v_lshl_add_u32 v195, v226, 5, v229
    v_lshlrev_b32 v229, 8, v228
    v_and_b32 v226, 1, v227
    v_lshl_add_u32 v229, v226, 3, v229
    v_lshrrev_b32 v226, 1, v227
    v_and_b32 v230, 7, v204
    v_xor_b32 v226, v226, v230
    v_lshl_add_u32 v229, v226, 4, v229
    v_add_u32 v206, s36, v229
    v_xor_b32 v207, 32, v206
    v_xor_b32 v208, 64, v206
    v_xor_b32 v209, 96, v206
    v_xor_b32 v210, 128, v206
    v_xor_b32 v211, 160, v206
    v_xor_b32 v212, 192, v206
    v_xor_b32 v213, 224, v206
    v_lshlrev_b32 v229, 4, v204
    v_add_u32 v205, s36, v229
    v_lshlrev_b32 v229, 8, v227
    v_add_u32 v226, 0, v227
    v_xor_b32 v226, v226, v228
    v_lshl_add_u32 v202, v226, 4, v229
    v_add_u32 v226, 4, v227
    v_xor_b32 v226, v226, v228
    v_lshl_add_u32 v203, v226, 4, v229
    s_waitcnt vmcnt(20)
    v_lshlrev_b32 v226, 16, v0
    v_and_b32 v227, s37, v0
    v_lshlrev_b32 v228, 16, v1
    v_and_b32 v229, s37, v1
    v_lshlrev_b32 v230, 16, v2
    v_and_b32 v231, s37, v2
    v_lshlrev_b32 v232, 16, v3
    v_and_b32 v233, s37, v3
    v_pk_mul_f32 v[226:227], v[226:227], s[34:35]
    v_pk_mul_f32 v[228:229], v[228:229], s[34:35]
    v_pk_mul_f32 v[230:231], v[230:231], s[34:35]
    v_pk_mul_f32 v[232:233], v[232:233], s[34:35]
    v_cvt_pk_bf16_f32 v238, v226, v227
    v_cvt_pk_bf16_f32 v239, v228, v229
    v_cvt_pk_bf16_f32 v240, v230, v231
    v_cvt_pk_bf16_f32 v241, v232, v233
    ds_write_b128 v205, v[238:241] offset:0
    s_add_u32 m0, s30, 65536
    s_nop 0
    buffer_load_dwordx4 v200, s[20:23], s29 offen offset:0 nt lds
    s_waitcnt vmcnt(20)
    v_lshlrev_b32 v226, 16, v4
    v_and_b32 v227, s37, v4
    v_lshlrev_b32 v228, 16, v5
    v_and_b32 v229, s37, v5
    v_lshlrev_b32 v230, 16, v6
    v_and_b32 v231, s37, v6
    v_lshlrev_b32 v232, 16, v7
    v_and_b32 v233, s37, v7
    v_pk_mul_f32 v[226:227], v[226:227], s[34:35]
    v_pk_mul_f32 v[228:229], v[228:229], s[34:35]
    v_pk_mul_f32 v[230:231], v[230:231], s[34:35]
    v_pk_mul_f32 v[232:233], v[232:233], s[34:35]
    v_cvt_pk_bf16_f32 v238, v226, v227
    v_cvt_pk_bf16_f32 v239, v228, v229
    v_cvt_pk_bf16_f32 v240, v230, v231
    v_cvt_pk_bf16_f32 v241, v232, v233
    ds_write_b128 v205, v[238:241] offset:1024
    buffer_load_dwordx4 v201, s[20:23], s29 offen offset:1024 nt lds
    s_waitcnt vmcnt(20)
    v_lshlrev_b32 v226, 16, v8
    v_and_b32 v227, s37, v8
    v_lshlrev_b32 v228, 16, v9
    v_and_b32 v229, s37, v9
    v_lshlrev_b32 v230, 16, v10
    v_and_b32 v231, s37, v10
    v_lshlrev_b32 v232, 16, v11
    v_and_b32 v233, s37, v11
    v_pk_mul_f32 v[226:227], v[226:227], s[34:35]
    v_pk_mul_f32 v[228:229], v[228:229], s[34:35]
    v_pk_mul_f32 v[230:231], v[230:231], s[34:35]
    v_pk_mul_f32 v[232:233], v[232:233], s[34:35]
    v_cvt_pk_bf16_f32 v238, v226, v227
    v_cvt_pk_bf16_f32 v239, v228, v229
    v_cvt_pk_bf16_f32 v240, v230, v231
    v_cvt_pk_bf16_f32 v241, v232, v233
    ds_write_b128 v205, v[238:241] offset:2048
    buffer_load_dwordx4 v200, s[20:23], s29 offen offset:2048 nt lds
    s_waitcnt vmcnt(20)
    v_lshlrev_b32 v226, 16, v12
    v_and_b32 v227, s37, v12
    v_lshlrev_b32 v228, 16, v13
    v_and_b32 v229, s37, v13
    v_lshlrev_b32 v230, 16, v14
    v_and_b32 v231, s37, v14
    v_lshlrev_b32 v232, 16, v15
    v_and_b32 v233, s37, v15
    v_pk_mul_f32 v[226:227], v[226:227], s[34:35]
    v_pk_mul_f32 v[228:229], v[228:229], s[34:35]
    v_pk_mul_f32 v[230:231], v[230:231], s[34:35]
    v_pk_mul_f32 v[232:233], v[232:233], s[34:35]
    v_cvt_pk_bf16_f32 v238, v226, v227
    v_cvt_pk_bf16_f32 v239, v228, v229
    v_cvt_pk_bf16_f32 v240, v230, v231
    v_cvt_pk_bf16_f32 v241, v232, v233
    ds_write_b128 v205, v[238:241] offset:3072
    buffer_load_dwordx4 v201, s[20:23], s29 offen offset:3072 nt lds
    s_add_u32 s29, s29, 16384
    s_waitcnt vmcnt(20)
    v_lshlrev_b32 v226, 16, v16
    v_and_b32 v227, s37, v16
    v_lshlrev_b32 v228, 16, v17
    v_and_b32 v229, s37, v17
    v_lshlrev_b32 v230, 16, v18
    v_and_b32 v231, s37, v18
    v_lshlrev_b32 v232, 16, v19
    v_and_b32 v233, s37, v19
    v_pk_mul_f32 v[226:227], v[226:227], s[34:35]
    v_pk_mul_f32 v[228:229], v[228:229], s[34:35]
    v_pk_mul_f32 v[230:231], v[230:231], s[34:35]
    v_pk_mul_f32 v[232:233], v[232:233], s[34:35]
    v_cvt_pk_bf16_f32 v238, v226, v227
    v_cvt_pk_bf16_f32 v239, v228, v229
    v_cvt_pk_bf16_f32 v240, v230, v231
    v_cvt_pk_bf16_f32 v241, v232, v233
    ds_write_b128 v205, v[238:241] offset:4096
    s_add_u32 m0, s30, 16384
    s_nop 0
    buffer_load_dwordx4 v196, s[16:19], s28 offen offset:0 nt lds
    s_waitcnt vmcnt(20)
    v_lshlrev_b32 v226, 16, v20
    v_and_b32 v227, s37, v20
    v_lshlrev_b32 v228, 16, v21
    v_and_b32 v229, s37, v21
    v_lshlrev_b32 v230, 16, v22
    v_and_b32 v231, s37, v22
    v_lshlrev_b32 v232, 16, v23
    v_and_b32 v233, s37, v23
    v_pk_mul_f32 v[226:227], v[226:227], s[34:35]
    v_pk_mul_f32 v[228:229], v[228:229], s[34:35]
    v_pk_mul_f32 v[230:231], v[230:231], s[34:35]
    v_pk_mul_f32 v[232:233], v[232:233], s[34:35]
    v_cvt_pk_bf16_f32 v238, v226, v227
    v_cvt_pk_bf16_f32 v239, v228, v229
    v_cvt_pk_bf16_f32 v240, v230, v231
    v_cvt_pk_bf16_f32 v241, v232, v233
    ds_write_b128 v205, v[238:241] offset:5120
    buffer_load_dwordx4 v197, s[16:19], s28 offen offset:1024 nt lds
    s_waitcnt vmcnt(20)
    v_lshlrev_b32 v226, 16, v24
    v_and_b32 v227, s37, v24
    v_lshlrev_b32 v228, 16, v25
    v_and_b32 v229, s37, v25
    v_lshlrev_b32 v230, 16, v26
    v_and_b32 v231, s37, v26
    v_lshlrev_b32 v232, 16, v27
    v_and_b32 v233, s37, v27
    v_pk_mul_f32 v[226:227], v[226:227], s[34:35]
    v_pk_mul_f32 v[228:229], v[228:229], s[34:35]
    v_pk_mul_f32 v[230:231], v[230:231], s[34:35]
    v_pk_mul_f32 v[232:233], v[232:233], s[34:35]
    v_cvt_pk_bf16_f32 v238, v226, v227
    v_cvt_pk_bf16_f32 v239, v228, v229
    v_cvt_pk_bf16_f32 v240, v230, v231
    v_cvt_pk_bf16_f32 v241, v232, v233
    ds_write_b128 v205, v[238:241] offset:6144
    buffer_load_dwordx4 v198, s[16:19], s28 offen offset:2048 nt lds
    s_waitcnt vmcnt(20)
    v_lshlrev_b32 v226, 16, v28
    v_and_b32 v227, s37, v28
    v_lshlrev_b32 v228, 16, v29
    v_and_b32 v229, s37, v29
    v_lshlrev_b32 v230, 16, v30
    v_and_b32 v231, s37, v30
    v_lshlrev_b32 v232, 16, v31
    v_and_b32 v233, s37, v31
    v_pk_mul_f32 v[226:227], v[226:227], s[34:35]
    v_pk_mul_f32 v[228:229], v[228:229], s[34:35]
    v_pk_mul_f32 v[230:231], v[230:231], s[34:35]
    v_pk_mul_f32 v[232:233], v[232:233], s[34:35]
    v_cvt_pk_bf16_f32 v238, v226, v227
    v_cvt_pk_bf16_f32 v239, v228, v229
    v_cvt_pk_bf16_f32 v240, v230, v231
    v_cvt_pk_bf16_f32 v241, v232, v233
    ds_write_b128 v205, v[238:241] offset:7168
    buffer_load_dwordx4 v199, s[16:19], s28 offen offset:3072 nt lds
    s_add_u32 s28, s28, 16384
    ds_read_b128 a[0:3], v214 offset:0
    ds_read_b128 a[4:7], v215 offset:0
    ds_read_b128 a[8:11], v216 offset:0
    ds_read_b128 a[12:15], v217 offset:0
    ds_read_b128 a[16:19], v214 offset:4096
    ds_read_b128 a[20:23], v215 offset:4096
    ds_read_b128 a[24:27], v216 offset:4096
    ds_read_b128 a[28:31], v217 offset:4096
    s_waitcnt vmcnt(15)
    v_lshlrev_b32 v226, 16, v32
    v_and_b32 v227, s37, v32
    v_lshlrev_b32 v228, 16, v33
    v_and_b32 v229, s37, v33
    v_lshlrev_b32 v230, 16, v34
    v_and_b32 v231, s37, v34
    v_lshlrev_b32 v232, 16, v35
    v_and_b32 v233, s37, v35
    v_pk_mul_f32 v[226:227], v[226:227], s[34:35]
    v_pk_mul_f32 v[228:229], v[228:229], s[34:35]
    v_pk_mul_f32 v[230:231], v[230:231], s[34:35]
    v_pk_mul_f32 v[232:233], v[232:233], s[34:35]
    v_cvt_pk_bf16_f32 v238, v226, v227
    v_cvt_pk_bf16_f32 v239, v228, v229
    v_cvt_pk_bf16_f32 v240, v230, v231
    v_cvt_pk_bf16_f32 v241, v232, v233
    ds_write_b128 v205, v[238:241] offset:0
    s_waitcnt vmcnt(14)
    v_lshlrev_b32 v226, 16, v36
    v_and_b32 v227, s37, v36
    v_lshlrev_b32 v228, 16, v37
    v_and_b32 v229, s37, v37
    v_lshlrev_b32 v230, 16, v38
    v_and_b32 v231, s37, v38
    v_lshlrev_b32 v232, 16, v39
    v_and_b32 v233, s37, v39
    v_pk_mul_f32 v[226:227], v[226:227], s[34:35]
    v_pk_mul_f32 v[228:229], v[228:229], s[34:35]
    v_pk_mul_f32 v[230:231], v[230:231], s[34:35]
    v_pk_mul_f32 v[232:233], v[232:233], s[34:35]
    v_cvt_pk_bf16_f32 v238, v226, v227
    v_cvt_pk_bf16_f32 v239, v228, v229
    v_cvt_pk_bf16_f32 v240, v230, v231
    v_cvt_pk_bf16_f32 v241, v232, v233
    ds_write_b128 v205, v[238:241] offset:1024
    s_waitcnt vmcnt(13)
    v_lshlrev_b32 v226, 16, v40
    v_and_b32 v227, s37, v40
    v_lshlrev_b32 v228, 16, v41
    v_and_b32 v229, s37, v41
    v_lshlrev_b32 v230, 16, v42
    v_and_b32 v231, s37, v42
    v_lshlrev_b32 v232, 16, v43
    v_and_b32 v233, s37, v43
    v_pk_mul_f32 v[226:227], v[226:227], s[34:35]
    v_pk_mul_f32 v[228:229], v[228:229], s[34:35]
    v_pk_mul_f32 v[230:231], v[230:231], s[34:35]
    v_pk_mul_f32 v[232:233], v[232:233], s[34:35]
    v_cvt_pk_bf16_f32 v238, v226, v227
    v_cvt_pk_bf16_f32 v239, v228, v229
    v_cvt_pk_bf16_f32 v240, v230, v231
    v_cvt_pk_bf16_f32 v241, v232, v233
    ds_write_b128 v205, v[238:241] offset:2048
    s_waitcnt vmcnt(12)
    v_lshlrev_b32 v226, 16, v44
    v_and_b32 v227, s37, v44
    v_lshlrev_b32 v228, 16, v45
    v_and_b32 v229, s37, v45
    v_lshlrev_b32 v230, 16, v46
    v_and_b32 v231, s37, v46
    v_lshlrev_b32 v232, 16, v47
    v_and_b32 v233, s37, v47
    v_pk_mul_f32 v[226:227], v[226:227], s[34:35]
    v_pk_mul_f32 v[228:229], v[228:229], s[34:35]
    v_pk_mul_f32 v[230:231], v[230:231], s[34:35]
    v_pk_mul_f32 v[232:233], v[232:233], s[34:35]
    v_cvt_pk_bf16_f32 v238, v226, v227
    v_cvt_pk_bf16_f32 v239, v228, v229
    v_cvt_pk_bf16_f32 v240, v230, v231
    v_cvt_pk_bf16_f32 v241, v232, v233
    ds_write_b128 v205, v[238:241] offset:3072
    s_waitcnt vmcnt(11)
    v_lshlrev_b32 v226, 16, v48
    v_and_b32 v227, s37, v48
    v_lshlrev_b32 v228, 16, v49
    v_and_b32 v229, s37, v49
    v_lshlrev_b32 v230, 16, v50
    v_and_b32 v231, s37, v50
    v_lshlrev_b32 v232, 16, v51
    v_and_b32 v233, s37, v51
    v_pk_mul_f32 v[226:227], v[226:227], s[34:35]
    v_pk_mul_f32 v[228:229], v[228:229], s[34:35]
    v_pk_mul_f32 v[230:231], v[230:231], s[34:35]
    v_pk_mul_f32 v[232:233], v[232:233], s[34:35]
    v_cvt_pk_bf16_f32 v238, v226, v227
    v_cvt_pk_bf16_f32 v239, v228, v229
    v_cvt_pk_bf16_f32 v240, v230, v231
    v_cvt_pk_bf16_f32 v241, v232, v233
    ds_write_b128 v205, v[238:241] offset:4096
    s_waitcnt vmcnt(10)
    v_lshlrev_b32 v226, 16, v52
    v_and_b32 v227, s37, v52
    v_lshlrev_b32 v228, 16, v53
    v_and_b32 v229, s37, v53
    v_lshlrev_b32 v230, 16, v54
    v_and_b32 v231, s37, v54
    v_lshlrev_b32 v232, 16, v55
    v_and_b32 v233, s37, v55
    v_pk_mul_f32 v[226:227], v[226:227], s[34:35]
    v_pk_mul_f32 v[228:229], v[228:229], s[34:35]
    v_pk_mul_f32 v[230:231], v[230:231], s[34:35]
    v_pk_mul_f32 v[232:233], v[232:233], s[34:35]
    v_cvt_pk_bf16_f32 v238, v226, v227
    v_cvt_pk_bf16_f32 v239, v228, v229
    v_cvt_pk_bf16_f32 v240, v230, v231
    v_cvt_pk_bf16_f32 v241, v232, v233
    ds_write_b128 v205, v[238:241] offset:5120
    s_waitcnt vmcnt(9)
    v_lshlrev_b32 v226, 16, v56
    v_and_b32 v227, s37, v56
    v_lshlrev_b32 v228, 16, v57
    v_and_b32 v229, s37, v57
    v_lshlrev_b32 v230, 16, v58
    v_and_b32 v231, s37, v58
    v_lshlrev_b32 v232, 16, v59
    v_and_b32 v233, s37, v59
    v_pk_mul_f32 v[226:227], v[226:227], s[34:35]
    v_pk_mul_f32 v[228:229], v[228:229], s[34:35]
    v_pk_mul_f32 v[230:231], v[230:231], s[34:35]
    v_pk_mul_f32 v[232:233], v[232:233], s[34:35]
    v_cvt_pk_bf16_f32 v238, v226, v227
    v_cvt_pk_bf16_f32 v239, v228, v229
    v_cvt_pk_bf16_f32 v240, v230, v231
    v_cvt_pk_bf16_f32 v241, v232, v233
    ds_write_b128 v205, v[238:241] offset:6144
    s_waitcnt vmcnt(8)
    v_lshlrev_b32 v226, 16, v60
    v_and_b32 v227, s37, v60
    v_lshlrev_b32 v228, 16, v61
    v_and_b32 v229, s37, v61
    v_lshlrev_b32 v230, 16, v62
    v_and_b32 v231, s37, v62
    v_lshlrev_b32 v232, 16, v63
    v_and_b32 v233, s37, v63
    v_pk_mul_f32 v[226:227], v[226:227], s[34:35]
    v_pk_mul_f32 v[228:229], v[228:229], s[34:35]
    v_pk_mul_f32 v[230:231], v[230:231], s[34:35]
    v_pk_mul_f32 v[232:233], v[232:233], s[34:35]
    v_cvt_pk_bf16_f32 v238, v226, v227
    v_cvt_pk_bf16_f32 v239, v228, v229
    v_cvt_pk_bf16_f32 v240, v230, v231
    v_cvt_pk_bf16_f32 v241, v232, v233
    ds_write_b128 v205, v[238:241] offset:7168
    ds_read_b128 a[32:35], v214 offset:0
    ds_read_b128 a[36:39], v215 offset:0
    ds_read_b128 a[40:43], v216 offset:0
    ds_read_b128 a[44:47], v217 offset:0
    ds_read_b128 a[48:51], v214 offset:4096
    ds_read_b128 a[52:55], v215 offset:4096
    ds_read_b128 a[56:59], v216 offset:4096
    ds_read_b128 a[60:63], v217 offset:4096
    v_mov_b32 v250, 0x207
    v_mov_b32 v242, 0x3f803f80
    v_mov_b32 v243, 0x3f803f80
    v_mov_b32 v244, 0x3f803f80
    v_mov_b32 v245, 0x3f803f80
    s_barrier
    ds_read_b128 a[64:67], v180 offset:0
    ds_read_b128 a[68:71], v181 offset:0
    ds_read_b128 a[72:75], v182 offset:0
    ds_read_b128 a[76:79], v183 offset:0
    ds_read_b128 a[80:83], v180 offset:4096
    ds_read_b128 a[84:87], v181 offset:4096
    ds_read_b128 a[88:91], v182 offset:4096
    ds_read_b128 a[92:95], v183 offset:4096
    s_waitcnt lgkmcnt(0)
    v_mfma_f32_16x16x32_bf16 v[128:131], a[64:67], a[0:3], 0
    v_mfma_f32_16x16x32_bf16 v[128:131], a[68:71], a[4:7], v[128:131]
    v_mfma_f32_16x16x32_bf16 v[128:131], a[72:75], a[8:11], v[128:131]
    v_mfma_f32_16x16x32_bf16 v[128:131], a[76:79], a[12:15], v[128:131]
    v_mfma_f32_16x16x32_bf16 v[136:139], a[64:67], a[16:19], 0
    v_mfma_f32_16x16x32_bf16 v[136:139], a[68:71], a[20:23], v[136:139]
    s_add_u32 m0, s30, 81920
    s_nop 0
    buffer_load_dwordx4 v200, s[20:23], s29 offen offset:0 nt lds
    v_mfma_f32_16x16x32_bf16 v[136:139], a[72:75], a[24:27], v[136:139]
    v_mfma_f32_16x16x32_bf16 v[136:139], a[76:79], a[28:31], v[136:139]
    v_mfma_f32_16x16x32_bf16 v[132:135], a[80:83], a[0:3], 0
    v_mfma_f32_16x16x32_bf16 v[132:135], a[84:87], a[4:7], v[132:135]
    v_mfma_f32_16x16x32_bf16 v[132:135], a[88:91], a[8:11], v[132:135]
    v_mfma_f32_16x16x32_bf16 v[132:135], a[92:95], a[12:15], v[132:135]
    v_mfma_f32_16x16x32_bf16 v[140:143], a[80:83], a[16:19], 0
    v_mfma_f32_16x16x32_bf16 v[140:143], a[84:87], a[20:23], v[140:143]
    buffer_load_dwordx4 v201, s[20:23], s29 offen offset:1024 nt lds
    v_mfma_f32_16x16x32_bf16 v[140:143], a[88:91], a[24:27], v[140:143]
    v_mfma_f32_16x16x32_bf16 v[140:143], a[92:95], a[28:31], v[140:143]
    buffer_load_dwordx4 v200, s[20:23], s29 offen offset:2048 nt lds
    buffer_load_dwordx4 v201, s[20:23], s29 offen offset:3072 nt lds
    s_add_u32 s29, s29, 16384
    v_mfma_f32_16x16x32_bf16 v[144:147], a[64:67], a[32:35], 0
    v_exp_f32 v128, v128
    v_mfma_f32_16x16x32_bf16 v[144:147], a[68:71], a[36:39], v[144:147]
    v_exp_f32 v129, v129
    v_mfma_f32_16x16x32_bf16 v[144:147], a[72:75], a[40:43], v[144:147]
    v_exp_f32 v130, v130
    v_mfma_f32_16x16x32_bf16 v[144:147], a[76:79], a[44:47], v[144:147]
    s_add_u32 m0, s30, 32768
    s_nop 0
    buffer_load_dwordx4 v196, s[16:19], s28 offen offset:0 nt lds
    v_mfma_f32_16x16x32_bf16 v[152:155], a[64:67], a[48:51], 0
    v_exp_f32 v131, v131
    v_cvt_pk_bf16_f32 v160, v128, v129
    v_mfma_f32_16x16x32_bf16 v[152:155], a[68:71], a[52:55], v[152:155]
    v_exp_f32 v132, v132
    v_mfma_f32_16x16x32_bf16 v[152:155], a[72:75], a[56:59], v[152:155]
    v_cvt_pk_bf16_f32 v161, v130, v131
    ds_read_b128 a[64:67], v180 offset:8192
    v_mfma_f32_16x16x32_bf16 v[152:155], a[76:79], a[60:63], v[152:155]
    v_exp_f32 v133, v133
    v_mfma_f32_16x16x32_bf16 v[148:151], a[80:83], a[32:35], 0
    v_cvt_pk_bf16_f32 v162, v132, v133
    ds_read_b128 a[68:71], v181 offset:8192
    v_mfma_f32_16x16x32_bf16 v[148:151], a[84:87], a[36:39], v[148:151]
    v_exp_f32 v134, v134
    v_mfma_f32_16x16x32_bf16 v[148:151], a[88:91], a[40:43], v[148:151]
    ds_read_b128 a[72:75], v182 offset:8192
    v_mfma_f32_16x16x32_bf16 v[148:151], a[92:95], a[44:47], v[148:151]
    v_exp_f32 v135, v135
    v_mfma_f32_16x16x32_bf16 v[156:159], a[80:83], a[48:51], 0
    v_cvt_pk_bf16_f32 v163, v134, v135
    ds_read_b128 a[76:79], v183 offset:8192
    v_mfma_f32_16x16x32_bf16 v[156:159], a[84:87], a[52:55], v[156:159]
    v_exp_f32 v136, v136
    v_mfma_f32_16x16x32_bf16 v[156:159], a[88:91], a[56:59], v[156:159]
    ds_read_b128 a[80:83], v180 offset:12288
    v_mfma_f32_16x16x32_bf16 v[156:159], a[92:95], a[60:63], v[156:159]
    buffer_load_dwordx4 v197, s[16:19], s28 offen offset:1024 nt lds
    ds_read_b128 a[84:87], v181 offset:12288
    v_exp_f32 v137, v137
    s_nop 0
    v_cvt_pk_bf16_f32 v164, v136, v137
    ds_read_b128 a[88:91], v182 offset:12288
    v_exp_f32 v138, v138
    ds_read_b128 a[92:95], v183 offset:12288
    v_exp_f32 v139, v139
    v_exp_f32 v140, v140
    v_exp_f32 v141, v141
    buffer_load_dwordx4 v198, s[16:19], s28 offen offset:2048 nt lds
    v_cvt_pk_bf16_f32 v165, v138, v139
    v_exp_f32 v142, v142
    v_exp_f32 v143, v143
    v_cvt_pk_bf16_f32 v166, v140, v141
    v_cvt_pk_bf16_f32 v167, v142, v143
    buffer_load_dwordx4 v199, s[16:19], s28 offen offset:3072 nt lds
    s_add_u32 s28, s28, 16384
    s_waitcnt lgkmcnt(0)
    v_mfma_f32_16x16x32_bf16 v[128:131], a[64:67], a[0:3], 0
    s_waitcnt vmcnt(12)
    s_barrier
    ds_read_b64_tr_b16 a[96:97], v188 offset:0
    v_mfma_f32_16x16x32_bf16 v[128:131], a[68:71], a[4:7], v[128:131]
    v_exp_f32 v144, v144
    v_mfma_f32_16x16x32_bf16 v[128:131], a[72:75], a[8:11], v[128:131]
    v_exp_f32 v145, v145
    ds_read_b64_tr_b16 a[98:99], v188 offset:4096
    v_mfma_f32_16x16x32_bf16 v[128:131], a[76:79], a[12:15], v[128:131]
    v_exp_f32 v146, v146
    v_mfma_f32_16x16x32_bf16 v[136:139], a[64:67], a[16:19], 0
    v_exp_f32 v147, v147
    ds_read_b64_tr_b16 a[100:101], v189 offset:0
    v_mfma_f32_16x16x32_bf16 v[136:139], a[68:71], a[20:23], v[136:139]
    s_add_u32 m0, s30, 98304
    s_nop 0
    buffer_load_dwordx4 v200, s[20:23], s29 offen offset:0 nt lds
    v_mfma_f32_16x16x32_bf16 v[136:139], a[72:75], a[24:27], v[136:139]
    v_exp_f32 v148, v148
    ds_read_b64_tr_b16 a[102:103], v189 offset:4096
    v_mfma_f32_16x16x32_bf16 v[136:139], a[76:79], a[28:31], v[136:139]
    v_exp_f32 v149, v149
    v_cvt_pk_bf16_f32 v168, v144, v145
    v_mfma_f32_16x16x32_bf16 v[132:135], a[80:83], a[0:3], 0
    v_exp_f32 v150, v150
    ds_read_b64_tr_b16 a[104:105], v190 offset:0
    v_mfma_f32_16x16x32_bf16 v[132:135], a[84:87], a[4:7], v[132:135]
    v_exp_f32 v151, v151
    v_cvt_pk_bf16_f32 v169, v146, v147
    v_mfma_f32_16x16x32_bf16 v[132:135], a[88:91], a[8:11], v[132:135]
    v_exp_f32 v152, v152
    ds_read_b64_tr_b16 a[106:107], v190 offset:4096
    v_mfma_f32_16x16x32_bf16 v[132:135], a[92:95], a[12:15], v[132:135]
    v_exp_f32 v153, v153
    v_cvt_pk_bf16_f32 v170, v148, v149
    v_mfma_f32_16x16x32_bf16 v[140:143], a[80:83], a[16:19], 0
    v_exp_f32 v154, v154
    ds_read_b64_tr_b16 a[108:109], v191 offset:0
    v_mfma_f32_16x16x32_bf16 v[140:143], a[84:87], a[20:23], v[140:143]
    v_exp_f32 v155, v155
    v_cvt_pk_bf16_f32 v171, v150, v151
    v_mfma_f32_16x16x32_bf16 v[140:143], a[88:91], a[24:27], v[140:143]
    v_cvt_pk_bf16_f32 v172, v152, v153
    ds_read_b64_tr_b16 a[110:111], v191 offset:4096
    v_mfma_f32_16x16x32_bf16 v[140:143], a[92:95], a[28:31], v[140:143]
    v_exp_f32 v156, v156
    v_mfma_f32_16x16x32_bf16 v[176:179], v[242:245], v[160:163], 0
    v_cvt_pk_bf16_f32 v173, v154, v155
    ds_read_b64_tr_b16 a[112:113], v192 offset:0
    v_mfma_f32_16x16x32_bf16 v[184:187], v[242:245], v[164:167], 0
    ds_read_b64_tr_b16 a[114:115], v192 offset:4096
    s_waitcnt lgkmcnt(8)
    v_mfma_f32_16x16x32_bf16 v[0:3], a[96:99], v[160:163], 0
    buffer_load_dwordx4 v201, s[20:23], s29 offen offset:1024 nt lds
    v_mfma_f32_16x16x32_bf16 v[32:35], a[96:99], v[164:167], 0
    ds_read_b64_tr_b16 a[116:117], v193 offset:0
    s_waitcnt lgkmcnt(7)
    v_mfma_f32_16x16x32_bf16 v[4:7], a[100:103], v[160:163], 0
    ds_read_b64_tr_b16 a[118:119], v193 offset:4096
    v_mfma_f32_16x16x32_bf16 v[36:39], a[100:103], v[164:167], 0
    s_waitcnt lgkmcnt(6)
    v_mfma_f32_16x16x32_bf16 v[8:11], a[104:107], v[160:163], 0
    ds_read_b64_tr_b16 a[120:121], v194 offset:0
    v_mfma_f32_16x16x32_bf16 v[40:43], a[104:107], v[164:167], 0
    ds_read_b64_tr_b16 a[122:123], v194 offset:4096
    s_waitcnt lgkmcnt(6)
    v_mfma_f32_16x16x32_bf16 v[12:15], a[108:111], v[160:163], 0
    v_exp_f32 v157, v157
    v_mfma_f32_16x16x32_bf16 v[44:47], a[108:111], v[164:167], 0
    ds_read_b64_tr_b16 a[124:125], v195 offset:0
    s_waitcnt lgkmcnt(5)
    v_mfma_f32_16x16x32_bf16 v[16:19], a[112:115], v[160:163], 0
    v_cvt_pk_bf16_f32 v174, v156, v157
    ds_read_b64_tr_b16 a[126:127], v195 offset:4096
    v_mfma_f32_16x16x32_bf16 v[48:51], a[112:115], v[164:167], 0
    s_waitcnt lgkmcnt(4)
    v_mfma_f32_16x16x32_bf16 v[20:23], a[116:119], v[160:163], 0
    v_exp_f32 v158, v158
    v_mfma_f32_16x16x32_bf16 v[52:55], a[116:119], v[164:167], 0
    buffer_load_dwordx4 v200, s[20:23], s29 offen offset:2048 nt lds
    s_waitcnt lgkmcnt(2)
    v_mfma_f32_16x16x32_bf16 v[24:27], a[120:123], v[160:163], 0
    v_exp_f32 v159, v159
    v_mfma_f32_16x16x32_bf16 v[56:59], a[120:123], v[164:167], 0
    v_cvt_pk_bf16_f32 v175, v158, v159
    s_waitcnt lgkmcnt(0)
    v_mfma_f32_16x16x32_bf16 v[28:31], a[124:127], v[160:163], 0
    v_mfma_f32_16x16x32_bf16 v[60:63], a[124:127], v[164:167], 0
    v_mfma_f32_16x16x32_bf16 v[144:147], a[64:67], a[32:35], 0
    v_exp_f32 v128, v128
    v_mfma_f32_16x16x32_bf16 v[144:147], a[68:71], a[36:39], v[144:147]
    v_exp_f32 v129, v129
    v_mfma_f32_16x16x32_bf16 v[144:147], a[72:75], a[40:43], v[144:147]
    v_exp_f32 v130, v130
    v_mfma_f32_16x16x32_bf16 v[144:147], a[76:79], a[44:47], v[144:147]
    s_add_u32 s38, s51, 0
    buffer_load_dwordx4 a[192:195], v196, s[12:15], s38 offen offset:0 nt
    v_mfma_f32_16x16x32_bf16 v[152:155], a[64:67], a[48:51], 0
    v_exp_f32 v131, v131
    v_cvt_pk_bf16_f32 v160, v128, v129
    v_mfma_f32_16x16x32_bf16 v[152:155], a[68:71], a[52:55], v[152:155]
    s_waitcnt vmcnt(12)
    s_barrier
    v_mfma_f32_16x16x32_bf16 v[152:155], a[72:75], a[56:59], v[152:155]
    v_cvt_pk_bf16_f32 v161, v130, v131
    ds_read_b128 a[64:67], v180 offset:16384
    v_mfma_f32_16x16x32_bf16 v[152:155], a[76:79], a[60:63], v[152:155]
    v_exp_f32 v132, v132
    v_mfma_f32_16x16x32_bf16 v[148:151], a[80:83], a[32:35], 0
    ds_read_b128 a[68:71], v181 offset:16384
    v_mfma_f32_16x16x32_bf16 v[148:151], a[84:87], a[36:39], v[148:151]
    v_exp_f32 v133, v133
    v_mfma_f32_16x16x32_bf16 v[148:151], a[88:91], a[40:43], v[148:151]
    v_cvt_pk_bf16_f32 v162, v132, v133
    ds_read_b128 a[72:75], v182 offset:16384
    v_mfma_f32_16x16x32_bf16 v[148:151], a[92:95], a[44:47], v[148:151]
    v_exp_f32 v134, v134
    v_mfma_f32_16x16x32_bf16 v[156:159], a[80:83], a[48:51], 0
    ds_read_b128 a[76:79], v183 offset:16384
    v_mfma_f32_16x16x32_bf16 v[156:159], a[84:87], a[52:55], v[156:159]
    v_exp_f32 v135, v135
    v_mfma_f32_16x16x32_bf16 v[156:159], a[88:91], a[56:59], v[156:159]
    v_cvt_pk_bf16_f32 v163, v134, v135
    ds_read_b128 a[80:83], v180 offset:20480
    v_mfma_f32_16x16x32_bf16 v[156:159], a[92:95], a[60:63], v[156:159]
    buffer_load_dwordx4 v201, s[20:23], s29 offen offset:3072 nt lds
    s_add_u32 s29, s29, 16384
    v_mfma_f32_16x16x32_bf16 v[222:225], v[242:245], v[168:171], 0
    ds_read_b128 a[84:87], v181 offset:20480
    v_mfma_f32_16x16x32_bf16 v[246:249], v[242:245], v[172:175], 0
    v_exp_f32 v136, v136
    v_mfma_f32_16x16x32_bf16 v[64:67], a[96:99], v[168:171], 0
    ds_read_b128 a[88:91], v182 offset:20480
    v_mfma_f32_16x16x32_bf16 v[96:99], a[96:99], v[172:175], 0
    v_exp_f32 v137, v137
    v_mfma_f32_16x16x32_bf16 v[68:71], a[100:103], v[168:171], 0
    v_cvt_pk_bf16_f32 v164, v136, v137
    ds_read_b128 a[92:95], v183 offset:20480
    v_mfma_f32_16x16x32_bf16 v[100:103], a[100:103], v[172:175], 0
    v_exp_f32 v138, v138
    v_mfma_f32_16x16x32_bf16 v[72:75], a[104:107], v[168:171], 0
    v_exp_f32 v139, v139
    v_mfma_f32_16x16x32_bf16 v[104:107], a[104:107], v[172:175], 0
    v_exp_f32 v140, v140
    v_mfma_f32_16x16x32_bf16 v[76:79], a[108:111], v[168:171], 0
    s_add_u32 m0, s30, 49152
    s_nop 0
    buffer_load_dwordx4 v196, s[16:19], s28 offen offset:0 nt lds
    v_mfma_f32_16x16x32_bf16 v[108:111], a[108:111], v[172:175], 0
    v_exp_f32 v141, v141
    v_cvt_pk_bf16_f32 v165, v138, v139
    v_mfma_f32_16x16x32_bf16 v[80:83], a[112:115], v[168:171], 0
    v_exp_f32 v142, v142
    v_mfma_f32_16x16x32_bf16 v[112:115], a[112:115], v[172:175], 0
    v_exp_f32 v143, v143
    v_mfma_f32_16x16x32_bf16 v[84:87], a[116:119], v[168:171], 0
    v_cvt_pk_bf16_f32 v166, v140, v141
    v_cvt_pk_bf16_f32 v167, v142, v143
    v_mfma_f32_16x16x32_bf16 v[116:119], a[116:119], v[172:175], 0
    v_mfma_f32_16x16x32_bf16 v[88:91], a[120:123], v[168:171], 0
    buffer_load_dwordx4 v197, s[16:19], s28 offen offset:1024 nt lds
    v_mfma_f32_16x16x32_bf16 v[120:123], a[120:123], v[172:175], 0
    v_mfma_f32_16x16x32_bf16 v[92:95], a[124:127], v[168:171], 0
    v_mfma_f32_16x16x32_bf16 v[124:127], a[124:127], v[172:175], 0
    s_waitcnt lgkmcnt(7)
    v_mfma_f32_16x16x32_bf16 v[128:131], a[64:67], a[0:3], 0
    ds_read_b64_tr_b16 a[96:97], v188 offset:8192
    s_waitcnt lgkmcnt(7)
    v_mfma_f32_16x16x32_bf16 v[128:131], a[68:71], a[4:7], v[128:131]
    v_exp_f32 v144, v144
    s_waitcnt lgkmcnt(6)
    v_mfma_f32_16x16x32_bf16 v[128:131], a[72:75], a[8:11], v[128:131]
    ds_read_b64_tr_b16 a[98:99], v188 offset:12288
    s_waitcnt lgkmcnt(6)
    v_mfma_f32_16x16x32_bf16 v[128:131], a[76:79], a[12:15], v[128:131]
    v_exp_f32 v145, v145
    v_mfma_f32_16x16x32_bf16 v[136:139], a[64:67], a[16:19], 0
    v_exp_f32 v146, v146
    ds_read_b64_tr_b16 a[100:101], v189 offset:8192
    v_mfma_f32_16x16x32_bf16 v[136:139], a[68:71], a[20:23], v[136:139]
    buffer_load_dwordx4 v198, s[16:19], s28 offen offset:2048 nt lds
    v_exp_f32 v147, v147
    v_mfma_f32_16x16x32_bf16 v[136:139], a[72:75], a[24:27], v[136:139]
    v_exp_f32 v148, v148
    ds_read_b64_tr_b16 a[102:103], v189 offset:12288
    v_mfma_f32_16x16x32_bf16 v[136:139], a[76:79], a[28:31], v[136:139]
    v_exp_f32 v149, v149
    s_waitcnt lgkmcnt(7)
    v_mfma_f32_16x16x32_bf16 v[132:135], a[80:83], a[0:3], 0
    v_cvt_pk_bf16_f32 v168, v144, v145
    ds_read_b64_tr_b16 a[104:105], v190 offset:8192
    s_waitcnt lgkmcnt(7)
    v_mfma_f32_16x16x32_bf16 v[132:135], a[84:87], a[4:7], v[132:135]
    v_exp_f32 v150, v150
    s_waitcnt lgkmcnt(6)
    v_mfma_f32_16x16x32_bf16 v[132:135], a[88:91], a[8:11], v[132:135]
    v_cvt_pk_bf16_f32 v169, v146, v147
    ds_read_b64_tr_b16 a[106:107], v190 offset:12288
    s_waitcnt lgkmcnt(6)
    v_mfma_f32_16x16x32_bf16 v[132:135], a[92:95], a[12:15], v[132:135]
    v_exp_f32 v151, v151
    v_cvt_pk_bf16_f32 v170, v148, v149
    v_mfma_f32_16x16x32_bf16 v[140:143], a[80:83], a[16:19], 0
    v_exp_f32 v152, v152
    ds_read_b64_tr_b16 a[108:109], v191 offset:8192
    v_mfma_f32_16x16x32_bf16 v[140:143], a[84:87], a[20:23], v[140:143]
    v_exp_f32 v153, v153
    v_mfma_f32_16x16x32_bf16 v[140:143], a[88:91], a[24:27], v[140:143]
    v_exp_f32 v154, v154
    ds_read_b64_tr_b16 a[110:111], v191 offset:12288
    v_mfma_f32_16x16x32_bf16 v[140:143], a[92:95], a[28:31], v[140:143]
    v_exp_f32 v155, v155
    v_cvt_pk_bf16_f32 v171, v150, v151
    v_mfma_f32_16x16x32_bf16 v[176:179], v[242:245], v[160:163], v[176:179]
    v_exp_f32 v156, v156
    ds_read_b64_tr_b16 a[112:113], v192 offset:8192
    v_mfma_f32_16x16x32_bf16 v[184:187], v[242:245], v[164:167], v[184:187]
    v_cvt_pk_bf16_f32 v172, v152, v153
    ds_read_b64_tr_b16 a[114:115], v192 offset:12288
    s_waitcnt lgkmcnt(8)
    v_mfma_f32_16x16x32_bf16 v[0:3], a[96:99], v[160:163], v[0:3]
    buffer_load_dwordx4 v199, s[16:19], s28 offen offset:3072 nt lds
    s_add_u32 s28, s28, 16384
    v_cvt_pk_bf16_f32 v173, v154, v155
    v_mfma_f32_16x16x32_bf16 v[32:35], a[96:99], v[164:167], v[32:35]
    ds_read_b64_tr_b16 a[116:117], v193 offset:8192
    s_waitcnt lgkmcnt(7)
    v_mfma_f32_16x16x32_bf16 v[4:7], a[100:103], v[160:163], v[4:7]
    ds_read_b64_tr_b16 a[118:119], v193 offset:12288
    v_mfma_f32_16x16x32_bf16 v[36:39], a[100:103], v[164:167], v[36:39]
    s_waitcnt lgkmcnt(6)
    v_mfma_f32_16x16x32_bf16 v[8:11], a[104:107], v[160:163], v[8:11]
    ds_read_b64_tr_b16 a[120:121], v194 offset:8192
    v_mfma_f32_16x16x32_bf16 v[40:43], a[104:107], v[164:167], v[40:43]
    ds_read_b64_tr_b16 a[122:123], v194 offset:12288
    s_waitcnt lgkmcnt(6)
    v_mfma_f32_16x16x32_bf16 v[12:15], a[108:111], v[160:163], v[12:15]
    v_exp_f32 v157, v157
    v_mfma_f32_16x16x32_bf16 v[44:47], a[108:111], v[164:167], v[44:47]
    ds_read_b64_tr_b16 a[124:125], v195 offset:8192
    s_waitcnt lgkmcnt(5)
    v_mfma_f32_16x16x32_bf16 v[16:19], a[112:115], v[160:163], v[16:19]
    v_cvt_pk_bf16_f32 v174, v156, v157
    ds_read_b64_tr_b16 a[126:127], v195 offset:12288
    v_mfma_f32_16x16x32_bf16 v[48:51], a[112:115], v[164:167], v[48:51]
    s_waitcnt lgkmcnt(4)
    v_mfma_f32_16x16x32_bf16 v[20:23], a[116:119], v[160:163], v[20:23]
    v_exp_f32 v158, v158
    v_mfma_f32_16x16x32_bf16 v[52:55], a[116:119], v[164:167], v[52:55]
    s_add_u32 m0, s30, 114688
    s_nop 0
    buffer_load_dwordx4 v200, s[20:23], s29 offen offset:0 nt lds
    s_waitcnt lgkmcnt(2)
    v_mfma_f32_16x16x32_bf16 v[24:27], a[120:123], v[160:163], v[24:27]
    v_exp_f32 v159, v159
    v_mfma_f32_16x16x32_bf16 v[56:59], a[120:123], v[164:167], v[56:59]
    v_cvt_pk_bf16_f32 v175, v158, v159
    s_waitcnt lgkmcnt(0)
    v_mfma_f32_16x16x32_bf16 v[28:31], a[124:127], v[160:163], v[28:31]
    v_mfma_f32_16x16x32_bf16 v[60:63], a[124:127], v[164:167], v[60:63]
    v_mfma_f32_16x16x32_bf16 v[144:147], a[64:67], a[32:35], 0
    v_exp_f32 v128, v128
    v_mfma_f32_16x16x32_bf16 v[144:147], a[68:71], a[36:39], v[144:147]
    v_exp_f32 v129, v129
    v_mfma_f32_16x16x32_bf16 v[144:147], a[72:75], a[40:43], v[144:147]
    v_exp_f32 v130, v130
    v_mfma_f32_16x16x32_bf16 v[144:147], a[76:79], a[44:47], v[144:147]
    s_add_u32 s38, s51, 0
    buffer_load_dwordx4 a[196:199], v197, s[12:15], s38 offen offset:1024 nt
    v_mfma_f32_16x16x32_bf16 v[152:155], a[64:67], a[48:51], 0
    v_exp_f32 v131, v131
    v_cvt_pk_bf16_f32 v160, v128, v129
    v_mfma_f32_16x16x32_bf16 v[152:155], a[68:71], a[52:55], v[152:155]
    v_exp_f32 v132, v132
    v_mfma_f32_16x16x32_bf16 v[152:155], a[72:75], a[56:59], v[152:155]
    v_cvt_pk_bf16_f32 v161, v130, v131
    ds_read_b128 a[64:67], v180 offset:24576
    v_mfma_f32_16x16x32_bf16 v[152:155], a[76:79], a[60:63], v[152:155]
    v_exp_f32 v133, v133
    v_mfma_f32_16x16x32_bf16 v[148:151], a[80:83], a[32:35], 0
    v_cvt_pk_bf16_f32 v162, v132, v133
    ds_read_b128 a[68:71], v181 offset:24576
    v_mfma_f32_16x16x32_bf16 v[148:151], a[84:87], a[36:39], v[148:151]
    v_exp_f32 v134, v134
    v_mfma_f32_16x16x32_bf16 v[148:151], a[88:91], a[40:43], v[148:151]
    ds_read_b128 a[72:75], v182 offset:24576
    v_mfma_f32_16x16x32_bf16 v[148:151], a[92:95], a[44:47], v[148:151]
    v_exp_f32 v135, v135
    v_mfma_f32_16x16x32_bf16 v[156:159], a[80:83], a[48:51], 0
    v_cvt_pk_bf16_f32 v163, v134, v135
    ds_read_b128 a[76:79], v183 offset:24576
    v_mfma_f32_16x16x32_bf16 v[156:159], a[84:87], a[52:55], v[156:159]
    v_exp_f32 v136, v136
    v_mfma_f32_16x16x32_bf16 v[156:159], a[88:91], a[56:59], v[156:159]
    ds_read_b128 a[80:83], v180 offset:28672
    v_mfma_f32_16x16x32_bf16 v[156:159], a[92:95], a[60:63], v[156:159]
    buffer_load_dwordx4 v201, s[20:23], s29 offen offset:1024 nt lds
    v_mfma_f32_16x16x32_bf16 v[222:225], v[242:245], v[168:171], v[222:225]
    ds_read_b128 a[84:87], v181 offset:28672
    v_mfma_f32_16x16x32_bf16 v[246:249], v[242:245], v[172:175], v[246:249]
    v_exp_f32 v137, v137
    v_mfma_f32_16x16x32_bf16 v[64:67], a[96:99], v[168:171], v[64:67]
    v_cvt_pk_bf16_f32 v164, v136, v137
    ds_read_b128 a[88:91], v182 offset:28672
    v_mfma_f32_16x16x32_bf16 v[96:99], a[96:99], v[172:175], v[96:99]
    v_exp_f32 v138, v138
    v_mfma_f32_16x16x32_bf16 v[68:71], a[100:103], v[168:171], v[68:71]
    ds_read_b128 a[92:95], v183 offset:28672
    v_mfma_f32_16x16x32_bf16 v[100:103], a[100:103], v[172:175], v[100:103]
    v_exp_f32 v139, v139
    v_mfma_f32_16x16x32_bf16 v[72:75], a[104:107], v[168:171], v[72:75]
    v_exp_f32 v140, v140
    v_mfma_f32_16x16x32_bf16 v[104:107], a[104:107], v[172:175], v[104:107]
    v_exp_f32 v141, v141
    v_mfma_f32_16x16x32_bf16 v[76:79], a[108:111], v[168:171], v[76:79]
    buffer_load_dwordx4 v200, s[20:23], s29 offen offset:2048 nt lds
    v_cvt_pk_bf16_f32 v165, v138, v139
    v_mfma_f32_16x16x32_bf16 v[108:111], a[108:111], v[172:175], v[108:111]
    v_exp_f32 v142, v142
    v_mfma_f32_16x16x32_bf16 v[80:83], a[112:115], v[168:171], v[80:83]
    v_exp_f32 v143, v143
    v_cvt_pk_bf16_f32 v166, v140, v141
    v_mfma_f32_16x16x32_bf16 v[112:115], a[112:115], v[172:175], v[112:115]
    v_cvt_pk_bf16_f32 v167, v142, v143
    v_mfma_f32_16x16x32_bf16 v[84:87], a[116:119], v[168:171], v[84:87]
    v_mfma_f32_16x16x32_bf16 v[116:119], a[116:119], v[172:175], v[116:119]
    v_mfma_f32_16x16x32_bf16 v[88:91], a[120:123], v[168:171], v[88:91]
    buffer_load_dwordx4 v201, s[20:23], s29 offen offset:3072 nt lds
    s_add_u32 s29, s29, 16384
    v_mfma_f32_16x16x32_bf16 v[120:123], a[120:123], v[172:175], v[120:123]
    v_mfma_f32_16x16x32_bf16 v[92:95], a[124:127], v[168:171], v[92:95]
    v_mfma_f32_16x16x32_bf16 v[124:127], a[124:127], v[172:175], v[124:127]
    s_waitcnt lgkmcnt(0)
    v_mfma_f32_16x16x32_bf16 v[128:131], a[64:67], a[0:3], 0
    s_waitcnt vmcnt(14)
    s_barrier
    ds_read_b64_tr_b16 a[96:97], v188 offset:16384
    v_mfma_f32_16x16x32_bf16 v[128:131], a[68:71], a[4:7], v[128:131]
    v_exp_f32 v144, v144
    v_mfma_f32_16x16x32_bf16 v[128:131], a[72:75], a[8:11], v[128:131]
    v_exp_f32 v145, v145
    ds_read_b64_tr_b16 a[98:99], v188 offset:20480
    v_mfma_f32_16x16x32_bf16 v[128:131], a[76:79], a[12:15], v[128:131]
    v_exp_f32 v146, v146
    v_mfma_f32_16x16x32_bf16 v[136:139], a[64:67], a[16:19], 0
    v_exp_f32 v147, v147
    ds_read_b64_tr_b16 a[100:101], v189 offset:16384
    v_mfma_f32_16x16x32_bf16 v[136:139], a[68:71], a[20:23], v[136:139]
    s_add_u32 m0, s30, 0
    s_nop 0
    buffer_load_dwordx4 v196, s[16:19], s28 offen offset:0 nt lds
    v_mfma_f32_16x16x32_bf16 v[136:139], a[72:75], a[24:27], v[136:139]
    v_exp_f32 v148, v148
    ds_read_b64_tr_b16 a[102:103], v189 offset:20480
    v_mfma_f32_16x16x32_bf16 v[136:139], a[76:79], a[28:31], v[136:139]
    v_exp_f32 v149, v149
    v_cvt_pk_bf16_f32 v168, v144, v145
    v_mfma_f32_16x16x32_bf16 v[132:135], a[80:83], a[0:3], 0
    v_exp_f32 v150, v150
    ds_read_b64_tr_b16 a[104:105], v190 offset:16384
    v_mfma_f32_16x16x32_bf16 v[132:135], a[84:87], a[4:7], v[132:135]
    v_exp_f32 v151, v151
    v_cvt_pk_bf16_f32 v169, v146, v147
    v_mfma_f32_16x16x32_bf16 v[132:135], a[88:91], a[8:11], v[132:135]
    v_exp_f32 v152, v152
    ds_read_b64_tr_b16 a[106:107], v190 offset:20480
    v_mfma_f32_16x16x32_bf16 v[132:135], a[92:95], a[12:15], v[132:135]
    v_exp_f32 v153, v153
    v_cvt_pk_bf16_f32 v170, v148, v149
    v_mfma_f32_16x16x32_bf16 v[140:143], a[80:83], a[16:19], 0
    v_exp_f32 v154, v154
    ds_read_b64_tr_b16 a[108:109], v191 offset:16384
    v_mfma_f32_16x16x32_bf16 v[140:143], a[84:87], a[20:23], v[140:143]
    v_exp_f32 v155, v155
    v_cvt_pk_bf16_f32 v171, v150, v151
    v_mfma_f32_16x16x32_bf16 v[140:143], a[88:91], a[24:27], v[140:143]
    v_cvt_pk_bf16_f32 v172, v152, v153
    ds_read_b64_tr_b16 a[110:111], v191 offset:20480
    v_mfma_f32_16x16x32_bf16 v[140:143], a[92:95], a[28:31], v[140:143]
    v_exp_f32 v156, v156
    v_mfma_f32_16x16x32_bf16 v[176:179], v[242:245], v[160:163], v[176:179]
    v_cvt_pk_bf16_f32 v173, v154, v155
    ds_read_b64_tr_b16 a[112:113], v192 offset:16384
    v_mfma_f32_16x16x32_bf16 v[184:187], v[242:245], v[164:167], v[184:187]
    ds_read_b64_tr_b16 a[114:115], v192 offset:20480
    s_waitcnt lgkmcnt(8)
    v_mfma_f32_16x16x32_bf16 v[0:3], a[96:99], v[160:163], v[0:3]
    buffer_load_dwordx4 v197, s[16:19], s28 offen offset:1024 nt lds
    v_mfma_f32_16x16x32_bf16 v[32:35], a[96:99], v[164:167], v[32:35]
    ds_read_b64_tr_b16 a[116:117], v193 offset:16384
    s_waitcnt lgkmcnt(7)
    v_mfma_f32_16x16x32_bf16 v[4:7], a[100:103], v[160:163], v[4:7]
    ds_read_b64_tr_b16 a[118:119], v193 offset:20480
    v_mfma_f32_16x16x32_bf16 v[36:39], a[100:103], v[164:167], v[36:39]
    s_waitcnt lgkmcnt(6)
    v_mfma_f32_16x16x32_bf16 v[8:11], a[104:107], v[160:163], v[8:11]
    ds_read_b64_tr_b16 a[120:121], v194 offset:16384
    v_mfma_f32_16x16x32_bf16 v[40:43], a[104:107], v[164:167], v[40:43]
    ds_read_b64_tr_b16 a[122:123], v194 offset:20480
    s_waitcnt lgkmcnt(6)
    v_mfma_f32_16x16x32_bf16 v[12:15], a[108:111], v[160:163], v[12:15]
    v_exp_f32 v157, v157
    v_mfma_f32_16x16x32_bf16 v[44:47], a[108:111], v[164:167], v[44:47]
    ds_read_b64_tr_b16 a[124:125], v195 offset:16384
    s_waitcnt lgkmcnt(5)
    v_mfma_f32_16x16x32_bf16 v[16:19], a[112:115], v[160:163], v[16:19]
    v_cvt_pk_bf16_f32 v174, v156, v157
    ds_read_b64_tr_b16 a[126:127], v195 offset:20480
    v_mfma_f32_16x16x32_bf16 v[48:51], a[112:115], v[164:167], v[48:51]
    s_waitcnt lgkmcnt(4)
    v_mfma_f32_16x16x32_bf16 v[20:23], a[116:119], v[160:163], v[20:23]
    v_exp_f32 v158, v158
    v_mfma_f32_16x16x32_bf16 v[52:55], a[116:119], v[164:167], v[52:55]
    buffer_load_dwordx4 v198, s[16:19], s28 offen offset:2048 nt lds
    s_waitcnt lgkmcnt(2)
    v_mfma_f32_16x16x32_bf16 v[24:27], a[120:123], v[160:163], v[24:27]
    v_exp_f32 v159, v159
    v_mfma_f32_16x16x32_bf16 v[56:59], a[120:123], v[164:167], v[56:59]
    v_cvt_pk_bf16_f32 v175, v158, v159
    s_waitcnt lgkmcnt(0)
    v_mfma_f32_16x16x32_bf16 v[28:31], a[124:127], v[160:163], v[28:31]
    v_mfma_f32_16x16x32_bf16 v[60:63], a[124:127], v[164:167], v[60:63]
    v_mfma_f32_16x16x32_bf16 v[144:147], a[64:67], a[32:35], 0
    v_exp_f32 v128, v128
    v_mfma_f32_16x16x32_bf16 v[144:147], a[68:71], a[36:39], v[144:147]
    v_exp_f32 v129, v129
    v_mfma_f32_16x16x32_bf16 v[144:147], a[72:75], a[40:43], v[144:147]
    v_exp_f32 v130, v130
    v_mfma_f32_16x16x32_bf16 v[144:147], a[76:79], a[44:47], v[144:147]
    s_add_u32 s38, s51, 0
    buffer_load_dwordx4 a[200:203], v198, s[12:15], s38 offen offset:2048 nt
    v_mfma_f32_16x16x32_bf16 v[152:155], a[64:67], a[48:51], 0
    v_exp_f32 v131, v131
    v_cvt_pk_bf16_f32 v160, v128, v129
    v_mfma_f32_16x16x32_bf16 v[152:155], a[68:71], a[52:55], v[152:155]
    v_exp_f32 v132, v132
    v_mfma_f32_16x16x32_bf16 v[152:155], a[72:75], a[56:59], v[152:155]
    v_cvt_pk_bf16_f32 v161, v130, v131
    ds_read_b128 a[64:67], v180 offset:32768
    v_mfma_f32_16x16x32_bf16 v[152:155], a[76:79], a[60:63], v[152:155]
    v_exp_f32 v133, v133
    v_mfma_f32_16x16x32_bf16 v[148:151], a[80:83], a[32:35], 0
    v_cvt_pk_bf16_f32 v162, v132, v133
    ds_read_b128 a[68:71], v181 offset:32768
    v_mfma_f32_16x16x32_bf16 v[148:151], a[84:87], a[36:39], v[148:151]
    v_exp_f32 v134, v134
    v_mfma_f32_16x16x32_bf16 v[148:151], a[88:91], a[40:43], v[148:151]
    ds_read_b128 a[72:75], v182 offset:32768
    v_mfma_f32_16x16x32_bf16 v[148:151], a[92:95], a[44:47], v[148:151]
    v_exp_f32 v135, v135
    v_mfma_f32_16x16x32_bf16 v[156:159], a[80:83], a[48:51], 0
    v_cvt_pk_bf16_f32 v163, v134, v135
    ds_read_b128 a[76:79], v183 offset:32768
    v_mfma_f32_16x16x32_bf16 v[156:159], a[84:87], a[52:55], v[156:159]
    v_exp_f32 v136, v136
    v_mfma_f32_16x16x32_bf16 v[156:159], a[88:91], a[56:59], v[156:159]
    ds_read_b128 a[80:83], v180 offset:36864
    v_mfma_f32_16x16x32_bf16 v[156:159], a[92:95], a[60:63], v[156:159]
    buffer_load_dwordx4 v199, s[16:19], s28 offen offset:3072 nt lds
    s_add_u32 s28, s28, 16384
    v_mfma_f32_16x16x32_bf16 v[222:225], v[242:245], v[168:171], v[222:225]
    ds_read_b128 a[84:87], v181 offset:36864
    v_mfma_f32_16x16x32_bf16 v[246:249], v[242:245], v[172:175], v[246:249]
    v_exp_f32 v137, v137
    v_mfma_f32_16x16x32_bf16 v[64:67], a[96:99], v[168:171], v[64:67]
    v_cvt_pk_bf16_f32 v164, v136, v137
    ds_read_b128 a[88:91], v182 offset:36864
    v_mfma_f32_16x16x32_bf16 v[96:99], a[96:99], v[172:175], v[96:99]
    v_exp_f32 v138, v138
    v_mfma_f32_16x16x32_bf16 v[68:71], a[100:103], v[168:171], v[68:71]
    ds_read_b128 a[92:95], v183 offset:36864
    v_mfma_f32_16x16x32_bf16 v[100:103], a[100:103], v[172:175], v[100:103]
    v_exp_f32 v139, v139
    v_mfma_f32_16x16x32_bf16 v[72:75], a[104:107], v[168:171], v[72:75]
    v_exp_f32 v140, v140
    v_mfma_f32_16x16x32_bf16 v[104:107], a[104:107], v[172:175], v[104:107]
    v_exp_f32 v141, v141
    v_mfma_f32_16x16x32_bf16 v[76:79], a[108:111], v[168:171], v[76:79]
    s_add_u32 m0, s30, 65536
    s_nop 0
    buffer_load_dwordx4 v200, s[20:23], s29 offen offset:0 nt lds
    v_mfma_f32_16x16x32_bf16 v[108:111], a[108:111], v[172:175], v[108:111]
    v_exp_f32 v142, v142
    v_cvt_pk_bf16_f32 v165, v138, v139
    v_mfma_f32_16x16x32_bf16 v[80:83], a[112:115], v[168:171], v[80:83]
    v_exp_f32 v143, v143
    v_cvt_pk_bf16_f32 v166, v140, v141
    v_mfma_f32_16x16x32_bf16 v[112:115], a[112:115], v[172:175], v[112:115]
    v_cvt_pk_bf16_f32 v167, v142, v143
    v_mfma_f32_16x16x32_bf16 v[84:87], a[116:119], v[168:171], v[84:87]
    v_mfma_f32_16x16x32_bf16 v[116:119], a[116:119], v[172:175], v[116:119]
    v_mfma_f32_16x16x32_bf16 v[88:91], a[120:123], v[168:171], v[88:91]
    buffer_load_dwordx4 v201, s[20:23], s29 offen offset:1024 nt lds
    v_mfma_f32_16x16x32_bf16 v[120:123], a[120:123], v[172:175], v[120:123]
    v_mfma_f32_16x16x32_bf16 v[92:95], a[124:127], v[168:171], v[92:95]
    v_mfma_f32_16x16x32_bf16 v[124:127], a[124:127], v[172:175], v[124:127]
    s_waitcnt lgkmcnt(7)
    v_mfma_f32_16x16x32_bf16 v[128:131], a[64:67], a[0:3], 0
    ds_read_b64_tr_b16 a[96:97], v188 offset:24576
    s_waitcnt lgkmcnt(7)
    v_mfma_f32_16x16x32_bf16 v[128:131], a[68:71], a[4:7], v[128:131]
    v_exp_f32 v144, v144
    s_waitcnt lgkmcnt(6)
    v_mfma_f32_16x16x32_bf16 v[128:131], a[72:75], a[8:11], v[128:131]
    ds_read_b64_tr_b16 a[98:99], v188 offset:28672
    s_waitcnt lgkmcnt(6)
    v_mfma_f32_16x16x32_bf16 v[128:131], a[76:79], a[12:15], v[128:131]
    v_exp_f32 v145, v145
    v_mfma_f32_16x16x32_bf16 v[136:139], a[64:67], a[16:19], 0
    v_exp_f32 v146, v146
    ds_read_b64_tr_b16 a[100:101], v189 offset:24576
    v_mfma_f32_16x16x32_bf16 v[136:139], a[68:71], a[20:23], v[136:139]
    buffer_load_dwordx4 v200, s[20:23], s29 offen offset:2048 nt lds
    v_exp_f32 v147, v147
    v_mfma_f32_16x16x32_bf16 v[136:139], a[72:75], a[24:27], v[136:139]
    v_exp_f32 v148, v148
    ds_read_b64_tr_b16 a[102:103], v189 offset:28672
    v_mfma_f32_16x16x32_bf16 v[136:139], a[76:79], a[28:31], v[136:139]
    v_exp_f32 v149, v149
    s_waitcnt lgkmcnt(7)
    v_mfma_f32_16x16x32_bf16 v[132:135], a[80:83], a[0:3], 0
    v_cvt_pk_bf16_f32 v168, v144, v145
    ds_read_b64_tr_b16 a[104:105], v190 offset:24576
    s_waitcnt lgkmcnt(7)
    v_mfma_f32_16x16x32_bf16 v[132:135], a[84:87], a[4:7], v[132:135]
    v_exp_f32 v150, v150
    s_waitcnt lgkmcnt(6)
    v_mfma_f32_16x16x32_bf16 v[132:135], a[88:91], a[8:11], v[132:135]
    v_cvt_pk_bf16_f32 v169, v146, v147
    ds_read_b64_tr_b16 a[106:107], v190 offset:28672
    s_waitcnt lgkmcnt(6)
    v_mfma_f32_16x16x32_bf16 v[132:135], a[92:95], a[12:15], v[132:135]
    v_exp_f32 v151, v151
    v_cvt_pk_bf16_f32 v170, v148, v149
    v_mfma_f32_16x16x32_bf16 v[140:143], a[80:83], a[16:19], 0
    v_exp_f32 v152, v152
    ds_read_b64_tr_b16 a[108:109], v191 offset:24576
    v_mfma_f32_16x16x32_bf16 v[140:143], a[84:87], a[20:23], v[140:143]
    v_exp_f32 v153, v153
    v_mfma_f32_16x16x32_bf16 v[140:143], a[88:91], a[24:27], v[140:143]
    v_exp_f32 v154, v154
    ds_read_b64_tr_b16 a[110:111], v191 offset:28672
    v_mfma_f32_16x16x32_bf16 v[140:143], a[92:95], a[28:31], v[140:143]
    v_exp_f32 v155, v155
    v_cvt_pk_bf16_f32 v171, v150, v151
    v_mfma_f32_16x16x32_bf16 v[176:179], v[242:245], v[160:163], v[176:179]
    v_exp_f32 v156, v156
    ds_read_b64_tr_b16 a[112:113], v192 offset:24576
    v_mfma_f32_16x16x32_bf16 v[184:187], v[242:245], v[164:167], v[184:187]
    v_cvt_pk_bf16_f32 v172, v152, v153
    ds_read_b64_tr_b16 a[114:115], v192 offset:28672
    s_waitcnt lgkmcnt(8)
    v_mfma_f32_16x16x32_bf16 v[0:3], a[96:99], v[160:163], v[0:3]
    buffer_load_dwordx4 v201, s[20:23], s29 offen offset:3072 nt lds
    s_add_u32 s29, s29, 16384
    v_cvt_pk_bf16_f32 v173, v154, v155
    v_mfma_f32_16x16x32_bf16 v[32:35], a[96:99], v[164:167], v[32:35]
    ds_read_b64_tr_b16 a[116:117], v193 offset:24576
    s_waitcnt lgkmcnt(7)
    v_mfma_f32_16x16x32_bf16 v[4:7], a[100:103], v[160:163], v[4:7]
    ds_read_b64_tr_b16 a[118:119], v193 offset:28672
    v_mfma_f32_16x16x32_bf16 v[36:39], a[100:103], v[164:167], v[36:39]
    s_waitcnt lgkmcnt(6)
    v_mfma_f32_16x16x32_bf16 v[8:11], a[104:107], v[160:163], v[8:11]
    ds_read_b64_tr_b16 a[120:121], v194 offset:24576
    v_mfma_f32_16x16x32_bf16 v[40:43], a[104:107], v[164:167], v[40:43]
    ds_read_b64_tr_b16 a[122:123], v194 offset:28672
    s_waitcnt lgkmcnt(6)
    v_mfma_f32_16x16x32_bf16 v[12:15], a[108:111], v[160:163], v[12:15]
    v_exp_f32 v157, v157
    v_mfma_f32_16x16x32_bf16 v[44:47], a[108:111], v[164:167], v[44:47]
    ds_read_b64_tr_b16 a[124:125], v195 offset:24576
    s_waitcnt lgkmcnt(5)
    v_mfma_f32_16x16x32_bf16 v[16:19], a[112:115], v[160:163], v[16:19]
    v_cvt_pk_bf16_f32 v174, v156, v157
    ds_read_b64_tr_b16 a[126:127], v195 offset:28672
    v_mfma_f32_16x16x32_bf16 v[48:51], a[112:115], v[164:167], v[48:51]
    s_waitcnt lgkmcnt(4)
    v_mfma_f32_16x16x32_bf16 v[20:23], a[116:119], v[160:163], v[20:23]
    v_exp_f32 v158, v158
    v_mfma_f32_16x16x32_bf16 v[52:55], a[116:119], v[164:167], v[52:55]
    s_add_u32 m0, s30, 16384
    s_nop 0
    buffer_load_dwordx4 v196, s[16:19], s28 offen offset:0 nt lds
    s_waitcnt lgkmcnt(2)
    v_mfma_f32_16x16x32_bf16 v[24:27], a[120:123], v[160:163], v[24:27]
    v_exp_f32 v159, v159
    v_mfma_f32_16x16x32_bf16 v[56:59], a[120:123], v[164:167], v[56:59]
    v_cvt_pk_bf16_f32 v175, v158, v159
    s_waitcnt lgkmcnt(0)
    v_mfma_f32_16x16x32_bf16 v[28:31], a[124:127], v[160:163], v[28:31]
    v_mfma_f32_16x16x32_bf16 v[60:63], a[124:127], v[164:167], v[60:63]
    v_mfma_f32_16x16x32_bf16 v[144:147], a[64:67], a[32:35], 0
    v_exp_f32 v128, v128
    v_mfma_f32_16x16x32_bf16 v[144:147], a[68:71], a[36:39], v[144:147]
    v_exp_f32 v129, v129
    v_mfma_f32_16x16x32_bf16 v[144:147], a[72:75], a[40:43], v[144:147]
    v_exp_f32 v130, v130
    v_mfma_f32_16x16x32_bf16 v[144:147], a[76:79], a[44:47], v[144:147]
    s_add_u32 s38, s51, 0
    buffer_load_dwordx4 a[204:207], v199, s[12:15], s38 offen offset:3072 nt
    v_mfma_f32_16x16x32_bf16 v[152:155], a[64:67], a[48:51], 0
    v_exp_f32 v131, v131
    v_cvt_pk_bf16_f32 v160, v128, v129
    v_mfma_f32_16x16x32_bf16 v[152:155], a[68:71], a[52:55], v[152:155]
    v_exp_f32 v132, v132
    v_mfma_f32_16x16x32_bf16 v[152:155], a[72:75], a[56:59], v[152:155]
    v_cvt_pk_bf16_f32 v161, v130, v131
    ds_read_b128 a[64:67], v180 offset:40960
    v_mfma_f32_16x16x32_bf16 v[152:155], a[76:79], a[60:63], v[152:155]
    v_exp_f32 v133, v133
    v_mfma_f32_16x16x32_bf16 v[148:151], a[80:83], a[32:35], 0
    v_cvt_pk_bf16_f32 v162, v132, v133
    ds_read_b128 a[68:71], v181 offset:40960
    v_mfma_f32_16x16x32_bf16 v[148:151], a[84:87], a[36:39], v[148:151]
    v_exp_f32 v134, v134
    v_mfma_f32_16x16x32_bf16 v[148:151], a[88:91], a[40:43], v[148:151]
    ds_read_b128 a[72:75], v182 offset:40960
    v_mfma_f32_16x16x32_bf16 v[148:151], a[92:95], a[44:47], v[148:151]
    v_exp_f32 v135, v135
    v_mfma_f32_16x16x32_bf16 v[156:159], a[80:83], a[48:51], 0
    v_cvt_pk_bf16_f32 v163, v134, v135
    ds_read_b128 a[76:79], v183 offset:40960
    v_mfma_f32_16x16x32_bf16 v[156:159], a[84:87], a[52:55], v[156:159]
    v_exp_f32 v136, v136
    v_mfma_f32_16x16x32_bf16 v[156:159], a[88:91], a[56:59], v[156:159]
    ds_read_b128 a[80:83], v180 offset:45056
    v_mfma_f32_16x16x32_bf16 v[156:159], a[92:95], a[60:63], v[156:159]
    buffer_load_dwordx4 v197, s[16:19], s28 offen offset:1024 nt lds
    v_mfma_f32_16x16x32_bf16 v[222:225], v[242:245], v[168:171], v[222:225]
    ds_read_b128 a[84:87], v181 offset:45056
    v_mfma_f32_16x16x32_bf16 v[246:249], v[242:245], v[172:175], v[246:249]
    v_exp_f32 v137, v137
    v_mfma_f32_16x16x32_bf16 v[64:67], a[96:99], v[168:171], v[64:67]
    v_cvt_pk_bf16_f32 v164, v136, v137
    ds_read_b128 a[88:91], v182 offset:45056
    v_mfma_f32_16x16x32_bf16 v[96:99], a[96:99], v[172:175], v[96:99]
    v_exp_f32 v138, v138
    v_mfma_f32_16x16x32_bf16 v[68:71], a[100:103], v[168:171], v[68:71]
    ds_read_b128 a[92:95], v183 offset:45056
    v_mfma_f32_16x16x32_bf16 v[100:103], a[100:103], v[172:175], v[100:103]
    v_exp_f32 v139, v139
    v_mfma_f32_16x16x32_bf16 v[72:75], a[104:107], v[168:171], v[72:75]
    v_exp_f32 v140, v140
    v_mfma_f32_16x16x32_bf16 v[104:107], a[104:107], v[172:175], v[104:107]
    v_exp_f32 v141, v141
    v_mfma_f32_16x16x32_bf16 v[76:79], a[108:111], v[168:171], v[76:79]
    buffer_load_dwordx4 v198, s[16:19], s28 offen offset:2048 nt lds
    v_cvt_pk_bf16_f32 v165, v138, v139
    v_mfma_f32_16x16x32_bf16 v[108:111], a[108:111], v[172:175], v[108:111]
    v_exp_f32 v142, v142
    v_mfma_f32_16x16x32_bf16 v[80:83], a[112:115], v[168:171], v[80:83]
    v_exp_f32 v143, v143
    v_cvt_pk_bf16_f32 v166, v140, v141
    v_mfma_f32_16x16x32_bf16 v[112:115], a[112:115], v[172:175], v[112:115]
    v_cvt_pk_bf16_f32 v167, v142, v143
    v_mfma_f32_16x16x32_bf16 v[84:87], a[116:119], v[168:171], v[84:87]
    v_mfma_f32_16x16x32_bf16 v[116:119], a[116:119], v[172:175], v[116:119]
    v_mfma_f32_16x16x32_bf16 v[88:91], a[120:123], v[168:171], v[88:91]
    buffer_load_dwordx4 v199, s[16:19], s28 offen offset:3072 nt lds
    s_add_u32 s28, s28, 16384
    v_mfma_f32_16x16x32_bf16 v[120:123], a[120:123], v[172:175], v[120:123]
    v_mfma_f32_16x16x32_bf16 v[92:95], a[124:127], v[168:171], v[92:95]
    v_mfma_f32_16x16x32_bf16 v[124:127], a[124:127], v[172:175], v[124:127]
    s_waitcnt lgkmcnt(0)
    v_mfma_f32_16x16x32_bf16 v[128:131], a[64:67], a[0:3], 0
    s_waitcnt vmcnt(19)
    s_barrier
    ds_read_b64_tr_b16 a[96:97], v188 offset:32768
    v_mfma_f32_16x16x32_bf16 v[128:131], a[68:71], a[4:7], v[128:131]
    v_exp_f32 v144, v144
    v_mfma_f32_16x16x32_bf16 v[128:131], a[72:75], a[8:11], v[128:131]
    v_exp_f32 v145, v145
    ds_read_b64_tr_b16 a[98:99], v188 offset:36864
    v_mfma_f32_16x16x32_bf16 v[128:131], a[76:79], a[12:15], v[128:131]
    v_exp_f32 v146, v146
    v_mfma_f32_16x16x32_bf16 v[136:139], a[64:67], a[16:19], 0
    v_exp_f32 v147, v147
    ds_read_b64_tr_b16 a[100:101], v189 offset:32768
    v_mfma_f32_16x16x32_bf16 v[136:139], a[68:71], a[20:23], v[136:139]
    v_exp_f32 v148, v148
    v_cvt_pk_bf16_f32 v168, v144, v145
    v_mfma_f32_16x16x32_bf16 v[136:139], a[72:75], a[24:27], v[136:139]
    v_exp_f32 v149, v149
    ds_read_b64_tr_b16 a[102:103], v189 offset:36864
    v_mfma_f32_16x16x32_bf16 v[136:139], a[76:79], a[28:31], v[136:139]
    v_exp_f32 v150, v150
    v_cvt_pk_bf16_f32 v169, v146, v147
    v_mfma_f32_16x16x32_bf16 v[132:135], a[80:83], a[0:3], 0
    v_exp_f32 v151, v151
    ds_read_b64_tr_b16 a[104:105], v190 offset:32768
    v_mfma_f32_16x16x32_bf16 v[132:135], a[84:87], a[4:7], v[132:135]
    s_add_u32 m0, s30, 81920
    s_nop 0
    buffer_load_dwordx4 v200, s[20:23], s29 offen offset:0 nt lds
    v_mfma_f32_16x16x32_bf16 v[132:135], a[88:91], a[8:11], v[132:135]
    v_exp_f32 v152, v152
    ds_read_b64_tr_b16 a[106:107], v190 offset:36864
    v_mfma_f32_16x16x32_bf16 v[132:135], a[92:95], a[12:15], v[132:135]
    v_exp_f32 v153, v153
    v_cvt_pk_bf16_f32 v170, v148, v149
    v_mfma_f32_16x16x32_bf16 v[140:143], a[80:83], a[16:19], 0
    v_exp_f32 v154, v154
    ds_read_b64_tr_b16 a[108:109], v191 offset:32768
    v_mfma_f32_16x16x32_bf16 v[140:143], a[84:87], a[20:23], v[140:143]
    v_exp_f32 v155, v155
    v_cvt_pk_bf16_f32 v171, v150, v151
    v_mfma_f32_16x16x32_bf16 v[140:143], a[88:91], a[24:27], v[140:143]
    v_cvt_pk_bf16_f32 v172, v152, v153
    ds_read_b64_tr_b16 a[110:111], v191 offset:36864
    v_mfma_f32_16x16x32_bf16 v[140:143], a[92:95], a[28:31], v[140:143]
    v_exp_f32 v156, v156
    v_mfma_f32_16x16x32_bf16 v[176:179], v[242:245], v[160:163], v[176:179]
    v_cvt_pk_bf16_f32 v173, v154, v155
    ds_read_b64_tr_b16 a[112:113], v192 offset:32768
    v_mfma_f32_16x16x32_bf16 v[184:187], v[242:245], v[164:167], v[184:187]
    ds_read_b64_tr_b16 a[114:115], v192 offset:36864
    s_waitcnt lgkmcnt(8)
    v_mfma_f32_16x16x32_bf16 v[0:3], a[96:99], v[160:163], v[0:3]
    v_exp_f32 v157, v157
    v_mfma_f32_16x16x32_bf16 v[32:35], a[96:99], v[164:167], v[32:35]
    ds_read_b64_tr_b16 a[116:117], v193 offset:32768
    s_waitcnt lgkmcnt(7)
    v_mfma_f32_16x16x32_bf16 v[4:7], a[100:103], v[160:163], v[4:7]
    v_cvt_pk_bf16_f32 v174, v156, v157
    ds_read_b64_tr_b16 a[118:119], v193 offset:36864
    v_mfma_f32_16x16x32_bf16 v[36:39], a[100:103], v[164:167], v[36:39]
    s_waitcnt lgkmcnt(6)
    v_mfma_f32_16x16x32_bf16 v[8:11], a[104:107], v[160:163], v[8:11]
    ds_read_b64_tr_b16 a[120:121], v194 offset:32768
    v_mfma_f32_16x16x32_bf16 v[40:43], a[104:107], v[164:167], v[40:43]
    ds_read_b64_tr_b16 a[122:123], v194 offset:36864
    s_waitcnt lgkmcnt(6)
    v_mfma_f32_16x16x32_bf16 v[12:15], a[108:111], v[160:163], v[12:15]
    v_exp_f32 v158, v158
    v_mfma_f32_16x16x32_bf16 v[44:47], a[108:111], v[164:167], v[44:47]
    ds_read_b64_tr_b16 a[124:125], v195 offset:32768
    s_waitcnt lgkmcnt(5)
    v_mfma_f32_16x16x32_bf16 v[16:19], a[112:115], v[160:163], v[16:19]
    ds_read_b64_tr_b16 a[126:127], v195 offset:36864
    v_mfma_f32_16x16x32_bf16 v[48:51], a[112:115], v[164:167], v[48:51]
    s_waitcnt lgkmcnt(4)
    v_mfma_f32_16x16x32_bf16 v[20:23], a[116:119], v[160:163], v[20:23]
    buffer_load_dwordx4 v201, s[20:23], s29 offen offset:1024 nt lds
    v_mfma_f32_16x16x32_bf16 v[52:55], a[116:119], v[164:167], v[52:55]
    s_waitcnt lgkmcnt(2)
    v_mfma_f32_16x16x32_bf16 v[24:27], a[120:123], v[160:163], v[24:27]
    v_exp_f32 v159, v159
    v_mfma_f32_16x16x32_bf16 v[56:59], a[120:123], v[164:167], v[56:59]
    v_cvt_pk_bf16_f32 v175, v158, v159
    s_waitcnt lgkmcnt(0)
    v_mfma_f32_16x16x32_bf16 v[28:31], a[124:127], v[160:163], v[28:31]
    v_mfma_f32_16x16x32_bf16 v[60:63], a[124:127], v[164:167], v[60:63]
    v_mfma_f32_16x16x32_bf16 v[144:147], a[64:67], a[32:35], 0
    v_exp_f32 v128, v128
    v_accvgpr_read_b32 v234, a192
    v_mfma_f32_16x16x32_bf16 v[144:147], a[68:71], a[36:39], v[144:147]
    v_exp_f32 v129, v129
    v_mfma_f32_16x16x32_bf16 v[144:147], a[72:75], a[40:43], v[144:147]
    v_exp_f32 v130, v130
    v_accvgpr_read_b32 v235, a193
    v_mfma_f32_16x16x32_bf16 v[144:147], a[76:79], a[44:47], v[144:147]
    v_exp_f32 v131, v131
    v_accvgpr_read_b32 v236, a194
    v_mfma_f32_16x16x32_bf16 v[152:155], a[64:67], a[48:51], 0
    s_add_u32 s38, s51, 4096
    buffer_load_dwordx4 a[208:211], v196, s[12:15], s38 offen offset:0 nt
    v_cvt_pk_bf16_f32 v160, v128, v129
    v_accvgpr_read_b32 v237, a195
    v_mfma_f32_16x16x32_bf16 v[152:155], a[68:71], a[52:55], v[152:155]
    v_exp_f32 v132, v132
    v_mfma_f32_16x16x32_bf16 v[152:155], a[72:75], a[56:59], v[152:155]
    v_cvt_pk_bf16_f32 v161, v130, v131
    v_lshlrev_b32 v226, 16, v234
    ds_read_b128 a[64:67], v180 offset:49152
    v_mfma_f32_16x16x32_bf16 v[152:155], a[76:79], a[60:63], v[152:155]
    v_exp_f32 v133, v133
    v_and_b32 v227, s37, v234
    v_mfma_f32_16x16x32_bf16 v[148:151], a[80:83], a[32:35], 0
    v_cvt_pk_bf16_f32 v162, v132, v133
    v_lshlrev_b32 v228, 16, v235
    ds_read_b128 a[68:71], v181 offset:49152
    v_mfma_f32_16x16x32_bf16 v[148:151], a[84:87], a[36:39], v[148:151]
    v_exp_f32 v134, v134
    v_mfma_f32_16x16x32_bf16 v[148:151], a[88:91], a[40:43], v[148:151]
    v_and_b32 v229, s37, v235
    ds_read_b128 a[72:75], v182 offset:49152
    v_mfma_f32_16x16x32_bf16 v[148:151], a[92:95], a[44:47], v[148:151]
    v_exp_f32 v135, v135
    v_lshlrev_b32 v230, 16, v236
    v_mfma_f32_16x16x32_bf16 v[156:159], a[80:83], a[48:51], 0
    v_cvt_pk_bf16_f32 v163, v134, v135
    v_and_b32 v231, s37, v236
    ds_read_b128 a[76:79], v183 offset:49152
    v_mfma_f32_16x16x32_bf16 v[156:159], a[84:87], a[52:55], v[156:159]
    v_exp_f32 v136, v136
    v_mfma_f32_16x16x32_bf16 v[156:159], a[88:91], a[56:59], v[156:159]
    v_lshlrev_b32 v232, 16, v237
    ds_read_b128 a[80:83], v180 offset:53248
    v_mfma_f32_16x16x32_bf16 v[156:159], a[92:95], a[60:63], v[156:159]
    v_exp_f32 v137, v137
    v_and_b32 v233, s37, v237
    v_mfma_f32_16x16x32_bf16 v[222:225], v[242:245], v[168:171], v[222:225]
    v_cvt_pk_bf16_f32 v164, v136, v137
    ds_read_b128 a[84:87], v181 offset:53248
    v_mfma_f32_16x16x32_bf16 v[246:249], v[242:245], v[172:175], v[246:249]
    v_exp_f32 v138, v138
    v_mul_f32 v226, s34, v226
    v_mfma_f32_16x16x32_bf16 v[64:67], a[96:99], v[168:171], v[64:67]
    v_mul_f32 v227, s34, v227
    ds_read_b128 a[88:91], v182 offset:53248
    v_mfma_f32_16x16x32_bf16 v[96:99], a[96:99], v[172:175], v[96:99]
    v_exp_f32 v139, v139
    v_mul_f32 v228, s34, v228
    v_mfma_f32_16x16x32_bf16 v[68:71], a[100:103], v[168:171], v[68:71]
    v_cvt_pk_bf16_f32 v165, v138, v139
    ds_read_b128 a[92:95], v183 offset:53248
    v_mfma_f32_16x16x32_bf16 v[100:103], a[100:103], v[172:175], v[100:103]
    buffer_load_dwordx4 v200, s[20:23], s29 offen offset:2048 nt lds
    v_mul_f32 v229, s34, v229
    v_mfma_f32_16x16x32_bf16 v[72:75], a[104:107], v[168:171], v[72:75]
    v_exp_f32 v140, v140
    v_mul_f32 v230, s34, v230
    v_mfma_f32_16x16x32_bf16 v[104:107], a[104:107], v[172:175], v[104:107]
    v_exp_f32 v141, v141
    v_mul_f32 v231, s34, v231
    v_mfma_f32_16x16x32_bf16 v[76:79], a[108:111], v[168:171], v[76:79]
    v_exp_f32 v142, v142
    v_mfma_f32_16x16x32_bf16 v[108:111], a[108:111], v[172:175], v[108:111]
    v_exp_f32 v143, v143
    v_mul_f32 v232, s34, v232
    v_mfma_f32_16x16x32_bf16 v[80:83], a[112:115], v[168:171], v[80:83]
    v_cvt_pk_bf16_f32 v166, v140, v141
    v_cvt_pk_bf16_f32 v167, v142, v143
    v_mul_f32 v233, s34, v233
    v_mfma_f32_16x16x32_bf16 v[112:115], a[112:115], v[172:175], v[112:115]
    v_cvt_pk_bf16_f32 v238, v226, v227
    v_mfma_f32_16x16x32_bf16 v[84:87], a[116:119], v[168:171], v[84:87]
    v_mfma_f32_16x16x32_bf16 v[116:119], a[116:119], v[172:175], v[116:119]
    buffer_load_dwordx4 v201, s[20:23], s29 offen offset:3072 nt lds
    s_add_u32 s29, s29, 16384
    v_cvt_pk_bf16_f32 v239, v228, v229
    v_mfma_f32_16x16x32_bf16 v[88:91], a[120:123], v[168:171], v[88:91]
    v_cvt_pk_bf16_f32 v240, v230, v231
    v_mfma_f32_16x16x32_bf16 v[120:123], a[120:123], v[172:175], v[120:123]
    v_cvt_pk_bf16_f32 v241, v232, v233
    v_mfma_f32_16x16x32_bf16 v[92:95], a[124:127], v[168:171], v[92:95]
    v_mfma_f32_16x16x32_bf16 v[124:127], a[124:127], v[172:175], v[124:127]
    ds_write_b128 v205, v[238:241] offset:0
    s_waitcnt lgkmcnt(8)
    v_mfma_f32_16x16x32_bf16 v[128:131], a[64:67], a[0:3], 0
    ds_read_b64_tr_b16 a[96:97], v188 offset:40960
    s_waitcnt lgkmcnt(8)
    v_mfma_f32_16x16x32_bf16 v[128:131], a[68:71], a[4:7], v[128:131]
    v_exp_f32 v144, v144
    s_waitcnt lgkmcnt(7)
    v_mfma_f32_16x16x32_bf16 v[128:131], a[72:75], a[8:11], v[128:131]
    ds_read_b64_tr_b16 a[98:99], v188 offset:45056
    s_waitcnt lgkmcnt(7)
    v_mfma_f32_16x16x32_bf16 v[128:131], a[76:79], a[12:15], v[128:131]
    v_exp_f32 v145, v145
    v_mfma_f32_16x16x32_bf16 v[136:139], a[64:67], a[16:19], 0
    v_exp_f32 v146, v146
    ds_read_b64_tr_b16 a[100:101], v189 offset:40960
    v_mfma_f32_16x16x32_bf16 v[136:139], a[68:71], a[20:23], v[136:139]
    v_exp_f32 v147, v147
    v_mfma_f32_16x16x32_bf16 v[136:139], a[72:75], a[24:27], v[136:139]
    v_exp_f32 v148, v148
    ds_read_b64_tr_b16 a[102:103], v189 offset:45056
    v_mfma_f32_16x16x32_bf16 v[136:139], a[76:79], a[28:31], v[136:139]
    v_exp_f32 v149, v149
    s_waitcnt lgkmcnt(8)
    v_mfma_f32_16x16x32_bf16 v[132:135], a[80:83], a[0:3], 0
    v_cvt_pk_bf16_f32 v168, v144, v145
    ds_read_b64_tr_b16 a[104:105], v190 offset:40960
    s_waitcnt lgkmcnt(8)
    v_mfma_f32_16x16x32_bf16 v[132:135], a[84:87], a[4:7], v[132:135]
    s_add_u32 m0, s30, 32768
    s_nop 0
    buffer_load_dwordx4 v196, s[16:19], s28 offen offset:0 nt lds
    s_waitcnt lgkmcnt(7)
    v_mfma_f32_16x16x32_bf16 v[132:135], a[88:91], a[8:11], v[132:135]
    v_cvt_pk_bf16_f32 v169, v146, v147
    ds_read_b64_tr_b16 a[106:107], v190 offset:45056
    s_waitcnt lgkmcnt(7)
    v_mfma_f32_16x16x32_bf16 v[132:135], a[92:95], a[12:15], v[132:135]
    v_exp_f32 v150, v150
    v_cvt_pk_bf16_f32 v170, v148, v149
    v_mfma_f32_16x16x32_bf16 v[140:143], a[80:83], a[16:19], 0
    v_exp_f32 v151, v151
    ds_read_b64_tr_b16 a[108:109], v191 offset:40960
    v_mfma_f32_16x16x32_bf16 v[140:143], a[84:87], a[20:23], v[140:143]
    v_exp_f32 v152, v152
    v_mfma_f32_16x16x32_bf16 v[140:143], a[88:91], a[24:27], v[140:143]
    v_exp_f32 v153, v153
    ds_read_b64_tr_b16 a[110:111], v191 offset:45056
    v_mfma_f32_16x16x32_bf16 v[140:143], a[92:95], a[28:31], v[140:143]
    v_exp_f32 v154, v154
    v_cvt_pk_bf16_f32 v171, v150, v151
    v_mfma_f32_16x16x32_bf16 v[176:179], v[242:245], v[160:163], v[176:179]
    v_exp_f32 v155, v155
    ds_read_b64_tr_b16 a[112:113], v192 offset:40960
    v_mfma_f32_16x16x32_bf16 v[184:187], v[242:245], v[164:167], v[184:187]
    v_cvt_pk_bf16_f32 v172, v152, v153
    ds_read_b64_tr_b16 a[114:115], v192 offset:45056
    s_waitcnt lgkmcnt(8)
    v_mfma_f32_16x16x32_bf16 v[0:3], a[96:99], v[160:163], v[0:3]
    v_exp_f32 v156, v156
    v_mfma_f32_16x16x32_bf16 v[32:35], a[96:99], v[164:167], v[32:35]
    v_cvt_pk_bf16_f32 v173, v154, v155
    ds_read_b64_tr_b16 a[116:117], v193 offset:40960
    s_waitcnt lgkmcnt(7)
    v_mfma_f32_16x16x32_bf16 v[4:7], a[100:103], v[160:163], v[4:7]
    v_exp_f32 v157, v157
    ds_read_b64_tr_b16 a[118:119], v193 offset:45056
    v_mfma_f32_16x16x32_bf16 v[36:39], a[100:103], v[164:167], v[36:39]
    v_cvt_pk_bf16_f32 v174, v156, v157
    s_waitcnt lgkmcnt(6)
    v_mfma_f32_16x16x32_bf16 v[8:11], a[104:107], v[160:163], v[8:11]
    ds_read_b64_tr_b16 a[120:121], v194 offset:40960
    v_mfma_f32_16x16x32_bf16 v[40:43], a[104:107], v[164:167], v[40:43]
    ds_read_b64_tr_b16 a[122:123], v194 offset:45056
    s_waitcnt lgkmcnt(6)
    v_mfma_f32_16x16x32_bf16 v[12:15], a[108:111], v[160:163], v[12:15]
    v_exp_f32 v158, v158
    v_mfma_f32_16x16x32_bf16 v[44:47], a[108:111], v[164:167], v[44:47]
    ds_read_b64_tr_b16 a[124:125], v195 offset:40960
    s_waitcnt lgkmcnt(5)
    v_mfma_f32_16x16x32_bf16 v[16:19], a[112:115], v[160:163], v[16:19]
    ds_read_b64_tr_b16 a[126:127], v195 offset:45056
    v_mfma_f32_16x16x32_bf16 v[48:51], a[112:115], v[164:167], v[48:51]
    s_waitcnt lgkmcnt(4)
    v_mfma_f32_16x16x32_bf16 v[20:23], a[116:119], v[160:163], v[20:23]
    buffer_load_dwordx4 v197, s[16:19], s28 offen offset:1024 nt lds
    v_mfma_f32_16x16x32_bf16 v[52:55], a[116:119], v[164:167], v[52:55]
    s_waitcnt lgkmcnt(2)
    v_mfma_f32_16x16x32_bf16 v[24:27], a[120:123], v[160:163], v[24:27]
    v_exp_f32 v159, v159
    v_mfma_f32_16x16x32_bf16 v[56:59], a[120:123], v[164:167], v[56:59]
    v_cvt_pk_bf16_f32 v175, v158, v159
    s_waitcnt lgkmcnt(0)
    v_mfma_f32_16x16x32_bf16 v[28:31], a[124:127], v[160:163], v[28:31]
    v_mfma_f32_16x16x32_bf16 v[60:63], a[124:127], v[164:167], v[60:63]
    v_mfma_f32_16x16x32_bf16 v[144:147], a[64:67], a[32:35], 0
    v_exp_f32 v128, v128
    s_waitcnt vmcnt(24)
    v_accvgpr_read_b32 v234, a196
    v_mfma_f32_16x16x32_bf16 v[144:147], a[68:71], a[36:39], v[144:147]
    v_exp_f32 v129, v129
    v_mfma_f32_16x16x32_bf16 v[144:147], a[72:75], a[40:43], v[144:147]
    v_exp_f32 v130, v130
    v_accvgpr_read_b32 v235, a197
    v_mfma_f32_16x16x32_bf16 v[144:147], a[76:79], a[44:47], v[144:147]
    v_exp_f32 v131, v131
    v_accvgpr_read_b32 v236, a198
    v_mfma_f32_16x16x32_bf16 v[152:155], a[64:67], a[48:51], 0
    s_add_u32 s38, s51, 4096
    buffer_load_dwordx4 a[212:215], v197, s[12:15], s38 offen offset:1024 nt
    v_cvt_pk_bf16_f32 v160, v128, v129
    v_accvgpr_read_b32 v237, a199
    v_mfma_f32_16x16x32_bf16 v[152:155], a[68:71], a[52:55], v[152:155]
    v_exp_f32 v132, v132
    v_mfma_f32_16x16x32_bf16 v[152:155], a[72:75], a[56:59], v[152:155]
    v_cvt_pk_bf16_f32 v161, v130, v131
    v_lshlrev_b32 v226, 16, v234
    ds_read_b128 a[64:67], v180 offset:57344
    v_mfma_f32_16x16x32_bf16 v[152:155], a[76:79], a[60:63], v[152:155]
    v_exp_f32 v133, v133
    v_and_b32 v227, s37, v234
    v_mfma_f32_16x16x32_bf16 v[148:151], a[80:83], a[32:35], 0
    v_cvt_pk_bf16_f32 v162, v132, v133
    v_lshlrev_b32 v228, 16, v235
    ds_read_b128 a[68:71], v181 offset:57344
    v_mfma_f32_16x16x32_bf16 v[148:151], a[84:87], a[36:39], v[148:151]
    v_exp_f32 v134, v134
    v_mfma_f32_16x16x32_bf16 v[148:151], a[88:91], a[40:43], v[148:151]
    v_and_b32 v229, s37, v235
    ds_read_b128 a[72:75], v182 offset:57344
    v_mfma_f32_16x16x32_bf16 v[148:151], a[92:95], a[44:47], v[148:151]
    v_exp_f32 v135, v135
    v_lshlrev_b32 v230, 16, v236
    v_mfma_f32_16x16x32_bf16 v[156:159], a[80:83], a[48:51], 0
    v_cvt_pk_bf16_f32 v163, v134, v135
    v_and_b32 v231, s37, v236
    ds_read_b128 a[76:79], v183 offset:57344
    v_mfma_f32_16x16x32_bf16 v[156:159], a[84:87], a[52:55], v[156:159]
    v_exp_f32 v136, v136
    v_mfma_f32_16x16x32_bf16 v[156:159], a[88:91], a[56:59], v[156:159]
    v_lshlrev_b32 v232, 16, v237
    ds_read_b128 a[80:83], v180 offset:61440
    v_mfma_f32_16x16x32_bf16 v[156:159], a[92:95], a[60:63], v[156:159]
    v_exp_f32 v137, v137
    v_and_b32 v233, s37, v237
    v_mfma_f32_16x16x32_bf16 v[222:225], v[242:245], v[168:171], v[222:225]
    v_cvt_pk_bf16_f32 v164, v136, v137
    ds_read_b128 a[84:87], v181 offset:61440
    v_mfma_f32_16x16x32_bf16 v[246:249], v[242:245], v[172:175], v[246:249]
    v_exp_f32 v138, v138
    v_mul_f32 v226, s34, v226
    v_mfma_f32_16x16x32_bf16 v[64:67], a[96:99], v[168:171], v[64:67]
    v_mul_f32 v227, s34, v227
    ds_read_b128 a[88:91], v182 offset:61440
    v_mfma_f32_16x16x32_bf16 v[96:99], a[96:99], v[172:175], v[96:99]
    v_exp_f32 v139, v139
    v_mul_f32 v228, s34, v228
    v_mfma_f32_16x16x32_bf16 v[68:71], a[100:103], v[168:171], v[68:71]
    v_cvt_pk_bf16_f32 v165, v138, v139
    ds_read_b128 a[92:95], v183 offset:61440
    v_mfma_f32_16x16x32_bf16 v[100:103], a[100:103], v[172:175], v[100:103]
    buffer_load_dwordx4 v198, s[16:19], s28 offen offset:2048 nt lds
    v_mul_f32 v229, s34, v229
    v_mfma_f32_16x16x32_bf16 v[72:75], a[104:107], v[168:171], v[72:75]
    v_exp_f32 v140, v140
    v_mul_f32 v230, s34, v230
    v_mfma_f32_16x16x32_bf16 v[104:107], a[104:107], v[172:175], v[104:107]
    v_exp_f32 v141, v141
    v_mul_f32 v231, s34, v231
    v_mfma_f32_16x16x32_bf16 v[76:79], a[108:111], v[168:171], v[76:79]
    v_exp_f32 v142, v142
    v_mfma_f32_16x16x32_bf16 v[108:111], a[108:111], v[172:175], v[108:111]
    v_exp_f32 v143, v143
    v_mul_f32 v232, s34, v232
    v_mfma_f32_16x16x32_bf16 v[80:83], a[112:115], v[168:171], v[80:83]
    v_cvt_pk_bf16_f32 v166, v140, v141
    v_cvt_pk_bf16_f32 v167, v142, v143
    v_mul_f32 v233, s34, v233
    v_mfma_f32_16x16x32_bf16 v[112:115], a[112:115], v[172:175], v[112:115]
    v_cvt_pk_bf16_f32 v238, v226, v227
    v_mfma_f32_16x16x32_bf16 v[84:87], a[116:119], v[168:171], v[84:87]
    v_mfma_f32_16x16x32_bf16 v[116:119], a[116:119], v[172:175], v[116:119]
    buffer_load_dwordx4 v199, s[16:19], s28 offen offset:3072 nt lds
    s_add_u32 s28, s28, 16384
    v_cvt_pk_bf16_f32 v239, v228, v229
    v_mfma_f32_16x16x32_bf16 v[88:91], a[120:123], v[168:171], v[88:91]
    v_cvt_pk_bf16_f32 v240, v230, v231
    v_mfma_f32_16x16x32_bf16 v[120:123], a[120:123], v[172:175], v[120:123]
    v_cvt_pk_bf16_f32 v241, v232, v233
    v_mfma_f32_16x16x32_bf16 v[92:95], a[124:127], v[168:171], v[92:95]
    v_mfma_f32_16x16x32_bf16 v[124:127], a[124:127], v[172:175], v[124:127]
    ds_write_b128 v205, v[238:241] offset:1024
    s_waitcnt lgkmcnt(1)
    v_mfma_f32_16x16x32_bf16 v[128:131], a[64:67], a[0:3], 0
    s_waitcnt vmcnt(19)
    s_barrier
    ds_read_b64_tr_b16 a[96:97], v188 offset:49152
    v_mfma_f32_16x16x32_bf16 v[128:131], a[68:71], a[4:7], v[128:131]
    v_exp_f32 v144, v144
    v_mfma_f32_16x16x32_bf16 v[128:131], a[72:75], a[8:11], v[128:131]
    v_exp_f32 v145, v145
    ds_read_b64_tr_b16 a[98:99], v188 offset:53248
    v_mfma_f32_16x16x32_bf16 v[128:131], a[76:79], a[12:15], v[128:131]
    v_exp_f32 v146, v146
    v_mfma_f32_16x16x32_bf16 v[136:139], a[64:67], a[16:19], 0
    v_exp_f32 v147, v147
    ds_read_b64_tr_b16 a[100:101], v189 offset:49152
    v_mfma_f32_16x16x32_bf16 v[136:139], a[68:71], a[20:23], v[136:139]
    v_exp_f32 v148, v148
    v_cvt_pk_bf16_f32 v168, v144, v145
    v_mfma_f32_16x16x32_bf16 v[136:139], a[72:75], a[24:27], v[136:139]
    v_exp_f32 v149, v149
    ds_read_b64_tr_b16 a[102:103], v189 offset:53248
    v_mfma_f32_16x16x32_bf16 v[136:139], a[76:79], a[28:31], v[136:139]
    v_exp_f32 v150, v150
    v_cvt_pk_bf16_f32 v169, v146, v147
    v_mfma_f32_16x16x32_bf16 v[132:135], a[80:83], a[0:3], 0
    v_exp_f32 v151, v151
    ds_read_b64_tr_b16 a[104:105], v190 offset:49152
    v_mfma_f32_16x16x32_bf16 v[132:135], a[84:87], a[4:7], v[132:135]
    s_add_u32 m0, s30, 98304
    s_nop 0
    buffer_load_dwordx4 v200, s[20:23], s29 offen offset:0 nt lds
    v_mfma_f32_16x16x32_bf16 v[132:135], a[88:91], a[8:11], v[132:135]
    v_exp_f32 v152, v152
    ds_read_b64_tr_b16 a[106:107], v190 offset:53248
    v_mfma_f32_16x16x32_bf16 v[132:135], a[92:95], a[12:15], v[132:135]
    v_exp_f32 v153, v153
    v_cvt_pk_bf16_f32 v170, v148, v149
    v_mfma_f32_16x16x32_bf16 v[140:143], a[80:83], a[16:19], 0
    v_exp_f32 v154, v154
    ds_read_b64_tr_b16 a[108:109], v191 offset:49152
    v_mfma_f32_16x16x32_bf16 v[140:143], a[84:87], a[20:23], v[140:143]
    v_exp_f32 v155, v155
    v_cvt_pk_bf16_f32 v171, v150, v151
    v_mfma_f32_16x16x32_bf16 v[140:143], a[88:91], a[24:27], v[140:143]
    v_cvt_pk_bf16_f32 v172, v152, v153
    ds_read_b64_tr_b16 a[110:111], v191 offset:53248
    v_mfma_f32_16x16x32_bf16 v[140:143], a[92:95], a[28:31], v[140:143]
    v_exp_f32 v156, v156
    v_mfma_f32_16x16x32_bf16 v[176:179], v[242:245], v[160:163], v[176:179]
    v_cvt_pk_bf16_f32 v173, v154, v155
    ds_read_b64_tr_b16 a[112:113], v192 offset:49152
    v_mfma_f32_16x16x32_bf16 v[184:187], v[242:245], v[164:167], v[184:187]
    ds_read_b64_tr_b16 a[114:115], v192 offset:53248
    s_waitcnt lgkmcnt(8)
    v_mfma_f32_16x16x32_bf16 v[0:3], a[96:99], v[160:163], v[0:3]
    v_exp_f32 v157, v157
    v_mfma_f32_16x16x32_bf16 v[32:35], a[96:99], v[164:167], v[32:35]
    ds_read_b64_tr_b16 a[116:117], v193 offset:49152
    s_waitcnt lgkmcnt(7)
    v_mfma_f32_16x16x32_bf16 v[4:7], a[100:103], v[160:163], v[4:7]
    v_cvt_pk_bf16_f32 v174, v156, v157
    ds_read_b64_tr_b16 a[118:119], v193 offset:53248
    v_mfma_f32_16x16x32_bf16 v[36:39], a[100:103], v[164:167], v[36:39]
    s_waitcnt lgkmcnt(6)
    v_mfma_f32_16x16x32_bf16 v[8:11], a[104:107], v[160:163], v[8:11]
    ds_read_b64_tr_b16 a[120:121], v194 offset:49152
    v_mfma_f32_16x16x32_bf16 v[40:43], a[104:107], v[164:167], v[40:43]
    ds_read_b64_tr_b16 a[122:123], v194 offset:53248
    s_waitcnt lgkmcnt(6)
    v_mfma_f32_16x16x32_bf16 v[12:15], a[108:111], v[160:163], v[12:15]
    v_exp_f32 v158, v158
    v_mfma_f32_16x16x32_bf16 v[44:47], a[108:111], v[164:167], v[44:47]
    ds_read_b64_tr_b16 a[124:125], v195 offset:49152
    s_waitcnt lgkmcnt(5)
    v_mfma_f32_16x16x32_bf16 v[16:19], a[112:115], v[160:163], v[16:19]
    ds_read_b64_tr_b16 a[126:127], v195 offset:53248
    v_mfma_f32_16x16x32_bf16 v[48:51], a[112:115], v[164:167], v[48:51]
    s_waitcnt lgkmcnt(4)
    v_mfma_f32_16x16x32_bf16 v[20:23], a[116:119], v[160:163], v[20:23]
    buffer_load_dwordx4 v201, s[20:23], s29 offen offset:1024 nt lds
    v_mfma_f32_16x16x32_bf16 v[52:55], a[116:119], v[164:167], v[52:55]
    s_waitcnt lgkmcnt(2)
    v_mfma_f32_16x16x32_bf16 v[24:27], a[120:123], v[160:163], v[24:27]
    v_exp_f32 v159, v159
    v_mfma_f32_16x16x32_bf16 v[56:59], a[120:123], v[164:167], v[56:59]
    v_cvt_pk_bf16_f32 v175, v158, v159
    s_waitcnt lgkmcnt(0)
    v_mfma_f32_16x16x32_bf16 v[28:31], a[124:127], v[160:163], v[28:31]
    v_mfma_f32_16x16x32_bf16 v[60:63], a[124:127], v[164:167], v[60:63]
    v_mfma_f32_16x16x32_bf16 v[144:147], a[64:67], a[32:35], 0
    v_exp_f32 v128, v128
    v_accvgpr_read_b32 v234, a200
    v_mfma_f32_16x16x32_bf16 v[144:147], a[68:71], a[36:39], v[144:147]
    v_exp_f32 v129, v129
    v_mfma_f32_16x16x32_bf16 v[144:147], a[72:75], a[40:43], v[144:147]
    v_exp_f32 v130, v130
    v_accvgpr_read_b32 v235, a201
    v_mfma_f32_16x16x32_bf16 v[144:147], a[76:79], a[44:47], v[144:147]
    v_exp_f32 v131, v131
    v_accvgpr_read_b32 v236, a202
    v_mfma_f32_16x16x32_bf16 v[152:155], a[64:67], a[48:51], 0
    s_add_u32 s38, s51, 4096
    buffer_load_dwordx4 a[216:219], v198, s[12:15], s38 offen offset:2048 nt
    v_cvt_pk_bf16_f32 v160, v128, v129
    v_accvgpr_read_b32 v237, a203
    v_mfma_f32_16x16x32_bf16 v[152:155], a[68:71], a[52:55], v[152:155]
    v_exp_f32 v132, v132
    v_mfma_f32_16x16x32_bf16 v[152:155], a[72:75], a[56:59], v[152:155]
    v_cvt_pk_bf16_f32 v161, v130, v131
    v_lshlrev_b32 v226, 16, v234
    ds_read_b128 a[64:67], v180 offset:0
    v_mfma_f32_16x16x32_bf16 v[152:155], a[76:79], a[60:63], v[152:155]
    v_exp_f32 v133, v133
    v_and_b32 v227, s37, v234
    v_mfma_f32_16x16x32_bf16 v[148:151], a[80:83], a[32:35], 0
    v_cvt_pk_bf16_f32 v162, v132, v133
    v_lshlrev_b32 v228, 16, v235
    ds_read_b128 a[68:71], v181 offset:0
    v_mfma_f32_16x16x32_bf16 v[148:151], a[84:87], a[36:39], v[148:151]
    v_exp_f32 v134, v134
    v_mfma_f32_16x16x32_bf16 v[148:151], a[88:91], a[40:43], v[148:151]
    v_and_b32 v229, s37, v235
    ds_read_b128 a[72:75], v182 offset:0
    v_mfma_f32_16x16x32_bf16 v[148:151], a[92:95], a[44:47], v[148:151]
    v_exp_f32 v135, v135
    v_lshlrev_b32 v230, 16, v236
    v_mfma_f32_16x16x32_bf16 v[156:159], a[80:83], a[48:51], 0
    v_cvt_pk_bf16_f32 v163, v134, v135
    v_and_b32 v231, s37, v236
    ds_read_b128 a[76:79], v183 offset:0
    v_mfma_f32_16x16x32_bf16 v[156:159], a[84:87], a[52:55], v[156:159]
    v_exp_f32 v136, v136
    v_mfma_f32_16x16x32_bf16 v[156:159], a[88:91], a[56:59], v[156:159]
    v_lshlrev_b32 v232, 16, v237
    ds_read_b128 a[80:83], v180 offset:4096
    v_mfma_f32_16x16x32_bf16 v[156:159], a[92:95], a[60:63], v[156:159]
    v_exp_f32 v137, v137
    v_and_b32 v233, s37, v237
    v_mfma_f32_16x16x32_bf16 v[222:225], v[242:245], v[168:171], v[222:225]
    v_cvt_pk_bf16_f32 v164, v136, v137
    ds_read_b128 a[84:87], v181 offset:4096
    v_mfma_f32_16x16x32_bf16 v[246:249], v[242:245], v[172:175], v[246:249]
    v_exp_f32 v138, v138
    v_mul_f32 v226, s34, v226
    v_mfma_f32_16x16x32_bf16 v[64:67], a[96:99], v[168:171], v[64:67]
    v_mul_f32 v227, s34, v227
    ds_read_b128 a[88:91], v182 offset:4096
    v_mfma_f32_16x16x32_bf16 v[96:99], a[96:99], v[172:175], v[96:99]
    v_exp_f32 v139, v139
    v_mul_f32 v228, s34, v228
    v_mfma_f32_16x16x32_bf16 v[68:71], a[100:103], v[168:171], v[68:71]
    v_cvt_pk_bf16_f32 v165, v138, v139
    ds_read_b128 a[92:95], v183 offset:4096
    v_mfma_f32_16x16x32_bf16 v[100:103], a[100:103], v[172:175], v[100:103]
    buffer_load_dwordx4 v200, s[20:23], s29 offen offset:2048 nt lds
    v_mul_f32 v229, s34, v229
    v_mfma_f32_16x16x32_bf16 v[72:75], a[104:107], v[168:171], v[72:75]
    v_exp_f32 v140, v140
    v_mul_f32 v230, s34, v230
    v_mfma_f32_16x16x32_bf16 v[104:107], a[104:107], v[172:175], v[104:107]
    v_exp_f32 v141, v141
    v_mul_f32 v231, s34, v231
    v_mfma_f32_16x16x32_bf16 v[76:79], a[108:111], v[168:171], v[76:79]
    v_exp_f32 v142, v142
    v_mfma_f32_16x16x32_bf16 v[108:111], a[108:111], v[172:175], v[108:111]
    v_exp_f32 v143, v143
    v_mul_f32 v232, s34, v232
    v_mfma_f32_16x16x32_bf16 v[80:83], a[112:115], v[168:171], v[80:83]
    v_cvt_pk_bf16_f32 v166, v140, v141
    v_cvt_pk_bf16_f32 v167, v142, v143
    v_mul_f32 v233, s34, v233
    v_mfma_f32_16x16x32_bf16 v[112:115], a[112:115], v[172:175], v[112:115]
    v_cvt_pk_bf16_f32 v238, v226, v227
    v_mfma_f32_16x16x32_bf16 v[84:87], a[116:119], v[168:171], v[84:87]
    v_mfma_f32_16x16x32_bf16 v[116:119], a[116:119], v[172:175], v[116:119]
    buffer_load_dwordx4 v201, s[20:23], s29 offen offset:3072 nt lds
    s_add_u32 s29, s29, 16384
    v_cvt_pk_bf16_f32 v239, v228, v229
    v_mfma_f32_16x16x32_bf16 v[88:91], a[120:123], v[168:171], v[88:91]
    v_cvt_pk_bf16_f32 v240, v230, v231
    v_mfma_f32_16x16x32_bf16 v[120:123], a[120:123], v[172:175], v[120:123]
    v_cvt_pk_bf16_f32 v241, v232, v233
    v_mfma_f32_16x16x32_bf16 v[92:95], a[124:127], v[168:171], v[92:95]
    v_mfma_f32_16x16x32_bf16 v[124:127], a[124:127], v[172:175], v[124:127]
    ds_write_b128 v205, v[238:241] offset:2048
    s_waitcnt lgkmcnt(8)
    v_mfma_f32_16x16x32_bf16 v[128:131], a[64:67], a[0:3], 0
    ds_read_b64_tr_b16 a[96:97], v188 offset:57344
    s_waitcnt lgkmcnt(8)
    v_mfma_f32_16x16x32_bf16 v[128:131], a[68:71], a[4:7], v[128:131]
    v_exp_f32 v144, v144
    s_waitcnt lgkmcnt(7)
    v_mfma_f32_16x16x32_bf16 v[128:131], a[72:75], a[8:11], v[128:131]
    ds_read_b64_tr_b16 a[98:99], v188 offset:61440
    s_waitcnt lgkmcnt(7)
    v_mfma_f32_16x16x32_bf16 v[128:131], a[76:79], a[12:15], v[128:131]
    v_exp_f32 v145, v145
    v_mfma_f32_16x16x32_bf16 v[136:139], a[64:67], a[16:19], 0
    v_exp_f32 v146, v146
    ds_read_b64_tr_b16 a[100:101], v189 offset:57344
    v_mfma_f32_16x16x32_bf16 v[136:139], a[68:71], a[20:23], v[136:139]
    v_exp_f32 v147, v147
    v_mfma_f32_16x16x32_bf16 v[136:139], a[72:75], a[24:27], v[136:139]
    v_exp_f32 v148, v148
    ds_read_b64_tr_b16 a[102:103], v189 offset:61440
    v_mfma_f32_16x16x32_bf16 v[136:139], a[76:79], a[28:31], v[136:139]
    v_exp_f32 v149, v149
    s_waitcnt lgkmcnt(8)
    v_mfma_f32_16x16x32_bf16 v[132:135], a[80:83], a[0:3], 0
    v_cvt_pk_bf16_f32 v168, v144, v145
    ds_read_b64_tr_b16 a[104:105], v190 offset:57344
    s_waitcnt lgkmcnt(8)
    v_mfma_f32_16x16x32_bf16 v[132:135], a[84:87], a[4:7], v[132:135]
    s_add_u32 m0, s30, 49152
    s_nop 0
    buffer_load_dwordx4 v196, s[16:19], s28 offen offset:0 nt lds
    s_waitcnt lgkmcnt(7)
    v_mfma_f32_16x16x32_bf16 v[132:135], a[88:91], a[8:11], v[132:135]
    v_cvt_pk_bf16_f32 v169, v146, v147
    ds_read_b64_tr_b16 a[106:107], v190 offset:61440
    s_waitcnt lgkmcnt(7)
    v_mfma_f32_16x16x32_bf16 v[132:135], a[92:95], a[12:15], v[132:135]
    v_exp_f32 v150, v150
    v_cvt_pk_bf16_f32 v170, v148, v149
    v_mfma_f32_16x16x32_bf16 v[140:143], a[80:83], a[16:19], 0
    v_exp_f32 v151, v151
    ds_read_b64_tr_b16 a[108:109], v191 offset:57344
    v_mfma_f32_16x16x32_bf16 v[140:143], a[84:87], a[20:23], v[140:143]
    v_exp_f32 v152, v152
    v_mfma_f32_16x16x32_bf16 v[140:143], a[88:91], a[24:27], v[140:143]
    v_exp_f32 v153, v153
    ds_read_b64_tr_b16 a[110:111], v191 offset:61440
    v_mfma_f32_16x16x32_bf16 v[140:143], a[92:95], a[28:31], v[140:143]
    v_exp_f32 v154, v154
    v_cvt_pk_bf16_f32 v171, v150, v151
    v_mfma_f32_16x16x32_bf16 v[176:179], v[242:245], v[160:163], v[176:179]
    v_exp_f32 v155, v155
    ds_read_b64_tr_b16 a[112:113], v192 offset:57344
    v_mfma_f32_16x16x32_bf16 v[184:187], v[242:245], v[164:167], v[184:187]
    v_cvt_pk_bf16_f32 v172, v152, v153
    ds_read_b64_tr_b16 a[114:115], v192 offset:61440
    s_waitcnt lgkmcnt(8)
    v_mfma_f32_16x16x32_bf16 v[0:3], a[96:99], v[160:163], v[0:3]
    v_exp_f32 v156, v156
    v_mfma_f32_16x16x32_bf16 v[32:35], a[96:99], v[164:167], v[32:35]
    v_cvt_pk_bf16_f32 v173, v154, v155
    ds_read_b64_tr_b16 a[116:117], v193 offset:57344
    s_waitcnt lgkmcnt(7)
    v_mfma_f32_16x16x32_bf16 v[4:7], a[100:103], v[160:163], v[4:7]
    v_exp_f32 v157, v157
    ds_read_b64_tr_b16 a[118:119], v193 offset:61440
    v_mfma_f32_16x16x32_bf16 v[36:39], a[100:103], v[164:167], v[36:39]
    v_cvt_pk_bf16_f32 v174, v156, v157
    s_waitcnt lgkmcnt(6)
    v_mfma_f32_16x16x32_bf16 v[8:11], a[104:107], v[160:163], v[8:11]
    ds_read_b64_tr_b16 a[120:121], v194 offset:57344
    v_mfma_f32_16x16x32_bf16 v[40:43], a[104:107], v[164:167], v[40:43]
    ds_read_b64_tr_b16 a[122:123], v194 offset:61440
    s_waitcnt lgkmcnt(6)
    v_mfma_f32_16x16x32_bf16 v[12:15], a[108:111], v[160:163], v[12:15]
    v_exp_f32 v158, v158
    v_mfma_f32_16x16x32_bf16 v[44:47], a[108:111], v[164:167], v[44:47]
    ds_read_b64_tr_b16 a[124:125], v195 offset:57344
    s_waitcnt lgkmcnt(5)
    v_mfma_f32_16x16x32_bf16 v[16:19], a[112:115], v[160:163], v[16:19]
    ds_read_b64_tr_b16 a[126:127], v195 offset:61440
    v_mfma_f32_16x16x32_bf16 v[48:51], a[112:115], v[164:167], v[48:51]
    s_waitcnt lgkmcnt(4)
    v_mfma_f32_16x16x32_bf16 v[20:23], a[116:119], v[160:163], v[20:23]
    buffer_load_dwordx4 v197, s[16:19], s28 offen offset:1024 nt lds
    v_mfma_f32_16x16x32_bf16 v[52:55], a[116:119], v[164:167], v[52:55]
    s_waitcnt lgkmcnt(2)
    v_mfma_f32_16x16x32_bf16 v[24:27], a[120:123], v[160:163], v[24:27]
    v_exp_f32 v159, v159
    v_mfma_f32_16x16x32_bf16 v[56:59], a[120:123], v[164:167], v[56:59]
    v_cvt_pk_bf16_f32 v175, v158, v159
    s_waitcnt lgkmcnt(0)
    v_mfma_f32_16x16x32_bf16 v[28:31], a[124:127], v[160:163], v[28:31]
    v_mfma_f32_16x16x32_bf16 v[60:63], a[124:127], v[164:167], v[60:63]
    v_mfma_f32_16x16x32_bf16 v[144:147], a[64:67], a[32:35], 0
    v_exp_f32 v128, v128
    s_waitcnt vmcnt(20)
    v_accvgpr_read_b32 v234, a204
    v_mfma_f32_16x16x32_bf16 v[144:147], a[68:71], a[36:39], v[144:147]
    v_exp_f32 v129, v129
    v_mfma_f32_16x16x32_bf16 v[144:147], a[72:75], a[40:43], v[144:147]
    v_exp_f32 v130, v130
    v_accvgpr_read_b32 v235, a205
    v_mfma_f32_16x16x32_bf16 v[144:147], a[76:79], a[44:47], v[144:147]
    v_exp_f32 v131, v131
    v_accvgpr_read_b32 v236, a206
    v_mfma_f32_16x16x32_bf16 v[152:155], a[64:67], a[48:51], 0
    s_add_u32 s38, s51, 4096
    buffer_load_dwordx4 a[220:223], v199, s[12:15], s38 offen offset:3072 nt
    v_cvt_pk_bf16_f32 v160, v128, v129
    v_accvgpr_read_b32 v237, a207
    v_mfma_f32_16x16x32_bf16 v[152:155], a[68:71], a[52:55], v[152:155]
    v_exp_f32 v132, v132
    v_mfma_f32_16x16x32_bf16 v[152:155], a[72:75], a[56:59], v[152:155]
    v_cvt_pk_bf16_f32 v161, v130, v131
    v_lshlrev_b32 v226, 16, v234
    ds_read_b128 a[64:67], v180 offset:8192
    v_mfma_f32_16x16x32_bf16 v[152:155], a[76:79], a[60:63], v[152:155]
    v_exp_f32 v133, v133
    v_and_b32 v227, s37, v234
    v_mfma_f32_16x16x32_bf16 v[148:151], a[80:83], a[32:35], 0
    v_cvt_pk_bf16_f32 v162, v132, v133
    v_lshlrev_b32 v228, 16, v235
    ds_read_b128 a[68:71], v181 offset:8192
    v_mfma_f32_16x16x32_bf16 v[148:151], a[84:87], a[36:39], v[148:151]
    v_exp_f32 v134, v134
    v_mfma_f32_16x16x32_bf16 v[148:151], a[88:91], a[40:43], v[148:151]
    v_and_b32 v229, s37, v235
    ds_read_b128 a[72:75], v182 offset:8192
    v_mfma_f32_16x16x32_bf16 v[148:151], a[92:95], a[44:47], v[148:151]
    v_exp_f32 v135, v135
    v_lshlrev_b32 v230, 16, v236
    v_mfma_f32_16x16x32_bf16 v[156:159], a[80:83], a[48:51], 0
    v_cvt_pk_bf16_f32 v163, v134, v135
    v_and_b32 v231, s37, v236
    ds_read_b128 a[76:79], v183 offset:8192
    v_mfma_f32_16x16x32_bf16 v[156:159], a[84:87], a[52:55], v[156:159]
    v_exp_f32 v136, v136
    v_mfma_f32_16x16x32_bf16 v[156:159], a[88:91], a[56:59], v[156:159]
    v_lshlrev_b32 v232, 16, v237
    ds_read_b128 a[80:83], v180 offset:12288
    v_mfma_f32_16x16x32_bf16 v[156:159], a[92:95], a[60:63], v[156:159]
    v_exp_f32 v137, v137
    v_and_b32 v233, s37, v237
    v_mfma_f32_16x16x32_bf16 v[222:225], v[242:245], v[168:171], v[222:225]
    v_cvt_pk_bf16_f32 v164, v136, v137
    ds_read_b128 a[84:87], v181 offset:12288
    v_mfma_f32_16x16x32_bf16 v[246:249], v[242:245], v[172:175], v[246:249]
    v_exp_f32 v138, v138
    v_mul_f32 v226, s34, v226
    v_mfma_f32_16x16x32_bf16 v[64:67], a[96:99], v[168:171], v[64:67]
    v_mul_f32 v227, s34, v227
    ds_read_b128 a[88:91], v182 offset:12288
    v_mfma_f32_16x16x32_bf16 v[96:99], a[96:99], v[172:175], v[96:99]
    v_exp_f32 v139, v139
    v_mul_f32 v228, s34, v228
    v_mfma_f32_16x16x32_bf16 v[68:71], a[100:103], v[168:171], v[68:71]
    v_cvt_pk_bf16_f32 v165, v138, v139
    ds_read_b128 a[92:95], v183 offset:12288
    v_mfma_f32_16x16x32_bf16 v[100:103], a[100:103], v[172:175], v[100:103]
    buffer_load_dwordx4 v198, s[16:19], s28 offen offset:2048 nt lds
    v_mul_f32 v229, s34, v229
    v_mfma_f32_16x16x32_bf16 v[72:75], a[104:107], v[168:171], v[72:75]
    v_exp_f32 v140, v140
    v_mul_f32 v230, s34, v230
    v_mfma_f32_16x16x32_bf16 v[104:107], a[104:107], v[172:175], v[104:107]
    v_exp_f32 v141, v141
    v_mul_f32 v231, s34, v231
    v_mfma_f32_16x16x32_bf16 v[76:79], a[108:111], v[168:171], v[76:79]
    v_exp_f32 v142, v142
    v_mfma_f32_16x16x32_bf16 v[108:111], a[108:111], v[172:175], v[108:111]
    v_exp_f32 v143, v143
    v_mul_f32 v232, s34, v232
    v_mfma_f32_16x16x32_bf16 v[80:83], a[112:115], v[168:171], v[80:83]
    v_cvt_pk_bf16_f32 v166, v140, v141
    v_cvt_pk_bf16_f32 v167, v142, v143
    v_mul_f32 v233, s34, v233
    v_mfma_f32_16x16x32_bf16 v[112:115], a[112:115], v[172:175], v[112:115]
    v_cvt_pk_bf16_f32 v238, v226, v227
    v_mfma_f32_16x16x32_bf16 v[84:87], a[116:119], v[168:171], v[84:87]
    v_mfma_f32_16x16x32_bf16 v[116:119], a[116:119], v[172:175], v[116:119]
    buffer_load_dwordx4 v199, s[16:19], s28 offen offset:3072 nt lds
    s_add_u32 s28, s28, 16384
    v_cvt_pk_bf16_f32 v239, v228, v229
    v_mfma_f32_16x16x32_bf16 v[88:91], a[120:123], v[168:171], v[88:91]
    v_cvt_pk_bf16_f32 v240, v230, v231
    v_mfma_f32_16x16x32_bf16 v[120:123], a[120:123], v[172:175], v[120:123]
    v_cvt_pk_bf16_f32 v241, v232, v233
    v_mfma_f32_16x16x32_bf16 v[92:95], a[124:127], v[168:171], v[92:95]
    v_mfma_f32_16x16x32_bf16 v[124:127], a[124:127], v[172:175], v[124:127]
    ds_write_b128 v205, v[238:241] offset:3072
    s_waitcnt lgkmcnt(1)
    v_mfma_f32_16x16x32_bf16 v[128:131], a[64:67], a[0:3], 0
    s_waitcnt vmcnt(20)
    s_barrier
    ds_read_b64_tr_b16 a[96:97], v188 offset:0
    v_mfma_f32_16x16x32_bf16 v[128:131], a[68:71], a[4:7], v[128:131]
    v_exp_f32 v144, v144
    v_mfma_f32_16x16x32_bf16 v[128:131], a[72:75], a[8:11], v[128:131]
    ds_read_b64_tr_b16 a[98:99], v188 offset:4096
    v_exp_f32 v145, v145
    v_mfma_f32_16x16x32_bf16 v[128:131], a[76:79], a[12:15], v[128:131]
    v_exp_f32 v146, v146
    v_mfma_f32_16x16x32_bf16 v[136:139], a[64:67], a[16:19], 0
    ds_read_b64_tr_b16 a[100:101], v189 offset:0
    v_exp_f32 v147, v147
    v_mfma_f32_16x16x32_bf16 v[136:139], a[68:71], a[20:23], v[136:139]
    v_exp_f32 v148, v148
    v_cvt_pk_bf16_f32 v168, v144, v145
    v_mfma_f32_16x16x32_bf16 v[136:139], a[72:75], a[24:27], v[136:139]
    ds_read_b64_tr_b16 a[102:103], v189 offset:4096
    v_exp_f32 v149, v149
    v_mfma_f32_16x16x32_bf16 v[136:139], a[76:79], a[28:31], v[136:139]
    v_exp_f32 v150, v150
    v_cvt_pk_bf16_f32 v169, v146, v147
    v_mfma_f32_16x16x32_bf16 v[132:135], a[80:83], a[0:3], 0
    ds_read_b64_tr_b16 a[104:105], v190 offset:0
    v_exp_f32 v151, v151
    v_mfma_f32_16x16x32_bf16 v[132:135], a[84:87], a[4:7], v[132:135]
    s_add_u32 m0, s30, 114688
    s_nop 0
    buffer_load_dwordx4 v200, s[20:23], s29 offen offset:0 nt lds
    v_mfma_f32_16x16x32_bf16 v[132:135], a[88:91], a[8:11], v[132:135]
    ds_read_b64_tr_b16 a[106:107], v190 offset:4096
    v_cvt_pk_bf16_f32 v170, v148, v149
    v_mfma_f32_16x16x32_bf16 v[132:135], a[92:95], a[12:15], v[132:135]
    v_exp_f32 v152, v152
    v_cvt_pk_bf16_f32 v171, v150, v151
    v_mfma_f32_16x16x32_bf16 v[140:143], a[80:83], a[16:19], 0
    ds_read_b64_tr_b16 a[108:109], v191 offset:0
    v_mfma_f32_16x16x32_bf16 v[140:143], a[84:87], a[20:23], v[140:143]
    v_exp_f32 v153, v153
    v_mfma_f32_16x16x32_bf16 v[140:143], a[88:91], a[24:27], v[140:143]
    ds_read_b64_tr_b16 a[110:111], v191 offset:4096
    v_cvt_pk_bf16_f32 v172, v152, v153
    v_mfma_f32_16x16x32_bf16 v[140:143], a[92:95], a[28:31], v[140:143]
    v_exp_f32 v154, v154
    v_mfma_f32_16x16x32_bf16 v[176:179], v[242:245], v[160:163], v[176:179]
    ds_read_b64_tr_b16 a[112:113], v192 offset:0
    v_mfma_f32_16x16x32_bf16 v[184:187], v[242:245], v[164:167], v[184:187]
    ds_read_b64_tr_b16 a[114:115], v192 offset:4096
    s_waitcnt lgkmcnt(6)
    v_mfma_f32_16x16x32_bf16 v[0:3], a[96:99], v[160:163], v[0:3]
    v_exp_f32 v155, v155
    v_mfma_f32_16x16x32_bf16 v[32:35], a[96:99], v[164:167], v[32:35]
    ds_read_b64_tr_b16 a[116:117], v193 offset:0
    v_cvt_pk_bf16_f32 v173, v154, v155
    v_mfma_f32_16x16x32_bf16 v[4:7], a[100:103], v[160:163], v[4:7]
    ds_read_b64_tr_b16 a[118:119], v193 offset:4096
    v_mfma_f32_16x16x32_bf16 v[36:39], a[100:103], v[164:167], v[36:39]
    s_waitcnt lgkmcnt(4)
    v_mfma_f32_16x16x32_bf16 v[8:11], a[104:107], v[160:163], v[8:11]
    ds_read_b64_tr_b16 a[120:121], v194 offset:0
    v_mfma_f32_16x16x32_bf16 v[40:43], a[104:107], v[164:167], v[40:43]
    ds_read_b64_tr_b16 a[122:123], v194 offset:4096
    v_mfma_f32_16x16x32_bf16 v[12:15], a[108:111], v[160:163], v[12:15]
    v_exp_f32 v156, v156
    v_mfma_f32_16x16x32_bf16 v[44:47], a[108:111], v[164:167], v[44:47]
    ds_read_b64_tr_b16 a[124:125], v195 offset:0
    s_waitcnt lgkmcnt(3)
    v_mfma_f32_16x16x32_bf16 v[16:19], a[112:115], v[160:163], v[16:19]
    ds_read_b64_tr_b16 a[126:127], v195 offset:4096
    v_mfma_f32_16x16x32_bf16 v[48:51], a[112:115], v[164:167], v[48:51]
    v_exp_f32 v157, v157
    v_mfma_f32_16x16x32_bf16 v[20:23], a[116:119], v[160:163], v[20:23]
    buffer_load_dwordx4 v201, s[20:23], s29 offen offset:1024 nt lds
    v_cvt_pk_bf16_f32 v174, v156, v157
    v_mfma_f32_16x16x32_bf16 v[52:55], a[116:119], v[164:167], v[52:55]
    s_waitcnt lgkmcnt(0)
    v_mfma_f32_16x16x32_bf16 v[24:27], a[120:123], v[160:163], v[24:27]
    v_exp_f32 v158, v158
    v_mfma_f32_16x16x32_bf16 v[56:59], a[120:123], v[164:167], v[56:59]
    v_exp_f32 v159, v159
    v_mfma_f32_16x16x32_bf16 v[28:31], a[124:127], v[160:163], v[28:31]
    v_cvt_pk_bf16_f32 v175, v158, v159
    v_mfma_f32_16x16x32_bf16 v[60:63], a[124:127], v[164:167], v[60:63]
    v_mfma_f32_16x16x32_bf16 v[144:147], a[64:67], a[32:35], 0
    v_exp_f32 v128, v128
    s_waitcnt vmcnt(19)
    v_accvgpr_read_b32 v234, a208
    v_mfma_f32_16x16x32_bf16 v[144:147], a[68:71], a[36:39], v[144:147]
    v_exp_f32 v129, v129
    v_mfma_f32_16x16x32_bf16 v[144:147], a[72:75], a[40:43], v[144:147]
    v_exp_f32 v130, v130
    v_accvgpr_read_b32 v235, a209
    v_mfma_f32_16x16x32_bf16 v[144:147], a[76:79], a[44:47], v[144:147]
    v_exp_f32 v131, v131
    v_accvgpr_read_b32 v236, a210
    v_mfma_f32_16x16x32_bf16 v[152:155], a[64:67], a[48:51], 0
    s_add_u32 s38, s51, 8192
    buffer_load_dwordx4 a[224:227], v196, s[12:15], s38 offen offset:0 nt
    v_cvt_pk_bf16_f32 v160, v128, v129
    v_accvgpr_read_b32 v237, a211
    v_mfma_f32_16x16x32_bf16 v[152:155], a[68:71], a[52:55], v[152:155]
    v_exp_f32 v132, v132
    v_mfma_f32_16x16x32_bf16 v[152:155], a[72:75], a[56:59], v[152:155]
    ds_read_b128 a[64:67], v180 offset:16384
    v_cvt_pk_bf16_f32 v161, v130, v131
    v_lshlrev_b32 v226, 16, v234
    v_mfma_f32_16x16x32_bf16 v[152:155], a[76:79], a[60:63], v[152:155]
    v_exp_f32 v133, v133
    v_and_b32 v227, s37, v234
    v_mfma_f32_16x16x32_bf16 v[148:151], a[80:83], a[32:35], 0
    ds_read_b128 a[68:71], v181 offset:16384
    v_cvt_pk_bf16_f32 v162, v132, v133
    v_lshlrev_b32 v228, 16, v235
    v_mfma_f32_16x16x32_bf16 v[148:151], a[84:87], a[36:39], v[148:151]
    v_exp_f32 v134, v134
    v_mfma_f32_16x16x32_bf16 v[148:151], a[88:91], a[40:43], v[148:151]
    ds_read_b128 a[72:75], v182 offset:16384
    v_and_b32 v229, s37, v235
    v_mfma_f32_16x16x32_bf16 v[148:151], a[92:95], a[44:47], v[148:151]
    v_exp_f32 v135, v135
    v_lshlrev_b32 v230, 16, v236
    v_mfma_f32_16x16x32_bf16 v[156:159], a[80:83], a[48:51], 0
    ds_read_b128 a[76:79], v183 offset:16384
    v_cvt_pk_bf16_f32 v163, v134, v135
    v_and_b32 v231, s37, v236
    v_mfma_f32_16x16x32_bf16 v[156:159], a[84:87], a[52:55], v[156:159]
    v_exp_f32 v136, v136
    v_mfma_f32_16x16x32_bf16 v[156:159], a[88:91], a[56:59], v[156:159]
    ds_read_b128 a[80:83], v180 offset:20480
    v_lshlrev_b32 v232, 16, v237
    v_mfma_f32_16x16x32_bf16 v[156:159], a[92:95], a[60:63], v[156:159]
    v_exp_f32 v137, v137
    v_and_b32 v233, s37, v237
    v_mfma_f32_16x16x32_bf16 v[222:225], v[242:245], v[168:171], v[222:225]
    ds_read_b128 a[84:87], v181 offset:20480
    v_cvt_pk_bf16_f32 v164, v136, v137
    v_mfma_f32_16x16x32_bf16 v[246:249], v[242:245], v[172:175], v[246:249]
    v_exp_f32 v138, v138
    v_mul_f32 v226, s34, v226
    v_mfma_f32_16x16x32_bf16 v[64:67], a[96:99], v[168:171], v[64:67]
    ds_read_b128 a[88:91], v182 offset:20480
    v_mul_f32 v227, s34, v227
    v_mfma_f32_16x16x32_bf16 v[96:99], a[96:99], v[172:175], v[96:99]
    v_exp_f32 v139, v139
    v_mul_f32 v228, s34, v228
    v_mfma_f32_16x16x32_bf16 v[68:71], a[100:103], v[168:171], v[68:71]
    ds_read_b128 a[92:95], v183 offset:20480
    v_cvt_pk_bf16_f32 v165, v138, v139
    v_mfma_f32_16x16x32_bf16 v[100:103], a[100:103], v[172:175], v[100:103]
    buffer_load_dwordx4 v200, s[20:23], s29 offen offset:2048 nt lds
    v_mul_f32 v229, s34, v229
    v_mfma_f32_16x16x32_bf16 v[72:75], a[104:107], v[168:171], v[72:75]
    v_exp_f32 v140, v140
    v_mul_f32 v230, s34, v230
    v_mfma_f32_16x16x32_bf16 v[104:107], a[104:107], v[172:175], v[104:107]
    v_exp_f32 v141, v141
    v_mul_f32 v231, s34, v231
    v_mfma_f32_16x16x32_bf16 v[76:79], a[108:111], v[168:171], v[76:79]
    v_exp_f32 v142, v142
    v_mfma_f32_16x16x32_bf16 v[108:111], a[108:111], v[172:175], v[108:111]
    v_exp_f32 v143, v143
    v_mul_f32 v232, s34, v232
    v_mfma_f32_16x16x32_bf16 v[80:83], a[112:115], v[168:171], v[80:83]
    v_cvt_pk_bf16_f32 v166, v140, v141
    v_cvt_pk_bf16_f32 v167, v142, v143
    v_mul_f32 v233, s34, v233
    v_mfma_f32_16x16x32_bf16 v[112:115], a[112:115], v[172:175], v[112:115]
    v_cvt_pk_bf16_f32 v238, v226, v227
    v_mfma_f32_16x16x32_bf16 v[84:87], a[116:119], v[168:171], v[84:87]
    v_mfma_f32_16x16x32_bf16 v[116:119], a[116:119], v[172:175], v[116:119]
    buffer_load_dwordx4 v201, s[20:23], s29 offen offset:3072 nt lds
    s_add_u32 s29, s29, 16384
    v_cvt_pk_bf16_f32 v239, v228, v229
    v_mfma_f32_16x16x32_bf16 v[88:91], a[120:123], v[168:171], v[88:91]
    v_cvt_pk_bf16_f32 v240, v230, v231
    v_mfma_f32_16x16x32_bf16 v[120:123], a[120:123], v[172:175], v[120:123]
    v_cvt_pk_bf16_f32 v241, v232, v233
    v_mfma_f32_16x16x32_bf16 v[92:95], a[124:127], v[168:171], v[92:95]
    v_mfma_f32_16x16x32_bf16 v[124:127], a[124:127], v[172:175], v[124:127]
    ds_write_b128 v205, v[238:241] offset:4096
    s_waitcnt lgkmcnt(1)
    v_mfma_f32_16x16x32_bf16 v[128:131], a[64:67], a[0:3], 0
    ds_read_b64_tr_b16 a[96:97], v188 offset:8192
    v_exp_f32 v144, v144
    v_mfma_f32_16x16x32_bf16 v[128:131], a[68:71], a[4:7], v[128:131]
    v_exp_f32 v145, v145
    v_mfma_f32_16x16x32_bf16 v[128:131], a[72:75], a[8:11], v[128:131]
    ds_read_b64_tr_b16 a[98:99], v188 offset:12288
    v_exp_f32 v146, v146
    v_mfma_f32_16x16x32_bf16 v[128:131], a[76:79], a[12:15], v[128:131]
    v_exp_f32 v147, v147
    v_mfma_f32_16x16x32_bf16 v[136:139], a[64:67], a[16:19], 0
    ds_read_b64_tr_b16 a[100:101], v189 offset:8192
    v_exp_f32 v148, v148
    v_mfma_f32_16x16x32_bf16 v[136:139], a[68:71], a[20:23], v[136:139]
    v_exp_f32 v149, v149
    v_cvt_pk_bf16_f32 v168, v144, v145
    v_mfma_f32_16x16x32_bf16 v[136:139], a[72:75], a[24:27], v[136:139]
    ds_read_b64_tr_b16 a[102:103], v189 offset:12288
    v_exp_f32 v150, v150
    v_mfma_f32_16x16x32_bf16 v[136:139], a[76:79], a[28:31], v[136:139]
    v_exp_f32 v151, v151
    v_cvt_pk_bf16_f32 v169, v146, v147
    v_mfma_f32_16x16x32_bf16 v[132:135], a[80:83], a[0:3], 0
    ds_read_b64_tr_b16 a[104:105], v190 offset:8192
    v_cvt_pk_bf16_f32 v170, v148, v149
    v_mfma_f32_16x16x32_bf16 v[132:135], a[84:87], a[4:7], v[132:135]
    s_add_u32 m0, s30, 0
    s_nop 0
    buffer_load_dwordx4 v196, s[16:19], s28 offen offset:0 nt lds
    v_mfma_f32_16x16x32_bf16 v[132:135], a[88:91], a[8:11], v[132:135]
    ds_read_b64_tr_b16 a[106:107], v190 offset:12288
    v_cvt_pk_bf16_f32 v171, v150, v151
    v_mfma_f32_16x16x32_bf16 v[132:135], a[92:95], a[12:15], v[132:135]
    v_exp_f32 v152, v152
    v_mfma_f32_16x16x32_bf16 v[140:143], a[80:83], a[16:19], 0
    ds_read_b64_tr_b16 a[108:109], v191 offset:8192
    v_mfma_f32_16x16x32_bf16 v[140:143], a[84:87], a[20:23], v[140:143]
    v_exp_f32 v153, v153
    v_mfma_f32_16x16x32_bf16 v[140:143], a[88:91], a[24:27], v[140:143]
    ds_read_b64_tr_b16 a[110:111], v191 offset:12288
    v_cvt_pk_bf16_f32 v172, v152, v153
    v_mfma_f32_16x16x32_bf16 v[140:143], a[92:95], a[28:31], v[140:143]
    v_exp_f32 v154, v154
    v_mfma_f32_16x16x32_bf16 v[176:179], v[242:245], v[160:163], v[176:179]
    ds_read_b64_tr_b16 a[112:113], v192 offset:8192
    v_mfma_f32_16x16x32_bf16 v[184:187], v[242:245], v[164:167], v[184:187]
    ds_read_b64_tr_b16 a[114:115], v192 offset:12288
    s_waitcnt lgkmcnt(6)
    v_mfma_f32_16x16x32_bf16 v[0:3], a[96:99], v[160:163], v[0:3]
    v_exp_f32 v155, v155
    v_mfma_f32_16x16x32_bf16 v[32:35], a[96:99], v[164:167], v[32:35]
    ds_read_b64_tr_b16 a[116:117], v193 offset:8192
    v_cvt_pk_bf16_f32 v173, v154, v155
    v_mfma_f32_16x16x32_bf16 v[4:7], a[100:103], v[160:163], v[4:7]
    ds_read_b64_tr_b16 a[118:119], v193 offset:12288
    v_mfma_f32_16x16x32_bf16 v[36:39], a[100:103], v[164:167], v[36:39]
    s_waitcnt lgkmcnt(4)
    v_mfma_f32_16x16x32_bf16 v[8:11], a[104:107], v[160:163], v[8:11]
    ds_read_b64_tr_b16 a[120:121], v194 offset:8192
    v_mfma_f32_16x16x32_bf16 v[40:43], a[104:107], v[164:167], v[40:43]
    ds_read_b64_tr_b16 a[122:123], v194 offset:12288
    v_mfma_f32_16x16x32_bf16 v[12:15], a[108:111], v[160:163], v[12:15]
    v_exp_f32 v156, v156
    v_mfma_f32_16x16x32_bf16 v[44:47], a[108:111], v[164:167], v[44:47]
    ds_read_b64_tr_b16 a[124:125], v195 offset:8192
    s_waitcnt lgkmcnt(3)
    v_mfma_f32_16x16x32_bf16 v[16:19], a[112:115], v[160:163], v[16:19]
    ds_read_b64_tr_b16 a[126:127], v195 offset:12288
    v_mfma_f32_16x16x32_bf16 v[48:51], a[112:115], v[164:167], v[48:51]
    v_exp_f32 v157, v157
    v_mfma_f32_16x16x32_bf16 v[20:23], a[116:119], v[160:163], v[20:23]
    buffer_load_dwordx4 v197, s[16:19], s28 offen offset:1024 nt lds
    v_cvt_pk_bf16_f32 v174, v156, v157
    v_mfma_f32_16x16x32_bf16 v[52:55], a[116:119], v[164:167], v[52:55]
    s_waitcnt lgkmcnt(0)
    v_mfma_f32_16x16x32_bf16 v[24:27], a[120:123], v[160:163], v[24:27]
    v_exp_f32 v158, v158
    v_mfma_f32_16x16x32_bf16 v[56:59], a[120:123], v[164:167], v[56:59]
    v_exp_f32 v159, v159
    v_mfma_f32_16x16x32_bf16 v[28:31], a[124:127], v[160:163], v[28:31]
    v_cvt_pk_bf16_f32 v175, v158, v159
    v_mfma_f32_16x16x32_bf16 v[60:63], a[124:127], v[164:167], v[60:63]
    v_mfma_f32_16x16x32_bf16 v[144:147], a[64:67], a[32:35], 0
    v_exp_f32 v128, v128
    s_waitcnt vmcnt(19)
    v_accvgpr_read_b32 v234, a212
    v_mfma_f32_16x16x32_bf16 v[144:147], a[68:71], a[36:39], v[144:147]
    v_exp_f32 v129, v129
    v_mfma_f32_16x16x32_bf16 v[144:147], a[72:75], a[40:43], v[144:147]
    v_exp_f32 v130, v130
    v_accvgpr_read_b32 v235, a213
    v_mfma_f32_16x16x32_bf16 v[144:147], a[76:79], a[44:47], v[144:147]
    v_exp_f32 v131, v131
    v_accvgpr_read_b32 v236, a214
    v_mfma_f32_16x16x32_bf16 v[152:155], a[64:67], a[48:51], 0
    s_add_u32 s38, s51, 8192
    buffer_load_dwordx4 a[228:231], v197, s[12:15], s38 offen offset:1024 nt
    v_cvt_pk_bf16_f32 v160, v128, v129
    v_accvgpr_read_b32 v237, a215
    v_mfma_f32_16x16x32_bf16 v[152:155], a[68:71], a[52:55], v[152:155]
    v_exp_f32 v132, v132
    v_mfma_f32_16x16x32_bf16 v[152:155], a[72:75], a[56:59], v[152:155]
    ds_read_b128 a[64:67], v180 offset:24576
    v_cvt_pk_bf16_f32 v161, v130, v131
    v_lshlrev_b32 v226, 16, v234
    v_mfma_f32_16x16x32_bf16 v[152:155], a[76:79], a[60:63], v[152:155]
    v_exp_f32 v133, v133
    v_and_b32 v227, s37, v234
    v_mfma_f32_16x16x32_bf16 v[148:151], a[80:83], a[32:35], 0
    ds_read_b128 a[68:71], v181 offset:24576
    v_cvt_pk_bf16_f32 v162, v132, v133
    v_lshlrev_b32 v228, 16, v235
    v_mfma_f32_16x16x32_bf16 v[148:151], a[84:87], a[36:39], v[148:151]
    v_exp_f32 v134, v134
    v_mfma_f32_16x16x32_bf16 v[148:151], a[88:91], a[40:43], v[148:151]
    ds_read_b128 a[72:75], v182 offset:24576
    v_and_b32 v229, s37, v235
    v_mfma_f32_16x16x32_bf16 v[148:151], a[92:95], a[44:47], v[148:151]
    v_exp_f32 v135, v135
    v_lshlrev_b32 v230, 16, v236
    v_mfma_f32_16x16x32_bf16 v[156:159], a[80:83], a[48:51], 0
    ds_read_b128 a[76:79], v183 offset:24576
    v_cvt_pk_bf16_f32 v163, v134, v135
    v_and_b32 v231, s37, v236
    v_mfma_f32_16x16x32_bf16 v[156:159], a[84:87], a[52:55], v[156:159]
    v_exp_f32 v136, v136
    v_mfma_f32_16x16x32_bf16 v[156:159], a[88:91], a[56:59], v[156:159]
    ds_read_b128 a[80:83], v180 offset:28672
    v_lshlrev_b32 v232, 16, v237
    v_mfma_f32_16x16x32_bf16 v[156:159], a[92:95], a[60:63], v[156:159]
    v_exp_f32 v137, v137
    v_and_b32 v233, s37, v237
    v_mfma_f32_16x16x32_bf16 v[222:225], v[242:245], v[168:171], v[222:225]
    ds_read_b128 a[84:87], v181 offset:28672
    v_cvt_pk_bf16_f32 v164, v136, v137
    v_mfma_f32_16x16x32_bf16 v[246:249], v[242:245], v[172:175], v[246:249]
    v_exp_f32 v138, v138
    v_mul_f32 v226, s34, v226
    v_mfma_f32_16x16x32_bf16 v[64:67], a[96:99], v[168:171], v[64:67]
    ds_read_b128 a[88:91], v182 offset:28672
    v_mul_f32 v227, s34, v227
    v_mfma_f32_16x16x32_bf16 v[96:99], a[96:99], v[172:175], v[96:99]
    v_exp_f32 v139, v139
    v_mul_f32 v228, s34, v228
    v_mfma_f32_16x16x32_bf16 v[68:71], a[100:103], v[168:171], v[68:71]
    ds_read_b128 a[92:95], v183 offset:28672
    v_cvt_pk_bf16_f32 v165, v138, v139
    v_mfma_f32_16x16x32_bf16 v[100:103], a[100:103], v[172:175], v[100:103]
    buffer_load_dwordx4 v198, s[16:19], s28 offen offset:2048 nt lds
    v_mul_f32 v229, s34, v229
    v_mfma_f32_16x16x32_bf16 v[72:75], a[104:107], v[168:171], v[72:75]
    v_exp_f32 v140, v140
    v_mul_f32 v230, s34, v230
    v_mfma_f32_16x16x32_bf16 v[104:107], a[104:107], v[172:175], v[104:107]
    v_exp_f32 v141, v141
    v_mul_f32 v231, s34, v231
    v_mfma_f32_16x16x32_bf16 v[76:79], a[108:111], v[168:171], v[76:79]
    v_exp_f32 v142, v142
    v_mfma_f32_16x16x32_bf16 v[108:111], a[108:111], v[172:175], v[108:111]
    v_exp_f32 v143, v143
    v_mul_f32 v232, s34, v232
    v_mfma_f32_16x16x32_bf16 v[80:83], a[112:115], v[168:171], v[80:83]
    v_cvt_pk_bf16_f32 v166, v140, v141
    v_cvt_pk_bf16_f32 v167, v142, v143
    v_mul_f32 v233, s34, v233
    v_mfma_f32_16x16x32_bf16 v[112:115], a[112:115], v[172:175], v[112:115]
    v_cvt_pk_bf16_f32 v238, v226, v227
    v_mfma_f32_16x16x32_bf16 v[84:87], a[116:119], v[168:171], v[84:87]
    v_mfma_f32_16x16x32_bf16 v[116:119], a[116:119], v[172:175], v[116:119]
    buffer_load_dwordx4 v199, s[16:19], s28 offen offset:3072 nt lds
    s_add_u32 s28, s28, 16384
    v_cvt_pk_bf16_f32 v239, v228, v229
    v_mfma_f32_16x16x32_bf16 v[88:91], a[120:123], v[168:171], v[88:91]
    v_cvt_pk_bf16_f32 v240, v230, v231
    v_mfma_f32_16x16x32_bf16 v[120:123], a[120:123], v[172:175], v[120:123]
    v_cvt_pk_bf16_f32 v241, v232, v233
    v_mfma_f32_16x16x32_bf16 v[92:95], a[124:127], v[168:171], v[92:95]
    v_mfma_f32_16x16x32_bf16 v[124:127], a[124:127], v[172:175], v[124:127]
    ds_write_b128 v205, v[238:241] offset:5120
    s_waitcnt lgkmcnt(1)
    v_mfma_f32_16x16x32_bf16 v[128:131], a[64:67], a[0:3], 0
    s_waitcnt vmcnt(20)
    s_barrier
    ds_read_b64_tr_b16 a[96:97], v188 offset:16384
    v_mfma_f32_16x16x32_bf16 v[128:131], a[68:71], a[4:7], v[128:131]
    v_exp_f32 v144, v144
    v_mfma_f32_16x16x32_bf16 v[128:131], a[72:75], a[8:11], v[128:131]
    ds_read_b64_tr_b16 a[98:99], v188 offset:20480
    v_exp_f32 v145, v145
    v_mfma_f32_16x16x32_bf16 v[128:131], a[76:79], a[12:15], v[128:131]
    v_exp_f32 v146, v146
    v_mfma_f32_16x16x32_bf16 v[136:139], a[64:67], a[16:19], 0
    ds_read_b64_tr_b16 a[100:101], v189 offset:16384
    v_exp_f32 v147, v147
    v_mfma_f32_16x16x32_bf16 v[136:139], a[68:71], a[20:23], v[136:139]
    v_exp_f32 v148, v148
    v_cvt_pk_bf16_f32 v168, v144, v145
    v_mfma_f32_16x16x32_bf16 v[136:139], a[72:75], a[24:27], v[136:139]
    ds_read_b64_tr_b16 a[102:103], v189 offset:20480
    v_exp_f32 v149, v149
    v_mfma_f32_16x16x32_bf16 v[136:139], a[76:79], a[28:31], v[136:139]
    v_exp_f32 v150, v150
    v_cvt_pk_bf16_f32 v169, v146, v147
    v_mfma_f32_16x16x32_bf16 v[132:135], a[80:83], a[0:3], 0
    ds_read_b64_tr_b16 a[104:105], v190 offset:16384
    v_exp_f32 v151, v151
    v_mfma_f32_16x16x32_bf16 v[132:135], a[84:87], a[4:7], v[132:135]
    s_add_u32 m0, s30, 65536
    s_nop 0
    buffer_load_dwordx4 v200, s[20:23], s29 offen offset:0 nt lds
    v_mfma_f32_16x16x32_bf16 v[132:135], a[88:91], a[8:11], v[132:135]
    ds_read_b64_tr_b16 a[106:107], v190 offset:20480
    v_cvt_pk_bf16_f32 v170, v148, v149
    v_mfma_f32_16x16x32_bf16 v[132:135], a[92:95], a[12:15], v[132:135]
    v_exp_f32 v152, v152
    v_cvt_pk_bf16_f32 v171, v150, v151
    v_mfma_f32_16x16x32_bf16 v[140:143], a[80:83], a[16:19], 0
    ds_read_b64_tr_b16 a[108:109], v191 offset:16384
    v_mfma_f32_16x16x32_bf16 v[140:143], a[84:87], a[20:23], v[140:143]
    v_exp_f32 v153, v153
    v_mfma_f32_16x16x32_bf16 v[140:143], a[88:91], a[24:27], v[140:143]
    ds_read_b64_tr_b16 a[110:111], v191 offset:20480
    v_cvt_pk_bf16_f32 v172, v152, v153
    v_mfma_f32_16x16x32_bf16 v[140:143], a[92:95], a[28:31], v[140:143]
    v_exp_f32 v154, v154
    v_mfma_f32_16x16x32_bf16 v[176:179], v[242:245], v[160:163], v[176:179]
    ds_read_b64_tr_b16 a[112:113], v192 offset:16384
    v_mfma_f32_16x16x32_bf16 v[184:187], v[242:245], v[164:167], v[184:187]
    ds_read_b64_tr_b16 a[114:115], v192 offset:20480
    s_waitcnt lgkmcnt(6)
    v_mfma_f32_16x16x32_bf16 v[0:3], a[96:99], v[160:163], v[0:3]
    v_exp_f32 v155, v155
    v_mfma_f32_16x16x32_bf16 v[32:35], a[96:99], v[164:167], v[32:35]
    ds_read_b64_tr_b16 a[116:117], v193 offset:16384
    v_cvt_pk_bf16_f32 v173, v154, v155
    v_mfma_f32_16x16x32_bf16 v[4:7], a[100:103], v[160:163], v[4:7]
    ds_read_b64_tr_b16 a[118:119], v193 offset:20480
    v_mfma_f32_16x16x32_bf16 v[36:39], a[100:103], v[164:167], v[36:39]
    s_waitcnt lgkmcnt(4)
    v_mfma_f32_16x16x32_bf16 v[8:11], a[104:107], v[160:163], v[8:11]
    ds_read_b64_tr_b16 a[120:121], v194 offset:16384
    v_mfma_f32_16x16x32_bf16 v[40:43], a[104:107], v[164:167], v[40:43]
    ds_read_b64_tr_b16 a[122:123], v194 offset:20480
    v_mfma_f32_16x16x32_bf16 v[12:15], a[108:111], v[160:163], v[12:15]
    v_exp_f32 v156, v156
    v_mfma_f32_16x16x32_bf16 v[44:47], a[108:111], v[164:167], v[44:47]
    ds_read_b64_tr_b16 a[124:125], v195 offset:16384
    s_waitcnt lgkmcnt(3)
    v_mfma_f32_16x16x32_bf16 v[16:19], a[112:115], v[160:163], v[16:19]
    ds_read_b64_tr_b16 a[126:127], v195 offset:20480
    v_mfma_f32_16x16x32_bf16 v[48:51], a[112:115], v[164:167], v[48:51]
    v_exp_f32 v157, v157
    v_mfma_f32_16x16x32_bf16 v[20:23], a[116:119], v[160:163], v[20:23]
    buffer_load_dwordx4 v201, s[20:23], s29 offen offset:1024 nt lds
    v_cvt_pk_bf16_f32 v174, v156, v157
    v_mfma_f32_16x16x32_bf16 v[52:55], a[116:119], v[164:167], v[52:55]
    s_waitcnt lgkmcnt(0)
    v_mfma_f32_16x16x32_bf16 v[24:27], a[120:123], v[160:163], v[24:27]
    v_exp_f32 v158, v158
    v_mfma_f32_16x16x32_bf16 v[56:59], a[120:123], v[164:167], v[56:59]
    v_exp_f32 v159, v159
    v_mfma_f32_16x16x32_bf16 v[28:31], a[124:127], v[160:163], v[28:31]
    v_cvt_pk_bf16_f32 v175, v158, v159
    v_mfma_f32_16x16x32_bf16 v[60:63], a[124:127], v[164:167], v[60:63]
    v_mfma_f32_16x16x32_bf16 v[144:147], a[64:67], a[32:35], 0
    v_exp_f32 v128, v128
    s_waitcnt vmcnt(19)
    v_accvgpr_read_b32 v234, a216
    v_mfma_f32_16x16x32_bf16 v[144:147], a[68:71], a[36:39], v[144:147]
    v_exp_f32 v129, v129
    v_mfma_f32_16x16x32_bf16 v[144:147], a[72:75], a[40:43], v[144:147]
    v_exp_f32 v130, v130
    v_accvgpr_read_b32 v235, a217
    v_mfma_f32_16x16x32_bf16 v[144:147], a[76:79], a[44:47], v[144:147]
    v_exp_f32 v131, v131
    v_accvgpr_read_b32 v236, a218
    v_mfma_f32_16x16x32_bf16 v[152:155], a[64:67], a[48:51], 0
    s_add_u32 s38, s51, 8192
    buffer_load_dwordx4 a[232:235], v198, s[12:15], s38 offen offset:2048 nt
    v_cvt_pk_bf16_f32 v160, v128, v129
    v_accvgpr_read_b32 v237, a219
    v_mfma_f32_16x16x32_bf16 v[152:155], a[68:71], a[52:55], v[152:155]
    v_exp_f32 v132, v132
    v_mfma_f32_16x16x32_bf16 v[152:155], a[72:75], a[56:59], v[152:155]
    ds_read_b128 a[64:67], v180 offset:32768
    v_cvt_pk_bf16_f32 v161, v130, v131
    v_lshlrev_b32 v226, 16, v234
    v_mfma_f32_16x16x32_bf16 v[152:155], a[76:79], a[60:63], v[152:155]
    v_exp_f32 v133, v133
    v_and_b32 v227, s37, v234
    v_mfma_f32_16x16x32_bf16 v[148:151], a[80:83], a[32:35], 0
    ds_read_b128 a[68:71], v181 offset:32768
    v_cvt_pk_bf16_f32 v162, v132, v133
    v_lshlrev_b32 v228, 16, v235
    v_mfma_f32_16x16x32_bf16 v[148:151], a[84:87], a[36:39], v[148:151]
    v_exp_f32 v134, v134
    v_mfma_f32_16x16x32_bf16 v[148:151], a[88:91], a[40:43], v[148:151]
    ds_read_b128 a[72:75], v182 offset:32768
    v_and_b32 v229, s37, v235
    v_mfma_f32_16x16x32_bf16 v[148:151], a[92:95], a[44:47], v[148:151]
    v_exp_f32 v135, v135
    v_lshlrev_b32 v230, 16, v236
    v_mfma_f32_16x16x32_bf16 v[156:159], a[80:83], a[48:51], 0
    ds_read_b128 a[76:79], v183 offset:32768
    v_cvt_pk_bf16_f32 v163, v134, v135
    v_and_b32 v231, s37, v236
    v_mfma_f32_16x16x32_bf16 v[156:159], a[84:87], a[52:55], v[156:159]
    v_exp_f32 v136, v136
    v_mfma_f32_16x16x32_bf16 v[156:159], a[88:91], a[56:59], v[156:159]
    ds_read_b128 a[80:83], v180 offset:36864
    v_lshlrev_b32 v232, 16, v237
    v_mfma_f32_16x16x32_bf16 v[156:159], a[92:95], a[60:63], v[156:159]
    v_exp_f32 v137, v137
    v_and_b32 v233, s37, v237
    v_mfma_f32_16x16x32_bf16 v[222:225], v[242:245], v[168:171], v[222:225]
    ds_read_b128 a[84:87], v181 offset:36864
    v_cvt_pk_bf16_f32 v164, v136, v137
    v_mfma_f32_16x16x32_bf16 v[246:249], v[242:245], v[172:175], v[246:249]
    v_exp_f32 v138, v138
    v_mul_f32 v226, s34, v226
    v_mfma_f32_16x16x32_bf16 v[64:67], a[96:99], v[168:171], v[64:67]
    ds_read_b128 a[88:91], v182 offset:36864
    v_mul_f32 v227, s34, v227
    v_mfma_f32_16x16x32_bf16 v[96:99], a[96:99], v[172:175], v[96:99]
    v_exp_f32 v139, v139
    v_mul_f32 v228, s34, v228
    v_mfma_f32_16x16x32_bf16 v[68:71], a[100:103], v[168:171], v[68:71]
    ds_read_b128 a[92:95], v183 offset:36864
    v_cvt_pk_bf16_f32 v165, v138, v139
    v_mfma_f32_16x16x32_bf16 v[100:103], a[100:103], v[172:175], v[100:103]
    buffer_load_dwordx4 v200, s[20:23], s29 offen offset:2048 nt lds
    v_mul_f32 v229, s34, v229
    v_mfma_f32_16x16x32_bf16 v[72:75], a[104:107], v[168:171], v[72:75]
    v_exp_f32 v140, v140
    v_mul_f32 v230, s34, v230
    v_mfma_f32_16x16x32_bf16 v[104:107], a[104:107], v[172:175], v[104:107]
    v_exp_f32 v141, v141
    v_mul_f32 v231, s34, v231
    v_mfma_f32_16x16x32_bf16 v[76:79], a[108:111], v[168:171], v[76:79]
    v_exp_f32 v142, v142
    v_mfma_f32_16x16x32_bf16 v[108:111], a[108:111], v[172:175], v[108:111]
    v_exp_f32 v143, v143
    v_mul_f32 v232, s34, v232
    v_mfma_f32_16x16x32_bf16 v[80:83], a[112:115], v[168:171], v[80:83]
    v_cvt_pk_bf16_f32 v166, v140, v141
    v_cvt_pk_bf16_f32 v167, v142, v143
    v_mul_f32 v233, s34, v233
    v_mfma_f32_16x16x32_bf16 v[112:115], a[112:115], v[172:175], v[112:115]
    v_cvt_pk_bf16_f32 v238, v226, v227
    v_mfma_f32_16x16x32_bf16 v[84:87], a[116:119], v[168:171], v[84:87]
    v_mfma_f32_16x16x32_bf16 v[116:119], a[116:119], v[172:175], v[116:119]
    buffer_load_dwordx4 v201, s[20:23], s29 offen offset:3072 nt lds
    s_add_u32 s29, s29, 16384
    v_cvt_pk_bf16_f32 v239, v228, v229
    v_mfma_f32_16x16x32_bf16 v[88:91], a[120:123], v[168:171], v[88:91]
    v_cvt_pk_bf16_f32 v240, v230, v231
    v_mfma_f32_16x16x32_bf16 v[120:123], a[120:123], v[172:175], v[120:123]
    v_cvt_pk_bf16_f32 v241, v232, v233
    v_mfma_f32_16x16x32_bf16 v[92:95], a[124:127], v[168:171], v[92:95]
    v_mfma_f32_16x16x32_bf16 v[124:127], a[124:127], v[172:175], v[124:127]
    ds_write_b128 v205, v[238:241] offset:6144
    s_waitcnt lgkmcnt(1)
    v_mfma_f32_16x16x32_bf16 v[128:131], a[64:67], a[0:3], 0
    ds_read_b64_tr_b16 a[96:97], v188 offset:24576
    v_exp_f32 v144, v144
    v_mfma_f32_16x16x32_bf16 v[128:131], a[68:71], a[4:7], v[128:131]
    v_exp_f32 v145, v145
    v_mfma_f32_16x16x32_bf16 v[128:131], a[72:75], a[8:11], v[128:131]
    ds_read_b64_tr_b16 a[98:99], v188 offset:28672
    v_exp_f32 v146, v146
    v_mfma_f32_16x16x32_bf16 v[128:131], a[76:79], a[12:15], v[128:131]
    v_exp_f32 v147, v147
    v_mfma_f32_16x16x32_bf16 v[136:139], a[64:67], a[16:19], 0
    ds_read_b64_tr_b16 a[100:101], v189 offset:24576
    v_exp_f32 v148, v148
    v_mfma_f32_16x16x32_bf16 v[136:139], a[68:71], a[20:23], v[136:139]
    v_exp_f32 v149, v149
    v_cvt_pk_bf16_f32 v168, v144, v145
    v_mfma_f32_16x16x32_bf16 v[136:139], a[72:75], a[24:27], v[136:139]
    ds_read_b64_tr_b16 a[102:103], v189 offset:28672
    v_exp_f32 v150, v150
    v_mfma_f32_16x16x32_bf16 v[136:139], a[76:79], a[28:31], v[136:139]
    v_exp_f32 v151, v151
    v_cvt_pk_bf16_f32 v169, v146, v147
    v_mfma_f32_16x16x32_bf16 v[132:135], a[80:83], a[0:3], 0
    ds_read_b64_tr_b16 a[104:105], v190 offset:24576
    v_cvt_pk_bf16_f32 v170, v148, v149
    v_mfma_f32_16x16x32_bf16 v[132:135], a[84:87], a[4:7], v[132:135]
    s_add_u32 m0, s30, 16384
    s_nop 0
    buffer_load_dwordx4 v196, s[16:19], s28 offen offset:0 nt lds
    v_mfma_f32_16x16x32_bf16 v[132:135], a[88:91], a[8:11], v[132:135]
    ds_read_b64_tr_b16 a[106:107], v190 offset:28672
    v_cvt_pk_bf16_f32 v171, v150, v151
    v_mfma_f32_16x16x32_bf16 v[132:135], a[92:95], a[12:15], v[132:135]
    v_exp_f32 v152, v152
    v_mfma_f32_16x16x32_bf16 v[140:143], a[80:83], a[16:19], 0
    ds_read_b64_tr_b16 a[108:109], v191 offset:24576
    v_mfma_f32_16x16x32_bf16 v[140:143], a[84:87], a[20:23], v[140:143]
    v_exp_f32 v153, v153
    v_mfma_f32_16x16x32_bf16 v[140:143], a[88:91], a[24:27], v[140:143]
    ds_read_b64_tr_b16 a[110:111], v191 offset:28672
    v_cvt_pk_bf16_f32 v172, v152, v153
    v_mfma_f32_16x16x32_bf16 v[140:143], a[92:95], a[28:31], v[140:143]
    v_exp_f32 v154, v154
    v_mfma_f32_16x16x32_bf16 v[176:179], v[242:245], v[160:163], v[176:179]
    ds_read_b64_tr_b16 a[112:113], v192 offset:24576
    v_mfma_f32_16x16x32_bf16 v[184:187], v[242:245], v[164:167], v[184:187]
    ds_read_b64_tr_b16 a[114:115], v192 offset:28672
    s_waitcnt lgkmcnt(6)
    v_mfma_f32_16x16x32_bf16 v[0:3], a[96:99], v[160:163], v[0:3]
    v_exp_f32 v155, v155
    v_mfma_f32_16x16x32_bf16 v[32:35], a[96:99], v[164:167], v[32:35]
    ds_read_b64_tr_b16 a[116:117], v193 offset:24576
    v_cvt_pk_bf16_f32 v173, v154, v155
    v_mfma_f32_16x16x32_bf16 v[4:7], a[100:103], v[160:163], v[4:7]
    ds_read_b64_tr_b16 a[118:119], v193 offset:28672
    v_mfma_f32_16x16x32_bf16 v[36:39], a[100:103], v[164:167], v[36:39]
    s_waitcnt lgkmcnt(4)
    v_mfma_f32_16x16x32_bf16 v[8:11], a[104:107], v[160:163], v[8:11]
    ds_read_b64_tr_b16 a[120:121], v194 offset:24576
    v_mfma_f32_16x16x32_bf16 v[40:43], a[104:107], v[164:167], v[40:43]
    ds_read_b64_tr_b16 a[122:123], v194 offset:28672
    v_mfma_f32_16x16x32_bf16 v[12:15], a[108:111], v[160:163], v[12:15]
    v_exp_f32 v156, v156
    v_mfma_f32_16x16x32_bf16 v[44:47], a[108:111], v[164:167], v[44:47]
    ds_read_b64_tr_b16 a[124:125], v195 offset:24576
    s_waitcnt lgkmcnt(3)
    v_mfma_f32_16x16x32_bf16 v[16:19], a[112:115], v[160:163], v[16:19]
    ds_read_b64_tr_b16 a[126:127], v195 offset:28672
    v_mfma_f32_16x16x32_bf16 v[48:51], a[112:115], v[164:167], v[48:51]
    v_exp_f32 v157, v157
    v_mfma_f32_16x16x32_bf16 v[20:23], a[116:119], v[160:163], v[20:23]
    buffer_load_dwordx4 v197, s[16:19], s28 offen offset:1024 nt lds
    v_cvt_pk_bf16_f32 v174, v156, v157
    v_mfma_f32_16x16x32_bf16 v[52:55], a[116:119], v[164:167], v[52:55]
    s_waitcnt lgkmcnt(0)
    v_mfma_f32_16x16x32_bf16 v[24:27], a[120:123], v[160:163], v[24:27]
    v_exp_f32 v158, v158
    v_mfma_f32_16x16x32_bf16 v[56:59], a[120:123], v[164:167], v[56:59]
    v_exp_f32 v159, v159
    v_mfma_f32_16x16x32_bf16 v[28:31], a[124:127], v[160:163], v[28:31]
    v_cvt_pk_bf16_f32 v175, v158, v159
    v_mfma_f32_16x16x32_bf16 v[60:63], a[124:127], v[164:167], v[60:63]
    v_mfma_f32_16x16x32_bf16 v[144:147], a[64:67], a[32:35], 0
    v_exp_f32 v128, v128
    s_waitcnt vmcnt(19)
    v_accvgpr_read_b32 v234, a220
    v_mfma_f32_16x16x32_bf16 v[144:147], a[68:71], a[36:39], v[144:147]
    v_exp_f32 v129, v129
    v_accvgpr_read_b32 v235, a221
    v_mfma_f32_16x16x32_bf16 v[144:147], a[72:75], a[40:43], v[144:147]
    v_exp_f32 v130, v130
    v_accvgpr_read_b32 v236, a222
    v_mfma_f32_16x16x32_bf16 v[144:147], a[76:79], a[44:47], v[144:147]
    v_exp_f32 v131, v131
    v_accvgpr_read_b32 v237, a223
    v_mfma_f32_16x16x32_bf16 v[152:155], a[64:67], a[48:51], 0
    s_add_u32 s38, s51, 8192
    buffer_load_dwordx4 a[236:239], v199, s[12:15], s38 offen offset:3072 nt
    v_cvt_pk_bf16_f32 v160, v128, v129
    v_lshlrev_b32 v226, 16, v234
    v_mfma_f32_16x16x32_bf16 v[152:155], a[68:71], a[52:55], v[152:155]
    v_exp_f32 v132, v132
    v_and_b32 v227, s37, v234
    v_mfma_f32_16x16x32_bf16 v[152:155], a[72:75], a[56:59], v[152:155]
    ds_read_b128 a[64:67], v180 offset:40960
    v_cvt_pk_bf16_f32 v161, v130, v131
    v_lshlrev_b32 v228, 16, v235
    v_mfma_f32_16x16x32_bf16 v[152:155], a[76:79], a[60:63], v[152:155]
    v_exp_f32 v133, v133
    v_and_b32 v229, s37, v235
    v_mfma_f32_16x16x32_bf16 v[148:151], a[80:83], a[32:35], 0
    ds_read_b128 a[68:71], v181 offset:40960
    v_cvt_pk_bf16_f32 v162, v132, v133
    v_lshlrev_b32 v230, 16, v236
    v_mfma_f32_16x16x32_bf16 v[148:151], a[84:87], a[36:39], v[148:151]
    v_exp_f32 v134, v134
    v_and_b32 v231, s37, v236
    v_mfma_f32_16x16x32_bf16 v[148:151], a[88:91], a[40:43], v[148:151]
    ds_read_b128 a[72:75], v182 offset:40960
    v_lshlrev_b32 v232, 16, v237
    v_mfma_f32_16x16x32_bf16 v[148:151], a[92:95], a[44:47], v[148:151]
    v_exp_f32 v135, v135
    v_and_b32 v233, s37, v237
    v_mfma_f32_16x16x32_bf16 v[156:159], a[80:83], a[48:51], 0
    ds_read_b128 a[76:79], v183 offset:40960
    v_cvt_pk_bf16_f32 v163, v134, v135
    v_mul_f32 v226, s34, v226
    v_mfma_f32_16x16x32_bf16 v[156:159], a[84:87], a[52:55], v[156:159]
    v_exp_f32 v136, v136
    v_mul_f32 v227, s34, v227
    v_mfma_f32_16x16x32_bf16 v[156:159], a[88:91], a[56:59], v[156:159]
    ds_read_b128 a[80:83], v180 offset:45056
    v_mul_f32 v228, s34, v228
    v_mfma_f32_16x16x32_bf16 v[156:159], a[92:95], a[60:63], v[156:159]
    v_exp_f32 v137, v137
    v_mul_f32 v229, s34, v229
    v_mfma_f32_16x16x32_bf16 v[222:225], v[242:245], v[168:171], v[222:225]
    ds_read_b128 a[84:87], v181 offset:45056
    v_cvt_pk_bf16_f32 v164, v136, v137
    v_mfma_f32_16x16x32_bf16 v[246:249], v[242:245], v[172:175], v[246:249]
    v_exp_f32 v138, v138
    v_mul_f32 v230, s34, v230
    v_mfma_f32_16x16x32_bf16 v[64:67], a[96:99], v[168:171], v[64:67]
    ds_read_b128 a[88:91], v182 offset:45056
    v_mul_f32 v231, s34, v231
    v_mfma_f32_16x16x32_bf16 v[96:99], a[96:99], v[172:175], v[96:99]
    v_exp_f32 v139, v139
    v_mul_f32 v232, s34, v232
    v_mfma_f32_16x16x32_bf16 v[68:71], a[100:103], v[168:171], v[68:71]
    ds_read_b128 a[92:95], v183 offset:45056
    v_cvt_pk_bf16_f32 v165, v138, v139
    v_mul_f32 v233, s34, v233
    v_mfma_f32_16x16x32_bf16 v[100:103], a[100:103], v[172:175], v[100:103]
    buffer_load_dwordx4 v198, s[16:19], s28 offen offset:2048 nt lds
    v_cvt_pk_bf16_f32 v238, v226, v227
    v_mfma_f32_16x16x32_bf16 v[72:75], a[104:107], v[168:171], v[72:75]
    v_exp_f32 v140, v140
    v_cvt_pk_bf16_f32 v239, v228, v229
    v_mfma_f32_16x16x32_bf16 v[104:107], a[104:107], v[172:175], v[104:107]
    v_exp_f32 v141, v141
    v_cvt_pk_bf16_f32 v240, v230, v231
    v_mfma_f32_16x16x32_bf16 v[76:79], a[108:111], v[168:171], v[76:79]
    v_exp_f32 v142, v142
    v_cvt_pk_bf16_f32 v241, v232, v233
    v_mfma_f32_16x16x32_bf16 v[108:111], a[108:111], v[172:175], v[108:111]
    ds_write_b128 v205, v[238:241] offset:7168
    v_exp_f32 v143, v143
    v_mfma_f32_16x16x32_bf16 v[80:83], a[112:115], v[168:171], v[80:83]
    ds_read_b128 a[128:131], v214 offset:0
    v_cvt_pk_bf16_f32 v166, v140, v141
    v_cvt_pk_bf16_f32 v167, v142, v143
    v_mfma_f32_16x16x32_bf16 v[112:115], a[112:115], v[172:175], v[112:115]
    ds_read_b128 a[132:135], v215 offset:0
    v_mfma_f32_16x16x32_bf16 v[84:87], a[116:119], v[168:171], v[84:87]
    ds_read_b128 a[136:139], v216 offset:0
    v_mfma_f32_16x16x32_bf16 v[116:119], a[116:119], v[172:175], v[116:119]
    buffer_load_dwordx4 v199, s[16:19], s28 offen offset:3072 nt lds
    s_add_u32 s28, s28, 16384
    ds_read_b128 a[140:143], v217 offset:0
    v_mfma_f32_16x16x32_bf16 v[88:91], a[120:123], v[168:171], v[88:91]
    ds_read_b128 a[144:147], v214 offset:4096
    v_mfma_f32_16x16x32_bf16 v[120:123], a[120:123], v[172:175], v[120:123]
    ds_read_b128 a[148:151], v215 offset:4096
    v_mfma_f32_16x16x32_bf16 v[92:95], a[124:127], v[168:171], v[92:95]
    ds_read_b128 a[152:155], v216 offset:4096
    v_mfma_f32_16x16x32_bf16 v[124:127], a[124:127], v[172:175], v[124:127]
    ds_read_b128 a[156:159], v217 offset:4096
    s_waitcnt lgkmcnt(9)
    v_mfma_f32_16x16x32_bf16 v[128:131], a[64:67], a[0:3], 0
    s_waitcnt vmcnt(20)
    s_barrier
    ds_read_b64_tr_b16 a[96:97], v188 offset:32768
    v_mfma_f32_16x16x32_bf16 v[128:131], a[68:71], a[4:7], v[128:131]
    v_exp_f32 v144, v144
    v_mfma_f32_16x16x32_bf16 v[128:131], a[72:75], a[8:11], v[128:131]
    ds_read_b64_tr_b16 a[98:99], v188 offset:36864
    v_exp_f32 v145, v145
    v_mfma_f32_16x16x32_bf16 v[128:131], a[76:79], a[12:15], v[128:131]
    v_exp_f32 v146, v146
    v_mfma_f32_16x16x32_bf16 v[136:139], a[64:67], a[16:19], 0
    ds_read_b64_tr_b16 a[100:101], v189 offset:32768
    v_exp_f32 v147, v147
    v_mfma_f32_16x16x32_bf16 v[136:139], a[68:71], a[20:23], v[136:139]
    v_exp_f32 v148, v148
    v_cvt_pk_bf16_f32 v168, v144, v145
    v_mfma_f32_16x16x32_bf16 v[136:139], a[72:75], a[24:27], v[136:139]
    ds_read_b64_tr_b16 a[102:103], v189 offset:36864
    v_exp_f32 v149, v149
    v_mfma_f32_16x16x32_bf16 v[136:139], a[76:79], a[28:31], v[136:139]
    v_exp_f32 v150, v150
    v_cvt_pk_bf16_f32 v169, v146, v147
    v_mfma_f32_16x16x32_bf16 v[132:135], a[80:83], a[0:3], 0
    ds_read_b64_tr_b16 a[104:105], v190 offset:32768
    v_exp_f32 v151, v151
    v_mfma_f32_16x16x32_bf16 v[132:135], a[84:87], a[4:7], v[132:135]
    s_add_u32 m0, s30, 81920
    s_nop 0
    buffer_load_dwordx4 v200, s[20:23], s29 offen offset:0 nt lds
    v_mfma_f32_16x16x32_bf16 v[132:135], a[88:91], a[8:11], v[132:135]
    ds_read_b64_tr_b16 a[106:107], v190 offset:36864
    v_cvt_pk_bf16_f32 v170, v148, v149
    v_mfma_f32_16x16x32_bf16 v[132:135], a[92:95], a[12:15], v[132:135]
    v_exp_f32 v152, v152
    v_cvt_pk_bf16_f32 v171, v150, v151
    v_mfma_f32_16x16x32_bf16 v[140:143], a[80:83], a[16:19], 0
    ds_read_b64_tr_b16 a[108:109], v191 offset:32768
    v_mfma_f32_16x16x32_bf16 v[140:143], a[84:87], a[20:23], v[140:143]
    v_exp_f32 v153, v153
    v_mfma_f32_16x16x32_bf16 v[140:143], a[88:91], a[24:27], v[140:143]
    ds_read_b64_tr_b16 a[110:111], v191 offset:36864
    v_cvt_pk_bf16_f32 v172, v152, v153
    v_mfma_f32_16x16x32_bf16 v[140:143], a[92:95], a[28:31], v[140:143]
    v_exp_f32 v154, v154
    v_mfma_f32_16x16x32_bf16 v[176:179], v[242:245], v[160:163], v[176:179]
    ds_read_b64_tr_b16 a[112:113], v192 offset:32768
    v_mfma_f32_16x16x32_bf16 v[184:187], v[242:245], v[164:167], v[184:187]
    ds_read_b64_tr_b16 a[114:115], v192 offset:36864
    s_waitcnt lgkmcnt(6)
    v_mfma_f32_16x16x32_bf16 v[0:3], a[96:99], v[160:163], v[0:3]
    v_exp_f32 v155, v155
    v_mfma_f32_16x16x32_bf16 v[32:35], a[96:99], v[164:167], v[32:35]
    ds_read_b64_tr_b16 a[116:117], v193 offset:32768
    v_cvt_pk_bf16_f32 v173, v154, v155
    v_mfma_f32_16x16x32_bf16 v[4:7], a[100:103], v[160:163], v[4:7]
    ds_read_b64_tr_b16 a[118:119], v193 offset:36864
    v_mfma_f32_16x16x32_bf16 v[36:39], a[100:103], v[164:167], v[36:39]
    s_waitcnt lgkmcnt(4)
    v_mfma_f32_16x16x32_bf16 v[8:11], a[104:107], v[160:163], v[8:11]
    ds_read_b64_tr_b16 a[120:121], v194 offset:32768
    v_mfma_f32_16x16x32_bf16 v[40:43], a[104:107], v[164:167], v[40:43]
    ds_read_b64_tr_b16 a[122:123], v194 offset:36864
    v_mfma_f32_16x16x32_bf16 v[12:15], a[108:111], v[160:163], v[12:15]
    v_exp_f32 v156, v156
    v_mfma_f32_16x16x32_bf16 v[44:47], a[108:111], v[164:167], v[44:47]
    ds_read_b64_tr_b16 a[124:125], v195 offset:32768
    s_waitcnt lgkmcnt(3)
    v_mfma_f32_16x16x32_bf16 v[16:19], a[112:115], v[160:163], v[16:19]
    ds_read_b64_tr_b16 a[126:127], v195 offset:36864
    v_mfma_f32_16x16x32_bf16 v[48:51], a[112:115], v[164:167], v[48:51]
    v_exp_f32 v157, v157
    v_mfma_f32_16x16x32_bf16 v[20:23], a[116:119], v[160:163], v[20:23]
    buffer_load_dwordx4 v201, s[20:23], s29 offen offset:1024 nt lds
    v_cvt_pk_bf16_f32 v174, v156, v157
    v_mfma_f32_16x16x32_bf16 v[52:55], a[116:119], v[164:167], v[52:55]
    s_waitcnt lgkmcnt(0)
    v_mfma_f32_16x16x32_bf16 v[24:27], a[120:123], v[160:163], v[24:27]
    v_exp_f32 v158, v158
    v_mfma_f32_16x16x32_bf16 v[56:59], a[120:123], v[164:167], v[56:59]
    v_exp_f32 v159, v159
    v_mfma_f32_16x16x32_bf16 v[28:31], a[124:127], v[160:163], v[28:31]
    v_cvt_pk_bf16_f32 v175, v158, v159
    v_mfma_f32_16x16x32_bf16 v[60:63], a[124:127], v[164:167], v[60:63]
    v_mfma_f32_16x16x32_bf16 v[144:147], a[64:67], a[32:35], 0
    v_exp_f32 v128, v128
    s_waitcnt vmcnt(19)
    v_accvgpr_read_b32 v234, a224
    v_mfma_f32_16x16x32_bf16 v[144:147], a[68:71], a[36:39], v[144:147]
    v_exp_f32 v129, v129
    v_mfma_f32_16x16x32_bf16 v[144:147], a[72:75], a[40:43], v[144:147]
    v_exp_f32 v130, v130
    v_accvgpr_read_b32 v235, a225
    v_mfma_f32_16x16x32_bf16 v[144:147], a[76:79], a[44:47], v[144:147]
    v_exp_f32 v131, v131
    v_accvgpr_read_b32 v236, a226
    v_mfma_f32_16x16x32_bf16 v[152:155], a[64:67], a[48:51], 0
    s_add_u32 s38, s51, 12288
    buffer_load_dwordx4 a[240:243], v196, s[12:15], s38 offen offset:0 nt
    v_cvt_pk_bf16_f32 v160, v128, v129
    v_accvgpr_read_b32 v237, a227
    v_mfma_f32_16x16x32_bf16 v[152:155], a[68:71], a[52:55], v[152:155]
    v_exp_f32 v132, v132
    v_mfma_f32_16x16x32_bf16 v[152:155], a[72:75], a[56:59], v[152:155]
    ds_read_b128 a[64:67], v180 offset:49152
    v_cvt_pk_bf16_f32 v161, v130, v131
    v_lshlrev_b32 v226, 16, v234
    v_mfma_f32_16x16x32_bf16 v[152:155], a[76:79], a[60:63], v[152:155]
    v_exp_f32 v133, v133
    v_and_b32 v227, s37, v234
    v_mfma_f32_16x16x32_bf16 v[148:151], a[80:83], a[32:35], 0
    ds_read_b128 a[68:71], v181 offset:49152
    v_cvt_pk_bf16_f32 v162, v132, v133
    v_lshlrev_b32 v228, 16, v235
    v_mfma_f32_16x16x32_bf16 v[148:151], a[84:87], a[36:39], v[148:151]
    v_exp_f32 v134, v134
    v_mfma_f32_16x16x32_bf16 v[148:151], a[88:91], a[40:43], v[148:151]
    ds_read_b128 a[72:75], v182 offset:49152
    v_and_b32 v229, s37, v235
    v_mfma_f32_16x16x32_bf16 v[148:151], a[92:95], a[44:47], v[148:151]
    v_exp_f32 v135, v135
    v_lshlrev_b32 v230, 16, v236
    v_mfma_f32_16x16x32_bf16 v[156:159], a[80:83], a[48:51], 0
    ds_read_b128 a[76:79], v183 offset:49152
    v_cvt_pk_bf16_f32 v163, v134, v135
    v_and_b32 v231, s37, v236
    v_mfma_f32_16x16x32_bf16 v[156:159], a[84:87], a[52:55], v[156:159]
    v_exp_f32 v136, v136
    v_mfma_f32_16x16x32_bf16 v[156:159], a[88:91], a[56:59], v[156:159]
    ds_read_b128 a[80:83], v180 offset:53248
    v_lshlrev_b32 v232, 16, v237
    v_mfma_f32_16x16x32_bf16 v[156:159], a[92:95], a[60:63], v[156:159]
    v_exp_f32 v137, v137
    v_and_b32 v233, s37, v237
    v_mfma_f32_16x16x32_bf16 v[222:225], v[242:245], v[168:171], v[222:225]
    ds_read_b128 a[84:87], v181 offset:53248
    v_cvt_pk_bf16_f32 v164, v136, v137
    v_mfma_f32_16x16x32_bf16 v[246:249], v[242:245], v[172:175], v[246:249]
    v_exp_f32 v138, v138
    v_mul_f32 v226, s34, v226
    v_mfma_f32_16x16x32_bf16 v[64:67], a[96:99], v[168:171], v[64:67]
    ds_read_b128 a[88:91], v182 offset:53248
    v_mul_f32 v227, s34, v227
    v_mfma_f32_16x16x32_bf16 v[96:99], a[96:99], v[172:175], v[96:99]
    v_exp_f32 v139, v139
    v_mul_f32 v228, s34, v228
    v_mfma_f32_16x16x32_bf16 v[68:71], a[100:103], v[168:171], v[68:71]
    ds_read_b128 a[92:95], v183 offset:53248
    v_cvt_pk_bf16_f32 v165, v138, v139
    v_mfma_f32_16x16x32_bf16 v[100:103], a[100:103], v[172:175], v[100:103]
    buffer_load_dwordx4 v200, s[20:23], s29 offen offset:2048 nt lds
    v_mul_f32 v229, s34, v229
    v_mfma_f32_16x16x32_bf16 v[72:75], a[104:107], v[168:171], v[72:75]
    v_exp_f32 v140, v140
    v_mul_f32 v230, s34, v230
    v_mfma_f32_16x16x32_bf16 v[104:107], a[104:107], v[172:175], v[104:107]
    v_exp_f32 v141, v141
    v_mul_f32 v231, s34, v231
    v_mfma_f32_16x16x32_bf16 v[76:79], a[108:111], v[168:171], v[76:79]
    v_exp_f32 v142, v142
    v_mfma_f32_16x16x32_bf16 v[108:111], a[108:111], v[172:175], v[108:111]
    v_exp_f32 v143, v143
    v_mul_f32 v232, s34, v232
    v_mfma_f32_16x16x32_bf16 v[80:83], a[112:115], v[168:171], v[80:83]
    v_cvt_pk_bf16_f32 v166, v140, v141
    v_cvt_pk_bf16_f32 v167, v142, v143
    v_mul_f32 v233, s34, v233
    v_mfma_f32_16x16x32_bf16 v[112:115], a[112:115], v[172:175], v[112:115]
    v_cvt_pk_bf16_f32 v238, v226, v227
    v_mfma_f32_16x16x32_bf16 v[84:87], a[116:119], v[168:171], v[84:87]
    v_mfma_f32_16x16x32_bf16 v[116:119], a[116:119], v[172:175], v[116:119]
    buffer_load_dwordx4 v201, s[20:23], s29 offen offset:3072 nt lds
    s_add_u32 s29, s29, 16384
    v_cvt_pk_bf16_f32 v239, v228, v229
    v_mfma_f32_16x16x32_bf16 v[88:91], a[120:123], v[168:171], v[88:91]
    v_cvt_pk_bf16_f32 v240, v230, v231
    v_mfma_f32_16x16x32_bf16 v[120:123], a[120:123], v[172:175], v[120:123]
    v_cvt_pk_bf16_f32 v241, v232, v233
    v_mfma_f32_16x16x32_bf16 v[92:95], a[124:127], v[168:171], v[92:95]
    v_mfma_f32_16x16x32_bf16 v[124:127], a[124:127], v[172:175], v[124:127]
    ds_write_b128 v205, v[238:241] offset:0
    s_waitcnt lgkmcnt(1)
    v_mfma_f32_16x16x32_bf16 v[128:131], a[64:67], a[0:3], 0
    ds_read_b64_tr_b16 a[96:97], v188 offset:40960
    v_exp_f32 v144, v144
    v_mfma_f32_16x16x32_bf16 v[128:131], a[68:71], a[4:7], v[128:131]
    v_exp_f32 v145, v145
    v_mfma_f32_16x16x32_bf16 v[128:131], a[72:75], a[8:11], v[128:131]
    ds_read_b64_tr_b16 a[98:99], v188 offset:45056
    v_exp_f32 v146, v146
    v_mfma_f32_16x16x32_bf16 v[128:131], a[76:79], a[12:15], v[128:131]
    v_exp_f32 v147, v147
    v_mfma_f32_16x16x32_bf16 v[136:139], a[64:67], a[16:19], 0
    ds_read_b64_tr_b16 a[100:101], v189 offset:40960
    v_exp_f32 v148, v148
    v_mfma_f32_16x16x32_bf16 v[136:139], a[68:71], a[20:23], v[136:139]
    v_exp_f32 v149, v149
    v_cvt_pk_bf16_f32 v168, v144, v145
    v_mfma_f32_16x16x32_bf16 v[136:139], a[72:75], a[24:27], v[136:139]
    ds_read_b64_tr_b16 a[102:103], v189 offset:45056
    v_exp_f32 v150, v150
    v_mfma_f32_16x16x32_bf16 v[136:139], a[76:79], a[28:31], v[136:139]
    v_exp_f32 v151, v151
    v_cvt_pk_bf16_f32 v169, v146, v147
    v_mfma_f32_16x16x32_bf16 v[132:135], a[80:83], a[0:3], 0
    ds_read_b64_tr_b16 a[104:105], v190 offset:40960
    v_cvt_pk_bf16_f32 v170, v148, v149
    v_mfma_f32_16x16x32_bf16 v[132:135], a[84:87], a[4:7], v[132:135]
    s_add_u32 m0, s30, 32768
    s_nop 0
    buffer_load_dwordx4 v196, s[16:19], s28 offen offset:0 nt lds
    v_mfma_f32_16x16x32_bf16 v[132:135], a[88:91], a[8:11], v[132:135]
    ds_read_b64_tr_b16 a[106:107], v190 offset:45056
    v_cvt_pk_bf16_f32 v171, v150, v151
    v_mfma_f32_16x16x32_bf16 v[132:135], a[92:95], a[12:15], v[132:135]
    v_exp_f32 v152, v152
    v_mfma_f32_16x16x32_bf16 v[140:143], a[80:83], a[16:19], 0
    ds_read_b64_tr_b16 a[108:109], v191 offset:40960
    v_mfma_f32_16x16x32_bf16 v[140:143], a[84:87], a[20:23], v[140:143]
    v_exp_f32 v153, v153
    v_mfma_f32_16x16x32_bf16 v[140:143], a[88:91], a[24:27], v[140:143]
    ds_read_b64_tr_b16 a[110:111], v191 offset:45056
    v_cvt_pk_bf16_f32 v172, v152, v153
    v_mfma_f32_16x16x32_bf16 v[140:143], a[92:95], a[28:31], v[140:143]
    v_exp_f32 v154, v154
    v_mfma_f32_16x16x32_bf16 v[176:179], v[242:245], v[160:163], v[176:179]
    ds_read_b64_tr_b16 a[112:113], v192 offset:40960
    v_mfma_f32_16x16x32_bf16 v[184:187], v[242:245], v[164:167], v[184:187]
    ds_read_b64_tr_b16 a[114:115], v192 offset:45056
    s_waitcnt lgkmcnt(6)
    v_mfma_f32_16x16x32_bf16 v[0:3], a[96:99], v[160:163], v[0:3]
    v_exp_f32 v155, v155
    v_mfma_f32_16x16x32_bf16 v[32:35], a[96:99], v[164:167], v[32:35]
    ds_read_b64_tr_b16 a[116:117], v193 offset:40960
    v_cvt_pk_bf16_f32 v173, v154, v155
    v_mfma_f32_16x16x32_bf16 v[4:7], a[100:103], v[160:163], v[4:7]
    ds_read_b64_tr_b16 a[118:119], v193 offset:45056
    v_mfma_f32_16x16x32_bf16 v[36:39], a[100:103], v[164:167], v[36:39]
    s_waitcnt lgkmcnt(4)
    v_mfma_f32_16x16x32_bf16 v[8:11], a[104:107], v[160:163], v[8:11]
    ds_read_b64_tr_b16 a[120:121], v194 offset:40960
    v_mfma_f32_16x16x32_bf16 v[40:43], a[104:107], v[164:167], v[40:43]
    ds_read_b64_tr_b16 a[122:123], v194 offset:45056
    v_mfma_f32_16x16x32_bf16 v[12:15], a[108:111], v[160:163], v[12:15]
    v_exp_f32 v156, v156
    v_mfma_f32_16x16x32_bf16 v[44:47], a[108:111], v[164:167], v[44:47]
    ds_read_b64_tr_b16 a[124:125], v195 offset:40960
    s_waitcnt lgkmcnt(3)
    v_mfma_f32_16x16x32_bf16 v[16:19], a[112:115], v[160:163], v[16:19]
    ds_read_b64_tr_b16 a[126:127], v195 offset:45056
    v_mfma_f32_16x16x32_bf16 v[48:51], a[112:115], v[164:167], v[48:51]
    v_exp_f32 v157, v157
    v_mfma_f32_16x16x32_bf16 v[20:23], a[116:119], v[160:163], v[20:23]
    buffer_load_dwordx4 v197, s[16:19], s28 offen offset:1024 nt lds
    v_cvt_pk_bf16_f32 v174, v156, v157
    v_mfma_f32_16x16x32_bf16 v[52:55], a[116:119], v[164:167], v[52:55]
    s_waitcnt lgkmcnt(0)
    v_mfma_f32_16x16x32_bf16 v[24:27], a[120:123], v[160:163], v[24:27]
    v_exp_f32 v158, v158
    v_mfma_f32_16x16x32_bf16 v[56:59], a[120:123], v[164:167], v[56:59]
    v_exp_f32 v159, v159
    v_mfma_f32_16x16x32_bf16 v[28:31], a[124:127], v[160:163], v[28:31]
    v_cvt_pk_bf16_f32 v175, v158, v159
    v_mfma_f32_16x16x32_bf16 v[60:63], a[124:127], v[164:167], v[60:63]
    v_mfma_f32_16x16x32_bf16 v[144:147], a[64:67], a[32:35], 0
    v_exp_f32 v128, v128
    s_waitcnt vmcnt(19)
    v_accvgpr_read_b32 v234, a228
    v_mfma_f32_16x16x32_bf16 v[144:147], a[68:71], a[36:39], v[144:147]
    v_exp_f32 v129, v129
    v_mfma_f32_16x16x32_bf16 v[144:147], a[72:75], a[40:43], v[144:147]
    v_exp_f32 v130, v130
    v_accvgpr_read_b32 v235, a229
    v_mfma_f32_16x16x32_bf16 v[144:147], a[76:79], a[44:47], v[144:147]
    v_exp_f32 v131, v131
    v_accvgpr_read_b32 v236, a230
    v_mfma_f32_16x16x32_bf16 v[152:155], a[64:67], a[48:51], 0
    s_add_u32 s38, s51, 12288
    buffer_load_dwordx4 a[244:247], v197, s[12:15], s38 offen offset:1024 nt
    v_cvt_pk_bf16_f32 v160, v128, v129
    v_accvgpr_read_b32 v237, a231
    v_mfma_f32_16x16x32_bf16 v[152:155], a[68:71], a[52:55], v[152:155]
    v_exp_f32 v132, v132
    v_mfma_f32_16x16x32_bf16 v[152:155], a[72:75], a[56:59], v[152:155]
    ds_read_b128 a[64:67], v180 offset:57344
    v_cvt_pk_bf16_f32 v161, v130, v131
    v_lshlrev_b32 v226, 16, v234
    v_mfma_f32_16x16x32_bf16 v[152:155], a[76:79], a[60:63], v[152:155]
    v_exp_f32 v133, v133
    v_and_b32 v227, s37, v234
    v_mfma_f32_16x16x32_bf16 v[148:151], a[80:83], a[32:35], 0
    ds_read_b128 a[68:71], v181 offset:57344
    v_cvt_pk_bf16_f32 v162, v132, v133
    v_lshlrev_b32 v228, 16, v235
    v_mfma_f32_16x16x32_bf16 v[148:151], a[84:87], a[36:39], v[148:151]
    v_exp_f32 v134, v134
    v_mfma_f32_16x16x32_bf16 v[148:151], a[88:91], a[40:43], v[148:151]
    ds_read_b128 a[72:75], v182 offset:57344
    v_and_b32 v229, s37, v235
    v_mfma_f32_16x16x32_bf16 v[148:151], a[92:95], a[44:47], v[148:151]
    v_exp_f32 v135, v135
    v_lshlrev_b32 v230, 16, v236
    v_mfma_f32_16x16x32_bf16 v[156:159], a[80:83], a[48:51], 0
    ds_read_b128 a[76:79], v183 offset:57344
    v_cvt_pk_bf16_f32 v163, v134, v135
    v_and_b32 v231, s37, v236
    v_mfma_f32_16x16x32_bf16 v[156:159], a[84:87], a[52:55], v[156:159]
    v_exp_f32 v136, v136
    v_mfma_f32_16x16x32_bf16 v[156:159], a[88:91], a[56:59], v[156:159]
    ds_read_b128 a[80:83], v180 offset:61440
    v_lshlrev_b32 v232, 16, v237
    v_mfma_f32_16x16x32_bf16 v[156:159], a[92:95], a[60:63], v[156:159]
    v_exp_f32 v137, v137
    v_and_b32 v233, s37, v237
    v_mfma_f32_16x16x32_bf16 v[222:225], v[242:245], v[168:171], v[222:225]
    ds_read_b128 a[84:87], v181 offset:61440
    v_cvt_pk_bf16_f32 v164, v136, v137
    v_mfma_f32_16x16x32_bf16 v[246:249], v[242:245], v[172:175], v[246:249]
    v_exp_f32 v138, v138
    v_mul_f32 v226, s34, v226
    v_mfma_f32_16x16x32_bf16 v[64:67], a[96:99], v[168:171], v[64:67]
    ds_read_b128 a[88:91], v182 offset:61440
    v_mul_f32 v227, s34, v227
    v_mfma_f32_16x16x32_bf16 v[96:99], a[96:99], v[172:175], v[96:99]
    v_exp_f32 v139, v139
    v_mul_f32 v228, s34, v228
    v_mfma_f32_16x16x32_bf16 v[68:71], a[100:103], v[168:171], v[68:71]
    ds_read_b128 a[92:95], v183 offset:61440
    v_cvt_pk_bf16_f32 v165, v138, v139
    v_mfma_f32_16x16x32_bf16 v[100:103], a[100:103], v[172:175], v[100:103]
    buffer_load_dwordx4 v198, s[16:19], s28 offen offset:2048 nt lds
    v_mul_f32 v229, s34, v229
    v_mfma_f32_16x16x32_bf16 v[72:75], a[104:107], v[168:171], v[72:75]
    v_exp_f32 v140, v140
    v_mul_f32 v230, s34, v230
    v_mfma_f32_16x16x32_bf16 v[104:107], a[104:107], v[172:175], v[104:107]
    v_exp_f32 v141, v141
    v_mul_f32 v231, s34, v231
    v_mfma_f32_16x16x32_bf16 v[76:79], a[108:111], v[168:171], v[76:79]
    v_exp_f32 v142, v142
    v_mfma_f32_16x16x32_bf16 v[108:111], a[108:111], v[172:175], v[108:111]
    v_exp_f32 v143, v143
    v_mul_f32 v232, s34, v232
    v_mfma_f32_16x16x32_bf16 v[80:83], a[112:115], v[168:171], v[80:83]
    v_cvt_pk_bf16_f32 v166, v140, v141
    v_cvt_pk_bf16_f32 v167, v142, v143
    v_mul_f32 v233, s34, v233
    v_mfma_f32_16x16x32_bf16 v[112:115], a[112:115], v[172:175], v[112:115]
    v_cvt_pk_bf16_f32 v238, v226, v227
    v_mfma_f32_16x16x32_bf16 v[84:87], a[116:119], v[168:171], v[84:87]
    v_mfma_f32_16x16x32_bf16 v[116:119], a[116:119], v[172:175], v[116:119]
    buffer_load_dwordx4 v199, s[16:19], s28 offen offset:3072 nt lds
    s_add_u32 s28, s28, 16384
    v_cvt_pk_bf16_f32 v239, v228, v229
    v_mfma_f32_16x16x32_bf16 v[88:91], a[120:123], v[168:171], v[88:91]
    v_cvt_pk_bf16_f32 v240, v230, v231
    v_mfma_f32_16x16x32_bf16 v[120:123], a[120:123], v[172:175], v[120:123]
    v_cvt_pk_bf16_f32 v241, v232, v233
    v_mfma_f32_16x16x32_bf16 v[92:95], a[124:127], v[168:171], v[92:95]
    v_mfma_f32_16x16x32_bf16 v[124:127], a[124:127], v[172:175], v[124:127]
    ds_write_b128 v205, v[238:241] offset:1024
    s_waitcnt lgkmcnt(1)
    v_mfma_f32_16x16x32_bf16 v[128:131], a[64:67], a[0:3], 0
    s_waitcnt vmcnt(20)
    s_barrier
    ds_read_b64_tr_b16 a[96:97], v188 offset:49152
    v_mfma_f32_16x16x32_bf16 v[128:131], a[68:71], a[4:7], v[128:131]
    v_exp_f32 v144, v144
    v_mfma_f32_16x16x32_bf16 v[128:131], a[72:75], a[8:11], v[128:131]
    ds_read_b64_tr_b16 a[98:99], v188 offset:53248
    v_exp_f32 v145, v145
    v_mfma_f32_16x16x32_bf16 v[128:131], a[76:79], a[12:15], v[128:131]
    v_exp_f32 v146, v146
    v_mfma_f32_16x16x32_bf16 v[136:139], a[64:67], a[16:19], 0
    ds_read_b64_tr_b16 a[100:101], v189 offset:49152
    v_exp_f32 v147, v147
    v_mfma_f32_16x16x32_bf16 v[136:139], a[68:71], a[20:23], v[136:139]
    v_exp_f32 v148, v148
    v_cvt_pk_bf16_f32 v168, v144, v145
    v_mfma_f32_16x16x32_bf16 v[136:139], a[72:75], a[24:27], v[136:139]
    ds_read_b64_tr_b16 a[102:103], v189 offset:53248
    v_exp_f32 v149, v149
    v_mfma_f32_16x16x32_bf16 v[136:139], a[76:79], a[28:31], v[136:139]
    v_exp_f32 v150, v150
    v_cvt_pk_bf16_f32 v169, v146, v147
    v_mfma_f32_16x16x32_bf16 v[132:135], a[80:83], a[0:3], 0
    ds_read_b64_tr_b16 a[104:105], v190 offset:49152
    v_exp_f32 v151, v151
    v_mfma_f32_16x16x32_bf16 v[132:135], a[84:87], a[4:7], v[132:135]
    s_add_u32 m0, s30, 98304
    s_nop 0
    buffer_load_dwordx4 v200, s[20:23], s29 offen offset:0 nt lds
    v_mfma_f32_16x16x32_bf16 v[132:135], a[88:91], a[8:11], v[132:135]
    ds_read_b64_tr_b16 a[106:107], v190 offset:53248
    v_cvt_pk_bf16_f32 v170, v148, v149
    v_mfma_f32_16x16x32_bf16 v[132:135], a[92:95], a[12:15], v[132:135]
    v_exp_f32 v152, v152
    v_cvt_pk_bf16_f32 v171, v150, v151
    v_mfma_f32_16x16x32_bf16 v[140:143], a[80:83], a[16:19], 0
    ds_read_b64_tr_b16 a[108:109], v191 offset:49152
    v_mfma_f32_16x16x32_bf16 v[140:143], a[84:87], a[20:23], v[140:143]
    v_exp_f32 v153, v153
    v_mfma_f32_16x16x32_bf16 v[140:143], a[88:91], a[24:27], v[140:143]
    ds_read_b64_tr_b16 a[110:111], v191 offset:53248
    v_cvt_pk_bf16_f32 v172, v152, v153
    v_mfma_f32_16x16x32_bf16 v[140:143], a[92:95], a[28:31], v[140:143]
    v_exp_f32 v154, v154
    v_mfma_f32_16x16x32_bf16 v[176:179], v[242:245], v[160:163], v[176:179]
    ds_read_b64_tr_b16 a[112:113], v192 offset:49152
    v_mfma_f32_16x16x32_bf16 v[184:187], v[242:245], v[164:167], v[184:187]
    ds_read_b64_tr_b16 a[114:115], v192 offset:53248
    s_waitcnt lgkmcnt(6)
    v_mfma_f32_16x16x32_bf16 v[0:3], a[96:99], v[160:163], v[0:3]
    v_exp_f32 v155, v155
    v_mfma_f32_16x16x32_bf16 v[32:35], a[96:99], v[164:167], v[32:35]
    ds_read_b64_tr_b16 a[116:117], v193 offset:49152
    v_cvt_pk_bf16_f32 v173, v154, v155
    v_mfma_f32_16x16x32_bf16 v[4:7], a[100:103], v[160:163], v[4:7]
    ds_read_b64_tr_b16 a[118:119], v193 offset:53248
    v_mfma_f32_16x16x32_bf16 v[36:39], a[100:103], v[164:167], v[36:39]
    s_waitcnt lgkmcnt(4)
    v_mfma_f32_16x16x32_bf16 v[8:11], a[104:107], v[160:163], v[8:11]
    ds_read_b64_tr_b16 a[120:121], v194 offset:49152
    v_mfma_f32_16x16x32_bf16 v[40:43], a[104:107], v[164:167], v[40:43]
    ds_read_b64_tr_b16 a[122:123], v194 offset:53248
    v_mfma_f32_16x16x32_bf16 v[12:15], a[108:111], v[160:163], v[12:15]
    v_exp_f32 v156, v156
    v_mfma_f32_16x16x32_bf16 v[44:47], a[108:111], v[164:167], v[44:47]
    ds_read_b64_tr_b16 a[124:125], v195 offset:49152
    s_waitcnt lgkmcnt(3)
    v_mfma_f32_16x16x32_bf16 v[16:19], a[112:115], v[160:163], v[16:19]
    ds_read_b64_tr_b16 a[126:127], v195 offset:53248
    v_mfma_f32_16x16x32_bf16 v[48:51], a[112:115], v[164:167], v[48:51]
    v_exp_f32 v157, v157
    v_mfma_f32_16x16x32_bf16 v[20:23], a[116:119], v[160:163], v[20:23]
    buffer_load_dwordx4 v201, s[20:23], s29 offen offset:1024 nt lds
    v_cvt_pk_bf16_f32 v174, v156, v157
    v_mfma_f32_16x16x32_bf16 v[52:55], a[116:119], v[164:167], v[52:55]
    s_waitcnt lgkmcnt(0)
    v_mfma_f32_16x16x32_bf16 v[24:27], a[120:123], v[160:163], v[24:27]
    v_exp_f32 v158, v158
    v_mfma_f32_16x16x32_bf16 v[56:59], a[120:123], v[164:167], v[56:59]
    v_exp_f32 v159, v159
    v_mfma_f32_16x16x32_bf16 v[28:31], a[124:127], v[160:163], v[28:31]
    v_cvt_pk_bf16_f32 v175, v158, v159
    v_mfma_f32_16x16x32_bf16 v[60:63], a[124:127], v[164:167], v[60:63]
    v_mfma_f32_16x16x32_bf16 v[144:147], a[64:67], a[32:35], 0
    v_exp_f32 v128, v128
    s_waitcnt vmcnt(19)
    v_accvgpr_read_b32 v234, a232
    v_mfma_f32_16x16x32_bf16 v[144:147], a[68:71], a[36:39], v[144:147]
    v_exp_f32 v129, v129
    v_mfma_f32_16x16x32_bf16 v[144:147], a[72:75], a[40:43], v[144:147]
    v_exp_f32 v130, v130
    v_accvgpr_read_b32 v235, a233
    v_mfma_f32_16x16x32_bf16 v[144:147], a[76:79], a[44:47], v[144:147]
    v_exp_f32 v131, v131
    v_accvgpr_read_b32 v236, a234
    v_mfma_f32_16x16x32_bf16 v[152:155], a[64:67], a[48:51], 0
    s_add_u32 s38, s51, 12288
    buffer_load_dwordx4 a[248:251], v198, s[12:15], s38 offen offset:2048 nt
    v_cvt_pk_bf16_f32 v160, v128, v129
    v_accvgpr_read_b32 v237, a235
    v_mfma_f32_16x16x32_bf16 v[152:155], a[68:71], a[52:55], v[152:155]
    v_exp_f32 v132, v132
    v_mfma_f32_16x16x32_bf16 v[152:155], a[72:75], a[56:59], v[152:155]
    ds_read_b128 a[64:67], v180 offset:0
    v_cvt_pk_bf16_f32 v161, v130, v131
    v_lshlrev_b32 v226, 16, v234
    v_mfma_f32_16x16x32_bf16 v[152:155], a[76:79], a[60:63], v[152:155]
    v_exp_f32 v133, v133
    v_and_b32 v227, s37, v234
    v_mfma_f32_16x16x32_bf16 v[148:151], a[80:83], a[32:35], 0
    ds_read_b128 a[68:71], v181 offset:0
    v_cvt_pk_bf16_f32 v162, v132, v133
    v_lshlrev_b32 v228, 16, v235
    v_mfma_f32_16x16x32_bf16 v[148:151], a[84:87], a[36:39], v[148:151]
    v_exp_f32 v134, v134
    v_mfma_f32_16x16x32_bf16 v[148:151], a[88:91], a[40:43], v[148:151]
    ds_read_b128 a[72:75], v182 offset:0
    v_and_b32 v229, s37, v235
    v_mfma_f32_16x16x32_bf16 v[148:151], a[92:95], a[44:47], v[148:151]
    v_exp_f32 v135, v135
    v_lshlrev_b32 v230, 16, v236
    v_mfma_f32_16x16x32_bf16 v[156:159], a[80:83], a[48:51], 0
    ds_read_b128 a[76:79], v183 offset:0
    v_cvt_pk_bf16_f32 v163, v134, v135
    v_and_b32 v231, s37, v236
    v_mfma_f32_16x16x32_bf16 v[156:159], a[84:87], a[52:55], v[156:159]
    v_exp_f32 v136, v136
    v_mfma_f32_16x16x32_bf16 v[156:159], a[88:91], a[56:59], v[156:159]
    ds_read_b128 a[80:83], v180 offset:4096
    v_lshlrev_b32 v232, 16, v237
    v_mfma_f32_16x16x32_bf16 v[156:159], a[92:95], a[60:63], v[156:159]
    v_exp_f32 v137, v137
    v_and_b32 v233, s37, v237
    v_mfma_f32_16x16x32_bf16 v[222:225], v[242:245], v[168:171], v[222:225]
    ds_read_b128 a[84:87], v181 offset:4096
    v_cvt_pk_bf16_f32 v164, v136, v137
    v_mfma_f32_16x16x32_bf16 v[246:249], v[242:245], v[172:175], v[246:249]
    v_exp_f32 v138, v138
    v_mul_f32 v226, s34, v226
    v_mfma_f32_16x16x32_bf16 v[64:67], a[96:99], v[168:171], v[64:67]
    ds_read_b128 a[88:91], v182 offset:4096
    v_mul_f32 v227, s34, v227
    v_mfma_f32_16x16x32_bf16 v[96:99], a[96:99], v[172:175], v[96:99]
    v_exp_f32 v139, v139
    v_mul_f32 v228, s34, v228
    v_mfma_f32_16x16x32_bf16 v[68:71], a[100:103], v[168:171], v[68:71]
    ds_read_b128 a[92:95], v183 offset:4096
    v_cvt_pk_bf16_f32 v165, v138, v139
    v_mfma_f32_16x16x32_bf16 v[100:103], a[100:103], v[172:175], v[100:103]
    buffer_load_dwordx4 v200, s[20:23], s29 offen offset:2048 nt lds
    v_mul_f32 v229, s34, v229
    v_mfma_f32_16x16x32_bf16 v[72:75], a[104:107], v[168:171], v[72:75]
    v_exp_f32 v140, v140
    v_mul_f32 v230, s34, v230
    v_mfma_f32_16x16x32_bf16 v[104:107], a[104:107], v[172:175], v[104:107]
    v_exp_f32 v141, v141
    v_mul_f32 v231, s34, v231
    v_mfma_f32_16x16x32_bf16 v[76:79], a[108:111], v[168:171], v[76:79]
    v_exp_f32 v142, v142
    v_mfma_f32_16x16x32_bf16 v[108:111], a[108:111], v[172:175], v[108:111]
    v_exp_f32 v143, v143
    v_mul_f32 v232, s34, v232
    v_mfma_f32_16x16x32_bf16 v[80:83], a[112:115], v[168:171], v[80:83]
    v_cvt_pk_bf16_f32 v166, v140, v141
    v_cvt_pk_bf16_f32 v167, v142, v143
    v_mul_f32 v233, s34, v233
    v_mfma_f32_16x16x32_bf16 v[112:115], a[112:115], v[172:175], v[112:115]
    v_cvt_pk_bf16_f32 v238, v226, v227
    v_mfma_f32_16x16x32_bf16 v[84:87], a[116:119], v[168:171], v[84:87]
    v_mfma_f32_16x16x32_bf16 v[116:119], a[116:119], v[172:175], v[116:119]
    buffer_load_dwordx4 v201, s[20:23], s29 offen offset:3072 nt lds
    s_add_u32 s29, s29, 16384
    v_cvt_pk_bf16_f32 v239, v228, v229
    v_mfma_f32_16x16x32_bf16 v[88:91], a[120:123], v[168:171], v[88:91]
    v_cvt_pk_bf16_f32 v240, v230, v231
    v_mfma_f32_16x16x32_bf16 v[120:123], a[120:123], v[172:175], v[120:123]
    v_cvt_pk_bf16_f32 v241, v232, v233
    v_mfma_f32_16x16x32_bf16 v[92:95], a[124:127], v[168:171], v[92:95]
    v_mfma_f32_16x16x32_bf16 v[124:127], a[124:127], v[172:175], v[124:127]
    ds_write_b128 v205, v[238:241] offset:2048
    s_waitcnt lgkmcnt(1)
    v_mfma_f32_16x16x32_bf16 v[128:131], a[64:67], a[0:3], 0
    ds_read_b64_tr_b16 a[96:97], v188 offset:57344
    v_exp_f32 v144, v144
    v_mfma_f32_16x16x32_bf16 v[128:131], a[68:71], a[4:7], v[128:131]
    v_exp_f32 v145, v145
    v_mfma_f32_16x16x32_bf16 v[128:131], a[72:75], a[8:11], v[128:131]
    ds_read_b64_tr_b16 a[98:99], v188 offset:61440
    v_exp_f32 v146, v146
    v_mfma_f32_16x16x32_bf16 v[128:131], a[76:79], a[12:15], v[128:131]
    v_exp_f32 v147, v147
    v_mfma_f32_16x16x32_bf16 v[136:139], a[64:67], a[16:19], 0
    ds_read_b64_tr_b16 a[100:101], v189 offset:57344
    v_exp_f32 v148, v148
    v_mfma_f32_16x16x32_bf16 v[136:139], a[68:71], a[20:23], v[136:139]
    v_exp_f32 v149, v149
    v_cvt_pk_bf16_f32 v168, v144, v145
    v_mfma_f32_16x16x32_bf16 v[136:139], a[72:75], a[24:27], v[136:139]
    ds_read_b64_tr_b16 a[102:103], v189 offset:61440
    v_exp_f32 v150, v150
    v_mfma_f32_16x16x32_bf16 v[136:139], a[76:79], a[28:31], v[136:139]
    v_exp_f32 v151, v151
    v_cvt_pk_bf16_f32 v169, v146, v147
    v_mfma_f32_16x16x32_bf16 v[132:135], a[80:83], a[0:3], 0
    ds_read_b64_tr_b16 a[104:105], v190 offset:57344
    v_cvt_pk_bf16_f32 v170, v148, v149
    v_mfma_f32_16x16x32_bf16 v[132:135], a[84:87], a[4:7], v[132:135]
    s_add_u32 m0, s30, 49152
    s_nop 0
    buffer_load_dwordx4 v196, s[16:19], s28 offen offset:0 nt lds
    v_mfma_f32_16x16x32_bf16 v[132:135], a[88:91], a[8:11], v[132:135]
    ds_read_b64_tr_b16 a[106:107], v190 offset:61440
    v_cvt_pk_bf16_f32 v171, v150, v151
    v_mfma_f32_16x16x32_bf16 v[132:135], a[92:95], a[12:15], v[132:135]
    v_exp_f32 v152, v152
    v_mfma_f32_16x16x32_bf16 v[140:143], a[80:83], a[16:19], 0
    ds_read_b64_tr_b16 a[108:109], v191 offset:57344
    v_mfma_f32_16x16x32_bf16 v[140:143], a[84:87], a[20:23], v[140:143]
    v_exp_f32 v153, v153
    v_mfma_f32_16x16x32_bf16 v[140:143], a[88:91], a[24:27], v[140:143]
    ds_read_b64_tr_b16 a[110:111], v191 offset:61440
    v_cvt_pk_bf16_f32 v172, v152, v153
    v_mfma_f32_16x16x32_bf16 v[140:143], a[92:95], a[28:31], v[140:143]
    v_exp_f32 v154, v154
    v_mfma_f32_16x16x32_bf16 v[176:179], v[242:245], v[160:163], v[176:179]
    ds_read_b64_tr_b16 a[112:113], v192 offset:57344
    v_mfma_f32_16x16x32_bf16 v[184:187], v[242:245], v[164:167], v[184:187]
    ds_read_b64_tr_b16 a[114:115], v192 offset:61440
    s_waitcnt lgkmcnt(6)
    v_mfma_f32_16x16x32_bf16 v[0:3], a[96:99], v[160:163], v[0:3]
    v_exp_f32 v155, v155
    v_mfma_f32_16x16x32_bf16 v[32:35], a[96:99], v[164:167], v[32:35]
    ds_read_b64_tr_b16 a[116:117], v193 offset:57344
    v_cvt_pk_bf16_f32 v173, v154, v155
    v_mfma_f32_16x16x32_bf16 v[4:7], a[100:103], v[160:163], v[4:7]
    ds_read_b64_tr_b16 a[118:119], v193 offset:61440
    v_mfma_f32_16x16x32_bf16 v[36:39], a[100:103], v[164:167], v[36:39]
    s_waitcnt lgkmcnt(4)
    v_mfma_f32_16x16x32_bf16 v[8:11], a[104:107], v[160:163], v[8:11]
    ds_read_b64_tr_b16 a[120:121], v194 offset:57344
    v_mfma_f32_16x16x32_bf16 v[40:43], a[104:107], v[164:167], v[40:43]
    ds_read_b64_tr_b16 a[122:123], v194 offset:61440
    v_mfma_f32_16x16x32_bf16 v[12:15], a[108:111], v[160:163], v[12:15]
    v_exp_f32 v156, v156
    v_mfma_f32_16x16x32_bf16 v[44:47], a[108:111], v[164:167], v[44:47]
    ds_read_b64_tr_b16 a[124:125], v195 offset:57344
    s_waitcnt lgkmcnt(3)
    v_mfma_f32_16x16x32_bf16 v[16:19], a[112:115], v[160:163], v[16:19]
    ds_read_b64_tr_b16 a[126:127], v195 offset:61440
    v_mfma_f32_16x16x32_bf16 v[48:51], a[112:115], v[164:167], v[48:51]
    v_exp_f32 v157, v157
    v_mfma_f32_16x16x32_bf16 v[20:23], a[116:119], v[160:163], v[20:23]
    buffer_load_dwordx4 v197, s[16:19], s28 offen offset:1024 nt lds
    v_cvt_pk_bf16_f32 v174, v156, v157
    v_mfma_f32_16x16x32_bf16 v[52:55], a[116:119], v[164:167], v[52:55]
    s_waitcnt lgkmcnt(0)
    v_mfma_f32_16x16x32_bf16 v[24:27], a[120:123], v[160:163], v[24:27]
    v_exp_f32 v158, v158
    v_mfma_f32_16x16x32_bf16 v[56:59], a[120:123], v[164:167], v[56:59]
    v_exp_f32 v159, v159
    v_mfma_f32_16x16x32_bf16 v[28:31], a[124:127], v[160:163], v[28:31]
    v_cvt_pk_bf16_f32 v175, v158, v159
    v_mfma_f32_16x16x32_bf16 v[60:63], a[124:127], v[164:167], v[60:63]
    v_mfma_f32_16x16x32_bf16 v[144:147], a[64:67], a[32:35], 0
    v_exp_f32 v128, v128
    s_waitcnt vmcnt(19)
    v_accvgpr_read_b32 v234, a236
    v_mfma_f32_16x16x32_bf16 v[144:147], a[68:71], a[36:39], v[144:147]
    v_exp_f32 v129, v129
    v_mfma_f32_16x16x32_bf16 v[144:147], a[72:75], a[40:43], v[144:147]
    v_exp_f32 v130, v130
    v_accvgpr_read_b32 v235, a237
    v_mfma_f32_16x16x32_bf16 v[144:147], a[76:79], a[44:47], v[144:147]
    v_exp_f32 v131, v131
    v_accvgpr_read_b32 v236, a238
    v_mfma_f32_16x16x32_bf16 v[152:155], a[64:67], a[48:51], 0
    s_add_u32 s38, s51, 12288
    buffer_load_dwordx4 a[252:255], v199, s[12:15], s38 offen offset:3072 nt
    v_cvt_pk_bf16_f32 v160, v128, v129
    v_accvgpr_read_b32 v237, a239
    v_mfma_f32_16x16x32_bf16 v[152:155], a[68:71], a[52:55], v[152:155]
    v_exp_f32 v132, v132
    v_mfma_f32_16x16x32_bf16 v[152:155], a[72:75], a[56:59], v[152:155]
    ds_read_b128 a[64:67], v180 offset:8192
    v_cvt_pk_bf16_f32 v161, v130, v131
    v_lshlrev_b32 v226, 16, v234
    v_mfma_f32_16x16x32_bf16 v[152:155], a[76:79], a[60:63], v[152:155]
    v_exp_f32 v133, v133
    v_and_b32 v227, s37, v234
    v_mfma_f32_16x16x32_bf16 v[148:151], a[80:83], a[32:35], 0
    ds_read_b128 a[68:71], v181 offset:8192
    v_cvt_pk_bf16_f32 v162, v132, v133
    v_lshlrev_b32 v228, 16, v235
    v_mfma_f32_16x16x32_bf16 v[148:151], a[84:87], a[36:39], v[148:151]
    v_exp_f32 v134, v134
    v_mfma_f32_16x16x32_bf16 v[148:151], a[88:91], a[40:43], v[148:151]
    ds_read_b128 a[72:75], v182 offset:8192
    v_and_b32 v229, s37, v235
    v_mfma_f32_16x16x32_bf16 v[148:151], a[92:95], a[44:47], v[148:151]
    v_exp_f32 v135, v135
    v_lshlrev_b32 v230, 16, v236
    v_mfma_f32_16x16x32_bf16 v[156:159], a[80:83], a[48:51], 0
    ds_read_b128 a[76:79], v183 offset:8192
    v_cvt_pk_bf16_f32 v163, v134, v135
    v_and_b32 v231, s37, v236
    v_mfma_f32_16x16x32_bf16 v[156:159], a[84:87], a[52:55], v[156:159]
    v_exp_f32 v136, v136
    v_mfma_f32_16x16x32_bf16 v[156:159], a[88:91], a[56:59], v[156:159]
    ds_read_b128 a[80:83], v180 offset:12288
    v_lshlrev_b32 v232, 16, v237
    v_mfma_f32_16x16x32_bf16 v[156:159], a[92:95], a[60:63], v[156:159]
    v_exp_f32 v137, v137
    v_and_b32 v233, s37, v237
    v_mfma_f32_16x16x32_bf16 v[222:225], v[242:245], v[168:171], v[222:225]
    ds_read_b128 a[84:87], v181 offset:12288
    v_cvt_pk_bf16_f32 v164, v136, v137
    v_mfma_f32_16x16x32_bf16 v[246:249], v[242:245], v[172:175], v[246:249]
    v_exp_f32 v138, v138
    v_mul_f32 v226, s34, v226
    v_mfma_f32_16x16x32_bf16 v[64:67], a[96:99], v[168:171], v[64:67]
    ds_read_b128 a[88:91], v182 offset:12288
    v_mul_f32 v227, s34, v227
    v_mfma_f32_16x16x32_bf16 v[96:99], a[96:99], v[172:175], v[96:99]
    v_exp_f32 v139, v139
    v_mul_f32 v228, s34, v228
    v_mfma_f32_16x16x32_bf16 v[68:71], a[100:103], v[168:171], v[68:71]
    ds_read_b128 a[92:95], v183 offset:12288
    v_cvt_pk_bf16_f32 v165, v138, v139
    v_mfma_f32_16x16x32_bf16 v[100:103], a[100:103], v[172:175], v[100:103]
    buffer_load_dwordx4 v198, s[16:19], s28 offen offset:2048 nt lds
    v_mul_f32 v229, s34, v229
    v_mfma_f32_16x16x32_bf16 v[72:75], a[104:107], v[168:171], v[72:75]
    v_exp_f32 v140, v140
    v_mul_f32 v230, s34, v230
    v_mfma_f32_16x16x32_bf16 v[104:107], a[104:107], v[172:175], v[104:107]
    v_exp_f32 v141, v141
    v_mul_f32 v231, s34, v231
    v_mfma_f32_16x16x32_bf16 v[76:79], a[108:111], v[168:171], v[76:79]
    v_exp_f32 v142, v142
    v_mfma_f32_16x16x32_bf16 v[108:111], a[108:111], v[172:175], v[108:111]
    v_exp_f32 v143, v143
    v_mul_f32 v232, s34, v232
    v_mfma_f32_16x16x32_bf16 v[80:83], a[112:115], v[168:171], v[80:83]
    v_cvt_pk_bf16_f32 v166, v140, v141
    v_cvt_pk_bf16_f32 v167, v142, v143
    v_mul_f32 v233, s34, v233
    v_mfma_f32_16x16x32_bf16 v[112:115], a[112:115], v[172:175], v[112:115]
    v_cvt_pk_bf16_f32 v238, v226, v227
    v_mfma_f32_16x16x32_bf16 v[84:87], a[116:119], v[168:171], v[84:87]
    v_mfma_f32_16x16x32_bf16 v[116:119], a[116:119], v[172:175], v[116:119]
    buffer_load_dwordx4 v199, s[16:19], s28 offen offset:3072 nt lds
    s_add_u32 s28, s28, 16384
    v_cvt_pk_bf16_f32 v239, v228, v229
    v_mfma_f32_16x16x32_bf16 v[88:91], a[120:123], v[168:171], v[88:91]
    v_cvt_pk_bf16_f32 v240, v230, v231
    v_mfma_f32_16x16x32_bf16 v[120:123], a[120:123], v[172:175], v[120:123]
    v_cvt_pk_bf16_f32 v241, v232, v233
    v_mfma_f32_16x16x32_bf16 v[92:95], a[124:127], v[168:171], v[92:95]
    v_mfma_f32_16x16x32_bf16 v[124:127], a[124:127], v[172:175], v[124:127]
    ds_write_b128 v205, v[238:241] offset:3072
    s_waitcnt lgkmcnt(1)
    v_mfma_f32_16x16x32_bf16 v[128:131], a[64:67], a[0:3], 0
    s_waitcnt vmcnt(20)
    s_barrier
    ds_read_b64_tr_b16 a[96:97], v188 offset:0
    v_mfma_f32_16x16x32_bf16 v[128:131], a[68:71], a[4:7], v[128:131]
    v_exp_f32 v144, v144
    v_mfma_f32_16x16x32_bf16 v[128:131], a[72:75], a[8:11], v[128:131]
    ds_read_b64_tr_b16 a[98:99], v188 offset:4096
    v_exp_f32 v145, v145
    v_mfma_f32_16x16x32_bf16 v[128:131], a[76:79], a[12:15], v[128:131]
    v_exp_f32 v146, v146
    v_mfma_f32_16x16x32_bf16 v[136:139], a[64:67], a[16:19], 0
    ds_read_b64_tr_b16 a[100:101], v189 offset:0
    v_exp_f32 v147, v147
    v_mfma_f32_16x16x32_bf16 v[136:139], a[68:71], a[20:23], v[136:139]
    v_exp_f32 v148, v148
    v_cvt_pk_bf16_f32 v168, v144, v145
    v_mfma_f32_16x16x32_bf16 v[136:139], a[72:75], a[24:27], v[136:139]
    ds_read_b64_tr_b16 a[102:103], v189 offset:4096
    v_exp_f32 v149, v149
    v_mfma_f32_16x16x32_bf16 v[136:139], a[76:79], a[28:31], v[136:139]
    v_exp_f32 v150, v150
    v_cvt_pk_bf16_f32 v169, v146, v147
    v_mfma_f32_16x16x32_bf16 v[132:135], a[80:83], a[0:3], 0
    ds_read_b64_tr_b16 a[104:105], v190 offset:0
    v_exp_f32 v151, v151
    v_mfma_f32_16x16x32_bf16 v[132:135], a[84:87], a[4:7], v[132:135]
    s_add_u32 m0, s30, 114688
    s_nop 0
    buffer_load_dwordx4 v200, s[20:23], s29 offen offset:0 nt lds
    v_mfma_f32_16x16x32_bf16 v[132:135], a[88:91], a[8:11], v[132:135]
    ds_read_b64_tr_b16 a[106:107], v190 offset:4096
    v_cvt_pk_bf16_f32 v170, v148, v149
    v_mfma_f32_16x16x32_bf16 v[132:135], a[92:95], a[12:15], v[132:135]
    v_exp_f32 v152, v152
    v_cvt_pk_bf16_f32 v171, v150, v151
    v_mfma_f32_16x16x32_bf16 v[140:143], a[80:83], a[16:19], 0
    ds_read_b64_tr_b16 a[108:109], v191 offset:0
    v_mfma_f32_16x16x32_bf16 v[140:143], a[84:87], a[20:23], v[140:143]
    v_exp_f32 v153, v153
    v_mfma_f32_16x16x32_bf16 v[140:143], a[88:91], a[24:27], v[140:143]
    ds_read_b64_tr_b16 a[110:111], v191 offset:4096
    v_cvt_pk_bf16_f32 v172, v152, v153
    v_mfma_f32_16x16x32_bf16 v[140:143], a[92:95], a[28:31], v[140:143]
    v_exp_f32 v154, v154
    v_mfma_f32_16x16x32_bf16 v[176:179], v[242:245], v[160:163], v[176:179]
    ds_read_b64_tr_b16 a[112:113], v192 offset:0
    v_mfma_f32_16x16x32_bf16 v[184:187], v[242:245], v[164:167], v[184:187]
    ds_read_b64_tr_b16 a[114:115], v192 offset:4096
    s_waitcnt lgkmcnt(6)
    v_mfma_f32_16x16x32_bf16 v[0:3], a[96:99], v[160:163], v[0:3]
    v_exp_f32 v155, v155
    v_mfma_f32_16x16x32_bf16 v[32:35], a[96:99], v[164:167], v[32:35]
    ds_read_b64_tr_b16 a[116:117], v193 offset:0
    v_cvt_pk_bf16_f32 v173, v154, v155
    v_mfma_f32_16x16x32_bf16 v[4:7], a[100:103], v[160:163], v[4:7]
    ds_read_b64_tr_b16 a[118:119], v193 offset:4096
    v_mfma_f32_16x16x32_bf16 v[36:39], a[100:103], v[164:167], v[36:39]
    s_waitcnt lgkmcnt(4)
    v_mfma_f32_16x16x32_bf16 v[8:11], a[104:107], v[160:163], v[8:11]
    ds_read_b64_tr_b16 a[120:121], v194 offset:0
    v_mfma_f32_16x16x32_bf16 v[40:43], a[104:107], v[164:167], v[40:43]
    ds_read_b64_tr_b16 a[122:123], v194 offset:4096
    v_mfma_f32_16x16x32_bf16 v[12:15], a[108:111], v[160:163], v[12:15]
    v_exp_f32 v156, v156
    v_mfma_f32_16x16x32_bf16 v[44:47], a[108:111], v[164:167], v[44:47]
    ds_read_b64_tr_b16 a[124:125], v195 offset:0
    s_waitcnt lgkmcnt(3)
    v_mfma_f32_16x16x32_bf16 v[16:19], a[112:115], v[160:163], v[16:19]
    ds_read_b64_tr_b16 a[126:127], v195 offset:4096
    v_mfma_f32_16x16x32_bf16 v[48:51], a[112:115], v[164:167], v[48:51]
    v_exp_f32 v157, v157
    v_mfma_f32_16x16x32_bf16 v[20:23], a[116:119], v[160:163], v[20:23]
    buffer_load_dwordx4 v201, s[20:23], s29 offen offset:1024 nt lds
    v_cvt_pk_bf16_f32 v174, v156, v157
    v_mfma_f32_16x16x32_bf16 v[52:55], a[116:119], v[164:167], v[52:55]
    s_waitcnt lgkmcnt(0)
    v_mfma_f32_16x16x32_bf16 v[24:27], a[120:123], v[160:163], v[24:27]
    v_exp_f32 v158, v158
    v_mfma_f32_16x16x32_bf16 v[56:59], a[120:123], v[164:167], v[56:59]
    v_exp_f32 v159, v159
    v_mfma_f32_16x16x32_bf16 v[28:31], a[124:127], v[160:163], v[28:31]
    v_cvt_pk_bf16_f32 v175, v158, v159
    v_mfma_f32_16x16x32_bf16 v[60:63], a[124:127], v[164:167], v[60:63]
    v_mfma_f32_16x16x32_bf16 v[144:147], a[64:67], a[32:35], 0
    v_exp_f32 v128, v128
    s_waitcnt vmcnt(19)
    v_accvgpr_read_b32 v234, a240
    v_mfma_f32_16x16x32_bf16 v[144:147], a[68:71], a[36:39], v[144:147]
    v_exp_f32 v129, v129
    v_mfma_f32_16x16x32_bf16 v[144:147], a[72:75], a[40:43], v[144:147]
    v_exp_f32 v130, v130
    v_accvgpr_read_b32 v235, a241
    v_mfma_f32_16x16x32_bf16 v[144:147], a[76:79], a[44:47], v[144:147]
    v_exp_f32 v131, v131
    v_accvgpr_read_b32 v236, a242
    v_mfma_f32_16x16x32_bf16 v[152:155], a[64:67], a[48:51], 0
    v_exp_f32 v132, v132
    v_cvt_pk_bf16_f32 v160, v128, v129
    v_accvgpr_read_b32 v237, a243
    v_mfma_f32_16x16x32_bf16 v[152:155], a[68:71], a[52:55], v[152:155]
    v_exp_f32 v133, v133
    v_mfma_f32_16x16x32_bf16 v[152:155], a[72:75], a[56:59], v[152:155]
    ds_read_b128 a[64:67], v180 offset:16384
    v_cvt_pk_bf16_f32 v161, v130, v131
    v_lshlrev_b32 v226, 16, v234
    v_mfma_f32_16x16x32_bf16 v[152:155], a[76:79], a[60:63], v[152:155]
    v_exp_f32 v134, v134
    v_and_b32 v227, s37, v234
    v_mfma_f32_16x16x32_bf16 v[148:151], a[80:83], a[32:35], 0
    ds_read_b128 a[68:71], v181 offset:16384
    v_cvt_pk_bf16_f32 v162, v132, v133
    v_lshlrev_b32 v228, 16, v235
    v_mfma_f32_16x16x32_bf16 v[148:151], a[84:87], a[36:39], v[148:151]
    buffer_load_dwordx4 v200, s[20:23], s29 offen offset:2048 nt lds
    v_mfma_f32_16x16x32_bf16 v[148:151], a[88:91], a[40:43], v[148:151]
    ds_read_b128 a[72:75], v182 offset:16384
    v_and_b32 v229, s37, v235
    v_mfma_f32_16x16x32_bf16 v[148:151], a[92:95], a[44:47], v[148:151]
    v_exp_f32 v135, v135
    v_lshlrev_b32 v230, 16, v236
    v_mfma_f32_16x16x32_bf16 v[156:159], a[80:83], a[48:51], 0
    ds_read_b128 a[76:79], v183 offset:16384
    v_cvt_pk_bf16_f32 v163, v134, v135
    v_and_b32 v231, s37, v236
    v_mfma_f32_16x16x32_bf16 v[156:159], a[84:87], a[52:55], v[156:159]
    v_exp_f32 v136, v136
    v_mfma_f32_16x16x32_bf16 v[156:159], a[88:91], a[56:59], v[156:159]
    ds_read_b128 a[80:83], v180 offset:20480
    v_lshlrev_b32 v232, 16, v237
    v_mfma_f32_16x16x32_bf16 v[156:159], a[92:95], a[60:63], v[156:159]
    v_exp_f32 v137, v137
    v_and_b32 v233, s37, v237
    v_mfma_f32_16x16x32_bf16 v[222:225], v[242:245], v[168:171], v[222:225]
    ds_read_b128 a[84:87], v181 offset:20480
    v_cvt_pk_bf16_f32 v164, v136, v137
    v_mfma_f32_16x16x32_bf16 v[246:249], v[242:245], v[172:175], v[246:249]
    v_exp_f32 v138, v138
    v_mul_f32 v226, s34, v226
    v_mfma_f32_16x16x32_bf16 v[64:67], a[96:99], v[168:171], v[64:67]
    ds_read_b128 a[88:91], v182 offset:20480
    v_mul_f32 v227, s34, v227
    v_mfma_f32_16x16x32_bf16 v[96:99], a[96:99], v[172:175], v[96:99]
    v_exp_f32 v139, v139
    v_mul_f32 v228, s34, v228
    v_mfma_f32_16x16x32_bf16 v[68:71], a[100:103], v[168:171], v[68:71]
    ds_read_b128 a[92:95], v183 offset:20480
    v_cvt_pk_bf16_f32 v165, v138, v139
    v_mfma_f32_16x16x32_bf16 v[100:103], a[100:103], v[172:175], v[100:103]
    v_exp_f32 v140, v140
    v_mul_f32 v229, s34, v229
    v_mfma_f32_16x16x32_bf16 v[72:75], a[104:107], v[168:171], v[72:75]
    v_exp_f32 v141, v141
    v_mul_f32 v230, s34, v230
    v_mfma_f32_16x16x32_bf16 v[104:107], a[104:107], v[172:175], v[104:107]
    v_exp_f32 v142, v142
    v_mul_f32 v231, s34, v231
    v_mfma_f32_16x16x32_bf16 v[76:79], a[108:111], v[168:171], v[76:79]
    v_exp_f32 v143, v143
    v_mfma_f32_16x16x32_bf16 v[108:111], a[108:111], v[172:175], v[108:111]
    v_cvt_pk_bf16_f32 v166, v140, v141
    v_cvt_pk_bf16_f32 v167, v142, v143
    v_mul_f32 v232, s34, v232
    v_mfma_f32_16x16x32_bf16 v[80:83], a[112:115], v[168:171], v[80:83]
    v_mul_f32 v233, s34, v233
    v_mfma_f32_16x16x32_bf16 v[112:115], a[112:115], v[172:175], v[112:115]
    buffer_load_dwordx4 v201, s[20:23], s29 offen offset:3072 nt lds
    s_add_u32 s29, s29, 16384
    v_cvt_pk_bf16_f32 v238, v226, v227
    v_mfma_f32_16x16x32_bf16 v[84:87], a[116:119], v[168:171], v[84:87]
    v_mfma_f32_16x16x32_bf16 v[116:119], a[116:119], v[172:175], v[116:119]
    v_cvt_pk_bf16_f32 v239, v228, v229
    v_mfma_f32_16x16x32_bf16 v[88:91], a[120:123], v[168:171], v[88:91]
    v_cvt_pk_bf16_f32 v240, v230, v231
    v_mfma_f32_16x16x32_bf16 v[120:123], a[120:123], v[172:175], v[120:123]
    v_cvt_pk_bf16_f32 v241, v232, v233
    v_mfma_f32_16x16x32_bf16 v[92:95], a[124:127], v[168:171], v[92:95]
    v_mfma_f32_16x16x32_bf16 v[124:127], a[124:127], v[172:175], v[124:127]
    ds_write_b128 v205, v[238:241] offset:4096
    s_waitcnt lgkmcnt(1)
    v_mfma_f32_16x16x32_bf16 v[128:131], a[64:67], a[0:3], 0
    ds_read_b64_tr_b16 a[96:97], v188 offset:8192
    v_exp_f32 v144, v144
    v_mfma_f32_16x16x32_bf16 v[128:131], a[68:71], a[4:7], v[128:131]
    v_exp_f32 v145, v145
    v_mfma_f32_16x16x32_bf16 v[128:131], a[72:75], a[8:11], v[128:131]
    ds_read_b64_tr_b16 a[98:99], v188 offset:12288
    v_exp_f32 v146, v146
    v_mfma_f32_16x16x32_bf16 v[128:131], a[76:79], a[12:15], v[128:131]
    v_exp_f32 v147, v147
    v_mfma_f32_16x16x32_bf16 v[136:139], a[64:67], a[16:19], 0
    ds_read_b64_tr_b16 a[100:101], v189 offset:8192
    v_exp_f32 v148, v148
    v_mfma_f32_16x16x32_bf16 v[136:139], a[68:71], a[20:23], v[136:139]
    v_exp_f32 v149, v149
    v_cvt_pk_bf16_f32 v168, v144, v145
    v_mfma_f32_16x16x32_bf16 v[136:139], a[72:75], a[24:27], v[136:139]
    ds_read_b64_tr_b16 a[102:103], v189 offset:12288
    v_exp_f32 v150, v150
    v_mfma_f32_16x16x32_bf16 v[136:139], a[76:79], a[28:31], v[136:139]
    v_exp_f32 v151, v151
    v_cvt_pk_bf16_f32 v169, v146, v147
    v_mfma_f32_16x16x32_bf16 v[132:135], a[80:83], a[0:3], 0
    ds_read_b64_tr_b16 a[104:105], v190 offset:8192
    v_cvt_pk_bf16_f32 v170, v148, v149
    v_mfma_f32_16x16x32_bf16 v[132:135], a[84:87], a[4:7], v[132:135]
    s_add_u32 m0, s30, 0
    s_nop 0
    buffer_load_dwordx4 v196, s[16:19], s28 offen offset:0 nt lds
    v_mfma_f32_16x16x32_bf16 v[132:135], a[88:91], a[8:11], v[132:135]
    ds_read_b64_tr_b16 a[106:107], v190 offset:12288
    v_cvt_pk_bf16_f32 v171, v150, v151
    v_mfma_f32_16x16x32_bf16 v[132:135], a[92:95], a[12:15], v[132:135]
    v_exp_f32 v152, v152
    v_mfma_f32_16x16x32_bf16 v[140:143], a[80:83], a[16:19], 0
    ds_read_b64_tr_b16 a[108:109], v191 offset:8192
    v_mfma_f32_16x16x32_bf16 v[140:143], a[84:87], a[20:23], v[140:143]
    v_exp_f32 v153, v153
    v_mfma_f32_16x16x32_bf16 v[140:143], a[88:91], a[24:27], v[140:143]
    ds_read_b64_tr_b16 a[110:111], v191 offset:12288
    v_cvt_pk_bf16_f32 v172, v152, v153
    v_mfma_f32_16x16x32_bf16 v[140:143], a[92:95], a[28:31], v[140:143]
    v_exp_f32 v154, v154
    v_mfma_f32_16x16x32_bf16 v[176:179], v[242:245], v[160:163], v[176:179]
    ds_read_b64_tr_b16 a[112:113], v192 offset:8192
    v_mfma_f32_16x16x32_bf16 v[184:187], v[242:245], v[164:167], v[184:187]
    ds_read_b64_tr_b16 a[114:115], v192 offset:12288
    s_waitcnt lgkmcnt(6)
    v_mfma_f32_16x16x32_bf16 v[0:3], a[96:99], v[160:163], v[0:3]
    v_exp_f32 v155, v155
    v_mfma_f32_16x16x32_bf16 v[32:35], a[96:99], v[164:167], v[32:35]
    ds_read_b64_tr_b16 a[116:117], v193 offset:8192
    v_cvt_pk_bf16_f32 v173, v154, v155
    v_mfma_f32_16x16x32_bf16 v[4:7], a[100:103], v[160:163], v[4:7]
    ds_read_b64_tr_b16 a[118:119], v193 offset:12288
    v_mfma_f32_16x16x32_bf16 v[36:39], a[100:103], v[164:167], v[36:39]
    s_waitcnt lgkmcnt(4)
    v_mfma_f32_16x16x32_bf16 v[8:11], a[104:107], v[160:163], v[8:11]
    ds_read_b64_tr_b16 a[120:121], v194 offset:8192
    v_mfma_f32_16x16x32_bf16 v[40:43], a[104:107], v[164:167], v[40:43]
    ds_read_b64_tr_b16 a[122:123], v194 offset:12288
    v_mfma_f32_16x16x32_bf16 v[12:15], a[108:111], v[160:163], v[12:15]
    v_exp_f32 v156, v156
    v_mfma_f32_16x16x32_bf16 v[44:47], a[108:111], v[164:167], v[44:47]
    ds_read_b64_tr_b16 a[124:125], v195 offset:8192
    s_waitcnt lgkmcnt(3)
    v_mfma_f32_16x16x32_bf16 v[16:19], a[112:115], v[160:163], v[16:19]
    ds_read_b64_tr_b16 a[126:127], v195 offset:12288
    v_mfma_f32_16x16x32_bf16 v[48:51], a[112:115], v[164:167], v[48:51]
    v_exp_f32 v157, v157
    v_mfma_f32_16x16x32_bf16 v[20:23], a[116:119], v[160:163], v[20:23]
    buffer_load_dwordx4 v197, s[16:19], s28 offen offset:1024 nt lds
    v_cvt_pk_bf16_f32 v174, v156, v157
    v_mfma_f32_16x16x32_bf16 v[52:55], a[116:119], v[164:167], v[52:55]
    s_waitcnt lgkmcnt(0)
    v_mfma_f32_16x16x32_bf16 v[24:27], a[120:123], v[160:163], v[24:27]
    v_exp_f32 v158, v158
    v_mfma_f32_16x16x32_bf16 v[56:59], a[120:123], v[164:167], v[56:59]
    v_exp_f32 v159, v159
    v_mfma_f32_16x16x32_bf16 v[28:31], a[124:127], v[160:163], v[28:31]
    v_cvt_pk_bf16_f32 v175, v158, v159
    v_mfma_f32_16x16x32_bf16 v[60:63], a[124:127], v[164:167], v[60:63]
    v_mfma_f32_16x16x32_bf16 v[144:147], a[64:67], a[32:35], 0
    v_exp_f32 v128, v128
    s_waitcnt vmcnt(18)
    v_accvgpr_read_b32 v234, a244
    v_mfma_f32_16x16x32_bf16 v[144:147], a[68:71], a[36:39], v[144:147]
    v_exp_f32 v129, v129
    v_mfma_f32_16x16x32_bf16 v[144:147], a[72:75], a[40:43], v[144:147]
    v_exp_f32 v130, v130
    v_accvgpr_read_b32 v235, a245
    v_mfma_f32_16x16x32_bf16 v[144:147], a[76:79], a[44:47], v[144:147]
    v_exp_f32 v131, v131
    v_accvgpr_read_b32 v236, a246
    v_mfma_f32_16x16x32_bf16 v[152:155], a[64:67], a[48:51], 0
    v_exp_f32 v132, v132
    v_cvt_pk_bf16_f32 v160, v128, v129
    v_accvgpr_read_b32 v237, a247
    v_mfma_f32_16x16x32_bf16 v[152:155], a[68:71], a[52:55], v[152:155]
    v_exp_f32 v133, v133
    v_mfma_f32_16x16x32_bf16 v[152:155], a[72:75], a[56:59], v[152:155]
    ds_read_b128 a[64:67], v180 offset:24576
    v_cvt_pk_bf16_f32 v161, v130, v131
    v_lshlrev_b32 v226, 16, v234
    v_mfma_f32_16x16x32_bf16 v[152:155], a[76:79], a[60:63], v[152:155]
    v_exp_f32 v134, v134
    v_and_b32 v227, s37, v234
    v_mfma_f32_16x16x32_bf16 v[148:151], a[80:83], a[32:35], 0
    ds_read_b128 a[68:71], v181 offset:24576
    v_cvt_pk_bf16_f32 v162, v132, v133
    v_lshlrev_b32 v228, 16, v235
    v_mfma_f32_16x16x32_bf16 v[148:151], a[84:87], a[36:39], v[148:151]
    buffer_load_dwordx4 v198, s[16:19], s28 offen offset:2048 nt lds
    v_mfma_f32_16x16x32_bf16 v[148:151], a[88:91], a[40:43], v[148:151]
    ds_read_b128 a[72:75], v182 offset:24576
    v_and_b32 v229, s37, v235
    v_mfma_f32_16x16x32_bf16 v[148:151], a[92:95], a[44:47], v[148:151]
    v_exp_f32 v135, v135
    v_lshlrev_b32 v230, 16, v236
    v_mfma_f32_16x16x32_bf16 v[156:159], a[80:83], a[48:51], 0
    ds_read_b128 a[76:79], v183 offset:24576
    v_cvt_pk_bf16_f32 v163, v134, v135
    v_and_b32 v231, s37, v236
    v_mfma_f32_16x16x32_bf16 v[156:159], a[84:87], a[52:55], v[156:159]
    v_exp_f32 v136, v136
    v_mfma_f32_16x16x32_bf16 v[156:159], a[88:91], a[56:59], v[156:159]
    ds_read_b128 a[80:83], v180 offset:28672
    v_lshlrev_b32 v232, 16, v237
    v_mfma_f32_16x16x32_bf16 v[156:159], a[92:95], a[60:63], v[156:159]
    v_exp_f32 v137, v137
    v_and_b32 v233, s37, v237
    v_mfma_f32_16x16x32_bf16 v[222:225], v[242:245], v[168:171], v[222:225]
    ds_read_b128 a[84:87], v181 offset:28672
    v_cvt_pk_bf16_f32 v164, v136, v137
    v_mfma_f32_16x16x32_bf16 v[246:249], v[242:245], v[172:175], v[246:249]
    v_exp_f32 v138, v138
    v_mul_f32 v226, s34, v226
    v_mfma_f32_16x16x32_bf16 v[64:67], a[96:99], v[168:171], v[64:67]
    ds_read_b128 a[88:91], v182 offset:28672
    v_mul_f32 v227, s34, v227
    v_mfma_f32_16x16x32_bf16 v[96:99], a[96:99], v[172:175], v[96:99]
    v_exp_f32 v139, v139
    v_mul_f32 v228, s34, v228
    v_mfma_f32_16x16x32_bf16 v[68:71], a[100:103], v[168:171], v[68:71]
    ds_read_b128 a[92:95], v183 offset:28672
    v_cvt_pk_bf16_f32 v165, v138, v139
    v_mfma_f32_16x16x32_bf16 v[100:103], a[100:103], v[172:175], v[100:103]
    v_exp_f32 v140, v140
    v_mul_f32 v229, s34, v229
    v_mfma_f32_16x16x32_bf16 v[72:75], a[104:107], v[168:171], v[72:75]
    v_exp_f32 v141, v141
    v_mul_f32 v230, s34, v230
    v_mfma_f32_16x16x32_bf16 v[104:107], a[104:107], v[172:175], v[104:107]
    v_exp_f32 v142, v142
    v_mul_f32 v231, s34, v231
    v_mfma_f32_16x16x32_bf16 v[76:79], a[108:111], v[168:171], v[76:79]
    v_exp_f32 v143, v143
    v_mfma_f32_16x16x32_bf16 v[108:111], a[108:111], v[172:175], v[108:111]
    v_cvt_pk_bf16_f32 v166, v140, v141
    v_cvt_pk_bf16_f32 v167, v142, v143
    v_mul_f32 v232, s34, v232
    v_mfma_f32_16x16x32_bf16 v[80:83], a[112:115], v[168:171], v[80:83]
    v_mul_f32 v233, s34, v233
    v_mfma_f32_16x16x32_bf16 v[112:115], a[112:115], v[172:175], v[112:115]
    buffer_load_dwordx4 v199, s[16:19], s28 offen offset:3072 nt lds
    s_add_u32 s28, s28, 16384
    v_cvt_pk_bf16_f32 v238, v226, v227
    v_mfma_f32_16x16x32_bf16 v[84:87], a[116:119], v[168:171], v[84:87]
    v_mfma_f32_16x16x32_bf16 v[116:119], a[116:119], v[172:175], v[116:119]
    v_cvt_pk_bf16_f32 v239, v228, v229
    v_mfma_f32_16x16x32_bf16 v[88:91], a[120:123], v[168:171], v[88:91]
    v_cvt_pk_bf16_f32 v240, v230, v231
    v_mfma_f32_16x16x32_bf16 v[120:123], a[120:123], v[172:175], v[120:123]
    v_cvt_pk_bf16_f32 v241, v232, v233
    v_mfma_f32_16x16x32_bf16 v[92:95], a[124:127], v[168:171], v[92:95]
    v_mfma_f32_16x16x32_bf16 v[124:127], a[124:127], v[172:175], v[124:127]
    ds_write_b128 v205, v[238:241] offset:5120
    s_waitcnt lgkmcnt(1)
    v_mfma_f32_16x16x32_bf16 v[128:131], a[64:67], a[0:3], 0
    s_waitcnt vmcnt(18)
    s_barrier
    ds_read_b64_tr_b16 a[96:97], v188 offset:16384
    v_mfma_f32_16x16x32_bf16 v[128:131], a[68:71], a[4:7], v[128:131]
    v_exp_f32 v144, v144
    v_mfma_f32_16x16x32_bf16 v[128:131], a[72:75], a[8:11], v[128:131]
    ds_read_b64_tr_b16 a[98:99], v188 offset:20480
    v_exp_f32 v145, v145
    v_mfma_f32_16x16x32_bf16 v[128:131], a[76:79], a[12:15], v[128:131]
    v_exp_f32 v146, v146
    v_mfma_f32_16x16x32_bf16 v[136:139], a[64:67], a[16:19], 0
    ds_read_b64_tr_b16 a[100:101], v189 offset:16384
    v_exp_f32 v147, v147
    v_mfma_f32_16x16x32_bf16 v[136:139], a[68:71], a[20:23], v[136:139]
    v_exp_f32 v148, v148
    v_cvt_pk_bf16_f32 v168, v144, v145
    v_mfma_f32_16x16x32_bf16 v[136:139], a[72:75], a[24:27], v[136:139]
    ds_read_b64_tr_b16 a[102:103], v189 offset:20480
    v_exp_f32 v149, v149
    v_mfma_f32_16x16x32_bf16 v[136:139], a[76:79], a[28:31], v[136:139]
    v_exp_f32 v150, v150
    v_cvt_pk_bf16_f32 v169, v146, v147
    v_mfma_f32_16x16x32_bf16 v[132:135], a[80:83], a[0:3], 0
    ds_read_b64_tr_b16 a[104:105], v190 offset:16384
    v_exp_f32 v151, v151
    v_mfma_f32_16x16x32_bf16 v[132:135], a[84:87], a[4:7], v[132:135]
    s_add_u32 m0, s30, 65536
    s_nop 0
    buffer_load_dwordx4 v200, s[20:23], s29 offen offset:0 nt lds
    v_mfma_f32_16x16x32_bf16 v[132:135], a[88:91], a[8:11], v[132:135]
    ds_read_b64_tr_b16 a[106:107], v190 offset:20480
    v_cvt_pk_bf16_f32 v170, v148, v149
    v_mfma_f32_16x16x32_bf16 v[132:135], a[92:95], a[12:15], v[132:135]
    v_exp_f32 v152, v152
    v_cvt_pk_bf16_f32 v171, v150, v151
    v_mfma_f32_16x16x32_bf16 v[140:143], a[80:83], a[16:19], 0
    ds_read_b64_tr_b16 a[108:109], v191 offset:16384
    v_mfma_f32_16x16x32_bf16 v[140:143], a[84:87], a[20:23], v[140:143]
    v_exp_f32 v153, v153
    v_mfma_f32_16x16x32_bf16 v[140:143], a[88:91], a[24:27], v[140:143]
    ds_read_b64_tr_b16 a[110:111], v191 offset:20480
    v_cvt_pk_bf16_f32 v172, v152, v153
    v_mfma_f32_16x16x32_bf16 v[140:143], a[92:95], a[28:31], v[140:143]
    v_exp_f32 v154, v154
    v_mfma_f32_16x16x32_bf16 v[176:179], v[242:245], v[160:163], v[176:179]
    ds_read_b64_tr_b16 a[112:113], v192 offset:16384
    v_mfma_f32_16x16x32_bf16 v[184:187], v[242:245], v[164:167], v[184:187]
    ds_read_b64_tr_b16 a[114:115], v192 offset:20480
    s_waitcnt lgkmcnt(6)
    v_mfma_f32_16x16x32_bf16 v[0:3], a[96:99], v[160:163], v[0:3]
    v_exp_f32 v155, v155
    v_mfma_f32_16x16x32_bf16 v[32:35], a[96:99], v[164:167], v[32:35]
    ds_read_b64_tr_b16 a[116:117], v193 offset:16384
    v_cvt_pk_bf16_f32 v173, v154, v155
    v_mfma_f32_16x16x32_bf16 v[4:7], a[100:103], v[160:163], v[4:7]
    ds_read_b64_tr_b16 a[118:119], v193 offset:20480
    v_mfma_f32_16x16x32_bf16 v[36:39], a[100:103], v[164:167], v[36:39]
    s_waitcnt lgkmcnt(4)
    v_mfma_f32_16x16x32_bf16 v[8:11], a[104:107], v[160:163], v[8:11]
    ds_read_b64_tr_b16 a[120:121], v194 offset:16384
    v_mfma_f32_16x16x32_bf16 v[40:43], a[104:107], v[164:167], v[40:43]
    ds_read_b64_tr_b16 a[122:123], v194 offset:20480
    v_mfma_f32_16x16x32_bf16 v[12:15], a[108:111], v[160:163], v[12:15]
    v_exp_f32 v156, v156
    v_mfma_f32_16x16x32_bf16 v[44:47], a[108:111], v[164:167], v[44:47]
    ds_read_b64_tr_b16 a[124:125], v195 offset:16384
    s_waitcnt lgkmcnt(3)
    v_mfma_f32_16x16x32_bf16 v[16:19], a[112:115], v[160:163], v[16:19]
    ds_read_b64_tr_b16 a[126:127], v195 offset:20480
    v_mfma_f32_16x16x32_bf16 v[48:51], a[112:115], v[164:167], v[48:51]
    v_exp_f32 v157, v157
    v_mfma_f32_16x16x32_bf16 v[20:23], a[116:119], v[160:163], v[20:23]
    buffer_load_dwordx4 v201, s[20:23], s29 offen offset:1024 nt lds
    v_cvt_pk_bf16_f32 v174, v156, v157
    v_mfma_f32_16x16x32_bf16 v[52:55], a[116:119], v[164:167], v[52:55]
    s_waitcnt lgkmcnt(0)
    v_mfma_f32_16x16x32_bf16 v[24:27], a[120:123], v[160:163], v[24:27]
    v_exp_f32 v158, v158
    v_mfma_f32_16x16x32_bf16 v[56:59], a[120:123], v[164:167], v[56:59]
    v_exp_f32 v159, v159
    v_mfma_f32_16x16x32_bf16 v[28:31], a[124:127], v[160:163], v[28:31]
    v_cvt_pk_bf16_f32 v175, v158, v159
    v_mfma_f32_16x16x32_bf16 v[60:63], a[124:127], v[164:167], v[60:63]
    v_mfma_f32_16x16x32_bf16 v[144:147], a[64:67], a[32:35], 0
    v_exp_f32 v128, v128
    s_waitcnt vmcnt(17)
    v_accvgpr_read_b32 v234, a248
    v_mfma_f32_16x16x32_bf16 v[144:147], a[68:71], a[36:39], v[144:147]
    v_exp_f32 v129, v129
    v_mfma_f32_16x16x32_bf16 v[144:147], a[72:75], a[40:43], v[144:147]
    v_exp_f32 v130, v130
    v_accvgpr_read_b32 v235, a249
    v_mfma_f32_16x16x32_bf16 v[144:147], a[76:79], a[44:47], v[144:147]
    v_exp_f32 v131, v131
    v_accvgpr_read_b32 v236, a250
    v_mfma_f32_16x16x32_bf16 v[152:155], a[64:67], a[48:51], 0
    v_exp_f32 v132, v132
    v_cvt_pk_bf16_f32 v160, v128, v129
    v_accvgpr_read_b32 v237, a251
    v_mfma_f32_16x16x32_bf16 v[152:155], a[68:71], a[52:55], v[152:155]
    v_exp_f32 v133, v133
    v_mfma_f32_16x16x32_bf16 v[152:155], a[72:75], a[56:59], v[152:155]
    ds_read_b128 a[64:67], v180 offset:32768
    v_cvt_pk_bf16_f32 v161, v130, v131
    v_lshlrev_b32 v226, 16, v234
    v_mfma_f32_16x16x32_bf16 v[152:155], a[76:79], a[60:63], v[152:155]
    v_exp_f32 v134, v134
    v_and_b32 v227, s37, v234
    v_mfma_f32_16x16x32_bf16 v[148:151], a[80:83], a[32:35], 0
    ds_read_b128 a[68:71], v181 offset:32768
    v_cvt_pk_bf16_f32 v162, v132, v133
    v_lshlrev_b32 v228, 16, v235
    v_mfma_f32_16x16x32_bf16 v[148:151], a[84:87], a[36:39], v[148:151]
    buffer_load_dwordx4 v200, s[20:23], s29 offen offset:2048 nt lds
    v_mfma_f32_16x16x32_bf16 v[148:151], a[88:91], a[40:43], v[148:151]
    ds_read_b128 a[72:75], v182 offset:32768
    v_and_b32 v229, s37, v235
    v_mfma_f32_16x16x32_bf16 v[148:151], a[92:95], a[44:47], v[148:151]
    v_exp_f32 v135, v135
    v_lshlrev_b32 v230, 16, v236
    v_mfma_f32_16x16x32_bf16 v[156:159], a[80:83], a[48:51], 0
    ds_read_b128 a[76:79], v183 offset:32768
    v_cvt_pk_bf16_f32 v163, v134, v135
    v_and_b32 v231, s37, v236
    v_mfma_f32_16x16x32_bf16 v[156:159], a[84:87], a[52:55], v[156:159]
    v_exp_f32 v136, v136
    v_mfma_f32_16x16x32_bf16 v[156:159], a[88:91], a[56:59], v[156:159]
    ds_read_b128 a[80:83], v180 offset:36864
    v_lshlrev_b32 v232, 16, v237
    v_mfma_f32_16x16x32_bf16 v[156:159], a[92:95], a[60:63], v[156:159]
    v_exp_f32 v137, v137
    v_and_b32 v233, s37, v237
    v_mfma_f32_16x16x32_bf16 v[222:225], v[242:245], v[168:171], v[222:225]
    ds_read_b128 a[84:87], v181 offset:36864
    v_cvt_pk_bf16_f32 v164, v136, v137
    v_mfma_f32_16x16x32_bf16 v[246:249], v[242:245], v[172:175], v[246:249]
    v_exp_f32 v138, v138
    v_mul_f32 v226, s34, v226
    v_mfma_f32_16x16x32_bf16 v[64:67], a[96:99], v[168:171], v[64:67]
    ds_read_b128 a[88:91], v182 offset:36864
    v_mul_f32 v227, s34, v227
    v_mfma_f32_16x16x32_bf16 v[96:99], a[96:99], v[172:175], v[96:99]
    v_exp_f32 v139, v139
    v_mul_f32 v228, s34, v228
    v_mfma_f32_16x16x32_bf16 v[68:71], a[100:103], v[168:171], v[68:71]
    ds_read_b128 a[92:95], v183 offset:36864
    v_cvt_pk_bf16_f32 v165, v138, v139
    v_mfma_f32_16x16x32_bf16 v[100:103], a[100:103], v[172:175], v[100:103]
    v_exp_f32 v140, v140
    v_mul_f32 v229, s34, v229
    v_mfma_f32_16x16x32_bf16 v[72:75], a[104:107], v[168:171], v[72:75]
    v_exp_f32 v141, v141
    v_mul_f32 v230, s34, v230
    v_mfma_f32_16x16x32_bf16 v[104:107], a[104:107], v[172:175], v[104:107]
    v_exp_f32 v142, v142
    v_mul_f32 v231, s34, v231
    v_mfma_f32_16x16x32_bf16 v[76:79], a[108:111], v[168:171], v[76:79]
    v_exp_f32 v143, v143
    v_mfma_f32_16x16x32_bf16 v[108:111], a[108:111], v[172:175], v[108:111]
    v_cvt_pk_bf16_f32 v166, v140, v141
    v_cvt_pk_bf16_f32 v167, v142, v143
    v_mul_f32 v232, s34, v232
    v_mfma_f32_16x16x32_bf16 v[80:83], a[112:115], v[168:171], v[80:83]
    v_mul_f32 v233, s34, v233
    v_mfma_f32_16x16x32_bf16 v[112:115], a[112:115], v[172:175], v[112:115]
    buffer_load_dwordx4 v201, s[20:23], s29 offen offset:3072 nt lds
    s_add_u32 s29, s29, 16384
    v_cvt_pk_bf16_f32 v238, v226, v227
    v_mfma_f32_16x16x32_bf16 v[84:87], a[116:119], v[168:171], v[84:87]
    v_mfma_f32_16x16x32_bf16 v[116:119], a[116:119], v[172:175], v[116:119]
    v_cvt_pk_bf16_f32 v239, v228, v229
    v_mfma_f32_16x16x32_bf16 v[88:91], a[120:123], v[168:171], v[88:91]
    v_cvt_pk_bf16_f32 v240, v230, v231
    v_mfma_f32_16x16x32_bf16 v[120:123], a[120:123], v[172:175], v[120:123]
    v_cvt_pk_bf16_f32 v241, v232, v233
    v_mfma_f32_16x16x32_bf16 v[92:95], a[124:127], v[168:171], v[92:95]
    v_mfma_f32_16x16x32_bf16 v[124:127], a[124:127], v[172:175], v[124:127]
    ds_write_b128 v205, v[238:241] offset:6144
    s_waitcnt lgkmcnt(1)
    v_mfma_f32_16x16x32_bf16 v[128:131], a[64:67], a[0:3], 0
    ds_read_b64_tr_b16 a[96:97], v188 offset:24576
    v_exp_f32 v144, v144
    v_mfma_f32_16x16x32_bf16 v[128:131], a[68:71], a[4:7], v[128:131]
    v_exp_f32 v145, v145
    v_mfma_f32_16x16x32_bf16 v[128:131], a[72:75], a[8:11], v[128:131]
    ds_read_b64_tr_b16 a[98:99], v188 offset:28672
    v_exp_f32 v146, v146
    v_mfma_f32_16x16x32_bf16 v[128:131], a[76:79], a[12:15], v[128:131]
    v_exp_f32 v147, v147
    v_mfma_f32_16x16x32_bf16 v[136:139], a[64:67], a[16:19], 0
    ds_read_b64_tr_b16 a[100:101], v189 offset:24576
    v_exp_f32 v148, v148
    v_mfma_f32_16x16x32_bf16 v[136:139], a[68:71], a[20:23], v[136:139]
    v_exp_f32 v149, v149
    v_cvt_pk_bf16_f32 v168, v144, v145
    v_mfma_f32_16x16x32_bf16 v[136:139], a[72:75], a[24:27], v[136:139]
    ds_read_b64_tr_b16 a[102:103], v189 offset:28672
    v_exp_f32 v150, v150
    v_mfma_f32_16x16x32_bf16 v[136:139], a[76:79], a[28:31], v[136:139]
    v_exp_f32 v151, v151
    v_cvt_pk_bf16_f32 v169, v146, v147
    v_mfma_f32_16x16x32_bf16 v[132:135], a[80:83], a[0:3], 0
    ds_read_b64_tr_b16 a[104:105], v190 offset:24576
    v_cvt_pk_bf16_f32 v170, v148, v149
    v_mfma_f32_16x16x32_bf16 v[132:135], a[84:87], a[4:7], v[132:135]
    s_add_u32 m0, s30, 16384
    s_nop 0
    buffer_load_dwordx4 v196, s[16:19], s28 offen offset:0 nt lds
    v_mfma_f32_16x16x32_bf16 v[132:135], a[88:91], a[8:11], v[132:135]
    ds_read_b64_tr_b16 a[106:107], v190 offset:28672
    v_cvt_pk_bf16_f32 v171, v150, v151
    v_mfma_f32_16x16x32_bf16 v[132:135], a[92:95], a[12:15], v[132:135]
    v_exp_f32 v152, v152
    v_mfma_f32_16x16x32_bf16 v[140:143], a[80:83], a[16:19], 0
    ds_read_b64_tr_b16 a[108:109], v191 offset:24576
    v_mfma_f32_16x16x32_bf16 v[140:143], a[84:87], a[20:23], v[140:143]
    v_exp_f32 v153, v153
    v_mfma_f32_16x16x32_bf16 v[140:143], a[88:91], a[24:27], v[140:143]
    ds_read_b64_tr_b16 a[110:111], v191 offset:28672
    v_cvt_pk_bf16_f32 v172, v152, v153
    v_mfma_f32_16x16x32_bf16 v[140:143], a[92:95], a[28:31], v[140:143]
    v_exp_f32 v154, v154
    v_mfma_f32_16x16x32_bf16 v[176:179], v[242:245], v[160:163], v[176:179]
    ds_read_b64_tr_b16 a[112:113], v192 offset:24576
    v_mfma_f32_16x16x32_bf16 v[184:187], v[242:245], v[164:167], v[184:187]
    ds_read_b64_tr_b16 a[114:115], v192 offset:28672
    s_waitcnt lgkmcnt(6)
    v_mfma_f32_16x16x32_bf16 v[0:3], a[96:99], v[160:163], v[0:3]
    v_exp_f32 v155, v155
    v_mfma_f32_16x16x32_bf16 v[32:35], a[96:99], v[164:167], v[32:35]
    ds_read_b64_tr_b16 a[116:117], v193 offset:24576
    v_cvt_pk_bf16_f32 v173, v154, v155
    v_mfma_f32_16x16x32_bf16 v[4:7], a[100:103], v[160:163], v[4:7]
    ds_read_b64_tr_b16 a[118:119], v193 offset:28672
    v_mfma_f32_16x16x32_bf16 v[36:39], a[100:103], v[164:167], v[36:39]
    s_waitcnt lgkmcnt(4)
    v_mfma_f32_16x16x32_bf16 v[8:11], a[104:107], v[160:163], v[8:11]
    ds_read_b64_tr_b16 a[120:121], v194 offset:24576
    v_mfma_f32_16x16x32_bf16 v[40:43], a[104:107], v[164:167], v[40:43]
    ds_read_b64_tr_b16 a[122:123], v194 offset:28672
    v_mfma_f32_16x16x32_bf16 v[12:15], a[108:111], v[160:163], v[12:15]
    v_exp_f32 v156, v156
    v_mfma_f32_16x16x32_bf16 v[44:47], a[108:111], v[164:167], v[44:47]
    ds_read_b64_tr_b16 a[124:125], v195 offset:24576
    s_waitcnt lgkmcnt(3)
    v_mfma_f32_16x16x32_bf16 v[16:19], a[112:115], v[160:163], v[16:19]
    ds_read_b64_tr_b16 a[126:127], v195 offset:28672
    v_mfma_f32_16x16x32_bf16 v[48:51], a[112:115], v[164:167], v[48:51]
    v_exp_f32 v157, v157
    v_mfma_f32_16x16x32_bf16 v[20:23], a[116:119], v[160:163], v[20:23]
    buffer_load_dwordx4 v197, s[16:19], s28 offen offset:1024 nt lds
    v_cvt_pk_bf16_f32 v174, v156, v157
    v_mfma_f32_16x16x32_bf16 v[52:55], a[116:119], v[164:167], v[52:55]
    s_waitcnt lgkmcnt(0)
    v_mfma_f32_16x16x32_bf16 v[24:27], a[120:123], v[160:163], v[24:27]
    v_exp_f32 v158, v158
    v_mfma_f32_16x16x32_bf16 v[56:59], a[120:123], v[164:167], v[56:59]
    v_exp_f32 v159, v159
    v_mfma_f32_16x16x32_bf16 v[28:31], a[124:127], v[160:163], v[28:31]
    v_cvt_pk_bf16_f32 v175, v158, v159
    v_mfma_f32_16x16x32_bf16 v[60:63], a[124:127], v[164:167], v[60:63]
    v_mfma_f32_16x16x32_bf16 v[144:147], a[64:67], a[32:35], 0
    v_exp_f32 v128, v128
    s_waitcnt vmcnt(16)
    v_accvgpr_read_b32 v234, a252
    v_mfma_f32_16x16x32_bf16 v[144:147], a[68:71], a[36:39], v[144:147]
    v_exp_f32 v129, v129
    v_accvgpr_read_b32 v235, a253
    v_mfma_f32_16x16x32_bf16 v[144:147], a[72:75], a[40:43], v[144:147]
    v_exp_f32 v130, v130
    v_accvgpr_read_b32 v236, a254
    v_mfma_f32_16x16x32_bf16 v[144:147], a[76:79], a[44:47], v[144:147]
    v_exp_f32 v131, v131
    v_accvgpr_read_b32 v237, a255
    v_mfma_f32_16x16x32_bf16 v[152:155], a[64:67], a[48:51], 0
    v_exp_f32 v132, v132
    v_cvt_pk_bf16_f32 v160, v128, v129
    v_lshlrev_b32 v226, 16, v234
    v_mfma_f32_16x16x32_bf16 v[152:155], a[68:71], a[52:55], v[152:155]
    v_exp_f32 v133, v133
    v_and_b32 v227, s37, v234
    v_mfma_f32_16x16x32_bf16 v[152:155], a[72:75], a[56:59], v[152:155]
    ds_read_b128 a[64:67], v180 offset:40960
    v_cvt_pk_bf16_f32 v161, v130, v131
    v_lshlrev_b32 v228, 16, v235
    v_mfma_f32_16x16x32_bf16 v[152:155], a[76:79], a[60:63], v[152:155]
    v_exp_f32 v134, v134
    v_and_b32 v229, s37, v235
    v_mfma_f32_16x16x32_bf16 v[148:151], a[80:83], a[32:35], 0
    ds_read_b128 a[68:71], v181 offset:40960
    v_cvt_pk_bf16_f32 v162, v132, v133
    v_lshlrev_b32 v230, 16, v236
    v_mfma_f32_16x16x32_bf16 v[148:151], a[84:87], a[36:39], v[148:151]
    buffer_load_dwordx4 v198, s[16:19], s28 offen offset:2048 nt lds
    v_and_b32 v231, s37, v236
    v_mfma_f32_16x16x32_bf16 v[148:151], a[88:91], a[40:43], v[148:151]
    ds_read_b128 a[72:75], v182 offset:40960
    v_lshlrev_b32 v232, 16, v237
    v_mfma_f32_16x16x32_bf16 v[148:151], a[92:95], a[44:47], v[148:151]
    v_exp_f32 v135, v135
    v_and_b32 v233, s37, v237
    v_mfma_f32_16x16x32_bf16 v[156:159], a[80:83], a[48:51], 0
    ds_read_b128 a[76:79], v183 offset:40960
    v_cvt_pk_bf16_f32 v163, v134, v135
    v_mul_f32 v226, s34, v226
    v_mfma_f32_16x16x32_bf16 v[156:159], a[84:87], a[52:55], v[156:159]
    v_exp_f32 v136, v136
    v_mul_f32 v227, s34, v227
    v_mfma_f32_16x16x32_bf16 v[156:159], a[88:91], a[56:59], v[156:159]
    ds_read_b128 a[80:83], v180 offset:45056
    v_mul_f32 v228, s34, v228
    v_mfma_f32_16x16x32_bf16 v[156:159], a[92:95], a[60:63], v[156:159]
    v_exp_f32 v137, v137
    v_mul_f32 v229, s34, v229
    v_mfma_f32_16x16x32_bf16 v[222:225], v[242:245], v[168:171], v[222:225]
    ds_read_b128 a[84:87], v181 offset:45056
    v_cvt_pk_bf16_f32 v164, v136, v137
    v_mfma_f32_16x16x32_bf16 v[246:249], v[242:245], v[172:175], v[246:249]
    v_exp_f32 v138, v138
    v_mul_f32 v230, s34, v230
    v_mfma_f32_16x16x32_bf16 v[64:67], a[96:99], v[168:171], v[64:67]
    ds_read_b128 a[88:91], v182 offset:45056
    v_mul_f32 v231, s34, v231
    v_mfma_f32_16x16x32_bf16 v[96:99], a[96:99], v[172:175], v[96:99]
    v_exp_f32 v139, v139
    v_mul_f32 v232, s34, v232
    v_mfma_f32_16x16x32_bf16 v[68:71], a[100:103], v[168:171], v[68:71]
    ds_read_b128 a[92:95], v183 offset:45056
    v_cvt_pk_bf16_f32 v165, v138, v139
    v_mul_f32 v233, s34, v233
    v_mfma_f32_16x16x32_bf16 v[100:103], a[100:103], v[172:175], v[100:103]
    v_exp_f32 v140, v140
    v_cvt_pk_bf16_f32 v238, v226, v227
    v_mfma_f32_16x16x32_bf16 v[72:75], a[104:107], v[168:171], v[72:75]
    v_exp_f32 v141, v141
    v_cvt_pk_bf16_f32 v239, v228, v229
    v_mfma_f32_16x16x32_bf16 v[104:107], a[104:107], v[172:175], v[104:107]
    v_exp_f32 v142, v142
    v_cvt_pk_bf16_f32 v240, v230, v231
    v_mfma_f32_16x16x32_bf16 v[76:79], a[108:111], v[168:171], v[76:79]
    v_exp_f32 v143, v143
    v_cvt_pk_bf16_f32 v241, v232, v233
    v_mfma_f32_16x16x32_bf16 v[108:111], a[108:111], v[172:175], v[108:111]
    ds_write_b128 v205, v[238:241] offset:7168
    v_cvt_pk_bf16_f32 v166, v140, v141
    v_cvt_pk_bf16_f32 v167, v142, v143
    v_mfma_f32_16x16x32_bf16 v[80:83], a[112:115], v[168:171], v[80:83]
    ds_read_b128 a[160:163], v214 offset:0
    v_mfma_f32_16x16x32_bf16 v[112:115], a[112:115], v[172:175], v[112:115]
    buffer_load_dwordx4 v199, s[16:19], s28 offen offset:3072 nt lds
    s_add_u32 s28, s28, 16384
    ds_read_b128 a[164:167], v215 offset:0
    v_mfma_f32_16x16x32_bf16 v[84:87], a[116:119], v[168:171], v[84:87]
    ds_read_b128 a[168:171], v216 offset:0
    v_mfma_f32_16x16x32_bf16 v[116:119], a[116:119], v[172:175], v[116:119]
    ds_read_b128 a[172:175], v217 offset:0
    v_mfma_f32_16x16x32_bf16 v[88:91], a[120:123], v[168:171], v[88:91]
    ds_read_b128 a[176:179], v214 offset:4096
    v_mfma_f32_16x16x32_bf16 v[120:123], a[120:123], v[172:175], v[120:123]
    ds_read_b128 a[180:183], v215 offset:4096
    v_mfma_f32_16x16x32_bf16 v[92:95], a[124:127], v[168:171], v[92:95]
    ds_read_b128 a[184:187], v216 offset:4096
    v_mfma_f32_16x16x32_bf16 v[124:127], a[124:127], v[172:175], v[124:127]
    ds_read_b128 a[188:191], v217 offset:4096
    s_waitcnt lgkmcnt(9)
    v_mfma_f32_16x16x32_bf16 v[128:131], a[64:67], a[0:3], 0
    s_waitcnt vmcnt(16)
    s_barrier
    ds_read_b64_tr_b16 a[96:97], v188 offset:32768
    v_mfma_f32_16x16x32_bf16 v[128:131], a[68:71], a[4:7], v[128:131]
    v_exp_f32 v144, v144
    v_mfma_f32_16x16x32_bf16 v[128:131], a[72:75], a[8:11], v[128:131]
    ds_read_b64_tr_b16 a[98:99], v188 offset:36864
    v_exp_f32 v145, v145
    v_mfma_f32_16x16x32_bf16 v[128:131], a[76:79], a[12:15], v[128:131]
    v_exp_f32 v146, v146
    v_mfma_f32_16x16x32_bf16 v[136:139], a[64:67], a[16:19], 0
    ds_read_b64_tr_b16 a[100:101], v189 offset:32768
    v_exp_f32 v147, v147
    v_mfma_f32_16x16x32_bf16 v[136:139], a[68:71], a[20:23], v[136:139]
    v_exp_f32 v148, v148
    v_cvt_pk_bf16_f32 v168, v144, v145
    v_mfma_f32_16x16x32_bf16 v[136:139], a[72:75], a[24:27], v[136:139]
    ds_read_b64_tr_b16 a[102:103], v189 offset:36864
    v_exp_f32 v149, v149
    v_mfma_f32_16x16x32_bf16 v[136:139], a[76:79], a[28:31], v[136:139]
    v_exp_f32 v150, v150
    v_cvt_pk_bf16_f32 v169, v146, v147
    v_mfma_f32_16x16x32_bf16 v[132:135], a[80:83], a[0:3], 0
    ds_read_b64_tr_b16 a[104:105], v190 offset:32768
    v_exp_f32 v151, v151
    v_mfma_f32_16x16x32_bf16 v[132:135], a[84:87], a[4:7], v[132:135]
    s_add_u32 m0, s30, 81920
    s_nop 0
    buffer_load_dwordx4 v200, s[20:23], s29 offen offset:0 nt lds
    v_mfma_f32_16x16x32_bf16 v[132:135], a[88:91], a[8:11], v[132:135]
    ds_read_b64_tr_b16 a[106:107], v190 offset:36864
    v_cvt_pk_bf16_f32 v170, v148, v149
    v_mfma_f32_16x16x32_bf16 v[132:135], a[92:95], a[12:15], v[132:135]
    v_exp_f32 v152, v152
    v_cvt_pk_bf16_f32 v171, v150, v151
    v_mfma_f32_16x16x32_bf16 v[140:143], a[80:83], a[16:19], 0
    ds_read_b64_tr_b16 a[108:109], v191 offset:32768
    v_mfma_f32_16x16x32_bf16 v[140:143], a[84:87], a[20:23], v[140:143]
    v_exp_f32 v153, v153
    v_mfma_f32_16x16x32_bf16 v[140:143], a[88:91], a[24:27], v[140:143]
    ds_read_b64_tr_b16 a[110:111], v191 offset:36864
    v_cvt_pk_bf16_f32 v172, v152, v153
    v_mfma_f32_16x16x32_bf16 v[140:143], a[92:95], a[28:31], v[140:143]
    v_exp_f32 v154, v154
    v_mfma_f32_16x16x32_bf16 v[176:179], v[242:245], v[160:163], v[176:179]
    ds_read_b64_tr_b16 a[112:113], v192 offset:32768
    v_mfma_f32_16x16x32_bf16 v[184:187], v[242:245], v[164:167], v[184:187]
    ds_read_b64_tr_b16 a[114:115], v192 offset:36864
    s_waitcnt lgkmcnt(6)
    v_mfma_f32_16x16x32_bf16 v[0:3], a[96:99], v[160:163], v[0:3]
    v_exp_f32 v155, v155
    v_mfma_f32_16x16x32_bf16 v[32:35], a[96:99], v[164:167], v[32:35]
    ds_read_b64_tr_b16 a[116:117], v193 offset:32768
    v_cvt_pk_bf16_f32 v173, v154, v155
    v_mfma_f32_16x16x32_bf16 v[4:7], a[100:103], v[160:163], v[4:7]
    ds_read_b64_tr_b16 a[118:119], v193 offset:36864
    v_mfma_f32_16x16x32_bf16 v[36:39], a[100:103], v[164:167], v[36:39]
    s_waitcnt lgkmcnt(4)
    v_mfma_f32_16x16x32_bf16 v[8:11], a[104:107], v[160:163], v[8:11]
    ds_read_b64_tr_b16 a[120:121], v194 offset:32768
    v_mfma_f32_16x16x32_bf16 v[40:43], a[104:107], v[164:167], v[40:43]
    ds_read_b64_tr_b16 a[122:123], v194 offset:36864
    v_mfma_f32_16x16x32_bf16 v[12:15], a[108:111], v[160:163], v[12:15]
    v_exp_f32 v156, v156
    v_mfma_f32_16x16x32_bf16 v[44:47], a[108:111], v[164:167], v[44:47]
    ds_read_b64_tr_b16 a[124:125], v195 offset:32768
    s_waitcnt lgkmcnt(3)
    v_mfma_f32_16x16x32_bf16 v[16:19], a[112:115], v[160:163], v[16:19]
    ds_read_b64_tr_b16 a[126:127], v195 offset:36864
    v_mfma_f32_16x16x32_bf16 v[48:51], a[112:115], v[164:167], v[48:51]
    v_exp_f32 v157, v157
    v_mfma_f32_16x16x32_bf16 v[20:23], a[116:119], v[160:163], v[20:23]
    buffer_load_dwordx4 v201, s[20:23], s29 offen offset:1024 nt lds
    v_cvt_pk_bf16_f32 v174, v156, v157
    v_mfma_f32_16x16x32_bf16 v[52:55], a[116:119], v[164:167], v[52:55]
    s_waitcnt lgkmcnt(0)
    v_mfma_f32_16x16x32_bf16 v[24:27], a[120:123], v[160:163], v[24:27]
    v_exp_f32 v158, v158
    v_mfma_f32_16x16x32_bf16 v[56:59], a[120:123], v[164:167], v[56:59]
    v_exp_f32 v159, v159
    v_mfma_f32_16x16x32_bf16 v[28:31], a[124:127], v[160:163], v[28:31]
    v_cvt_pk_bf16_f32 v175, v158, v159
    v_mfma_f32_16x16x32_bf16 v[60:63], a[124:127], v[164:167], v[60:63]
    v_mfma_f32_16x16x32_bf16 v[144:147], a[64:67], a[32:35], 0
    v_exp_f32 v128, v128
    v_mfma_f32_16x16x32_bf16 v[144:147], a[68:71], a[36:39], v[144:147]
    v_exp_f32 v129, v129
    v_mfma_f32_16x16x32_bf16 v[144:147], a[72:75], a[40:43], v[144:147]
    v_exp_f32 v130, v130
    v_mfma_f32_16x16x32_bf16 v[144:147], a[76:79], a[44:47], v[144:147]
    v_exp_f32 v131, v131
    v_mfma_f32_16x16x32_bf16 v[152:155], a[64:67], a[48:51], 0
    v_exp_f32 v132, v132
    v_cvt_pk_bf16_f32 v160, v128, v129
    v_mfma_f32_16x16x32_bf16 v[152:155], a[68:71], a[52:55], v[152:155]
    v_exp_f32 v133, v133
    v_mfma_f32_16x16x32_bf16 v[152:155], a[72:75], a[56:59], v[152:155]
    ds_read_b128 a[64:67], v180 offset:49152
    v_cvt_pk_bf16_f32 v161, v130, v131
    v_mfma_f32_16x16x32_bf16 v[152:155], a[76:79], a[60:63], v[152:155]
    v_exp_f32 v134, v134
    v_mfma_f32_16x16x32_bf16 v[148:151], a[80:83], a[32:35], 0
    ds_read_b128 a[68:71], v181 offset:49152
    v_cvt_pk_bf16_f32 v162, v132, v133
    v_mfma_f32_16x16x32_bf16 v[148:151], a[84:87], a[36:39], v[148:151]
    buffer_load_dwordx4 v200, s[20:23], s29 offen offset:2048 nt lds
    v_mfma_f32_16x16x32_bf16 v[148:151], a[88:91], a[40:43], v[148:151]
    ds_read_b128 a[72:75], v182 offset:49152
    v_mfma_f32_16x16x32_bf16 v[148:151], a[92:95], a[44:47], v[148:151]
    v_exp_f32 v135, v135
    v_mfma_f32_16x16x32_bf16 v[156:159], a[80:83], a[48:51], 0
    ds_read_b128 a[76:79], v183 offset:49152
    v_cvt_pk_bf16_f32 v163, v134, v135
    v_mfma_f32_16x16x32_bf16 v[156:159], a[84:87], a[52:55], v[156:159]
    v_exp_f32 v136, v136
    v_mfma_f32_16x16x32_bf16 v[156:159], a[88:91], a[56:59], v[156:159]
    ds_read_b128 a[80:83], v180 offset:53248
    v_mfma_f32_16x16x32_bf16 v[156:159], a[92:95], a[60:63], v[156:159]
    v_exp_f32 v137, v137
    v_mfma_f32_16x16x32_bf16 v[222:225], v[242:245], v[168:171], v[222:225]
    ds_read_b128 a[84:87], v181 offset:53248
    v_cvt_pk_bf16_f32 v164, v136, v137
    v_mfma_f32_16x16x32_bf16 v[246:249], v[242:245], v[172:175], v[246:249]
    v_exp_f32 v138, v138
    v_mfma_f32_16x16x32_bf16 v[64:67], a[96:99], v[168:171], v[64:67]
    ds_read_b128 a[88:91], v182 offset:53248
    v_mfma_f32_16x16x32_bf16 v[96:99], a[96:99], v[172:175], v[96:99]
    v_exp_f32 v139, v139
    v_mfma_f32_16x16x32_bf16 v[68:71], a[100:103], v[168:171], v[68:71]
    ds_read_b128 a[92:95], v183 offset:53248
    v_cvt_pk_bf16_f32 v165, v138, v139
    v_mfma_f32_16x16x32_bf16 v[100:103], a[100:103], v[172:175], v[100:103]
    v_exp_f32 v140, v140
    v_mfma_f32_16x16x32_bf16 v[72:75], a[104:107], v[168:171], v[72:75]
    v_exp_f32 v141, v141
    v_mfma_f32_16x16x32_bf16 v[104:107], a[104:107], v[172:175], v[104:107]
    v_exp_f32 v142, v142
    v_mfma_f32_16x16x32_bf16 v[76:79], a[108:111], v[168:171], v[76:79]
    v_exp_f32 v143, v143
    v_mfma_f32_16x16x32_bf16 v[108:111], a[108:111], v[172:175], v[108:111]
    v_cvt_pk_bf16_f32 v166, v140, v141
    v_cvt_pk_bf16_f32 v167, v142, v143
    v_mfma_f32_16x16x32_bf16 v[80:83], a[112:115], v[168:171], v[80:83]
    v_mfma_f32_16x16x32_bf16 v[112:115], a[112:115], v[172:175], v[112:115]
    buffer_load_dwordx4 v201, s[20:23], s29 offen offset:3072 nt lds
    s_add_u32 s29, s29, 16384
    v_mfma_f32_16x16x32_bf16 v[84:87], a[116:119], v[168:171], v[84:87]
    v_mfma_f32_16x16x32_bf16 v[116:119], a[116:119], v[172:175], v[116:119]
    v_mfma_f32_16x16x32_bf16 v[88:91], a[120:123], v[168:171], v[88:91]
    v_mfma_f32_16x16x32_bf16 v[120:123], a[120:123], v[172:175], v[120:123]
    v_mfma_f32_16x16x32_bf16 v[92:95], a[124:127], v[168:171], v[92:95]
    v_mfma_f32_16x16x32_bf16 v[124:127], a[124:127], v[172:175], v[124:127]
    s_waitcnt lgkmcnt(0)
    v_mfma_f32_16x16x32_bf16 v[128:131], a[64:67], a[0:3], 0
    ds_read_b64_tr_b16 a[96:97], v188 offset:40960
    v_exp_f32 v144, v144
    v_mfma_f32_16x16x32_bf16 v[128:131], a[68:71], a[4:7], v[128:131]
    v_exp_f32 v145, v145
    v_mfma_f32_16x16x32_bf16 v[128:131], a[72:75], a[8:11], v[128:131]
    ds_read_b64_tr_b16 a[98:99], v188 offset:45056
    v_exp_f32 v146, v146
    v_mfma_f32_16x16x32_bf16 v[128:131], a[76:79], a[12:15], v[128:131]
    v_exp_f32 v147, v147
    v_mfma_f32_16x16x32_bf16 v[136:139], a[64:67], a[16:19], 0
    ds_read_b64_tr_b16 a[100:101], v189 offset:40960
    v_exp_f32 v148, v148
    v_mfma_f32_16x16x32_bf16 v[136:139], a[68:71], a[20:23], v[136:139]
    v_exp_f32 v149, v149
    v_cvt_pk_bf16_f32 v168, v144, v145
    v_mfma_f32_16x16x32_bf16 v[136:139], a[72:75], a[24:27], v[136:139]
    ds_read_b64_tr_b16 a[102:103], v189 offset:45056
    v_exp_f32 v150, v150
    v_mfma_f32_16x16x32_bf16 v[136:139], a[76:79], a[28:31], v[136:139]
    v_exp_f32 v151, v151
    v_cvt_pk_bf16_f32 v169, v146, v147
    v_mfma_f32_16x16x32_bf16 v[132:135], a[80:83], a[0:3], 0
    ds_read_b64_tr_b16 a[104:105], v190 offset:40960
    v_cvt_pk_bf16_f32 v170, v148, v149
    v_mfma_f32_16x16x32_bf16 v[132:135], a[84:87], a[4:7], v[132:135]
    s_add_u32 m0, s30, 32768
    s_nop 0
    buffer_load_dwordx4 v196, s[16:19], s28 offen offset:0 nt lds
    v_mfma_f32_16x16x32_bf16 v[132:135], a[88:91], a[8:11], v[132:135]
    ds_read_b64_tr_b16 a[106:107], v190 offset:45056
    v_cvt_pk_bf16_f32 v171, v150, v151
    v_mfma_f32_16x16x32_bf16 v[132:135], a[92:95], a[12:15], v[132:135]
    v_exp_f32 v152, v152
    v_mfma_f32_16x16x32_bf16 v[140:143], a[80:83], a[16:19], 0
    ds_read_b64_tr_b16 a[108:109], v191 offset:40960
    v_mfma_f32_16x16x32_bf16 v[140:143], a[84:87], a[20:23], v[140:143]
    v_exp_f32 v153, v153
    v_mfma_f32_16x16x32_bf16 v[140:143], a[88:91], a[24:27], v[140:143]
    ds_read_b64_tr_b16 a[110:111], v191 offset:45056
    v_cvt_pk_bf16_f32 v172, v152, v153
    v_mfma_f32_16x16x32_bf16 v[140:143], a[92:95], a[28:31], v[140:143]
    v_exp_f32 v154, v154
    v_mfma_f32_16x16x32_bf16 v[176:179], v[242:245], v[160:163], v[176:179]
    ds_read_b64_tr_b16 a[112:113], v192 offset:40960
    v_mfma_f32_16x16x32_bf16 v[184:187], v[242:245], v[164:167], v[184:187]
    ds_read_b64_tr_b16 a[114:115], v192 offset:45056
    s_waitcnt lgkmcnt(6)
    v_mfma_f32_16x16x32_bf16 v[0:3], a[96:99], v[160:163], v[0:3]
    v_exp_f32 v155, v155
    v_mfma_f32_16x16x32_bf16 v[32:35], a[96:99], v[164:167], v[32:35]
    ds_read_b64_tr_b16 a[116:117], v193 offset:40960
    v_cvt_pk_bf16_f32 v173, v154, v155
    v_mfma_f32_16x16x32_bf16 v[4:7], a[100:103], v[160:163], v[4:7]
    ds_read_b64_tr_b16 a[118:119], v193 offset:45056
    v_mfma_f32_16x16x32_bf16 v[36:39], a[100:103], v[164:167], v[36:39]
    s_waitcnt lgkmcnt(4)
    v_mfma_f32_16x16x32_bf16 v[8:11], a[104:107], v[160:163], v[8:11]
    ds_read_b64_tr_b16 a[120:121], v194 offset:40960
    v_mfma_f32_16x16x32_bf16 v[40:43], a[104:107], v[164:167], v[40:43]
    ds_read_b64_tr_b16 a[122:123], v194 offset:45056
    v_mfma_f32_16x16x32_bf16 v[12:15], a[108:111], v[160:163], v[12:15]
    v_exp_f32 v156, v156
    v_mfma_f32_16x16x32_bf16 v[44:47], a[108:111], v[164:167], v[44:47]
    ds_read_b64_tr_b16 a[124:125], v195 offset:40960
    s_waitcnt lgkmcnt(3)
    v_mfma_f32_16x16x32_bf16 v[16:19], a[112:115], v[160:163], v[16:19]
    ds_read_b64_tr_b16 a[126:127], v195 offset:45056
    v_mfma_f32_16x16x32_bf16 v[48:51], a[112:115], v[164:167], v[48:51]
    v_exp_f32 v157, v157
    v_mfma_f32_16x16x32_bf16 v[20:23], a[116:119], v[160:163], v[20:23]
    buffer_load_dwordx4 v197, s[16:19], s28 offen offset:1024 nt lds
    v_cvt_pk_bf16_f32 v174, v156, v157
    v_mfma_f32_16x16x32_bf16 v[52:55], a[116:119], v[164:167], v[52:55]
    s_waitcnt lgkmcnt(0)
    v_mfma_f32_16x16x32_bf16 v[24:27], a[120:123], v[160:163], v[24:27]
    v_exp_f32 v158, v158
    v_mfma_f32_16x16x32_bf16 v[56:59], a[120:123], v[164:167], v[56:59]
    v_exp_f32 v159, v159
    v_mfma_f32_16x16x32_bf16 v[28:31], a[124:127], v[160:163], v[28:31]
    v_cvt_pk_bf16_f32 v175, v158, v159
    v_mfma_f32_16x16x32_bf16 v[60:63], a[124:127], v[164:167], v[60:63]
    v_mfma_f32_16x16x32_bf16 v[144:147], a[64:67], a[32:35], 0
    v_exp_f32 v128, v128
    v_mfma_f32_16x16x32_bf16 v[144:147], a[68:71], a[36:39], v[144:147]
    v_exp_f32 v129, v129
    v_mfma_f32_16x16x32_bf16 v[144:147], a[72:75], a[40:43], v[144:147]
    v_exp_f32 v130, v130
    v_mfma_f32_16x16x32_bf16 v[144:147], a[76:79], a[44:47], v[144:147]
    v_exp_f32 v131, v131
    v_mfma_f32_16x16x32_bf16 v[152:155], a[64:67], a[48:51], 0
    v_exp_f32 v132, v132
    v_cvt_pk_bf16_f32 v160, v128, v129
    v_mfma_f32_16x16x32_bf16 v[152:155], a[68:71], a[52:55], v[152:155]
    v_exp_f32 v133, v133
    v_mfma_f32_16x16x32_bf16 v[152:155], a[72:75], a[56:59], v[152:155]
    ds_read_b128 a[64:67], v180 offset:57344
    v_cvt_pk_bf16_f32 v161, v130, v131
    v_mfma_f32_16x16x32_bf16 v[152:155], a[76:79], a[60:63], v[152:155]
    v_exp_f32 v134, v134
    v_mfma_f32_16x16x32_bf16 v[148:151], a[80:83], a[32:35], 0
    ds_read_b128 a[68:71], v181 offset:57344
    v_cvt_pk_bf16_f32 v162, v132, v133
    v_mfma_f32_16x16x32_bf16 v[148:151], a[84:87], a[36:39], v[148:151]
    buffer_load_dwordx4 v198, s[16:19], s28 offen offset:2048 nt lds
    v_mfma_f32_16x16x32_bf16 v[148:151], a[88:91], a[40:43], v[148:151]
    ds_read_b128 a[72:75], v182 offset:57344
    v_mfma_f32_16x16x32_bf16 v[148:151], a[92:95], a[44:47], v[148:151]
    v_exp_f32 v135, v135
    v_mfma_f32_16x16x32_bf16 v[156:159], a[80:83], a[48:51], 0
    ds_read_b128 a[76:79], v183 offset:57344
    v_cvt_pk_bf16_f32 v163, v134, v135
    v_mfma_f32_16x16x32_bf16 v[156:159], a[84:87], a[52:55], v[156:159]
    v_exp_f32 v136, v136
    v_mfma_f32_16x16x32_bf16 v[156:159], a[88:91], a[56:59], v[156:159]
    ds_read_b128 a[80:83], v180 offset:61440
    v_mfma_f32_16x16x32_bf16 v[156:159], a[92:95], a[60:63], v[156:159]
    v_exp_f32 v137, v137
    v_mfma_f32_16x16x32_bf16 v[222:225], v[242:245], v[168:171], v[222:225]
    ds_read_b128 a[84:87], v181 offset:61440
    v_cvt_pk_bf16_f32 v164, v136, v137
    v_mfma_f32_16x16x32_bf16 v[246:249], v[242:245], v[172:175], v[246:249]
    v_exp_f32 v138, v138
    v_mfma_f32_16x16x32_bf16 v[64:67], a[96:99], v[168:171], v[64:67]
    ds_read_b128 a[88:91], v182 offset:61440
    v_mfma_f32_16x16x32_bf16 v[96:99], a[96:99], v[172:175], v[96:99]
    v_exp_f32 v139, v139
    v_mfma_f32_16x16x32_bf16 v[68:71], a[100:103], v[168:171], v[68:71]
    ds_read_b128 a[92:95], v183 offset:61440
    v_cvt_pk_bf16_f32 v165, v138, v139
    v_mfma_f32_16x16x32_bf16 v[100:103], a[100:103], v[172:175], v[100:103]
    v_exp_f32 v140, v140
    v_mfma_f32_16x16x32_bf16 v[72:75], a[104:107], v[168:171], v[72:75]
    v_exp_f32 v141, v141
    v_mfma_f32_16x16x32_bf16 v[104:107], a[104:107], v[172:175], v[104:107]
    v_exp_f32 v142, v142
    v_mfma_f32_16x16x32_bf16 v[76:79], a[108:111], v[168:171], v[76:79]
    v_exp_f32 v143, v143
    v_mfma_f32_16x16x32_bf16 v[108:111], a[108:111], v[172:175], v[108:111]
    v_cvt_pk_bf16_f32 v166, v140, v141
    v_cvt_pk_bf16_f32 v167, v142, v143
    v_mfma_f32_16x16x32_bf16 v[80:83], a[112:115], v[168:171], v[80:83]
    v_mfma_f32_16x16x32_bf16 v[112:115], a[112:115], v[172:175], v[112:115]
    buffer_load_dwordx4 v199, s[16:19], s28 offen offset:3072 nt lds
    s_add_u32 s28, s28, 16384
    v_mfma_f32_16x16x32_bf16 v[84:87], a[116:119], v[168:171], v[84:87]
    v_mfma_f32_16x16x32_bf16 v[116:119], a[116:119], v[172:175], v[116:119]
    v_mfma_f32_16x16x32_bf16 v[88:91], a[120:123], v[168:171], v[88:91]
    v_mfma_f32_16x16x32_bf16 v[120:123], a[120:123], v[172:175], v[120:123]
    v_mfma_f32_16x16x32_bf16 v[92:95], a[124:127], v[168:171], v[92:95]
    v_mfma_f32_16x16x32_bf16 v[124:127], a[124:127], v[172:175], v[124:127]
    s_waitcnt lgkmcnt(0)
    v_mfma_f32_16x16x32_bf16 v[128:131], a[64:67], a[0:3], 0
    s_waitcnt vmcnt(16)
    s_barrier
    ds_read_b64_tr_b16 a[96:97], v188 offset:49152
    v_mfma_f32_16x16x32_bf16 v[128:131], a[68:71], a[4:7], v[128:131]
    v_exp_f32 v144, v144
    v_mfma_f32_16x16x32_bf16 v[128:131], a[72:75], a[8:11], v[128:131]
    ds_read_b64_tr_b16 a[98:99], v188 offset:53248
    v_exp_f32 v145, v145
    v_mfma_f32_16x16x32_bf16 v[128:131], a[76:79], a[12:15], v[128:131]
    v_exp_f32 v146, v146
    v_mfma_f32_16x16x32_bf16 v[136:139], a[64:67], a[16:19], 0
    ds_read_b64_tr_b16 a[100:101], v189 offset:49152
    v_exp_f32 v147, v147
    v_mfma_f32_16x16x32_bf16 v[136:139], a[68:71], a[20:23], v[136:139]
    v_exp_f32 v148, v148
    v_cvt_pk_bf16_f32 v168, v144, v145
    v_mfma_f32_16x16x32_bf16 v[136:139], a[72:75], a[24:27], v[136:139]
    ds_read_b64_tr_b16 a[102:103], v189 offset:53248
    v_exp_f32 v149, v149
    v_mfma_f32_16x16x32_bf16 v[136:139], a[76:79], a[28:31], v[136:139]
    v_exp_f32 v150, v150
    v_cvt_pk_bf16_f32 v169, v146, v147
    v_mfma_f32_16x16x32_bf16 v[132:135], a[80:83], a[0:3], 0
    ds_read_b64_tr_b16 a[104:105], v190 offset:49152
    v_exp_f32 v151, v151
    v_mfma_f32_16x16x32_bf16 v[132:135], a[84:87], a[4:7], v[132:135]
    s_add_u32 m0, s30, 98304
    s_nop 0
    buffer_load_dwordx4 v200, s[20:23], s29 offen offset:0 nt lds
    v_mfma_f32_16x16x32_bf16 v[132:135], a[88:91], a[8:11], v[132:135]
    ds_read_b64_tr_b16 a[106:107], v190 offset:53248
    v_cvt_pk_bf16_f32 v170, v148, v149
    v_mfma_f32_16x16x32_bf16 v[132:135], a[92:95], a[12:15], v[132:135]
    v_exp_f32 v152, v152
    v_cvt_pk_bf16_f32 v171, v150, v151
    v_mfma_f32_16x16x32_bf16 v[140:143], a[80:83], a[16:19], 0
    ds_read_b64_tr_b16 a[108:109], v191 offset:49152
    v_mfma_f32_16x16x32_bf16 v[140:143], a[84:87], a[20:23], v[140:143]
    v_exp_f32 v153, v153
    v_mfma_f32_16x16x32_bf16 v[140:143], a[88:91], a[24:27], v[140:143]
    ds_read_b64_tr_b16 a[110:111], v191 offset:53248
    v_cvt_pk_bf16_f32 v172, v152, v153
    v_mfma_f32_16x16x32_bf16 v[140:143], a[92:95], a[28:31], v[140:143]
    v_exp_f32 v154, v154
    v_mfma_f32_16x16x32_bf16 v[176:179], v[242:245], v[160:163], v[176:179]
    ds_read_b64_tr_b16 a[112:113], v192 offset:49152
    v_mfma_f32_16x16x32_bf16 v[184:187], v[242:245], v[164:167], v[184:187]
    ds_read_b64_tr_b16 a[114:115], v192 offset:53248
    s_waitcnt lgkmcnt(6)
    v_mfma_f32_16x16x32_bf16 v[0:3], a[96:99], v[160:163], v[0:3]
    v_exp_f32 v155, v155
    v_mfma_f32_16x16x32_bf16 v[32:35], a[96:99], v[164:167], v[32:35]
    ds_read_b64_tr_b16 a[116:117], v193 offset:49152
    v_cvt_pk_bf16_f32 v173, v154, v155
    v_mfma_f32_16x16x32_bf16 v[4:7], a[100:103], v[160:163], v[4:7]
    ds_read_b64_tr_b16 a[118:119], v193 offset:53248
    v_mfma_f32_16x16x32_bf16 v[36:39], a[100:103], v[164:167], v[36:39]
    s_waitcnt lgkmcnt(4)
    v_mfma_f32_16x16x32_bf16 v[8:11], a[104:107], v[160:163], v[8:11]
    ds_read_b64_tr_b16 a[120:121], v194 offset:49152
    v_mfma_f32_16x16x32_bf16 v[40:43], a[104:107], v[164:167], v[40:43]
    ds_read_b64_tr_b16 a[122:123], v194 offset:53248
    v_mfma_f32_16x16x32_bf16 v[12:15], a[108:111], v[160:163], v[12:15]
    v_exp_f32 v156, v156
    v_mfma_f32_16x16x32_bf16 v[44:47], a[108:111], v[164:167], v[44:47]
    ds_read_b64_tr_b16 a[124:125], v195 offset:49152
    s_waitcnt lgkmcnt(3)
    v_mfma_f32_16x16x32_bf16 v[16:19], a[112:115], v[160:163], v[16:19]
    ds_read_b64_tr_b16 a[126:127], v195 offset:53248
    v_mfma_f32_16x16x32_bf16 v[48:51], a[112:115], v[164:167], v[48:51]
    v_exp_f32 v157, v157
    v_mfma_f32_16x16x32_bf16 v[20:23], a[116:119], v[160:163], v[20:23]
    buffer_load_dwordx4 v201, s[20:23], s29 offen offset:1024 nt lds
    v_cvt_pk_bf16_f32 v174, v156, v157
    v_mfma_f32_16x16x32_bf16 v[52:55], a[116:119], v[164:167], v[52:55]
    s_waitcnt lgkmcnt(0)
    v_mfma_f32_16x16x32_bf16 v[24:27], a[120:123], v[160:163], v[24:27]
    v_exp_f32 v158, v158
    v_mfma_f32_16x16x32_bf16 v[56:59], a[120:123], v[164:167], v[56:59]
    v_exp_f32 v159, v159
    v_mfma_f32_16x16x32_bf16 v[28:31], a[124:127], v[160:163], v[28:31]
    v_cvt_pk_bf16_f32 v175, v158, v159
    v_mfma_f32_16x16x32_bf16 v[60:63], a[124:127], v[164:167], v[60:63]
    v_mfma_f32_16x16x32_bf16 v[144:147], a[64:67], a[32:35], 0
    v_exp_f32 v128, v128
    v_mfma_f32_16x16x32_bf16 v[144:147], a[68:71], a[36:39], v[144:147]
    v_exp_f32 v129, v129
    v_mfma_f32_16x16x32_bf16 v[144:147], a[72:75], a[40:43], v[144:147]
    v_exp_f32 v130, v130
    v_mfma_f32_16x16x32_bf16 v[144:147], a[76:79], a[44:47], v[144:147]
    v_exp_f32 v131, v131
    v_mfma_f32_16x16x32_bf16 v[152:155], a[64:67], a[48:51], 0
    v_exp_f32 v132, v132
    v_cvt_pk_bf16_f32 v160, v128, v129
    v_mfma_f32_16x16x32_bf16 v[152:155], a[68:71], a[52:55], v[152:155]
    v_exp_f32 v133, v133
    v_mfma_f32_16x16x32_bf16 v[152:155], a[72:75], a[56:59], v[152:155]
    ds_read_b128 a[64:67], v180 offset:0
    v_cvt_pk_bf16_f32 v161, v130, v131
    v_mfma_f32_16x16x32_bf16 v[152:155], a[76:79], a[60:63], v[152:155]
    v_exp_f32 v134, v134
    v_mfma_f32_16x16x32_bf16 v[148:151], a[80:83], a[32:35], 0
    ds_read_b128 a[68:71], v181 offset:0
    v_cvt_pk_bf16_f32 v162, v132, v133
    v_mfma_f32_16x16x32_bf16 v[148:151], a[84:87], a[36:39], v[148:151]
    buffer_load_dwordx4 v200, s[20:23], s29 offen offset:2048 nt lds
    v_mfma_f32_16x16x32_bf16 v[148:151], a[88:91], a[40:43], v[148:151]
    ds_read_b128 a[72:75], v182 offset:0
    v_mfma_f32_16x16x32_bf16 v[148:151], a[92:95], a[44:47], v[148:151]
    v_exp_f32 v135, v135
    v_mfma_f32_16x16x32_bf16 v[156:159], a[80:83], a[48:51], 0
    ds_read_b128 a[76:79], v183 offset:0
    v_cvt_pk_bf16_f32 v163, v134, v135
    v_mfma_f32_16x16x32_bf16 v[156:159], a[84:87], a[52:55], v[156:159]
    v_exp_f32 v136, v136
    v_mfma_f32_16x16x32_bf16 v[156:159], a[88:91], a[56:59], v[156:159]
    ds_read_b128 a[80:83], v180 offset:4096
    v_mfma_f32_16x16x32_bf16 v[156:159], a[92:95], a[60:63], v[156:159]
    v_exp_f32 v137, v137
    v_mfma_f32_16x16x32_bf16 v[222:225], v[242:245], v[168:171], v[222:225]
    ds_read_b128 a[84:87], v181 offset:4096
    v_cvt_pk_bf16_f32 v164, v136, v137
    v_mfma_f32_16x16x32_bf16 v[246:249], v[242:245], v[172:175], v[246:249]
    v_exp_f32 v138, v138
    v_mfma_f32_16x16x32_bf16 v[64:67], a[96:99], v[168:171], v[64:67]
    ds_read_b128 a[88:91], v182 offset:4096
    v_mfma_f32_16x16x32_bf16 v[96:99], a[96:99], v[172:175], v[96:99]
    v_exp_f32 v139, v139
    v_mfma_f32_16x16x32_bf16 v[68:71], a[100:103], v[168:171], v[68:71]
    ds_read_b128 a[92:95], v183 offset:4096
    v_cvt_pk_bf16_f32 v165, v138, v139
    v_mfma_f32_16x16x32_bf16 v[100:103], a[100:103], v[172:175], v[100:103]
    v_exp_f32 v140, v140
    v_mfma_f32_16x16x32_bf16 v[72:75], a[104:107], v[168:171], v[72:75]
    v_exp_f32 v141, v141
    v_mfma_f32_16x16x32_bf16 v[104:107], a[104:107], v[172:175], v[104:107]
    v_exp_f32 v142, v142
    v_mfma_f32_16x16x32_bf16 v[76:79], a[108:111], v[168:171], v[76:79]
    v_exp_f32 v143, v143
    v_mfma_f32_16x16x32_bf16 v[108:111], a[108:111], v[172:175], v[108:111]
    v_cvt_pk_bf16_f32 v166, v140, v141
    v_cvt_pk_bf16_f32 v167, v142, v143
    v_mfma_f32_16x16x32_bf16 v[80:83], a[112:115], v[168:171], v[80:83]
    v_mfma_f32_16x16x32_bf16 v[112:115], a[112:115], v[172:175], v[112:115]
    buffer_load_dwordx4 v201, s[20:23], s29 offen offset:3072 nt lds
    s_add_u32 s29, s29, 16384
    v_mfma_f32_16x16x32_bf16 v[84:87], a[116:119], v[168:171], v[84:87]
    v_mfma_f32_16x16x32_bf16 v[116:119], a[116:119], v[172:175], v[116:119]
    v_mfma_f32_16x16x32_bf16 v[88:91], a[120:123], v[168:171], v[88:91]
    v_mfma_f32_16x16x32_bf16 v[120:123], a[120:123], v[172:175], v[120:123]
    v_mfma_f32_16x16x32_bf16 v[92:95], a[124:127], v[168:171], v[92:95]
    v_mfma_f32_16x16x32_bf16 v[124:127], a[124:127], v[172:175], v[124:127]
    s_waitcnt lgkmcnt(0)
    v_mfma_f32_16x16x32_bf16 v[128:131], a[64:67], a[0:3], 0
    ds_read_b64_tr_b16 a[96:97], v188 offset:57344
    v_exp_f32 v144, v144
    v_mfma_f32_16x16x32_bf16 v[128:131], a[68:71], a[4:7], v[128:131]
    v_exp_f32 v145, v145
    v_mfma_f32_16x16x32_bf16 v[128:131], a[72:75], a[8:11], v[128:131]
    ds_read_b64_tr_b16 a[98:99], v188 offset:61440
    v_exp_f32 v146, v146
    v_mfma_f32_16x16x32_bf16 v[128:131], a[76:79], a[12:15], v[128:131]
    v_exp_f32 v147, v147
    v_mfma_f32_16x16x32_bf16 v[136:139], a[64:67], a[16:19], 0
    ds_read_b64_tr_b16 a[100:101], v189 offset:57344
    v_exp_f32 v148, v148
    v_mfma_f32_16x16x32_bf16 v[136:139], a[68:71], a[20:23], v[136:139]
    v_exp_f32 v149, v149
    v_cvt_pk_bf16_f32 v168, v144, v145
    v_mfma_f32_16x16x32_bf16 v[136:139], a[72:75], a[24:27], v[136:139]
    ds_read_b64_tr_b16 a[102:103], v189 offset:61440
    v_exp_f32 v150, v150
    v_mfma_f32_16x16x32_bf16 v[136:139], a[76:79], a[28:31], v[136:139]
    v_exp_f32 v151, v151
    v_cvt_pk_bf16_f32 v169, v146, v147
    v_mfma_f32_16x16x32_bf16 v[132:135], a[80:83], a[0:3], 0
    ds_read_b64_tr_b16 a[104:105], v190 offset:57344
    v_cvt_pk_bf16_f32 v170, v148, v149
    v_mfma_f32_16x16x32_bf16 v[132:135], a[84:87], a[4:7], v[132:135]
    s_add_u32 m0, s30, 49152
    s_nop 0
    buffer_load_dwordx4 v196, s[16:19], s28 offen offset:0 nt lds
    v_mfma_f32_16x16x32_bf16 v[132:135], a[88:91], a[8:11], v[132:135]
    ds_read_b64_tr_b16 a[106:107], v190 offset:61440
    v_cvt_pk_bf16_f32 v171, v150, v151
    v_mfma_f32_16x16x32_bf16 v[132:135], a[92:95], a[12:15], v[132:135]
    v_exp_f32 v152, v152
    v_mfma_f32_16x16x32_bf16 v[140:143], a[80:83], a[16:19], 0
    ds_read_b64_tr_b16 a[108:109], v191 offset:57344
    v_mfma_f32_16x16x32_bf16 v[140:143], a[84:87], a[20:23], v[140:143]
    v_exp_f32 v153, v153
    v_mfma_f32_16x16x32_bf16 v[140:143], a[88:91], a[24:27], v[140:143]
    ds_read_b64_tr_b16 a[110:111], v191 offset:61440
    v_cvt_pk_bf16_f32 v172, v152, v153
    v_mfma_f32_16x16x32_bf16 v[140:143], a[92:95], a[28:31], v[140:143]
    v_exp_f32 v154, v154
    v_mfma_f32_16x16x32_bf16 v[176:179], v[242:245], v[160:163], v[176:179]
    ds_read_b64_tr_b16 a[112:113], v192 offset:57344
    v_mfma_f32_16x16x32_bf16 v[184:187], v[242:245], v[164:167], v[184:187]
    ds_read_b64_tr_b16 a[114:115], v192 offset:61440
    s_waitcnt lgkmcnt(6)
    v_mfma_f32_16x16x32_bf16 v[0:3], a[96:99], v[160:163], v[0:3]
    v_exp_f32 v155, v155
    v_mfma_f32_16x16x32_bf16 v[32:35], a[96:99], v[164:167], v[32:35]
    ds_read_b64_tr_b16 a[116:117], v193 offset:57344
    v_cvt_pk_bf16_f32 v173, v154, v155
    v_mfma_f32_16x16x32_bf16 v[4:7], a[100:103], v[160:163], v[4:7]
    ds_read_b64_tr_b16 a[118:119], v193 offset:61440
    v_mfma_f32_16x16x32_bf16 v[36:39], a[100:103], v[164:167], v[36:39]
    s_waitcnt lgkmcnt(4)
    v_mfma_f32_16x16x32_bf16 v[8:11], a[104:107], v[160:163], v[8:11]
    ds_read_b64_tr_b16 a[120:121], v194 offset:57344
    v_mfma_f32_16x16x32_bf16 v[40:43], a[104:107], v[164:167], v[40:43]
    ds_read_b64_tr_b16 a[122:123], v194 offset:61440
    v_mfma_f32_16x16x32_bf16 v[12:15], a[108:111], v[160:163], v[12:15]
    v_exp_f32 v156, v156
    v_mfma_f32_16x16x32_bf16 v[44:47], a[108:111], v[164:167], v[44:47]
    ds_read_b64_tr_b16 a[124:125], v195 offset:57344
    s_waitcnt lgkmcnt(3)
    v_mfma_f32_16x16x32_bf16 v[16:19], a[112:115], v[160:163], v[16:19]
    ds_read_b64_tr_b16 a[126:127], v195 offset:61440
    v_mfma_f32_16x16x32_bf16 v[48:51], a[112:115], v[164:167], v[48:51]
    v_exp_f32 v157, v157
    v_mfma_f32_16x16x32_bf16 v[20:23], a[116:119], v[160:163], v[20:23]
    buffer_load_dwordx4 v197, s[16:19], s28 offen offset:1024 nt lds
    v_cvt_pk_bf16_f32 v174, v156, v157
    v_mfma_f32_16x16x32_bf16 v[52:55], a[116:119], v[164:167], v[52:55]
    s_waitcnt lgkmcnt(0)
    v_mfma_f32_16x16x32_bf16 v[24:27], a[120:123], v[160:163], v[24:27]
    v_exp_f32 v158, v158
    v_mfma_f32_16x16x32_bf16 v[56:59], a[120:123], v[164:167], v[56:59]
    v_exp_f32 v159, v159
    v_mfma_f32_16x16x32_bf16 v[28:31], a[124:127], v[160:163], v[28:31]
    v_cvt_pk_bf16_f32 v175, v158, v159
    v_mfma_f32_16x16x32_bf16 v[60:63], a[124:127], v[164:167], v[60:63]
    v_mfma_f32_16x16x32_bf16 v[144:147], a[64:67], a[32:35], 0
    v_exp_f32 v128, v128
    v_mfma_f32_16x16x32_bf16 v[144:147], a[68:71], a[36:39], v[144:147]
    v_exp_f32 v129, v129
    v_mfma_f32_16x16x32_bf16 v[144:147], a[72:75], a[40:43], v[144:147]
    v_exp_f32 v130, v130
    v_mfma_f32_16x16x32_bf16 v[144:147], a[76:79], a[44:47], v[144:147]
    v_exp_f32 v131, v131
    v_mfma_f32_16x16x32_bf16 v[152:155], a[64:67], a[48:51], 0
    v_exp_f32 v132, v132
    v_cvt_pk_bf16_f32 v160, v128, v129
    v_mfma_f32_16x16x32_bf16 v[152:155], a[68:71], a[52:55], v[152:155]
    v_exp_f32 v133, v133
    v_mfma_f32_16x16x32_bf16 v[152:155], a[72:75], a[56:59], v[152:155]
    ds_read_b128 a[64:67], v180 offset:8192
    v_cvt_pk_bf16_f32 v161, v130, v131
    v_mfma_f32_16x16x32_bf16 v[152:155], a[76:79], a[60:63], v[152:155]
    v_exp_f32 v134, v134
    v_mfma_f32_16x16x32_bf16 v[148:151], a[80:83], a[32:35], 0
    ds_read_b128 a[68:71], v181 offset:8192
    v_cvt_pk_bf16_f32 v162, v132, v133
    v_mfma_f32_16x16x32_bf16 v[148:151], a[84:87], a[36:39], v[148:151]
    buffer_load_dwordx4 v198, s[16:19], s28 offen offset:2048 nt lds
    v_mfma_f32_16x16x32_bf16 v[148:151], a[88:91], a[40:43], v[148:151]
    ds_read_b128 a[72:75], v182 offset:8192
    v_mfma_f32_16x16x32_bf16 v[148:151], a[92:95], a[44:47], v[148:151]
    v_exp_f32 v135, v135
    v_mfma_f32_16x16x32_bf16 v[156:159], a[80:83], a[48:51], 0
    ds_read_b128 a[76:79], v183 offset:8192
    v_cvt_pk_bf16_f32 v163, v134, v135
    v_mfma_f32_16x16x32_bf16 v[156:159], a[84:87], a[52:55], v[156:159]
    v_exp_f32 v136, v136
    v_mfma_f32_16x16x32_bf16 v[156:159], a[88:91], a[56:59], v[156:159]
    ds_read_b128 a[80:83], v180 offset:12288
    v_mfma_f32_16x16x32_bf16 v[156:159], a[92:95], a[60:63], v[156:159]
    v_exp_f32 v137, v137
    v_mfma_f32_16x16x32_bf16 v[222:225], v[242:245], v[168:171], v[222:225]
    ds_read_b128 a[84:87], v181 offset:12288
    v_cvt_pk_bf16_f32 v164, v136, v137
    v_mfma_f32_16x16x32_bf16 v[246:249], v[242:245], v[172:175], v[246:249]
    v_exp_f32 v138, v138
    v_mfma_f32_16x16x32_bf16 v[64:67], a[96:99], v[168:171], v[64:67]
    ds_read_b128 a[88:91], v182 offset:12288
    v_mfma_f32_16x16x32_bf16 v[96:99], a[96:99], v[172:175], v[96:99]
    v_exp_f32 v139, v139
    v_mfma_f32_16x16x32_bf16 v[68:71], a[100:103], v[168:171], v[68:71]
    ds_read_b128 a[92:95], v183 offset:12288
    v_cvt_pk_bf16_f32 v165, v138, v139
    v_mfma_f32_16x16x32_bf16 v[100:103], a[100:103], v[172:175], v[100:103]
    v_exp_f32 v140, v140
    v_mfma_f32_16x16x32_bf16 v[72:75], a[104:107], v[168:171], v[72:75]
    v_exp_f32 v141, v141
    v_mfma_f32_16x16x32_bf16 v[104:107], a[104:107], v[172:175], v[104:107]
    v_exp_f32 v142, v142
    v_mfma_f32_16x16x32_bf16 v[76:79], a[108:111], v[168:171], v[76:79]
    v_exp_f32 v143, v143
    v_mfma_f32_16x16x32_bf16 v[108:111], a[108:111], v[172:175], v[108:111]
    v_cvt_pk_bf16_f32 v166, v140, v141
    v_cvt_pk_bf16_f32 v167, v142, v143
    v_mfma_f32_16x16x32_bf16 v[80:83], a[112:115], v[168:171], v[80:83]
    v_mfma_f32_16x16x32_bf16 v[112:115], a[112:115], v[172:175], v[112:115]
    buffer_load_dwordx4 v199, s[16:19], s28 offen offset:3072 nt lds
    s_add_u32 s28, s28, 16384
    v_mfma_f32_16x16x32_bf16 v[84:87], a[116:119], v[168:171], v[84:87]
    v_mfma_f32_16x16x32_bf16 v[116:119], a[116:119], v[172:175], v[116:119]
    v_mfma_f32_16x16x32_bf16 v[88:91], a[120:123], v[168:171], v[88:91]
    v_mfma_f32_16x16x32_bf16 v[120:123], a[120:123], v[172:175], v[120:123]
    v_mfma_f32_16x16x32_bf16 v[92:95], a[124:127], v[168:171], v[92:95]
    v_mfma_f32_16x16x32_bf16 v[124:127], a[124:127], v[172:175], v[124:127]
    s_waitcnt lgkmcnt(0)
    v_mfma_f32_16x16x32_bf16 v[128:131], a[64:67], a[0:3], 0
    s_waitcnt vmcnt(16)
    s_barrier
    ds_read_b64_tr_b16 a[96:97], v188 offset:0
    v_mfma_f32_16x16x32_bf16 v[128:131], a[68:71], a[4:7], v[128:131]
    v_exp_f32 v144, v144
    v_mfma_f32_16x16x32_bf16 v[128:131], a[72:75], a[8:11], v[128:131]
    ds_read_b64_tr_b16 a[98:99], v188 offset:4096
    v_exp_f32 v145, v145
    v_mfma_f32_16x16x32_bf16 v[128:131], a[76:79], a[12:15], v[128:131]
    v_exp_f32 v146, v146
    v_mfma_f32_16x16x32_bf16 v[136:139], a[64:67], a[16:19], 0
    ds_read_b64_tr_b16 a[100:101], v189 offset:0
    v_exp_f32 v147, v147
    v_mfma_f32_16x16x32_bf16 v[136:139], a[68:71], a[20:23], v[136:139]
    v_exp_f32 v148, v148
    v_cvt_pk_bf16_f32 v168, v144, v145
    v_mfma_f32_16x16x32_bf16 v[136:139], a[72:75], a[24:27], v[136:139]
    ds_read_b64_tr_b16 a[102:103], v189 offset:4096
    v_exp_f32 v149, v149
    v_mfma_f32_16x16x32_bf16 v[136:139], a[76:79], a[28:31], v[136:139]
    v_exp_f32 v150, v150
    v_cvt_pk_bf16_f32 v169, v146, v147
    v_mfma_f32_16x16x32_bf16 v[132:135], a[80:83], a[0:3], 0
    ds_read_b64_tr_b16 a[104:105], v190 offset:0
    v_exp_f32 v151, v151
    v_mfma_f32_16x16x32_bf16 v[132:135], a[84:87], a[4:7], v[132:135]
    s_add_u32 m0, s30, 114688
    s_nop 0
    buffer_load_dwordx4 v200, s[20:23], s29 offen offset:0 nt lds
    v_mfma_f32_16x16x32_bf16 v[132:135], a[88:91], a[8:11], v[132:135]
    ds_read_b64_tr_b16 a[106:107], v190 offset:4096
    v_cvt_pk_bf16_f32 v170, v148, v149
    v_mfma_f32_16x16x32_bf16 v[132:135], a[92:95], a[12:15], v[132:135]
    v_exp_f32 v152, v152
    v_cvt_pk_bf16_f32 v171, v150, v151
    v_mfma_f32_16x16x32_bf16 v[140:143], a[80:83], a[16:19], 0
    ds_read_b64_tr_b16 a[108:109], v191 offset:0
    v_mfma_f32_16x16x32_bf16 v[140:143], a[84:87], a[20:23], v[140:143]
    v_exp_f32 v153, v153
    v_mfma_f32_16x16x32_bf16 v[140:143], a[88:91], a[24:27], v[140:143]
    ds_read_b64_tr_b16 a[110:111], v191 offset:4096
    v_cvt_pk_bf16_f32 v172, v152, v153
    v_mfma_f32_16x16x32_bf16 v[140:143], a[92:95], a[28:31], v[140:143]
    v_exp_f32 v154, v154
    v_mfma_f32_16x16x32_bf16 v[176:179], v[242:245], v[160:163], v[176:179]
    ds_read_b64_tr_b16 a[112:113], v192 offset:0
    v_mfma_f32_16x16x32_bf16 v[184:187], v[242:245], v[164:167], v[184:187]
    ds_read_b64_tr_b16 a[114:115], v192 offset:4096
    s_waitcnt lgkmcnt(6)
    v_mfma_f32_16x16x32_bf16 v[0:3], a[96:99], v[160:163], v[0:3]
    v_exp_f32 v155, v155
    v_mfma_f32_16x16x32_bf16 v[32:35], a[96:99], v[164:167], v[32:35]
    ds_read_b64_tr_b16 a[116:117], v193 offset:0
    v_cvt_pk_bf16_f32 v173, v154, v155
    v_mfma_f32_16x16x32_bf16 v[4:7], a[100:103], v[160:163], v[4:7]
    ds_read_b64_tr_b16 a[118:119], v193 offset:4096
    v_mfma_f32_16x16x32_bf16 v[36:39], a[100:103], v[164:167], v[36:39]
    s_waitcnt lgkmcnt(4)
    v_mfma_f32_16x16x32_bf16 v[8:11], a[104:107], v[160:163], v[8:11]
    ds_read_b64_tr_b16 a[120:121], v194 offset:0
    v_mfma_f32_16x16x32_bf16 v[40:43], a[104:107], v[164:167], v[40:43]
    ds_read_b64_tr_b16 a[122:123], v194 offset:4096
    v_mfma_f32_16x16x32_bf16 v[12:15], a[108:111], v[160:163], v[12:15]
    v_exp_f32 v156, v156
    v_mfma_f32_16x16x32_bf16 v[44:47], a[108:111], v[164:167], v[44:47]
    ds_read_b64_tr_b16 a[124:125], v195 offset:0
    s_waitcnt lgkmcnt(3)
    v_mfma_f32_16x16x32_bf16 v[16:19], a[112:115], v[160:163], v[16:19]
    ds_read_b64_tr_b16 a[126:127], v195 offset:4096
    v_mfma_f32_16x16x32_bf16 v[48:51], a[112:115], v[164:167], v[48:51]
    v_exp_f32 v157, v157
    v_mfma_f32_16x16x32_bf16 v[20:23], a[116:119], v[160:163], v[20:23]
    buffer_load_dwordx4 v201, s[20:23], s29 offen offset:1024 nt lds
    v_cvt_pk_bf16_f32 v174, v156, v157
    v_mfma_f32_16x16x32_bf16 v[52:55], a[116:119], v[164:167], v[52:55]
    s_waitcnt lgkmcnt(0)
    v_mfma_f32_16x16x32_bf16 v[24:27], a[120:123], v[160:163], v[24:27]
    v_exp_f32 v158, v158
    v_mfma_f32_16x16x32_bf16 v[56:59], a[120:123], v[164:167], v[56:59]
    v_exp_f32 v159, v159
    v_mfma_f32_16x16x32_bf16 v[28:31], a[124:127], v[160:163], v[28:31]
    v_cvt_pk_bf16_f32 v175, v158, v159
    v_mfma_f32_16x16x32_bf16 v[60:63], a[124:127], v[164:167], v[60:63]
    v_mfma_f32_16x16x32_bf16 v[144:147], a[64:67], a[32:35], 0
    v_exp_f32 v128, v128
    v_mfma_f32_16x16x32_bf16 v[144:147], a[68:71], a[36:39], v[144:147]
    v_exp_f32 v129, v129
    v_mfma_f32_16x16x32_bf16 v[144:147], a[72:75], a[40:43], v[144:147]
    v_exp_f32 v130, v130
    v_mfma_f32_16x16x32_bf16 v[144:147], a[76:79], a[44:47], v[144:147]
    v_exp_f32 v131, v131
    v_mfma_f32_16x16x32_bf16 v[152:155], a[64:67], a[48:51], 0
    v_exp_f32 v132, v132
    v_cvt_pk_bf16_f32 v160, v128, v129
    v_mfma_f32_16x16x32_bf16 v[152:155], a[68:71], a[52:55], v[152:155]
    v_exp_f32 v133, v133
    v_mfma_f32_16x16x32_bf16 v[152:155], a[72:75], a[56:59], v[152:155]
    ds_read_b128 a[64:67], v180 offset:16384
    v_cvt_pk_bf16_f32 v161, v130, v131
    v_mfma_f32_16x16x32_bf16 v[152:155], a[76:79], a[60:63], v[152:155]
    v_exp_f32 v134, v134
    v_mfma_f32_16x16x32_bf16 v[148:151], a[80:83], a[32:35], 0
    ds_read_b128 a[68:71], v181 offset:16384
    v_cvt_pk_bf16_f32 v162, v132, v133
    v_mfma_f32_16x16x32_bf16 v[148:151], a[84:87], a[36:39], v[148:151]
    buffer_load_dwordx4 v200, s[20:23], s29 offen offset:2048 nt lds
    v_mfma_f32_16x16x32_bf16 v[148:151], a[88:91], a[40:43], v[148:151]
    ds_read_b128 a[72:75], v182 offset:16384
    v_mfma_f32_16x16x32_bf16 v[148:151], a[92:95], a[44:47], v[148:151]
    v_exp_f32 v135, v135
    v_mfma_f32_16x16x32_bf16 v[156:159], a[80:83], a[48:51], 0
    ds_read_b128 a[76:79], v183 offset:16384
    v_cvt_pk_bf16_f32 v163, v134, v135
    v_mfma_f32_16x16x32_bf16 v[156:159], a[84:87], a[52:55], v[156:159]
    v_exp_f32 v136, v136
    v_mfma_f32_16x16x32_bf16 v[156:159], a[88:91], a[56:59], v[156:159]
    ds_read_b128 a[80:83], v180 offset:20480
    v_mfma_f32_16x16x32_bf16 v[156:159], a[92:95], a[60:63], v[156:159]
    v_exp_f32 v137, v137
    v_mfma_f32_16x16x32_bf16 v[222:225], v[242:245], v[168:171], v[222:225]
    ds_read_b128 a[84:87], v181 offset:20480
    v_cvt_pk_bf16_f32 v164, v136, v137
    v_mfma_f32_16x16x32_bf16 v[246:249], v[242:245], v[172:175], v[246:249]
    v_exp_f32 v138, v138
    v_mfma_f32_16x16x32_bf16 v[64:67], a[96:99], v[168:171], v[64:67]
    ds_read_b128 a[88:91], v182 offset:20480
    v_mfma_f32_16x16x32_bf16 v[96:99], a[96:99], v[172:175], v[96:99]
    v_exp_f32 v139, v139
    v_mfma_f32_16x16x32_bf16 v[68:71], a[100:103], v[168:171], v[68:71]
    ds_read_b128 a[92:95], v183 offset:20480
    v_cvt_pk_bf16_f32 v165, v138, v139
    v_mfma_f32_16x16x32_bf16 v[100:103], a[100:103], v[172:175], v[100:103]
    v_exp_f32 v140, v140
    v_mfma_f32_16x16x32_bf16 v[72:75], a[104:107], v[168:171], v[72:75]
    v_exp_f32 v141, v141
    v_mfma_f32_16x16x32_bf16 v[104:107], a[104:107], v[172:175], v[104:107]
    v_exp_f32 v142, v142
    v_mfma_f32_16x16x32_bf16 v[76:79], a[108:111], v[168:171], v[76:79]
    v_exp_f32 v143, v143
    v_mfma_f32_16x16x32_bf16 v[108:111], a[108:111], v[172:175], v[108:111]
    v_cvt_pk_bf16_f32 v166, v140, v141
    v_cvt_pk_bf16_f32 v167, v142, v143
    v_mfma_f32_16x16x32_bf16 v[80:83], a[112:115], v[168:171], v[80:83]
    v_mfma_f32_16x16x32_bf16 v[112:115], a[112:115], v[172:175], v[112:115]
    buffer_load_dwordx4 v201, s[20:23], s29 offen offset:3072 nt lds
    s_add_u32 s29, s29, 16384
    v_mfma_f32_16x16x32_bf16 v[84:87], a[116:119], v[168:171], v[84:87]
    v_mfma_f32_16x16x32_bf16 v[116:119], a[116:119], v[172:175], v[116:119]
    v_mfma_f32_16x16x32_bf16 v[88:91], a[120:123], v[168:171], v[88:91]
    v_mfma_f32_16x16x32_bf16 v[120:123], a[120:123], v[172:175], v[120:123]
    v_mfma_f32_16x16x32_bf16 v[92:95], a[124:127], v[168:171], v[92:95]
    v_mfma_f32_16x16x32_bf16 v[124:127], a[124:127], v[172:175], v[124:127]
    s_waitcnt lgkmcnt(0)
    v_mfma_f32_16x16x32_bf16 v[128:131], a[64:67], a[0:3], 0
    ds_read_b64_tr_b16 a[96:97], v188 offset:8192
    v_exp_f32 v144, v144
    v_mfma_f32_16x16x32_bf16 v[128:131], a[68:71], a[4:7], v[128:131]
    v_exp_f32 v145, v145
    v_mfma_f32_16x16x32_bf16 v[128:131], a[72:75], a[8:11], v[128:131]
    ds_read_b64_tr_b16 a[98:99], v188 offset:12288
    v_exp_f32 v146, v146
    v_mfma_f32_16x16x32_bf16 v[128:131], a[76:79], a[12:15], v[128:131]
    v_exp_f32 v147, v147
    v_mfma_f32_16x16x32_bf16 v[136:139], a[64:67], a[16:19], 0
    ds_read_b64_tr_b16 a[100:101], v189 offset:8192
    v_exp_f32 v148, v148
    v_mfma_f32_16x16x32_bf16 v[136:139], a[68:71], a[20:23], v[136:139]
    v_exp_f32 v149, v149
    v_cvt_pk_bf16_f32 v168, v144, v145
    v_mfma_f32_16x16x32_bf16 v[136:139], a[72:75], a[24:27], v[136:139]
    ds_read_b64_tr_b16 a[102:103], v189 offset:12288
    v_exp_f32 v150, v150
    v_mfma_f32_16x16x32_bf16 v[136:139], a[76:79], a[28:31], v[136:139]
    v_exp_f32 v151, v151
    v_cvt_pk_bf16_f32 v169, v146, v147
    v_mfma_f32_16x16x32_bf16 v[132:135], a[80:83], a[0:3], 0
    ds_read_b64_tr_b16 a[104:105], v190 offset:8192
    v_cvt_pk_bf16_f32 v170, v148, v149
    v_mfma_f32_16x16x32_bf16 v[132:135], a[84:87], a[4:7], v[132:135]
    s_add_u32 m0, s30, 0
    s_nop 0
    buffer_load_dwordx4 v196, s[16:19], s28 offen offset:0 nt lds
    v_mfma_f32_16x16x32_bf16 v[132:135], a[88:91], a[8:11], v[132:135]
    ds_read_b64_tr_b16 a[106:107], v190 offset:12288
    v_cvt_pk_bf16_f32 v171, v150, v151
    v_mfma_f32_16x16x32_bf16 v[132:135], a[92:95], a[12:15], v[132:135]
    v_exp_f32 v152, v152
    v_mfma_f32_16x16x32_bf16 v[140:143], a[80:83], a[16:19], 0
    ds_read_b64_tr_b16 a[108:109], v191 offset:8192
    v_mfma_f32_16x16x32_bf16 v[140:143], a[84:87], a[20:23], v[140:143]
    v_exp_f32 v153, v153
    v_mfma_f32_16x16x32_bf16 v[140:143], a[88:91], a[24:27], v[140:143]
    ds_read_b64_tr_b16 a[110:111], v191 offset:12288
    v_cvt_pk_bf16_f32 v172, v152, v153
    v_mfma_f32_16x16x32_bf16 v[140:143], a[92:95], a[28:31], v[140:143]
    v_exp_f32 v154, v154
    v_mfma_f32_16x16x32_bf16 v[176:179], v[242:245], v[160:163], v[176:179]
    ds_read_b64_tr_b16 a[112:113], v192 offset:8192
    v_mfma_f32_16x16x32_bf16 v[184:187], v[242:245], v[164:167], v[184:187]
    ds_read_b64_tr_b16 a[114:115], v192 offset:12288
    s_waitcnt lgkmcnt(6)
    v_mfma_f32_16x16x32_bf16 v[0:3], a[96:99], v[160:163], v[0:3]
    v_exp_f32 v155, v155
    v_mfma_f32_16x16x32_bf16 v[32:35], a[96:99], v[164:167], v[32:35]
    ds_read_b64_tr_b16 a[116:117], v193 offset:8192
    v_cvt_pk_bf16_f32 v173, v154, v155
    v_mfma_f32_16x16x32_bf16 v[4:7], a[100:103], v[160:163], v[4:7]
    ds_read_b64_tr_b16 a[118:119], v193 offset:12288
    v_mfma_f32_16x16x32_bf16 v[36:39], a[100:103], v[164:167], v[36:39]
    s_waitcnt lgkmcnt(4)
    v_mfma_f32_16x16x32_bf16 v[8:11], a[104:107], v[160:163], v[8:11]
    ds_read_b64_tr_b16 a[120:121], v194 offset:8192
    v_mfma_f32_16x16x32_bf16 v[40:43], a[104:107], v[164:167], v[40:43]
    ds_read_b64_tr_b16 a[122:123], v194 offset:12288
    v_mfma_f32_16x16x32_bf16 v[12:15], a[108:111], v[160:163], v[12:15]
    v_exp_f32 v156, v156
    v_mfma_f32_16x16x32_bf16 v[44:47], a[108:111], v[164:167], v[44:47]
    ds_read_b64_tr_b16 a[124:125], v195 offset:8192
    s_waitcnt lgkmcnt(3)
    v_mfma_f32_16x16x32_bf16 v[16:19], a[112:115], v[160:163], v[16:19]
    ds_read_b64_tr_b16 a[126:127], v195 offset:12288
    v_mfma_f32_16x16x32_bf16 v[48:51], a[112:115], v[164:167], v[48:51]
    v_exp_f32 v157, v157
    v_mfma_f32_16x16x32_bf16 v[20:23], a[116:119], v[160:163], v[20:23]
    buffer_load_dwordx4 v197, s[16:19], s28 offen offset:1024 nt lds
    v_cvt_pk_bf16_f32 v174, v156, v157
    v_mfma_f32_16x16x32_bf16 v[52:55], a[116:119], v[164:167], v[52:55]
    s_waitcnt lgkmcnt(0)
    v_mfma_f32_16x16x32_bf16 v[24:27], a[120:123], v[160:163], v[24:27]
    v_exp_f32 v158, v158
    v_mfma_f32_16x16x32_bf16 v[56:59], a[120:123], v[164:167], v[56:59]
    v_exp_f32 v159, v159
    v_mfma_f32_16x16x32_bf16 v[28:31], a[124:127], v[160:163], v[28:31]
    v_cvt_pk_bf16_f32 v175, v158, v159
    v_mfma_f32_16x16x32_bf16 v[60:63], a[124:127], v[164:167], v[60:63]
    v_mfma_f32_16x16x32_bf16 v[144:147], a[64:67], a[32:35], 0
    v_exp_f32 v128, v128
    v_mfma_f32_16x16x32_bf16 v[144:147], a[68:71], a[36:39], v[144:147]
    v_exp_f32 v129, v129
    v_mfma_f32_16x16x32_bf16 v[144:147], a[72:75], a[40:43], v[144:147]
    v_exp_f32 v130, v130
    v_mfma_f32_16x16x32_bf16 v[144:147], a[76:79], a[44:47], v[144:147]
    v_exp_f32 v131, v131
    v_mfma_f32_16x16x32_bf16 v[152:155], a[64:67], a[48:51], 0
    v_exp_f32 v132, v132
    v_cvt_pk_bf16_f32 v160, v128, v129
    v_mfma_f32_16x16x32_bf16 v[152:155], a[68:71], a[52:55], v[152:155]
    v_exp_f32 v133, v133
    v_mfma_f32_16x16x32_bf16 v[152:155], a[72:75], a[56:59], v[152:155]
    ds_read_b128 a[64:67], v180 offset:24576
    v_cvt_pk_bf16_f32 v161, v130, v131
    v_mfma_f32_16x16x32_bf16 v[152:155], a[76:79], a[60:63], v[152:155]
    v_exp_f32 v134, v134
    v_mfma_f32_16x16x32_bf16 v[148:151], a[80:83], a[32:35], 0
    ds_read_b128 a[68:71], v181 offset:24576
    v_cvt_pk_bf16_f32 v162, v132, v133
    v_mfma_f32_16x16x32_bf16 v[148:151], a[84:87], a[36:39], v[148:151]
    buffer_load_dwordx4 v198, s[16:19], s28 offen offset:2048 nt lds
    v_mfma_f32_16x16x32_bf16 v[148:151], a[88:91], a[40:43], v[148:151]
    ds_read_b128 a[72:75], v182 offset:24576
    v_mfma_f32_16x16x32_bf16 v[148:151], a[92:95], a[44:47], v[148:151]
    v_exp_f32 v135, v135
    v_mfma_f32_16x16x32_bf16 v[156:159], a[80:83], a[48:51], 0
    ds_read_b128 a[76:79], v183 offset:24576
    v_cvt_pk_bf16_f32 v163, v134, v135
    v_mfma_f32_16x16x32_bf16 v[156:159], a[84:87], a[52:55], v[156:159]
    v_exp_f32 v136, v136
    v_mfma_f32_16x16x32_bf16 v[156:159], a[88:91], a[56:59], v[156:159]
    ds_read_b128 a[80:83], v180 offset:28672
    v_mfma_f32_16x16x32_bf16 v[156:159], a[92:95], a[60:63], v[156:159]
    v_exp_f32 v137, v137
    v_mfma_f32_16x16x32_bf16 v[222:225], v[242:245], v[168:171], v[222:225]
    ds_read_b128 a[84:87], v181 offset:28672
    v_cvt_pk_bf16_f32 v164, v136, v137
    v_mfma_f32_16x16x32_bf16 v[246:249], v[242:245], v[172:175], v[246:249]
    v_exp_f32 v138, v138
    v_mfma_f32_16x16x32_bf16 v[64:67], a[96:99], v[168:171], v[64:67]
    ds_read_b128 a[88:91], v182 offset:28672
    v_mfma_f32_16x16x32_bf16 v[96:99], a[96:99], v[172:175], v[96:99]
    v_exp_f32 v139, v139
    v_mfma_f32_16x16x32_bf16 v[68:71], a[100:103], v[168:171], v[68:71]
    ds_read_b128 a[92:95], v183 offset:28672
    v_cvt_pk_bf16_f32 v165, v138, v139
    v_mfma_f32_16x16x32_bf16 v[100:103], a[100:103], v[172:175], v[100:103]
    v_exp_f32 v140, v140
    v_mfma_f32_16x16x32_bf16 v[72:75], a[104:107], v[168:171], v[72:75]
    v_exp_f32 v141, v141
    v_mfma_f32_16x16x32_bf16 v[104:107], a[104:107], v[172:175], v[104:107]
    v_exp_f32 v142, v142
    v_mfma_f32_16x16x32_bf16 v[76:79], a[108:111], v[168:171], v[76:79]
    v_exp_f32 v143, v143
    v_mfma_f32_16x16x32_bf16 v[108:111], a[108:111], v[172:175], v[108:111]
    v_cvt_pk_bf16_f32 v166, v140, v141
    v_cvt_pk_bf16_f32 v167, v142, v143
    v_mfma_f32_16x16x32_bf16 v[80:83], a[112:115], v[168:171], v[80:83]
    v_mfma_f32_16x16x32_bf16 v[112:115], a[112:115], v[172:175], v[112:115]
    buffer_load_dwordx4 v199, s[16:19], s28 offen offset:3072 nt lds
    s_add_u32 s28, s28, 16384
    v_mfma_f32_16x16x32_bf16 v[84:87], a[116:119], v[168:171], v[84:87]
    v_mfma_f32_16x16x32_bf16 v[116:119], a[116:119], v[172:175], v[116:119]
    v_mfma_f32_16x16x32_bf16 v[88:91], a[120:123], v[168:171], v[88:91]
    v_mfma_f32_16x16x32_bf16 v[120:123], a[120:123], v[172:175], v[120:123]
    v_mfma_f32_16x16x32_bf16 v[92:95], a[124:127], v[168:171], v[92:95]
    v_mfma_f32_16x16x32_bf16 v[124:127], a[124:127], v[172:175], v[124:127]
    s_waitcnt lgkmcnt(0)
    v_mfma_f32_16x16x32_bf16 v[128:131], a[64:67], a[0:3], 0
    s_waitcnt vmcnt(16)
    s_barrier
    ds_read_b64_tr_b16 a[96:97], v188 offset:16384
    v_mfma_f32_16x16x32_bf16 v[128:131], a[68:71], a[4:7], v[128:131]
    v_exp_f32 v144, v144
    v_mfma_f32_16x16x32_bf16 v[128:131], a[72:75], a[8:11], v[128:131]
    ds_read_b64_tr_b16 a[98:99], v188 offset:20480
    v_exp_f32 v145, v145
    v_mfma_f32_16x16x32_bf16 v[128:131], a[76:79], a[12:15], v[128:131]
    v_exp_f32 v146, v146
    v_mfma_f32_16x16x32_bf16 v[136:139], a[64:67], a[16:19], 0
    ds_read_b64_tr_b16 a[100:101], v189 offset:16384
    v_exp_f32 v147, v147
    v_mfma_f32_16x16x32_bf16 v[136:139], a[68:71], a[20:23], v[136:139]
    v_exp_f32 v148, v148
    v_cvt_pk_bf16_f32 v168, v144, v145
    v_mfma_f32_16x16x32_bf16 v[136:139], a[72:75], a[24:27], v[136:139]
    ds_read_b64_tr_b16 a[102:103], v189 offset:20480
    v_exp_f32 v149, v149
    v_mfma_f32_16x16x32_bf16 v[136:139], a[76:79], a[28:31], v[136:139]
    v_exp_f32 v150, v150
    v_cvt_pk_bf16_f32 v169, v146, v147
    v_mfma_f32_16x16x32_bf16 v[132:135], a[80:83], a[0:3], 0
    ds_read_b64_tr_b16 a[104:105], v190 offset:16384
    v_exp_f32 v151, v151
    v_mfma_f32_16x16x32_bf16 v[132:135], a[84:87], a[4:7], v[132:135]
    s_add_u32 m0, s30, 65536
    s_nop 0
    buffer_load_dwordx4 v200, s[20:23], s29 offen offset:0 nt lds
    v_mfma_f32_16x16x32_bf16 v[132:135], a[88:91], a[8:11], v[132:135]
    ds_read_b64_tr_b16 a[106:107], v190 offset:20480
    v_cvt_pk_bf16_f32 v170, v148, v149
    v_mfma_f32_16x16x32_bf16 v[132:135], a[92:95], a[12:15], v[132:135]
    v_exp_f32 v152, v152
    v_cvt_pk_bf16_f32 v171, v150, v151
    v_mfma_f32_16x16x32_bf16 v[140:143], a[80:83], a[16:19], 0
    ds_read_b64_tr_b16 a[108:109], v191 offset:16384
    v_mfma_f32_16x16x32_bf16 v[140:143], a[84:87], a[20:23], v[140:143]
    v_exp_f32 v153, v153
    v_mfma_f32_16x16x32_bf16 v[140:143], a[88:91], a[24:27], v[140:143]
    ds_read_b64_tr_b16 a[110:111], v191 offset:20480
    v_cvt_pk_bf16_f32 v172, v152, v153
    v_mfma_f32_16x16x32_bf16 v[140:143], a[92:95], a[28:31], v[140:143]
    v_exp_f32 v154, v154
    v_mfma_f32_16x16x32_bf16 v[176:179], v[242:245], v[160:163], v[176:179]
    ds_read_b64_tr_b16 a[112:113], v192 offset:16384
    v_mfma_f32_16x16x32_bf16 v[184:187], v[242:245], v[164:167], v[184:187]
    ds_read_b64_tr_b16 a[114:115], v192 offset:20480
    s_waitcnt lgkmcnt(6)
    v_mfma_f32_16x16x32_bf16 v[0:3], a[96:99], v[160:163], v[0:3]
    v_exp_f32 v155, v155
    v_mfma_f32_16x16x32_bf16 v[32:35], a[96:99], v[164:167], v[32:35]
    ds_read_b64_tr_b16 a[116:117], v193 offset:16384
    v_cvt_pk_bf16_f32 v173, v154, v155
    v_mfma_f32_16x16x32_bf16 v[4:7], a[100:103], v[160:163], v[4:7]
    ds_read_b64_tr_b16 a[118:119], v193 offset:20480
    v_mfma_f32_16x16x32_bf16 v[36:39], a[100:103], v[164:167], v[36:39]
    s_waitcnt lgkmcnt(4)
    v_mfma_f32_16x16x32_bf16 v[8:11], a[104:107], v[160:163], v[8:11]
    ds_read_b64_tr_b16 a[120:121], v194 offset:16384
    v_mfma_f32_16x16x32_bf16 v[40:43], a[104:107], v[164:167], v[40:43]
    ds_read_b64_tr_b16 a[122:123], v194 offset:20480
    v_mfma_f32_16x16x32_bf16 v[12:15], a[108:111], v[160:163], v[12:15]
    v_exp_f32 v156, v156
    v_mfma_f32_16x16x32_bf16 v[44:47], a[108:111], v[164:167], v[44:47]
    ds_read_b64_tr_b16 a[124:125], v195 offset:16384
    s_waitcnt lgkmcnt(3)
    v_mfma_f32_16x16x32_bf16 v[16:19], a[112:115], v[160:163], v[16:19]
    ds_read_b64_tr_b16 a[126:127], v195 offset:20480
    v_mfma_f32_16x16x32_bf16 v[48:51], a[112:115], v[164:167], v[48:51]
    v_exp_f32 v157, v157
    v_mfma_f32_16x16x32_bf16 v[20:23], a[116:119], v[160:163], v[20:23]
    buffer_load_dwordx4 v201, s[20:23], s29 offen offset:1024 nt lds
    v_cvt_pk_bf16_f32 v174, v156, v157
    v_mfma_f32_16x16x32_bf16 v[52:55], a[116:119], v[164:167], v[52:55]
    s_waitcnt lgkmcnt(0)
    v_mfma_f32_16x16x32_bf16 v[24:27], a[120:123], v[160:163], v[24:27]
    v_exp_f32 v158, v158
    v_mfma_f32_16x16x32_bf16 v[56:59], a[120:123], v[164:167], v[56:59]
    v_exp_f32 v159, v159
    v_mfma_f32_16x16x32_bf16 v[28:31], a[124:127], v[160:163], v[28:31]
    v_cvt_pk_bf16_f32 v175, v158, v159
    v_mfma_f32_16x16x32_bf16 v[60:63], a[124:127], v[164:167], v[60:63]
    v_mfma_f32_16x16x32_bf16 v[144:147], a[64:67], a[32:35], 0
    v_exp_f32 v128, v128
    v_mfma_f32_16x16x32_bf16 v[144:147], a[68:71], a[36:39], v[144:147]
    v_exp_f32 v129, v129
    v_mfma_f32_16x16x32_bf16 v[144:147], a[72:75], a[40:43], v[144:147]
    v_exp_f32 v130, v130
    v_mfma_f32_16x16x32_bf16 v[144:147], a[76:79], a[44:47], v[144:147]
    v_exp_f32 v131, v131
    v_mfma_f32_16x16x32_bf16 v[152:155], a[64:67], a[48:51], 0
    v_exp_f32 v132, v132
    v_cvt_pk_bf16_f32 v160, v128, v129
    v_mfma_f32_16x16x32_bf16 v[152:155], a[68:71], a[52:55], v[152:155]
    v_exp_f32 v133, v133
    v_mfma_f32_16x16x32_bf16 v[152:155], a[72:75], a[56:59], v[152:155]
    ds_read_b128 a[64:67], v180 offset:32768
    v_cvt_pk_bf16_f32 v161, v130, v131
    v_mfma_f32_16x16x32_bf16 v[152:155], a[76:79], a[60:63], v[152:155]
    v_exp_f32 v134, v134
    v_mfma_f32_16x16x32_bf16 v[148:151], a[80:83], a[32:35], 0
    ds_read_b128 a[68:71], v181 offset:32768
    v_cvt_pk_bf16_f32 v162, v132, v133
    v_mfma_f32_16x16x32_bf16 v[148:151], a[84:87], a[36:39], v[148:151]
    buffer_load_dwordx4 v200, s[20:23], s29 offen offset:2048 nt lds
    v_mfma_f32_16x16x32_bf16 v[148:151], a[88:91], a[40:43], v[148:151]
    ds_read_b128 a[72:75], v182 offset:32768
    v_mfma_f32_16x16x32_bf16 v[148:151], a[92:95], a[44:47], v[148:151]
    v_exp_f32 v135, v135
    v_mfma_f32_16x16x32_bf16 v[156:159], a[80:83], a[48:51], 0
    ds_read_b128 a[76:79], v183 offset:32768
    v_cvt_pk_bf16_f32 v163, v134, v135
    v_mfma_f32_16x16x32_bf16 v[156:159], a[84:87], a[52:55], v[156:159]
    v_exp_f32 v136, v136
    v_mfma_f32_16x16x32_bf16 v[156:159], a[88:91], a[56:59], v[156:159]
    ds_read_b128 a[80:83], v180 offset:36864
    v_mfma_f32_16x16x32_bf16 v[156:159], a[92:95], a[60:63], v[156:159]
    v_exp_f32 v137, v137
    v_mfma_f32_16x16x32_bf16 v[222:225], v[242:245], v[168:171], v[222:225]
    ds_read_b128 a[84:87], v181 offset:36864
    v_cvt_pk_bf16_f32 v164, v136, v137
    v_mfma_f32_16x16x32_bf16 v[246:249], v[242:245], v[172:175], v[246:249]
    v_exp_f32 v138, v138
    v_mfma_f32_16x16x32_bf16 v[64:67], a[96:99], v[168:171], v[64:67]
    ds_read_b128 a[88:91], v182 offset:36864
    v_mfma_f32_16x16x32_bf16 v[96:99], a[96:99], v[172:175], v[96:99]
    v_exp_f32 v139, v139
    v_mfma_f32_16x16x32_bf16 v[68:71], a[100:103], v[168:171], v[68:71]
    ds_read_b128 a[92:95], v183 offset:36864
    v_cvt_pk_bf16_f32 v165, v138, v139
    v_mfma_f32_16x16x32_bf16 v[100:103], a[100:103], v[172:175], v[100:103]
    v_exp_f32 v140, v140
    v_mfma_f32_16x16x32_bf16 v[72:75], a[104:107], v[168:171], v[72:75]
    v_exp_f32 v141, v141
    v_mfma_f32_16x16x32_bf16 v[104:107], a[104:107], v[172:175], v[104:107]
    v_exp_f32 v142, v142
    v_mfma_f32_16x16x32_bf16 v[76:79], a[108:111], v[168:171], v[76:79]
    v_exp_f32 v143, v143
    v_mfma_f32_16x16x32_bf16 v[108:111], a[108:111], v[172:175], v[108:111]
    v_cvt_pk_bf16_f32 v166, v140, v141
    v_cvt_pk_bf16_f32 v167, v142, v143
    v_mfma_f32_16x16x32_bf16 v[80:83], a[112:115], v[168:171], v[80:83]
    v_mfma_f32_16x16x32_bf16 v[112:115], a[112:115], v[172:175], v[112:115]
    buffer_load_dwordx4 v201, s[20:23], s29 offen offset:3072 nt lds
    s_add_u32 s29, s29, 16384
    v_mfma_f32_16x16x32_bf16 v[84:87], a[116:119], v[168:171], v[84:87]
    v_mfma_f32_16x16x32_bf16 v[116:119], a[116:119], v[172:175], v[116:119]
    v_mfma_f32_16x16x32_bf16 v[88:91], a[120:123], v[168:171], v[88:91]
    v_mfma_f32_16x16x32_bf16 v[120:123], a[120:123], v[172:175], v[120:123]
    v_mfma_f32_16x16x32_bf16 v[92:95], a[124:127], v[168:171], v[92:95]
    v_mfma_f32_16x16x32_bf16 v[124:127], a[124:127], v[172:175], v[124:127]
    s_waitcnt lgkmcnt(0)
    v_mfma_f32_16x16x32_bf16 v[128:131], a[64:67], a[0:3], 0
    ds_read_b64_tr_b16 a[96:97], v188 offset:24576
    v_exp_f32 v144, v144
    v_mfma_f32_16x16x32_bf16 v[128:131], a[68:71], a[4:7], v[128:131]
    v_exp_f32 v145, v145
    v_mfma_f32_16x16x32_bf16 v[128:131], a[72:75], a[8:11], v[128:131]
    ds_read_b64_tr_b16 a[98:99], v188 offset:28672
    v_exp_f32 v146, v146
    v_mfma_f32_16x16x32_bf16 v[128:131], a[76:79], a[12:15], v[128:131]
    v_exp_f32 v147, v147
    v_mfma_f32_16x16x32_bf16 v[136:139], a[64:67], a[16:19], 0
    ds_read_b64_tr_b16 a[100:101], v189 offset:24576
    v_exp_f32 v148, v148
    v_mfma_f32_16x16x32_bf16 v[136:139], a[68:71], a[20:23], v[136:139]
    v_exp_f32 v149, v149
    v_cvt_pk_bf16_f32 v168, v144, v145
    v_mfma_f32_16x16x32_bf16 v[136:139], a[72:75], a[24:27], v[136:139]
    ds_read_b64_tr_b16 a[102:103], v189 offset:28672
    v_exp_f32 v150, v150
    v_mfma_f32_16x16x32_bf16 v[136:139], a[76:79], a[28:31], v[136:139]
    v_exp_f32 v151, v151
    v_cvt_pk_bf16_f32 v169, v146, v147
    v_mfma_f32_16x16x32_bf16 v[132:135], a[80:83], a[0:3], 0
    ds_read_b64_tr_b16 a[104:105], v190 offset:24576
    v_cvt_pk_bf16_f32 v170, v148, v149
    v_mfma_f32_16x16x32_bf16 v[132:135], a[84:87], a[4:7], v[132:135]
    s_add_u32 m0, s30, 16384
    s_nop 0
    buffer_load_dwordx4 v196, s[16:19], s28 offen offset:0 nt lds
    v_mfma_f32_16x16x32_bf16 v[132:135], a[88:91], a[8:11], v[132:135]
    ds_read_b64_tr_b16 a[106:107], v190 offset:28672
    v_cvt_pk_bf16_f32 v171, v150, v151
    v_mfma_f32_16x16x32_bf16 v[132:135], a[92:95], a[12:15], v[132:135]
    v_exp_f32 v152, v152
    v_mfma_f32_16x16x32_bf16 v[140:143], a[80:83], a[16:19], 0
    ds_read_b64_tr_b16 a[108:109], v191 offset:24576
    v_mfma_f32_16x16x32_bf16 v[140:143], a[84:87], a[20:23], v[140:143]
    v_exp_f32 v153, v153
    v_mfma_f32_16x16x32_bf16 v[140:143], a[88:91], a[24:27], v[140:143]
    ds_read_b64_tr_b16 a[110:111], v191 offset:28672
    v_cvt_pk_bf16_f32 v172, v152, v153
    v_mfma_f32_16x16x32_bf16 v[140:143], a[92:95], a[28:31], v[140:143]
    v_exp_f32 v154, v154
    v_mfma_f32_16x16x32_bf16 v[176:179], v[242:245], v[160:163], v[176:179]
    ds_read_b64_tr_b16 a[112:113], v192 offset:24576
    v_mfma_f32_16x16x32_bf16 v[184:187], v[242:245], v[164:167], v[184:187]
    ds_read_b64_tr_b16 a[114:115], v192 offset:28672
    s_waitcnt lgkmcnt(6)
    v_mfma_f32_16x16x32_bf16 v[0:3], a[96:99], v[160:163], v[0:3]
    v_exp_f32 v155, v155
    v_mfma_f32_16x16x32_bf16 v[32:35], a[96:99], v[164:167], v[32:35]
    ds_read_b64_tr_b16 a[116:117], v193 offset:24576
    v_cvt_pk_bf16_f32 v173, v154, v155
    v_mfma_f32_16x16x32_bf16 v[4:7], a[100:103], v[160:163], v[4:7]
    ds_read_b64_tr_b16 a[118:119], v193 offset:28672
    v_mfma_f32_16x16x32_bf16 v[36:39], a[100:103], v[164:167], v[36:39]
    s_waitcnt lgkmcnt(4)
    v_mfma_f32_16x16x32_bf16 v[8:11], a[104:107], v[160:163], v[8:11]
    ds_read_b64_tr_b16 a[120:121], v194 offset:24576
    v_mfma_f32_16x16x32_bf16 v[40:43], a[104:107], v[164:167], v[40:43]
    ds_read_b64_tr_b16 a[122:123], v194 offset:28672
    v_mfma_f32_16x16x32_bf16 v[12:15], a[108:111], v[160:163], v[12:15]
    v_exp_f32 v156, v156
    v_mfma_f32_16x16x32_bf16 v[44:47], a[108:111], v[164:167], v[44:47]
    ds_read_b64_tr_b16 a[124:125], v195 offset:24576
    s_waitcnt lgkmcnt(3)
    v_mfma_f32_16x16x32_bf16 v[16:19], a[112:115], v[160:163], v[16:19]
    ds_read_b64_tr_b16 a[126:127], v195 offset:28672
    v_mfma_f32_16x16x32_bf16 v[48:51], a[112:115], v[164:167], v[48:51]
    v_exp_f32 v157, v157
    v_mfma_f32_16x16x32_bf16 v[20:23], a[116:119], v[160:163], v[20:23]
    buffer_load_dwordx4 v197, s[16:19], s28 offen offset:1024 nt lds
    v_cvt_pk_bf16_f32 v174, v156, v157
    v_mfma_f32_16x16x32_bf16 v[52:55], a[116:119], v[164:167], v[52:55]
    s_waitcnt lgkmcnt(0)
    v_mfma_f32_16x16x32_bf16 v[24:27], a[120:123], v[160:163], v[24:27]
    v_exp_f32 v158, v158
    v_mfma_f32_16x16x32_bf16 v[56:59], a[120:123], v[164:167], v[56:59]
    v_exp_f32 v159, v159
    v_mfma_f32_16x16x32_bf16 v[28:31], a[124:127], v[160:163], v[28:31]
    v_cvt_pk_bf16_f32 v175, v158, v159
    v_mfma_f32_16x16x32_bf16 v[60:63], a[124:127], v[164:167], v[60:63]
    v_mfma_f32_16x16x32_bf16 v[144:147], a[64:67], a[32:35], 0
    v_exp_f32 v128, v128
    v_mfma_f32_16x16x32_bf16 v[144:147], a[68:71], a[36:39], v[144:147]
    v_exp_f32 v129, v129
    v_mfma_f32_16x16x32_bf16 v[144:147], a[72:75], a[40:43], v[144:147]
    v_exp_f32 v130, v130
    v_mfma_f32_16x16x32_bf16 v[144:147], a[76:79], a[44:47], v[144:147]
    v_exp_f32 v131, v131
    v_mfma_f32_16x16x32_bf16 v[152:155], a[64:67], a[48:51], 0
    v_exp_f32 v132, v132
    v_cvt_pk_bf16_f32 v160, v128, v129
    v_mfma_f32_16x16x32_bf16 v[152:155], a[68:71], a[52:55], v[152:155]
    v_exp_f32 v133, v133
    v_mfma_f32_16x16x32_bf16 v[152:155], a[72:75], a[56:59], v[152:155]
    ds_read_b128 a[64:67], v180 offset:40960
    v_cvt_pk_bf16_f32 v161, v130, v131
    v_mfma_f32_16x16x32_bf16 v[152:155], a[76:79], a[60:63], v[152:155]
    v_exp_f32 v134, v134
    v_mfma_f32_16x16x32_bf16 v[148:151], a[80:83], a[32:35], 0
    ds_read_b128 a[68:71], v181 offset:40960
    v_cvt_pk_bf16_f32 v162, v132, v133
    v_mfma_f32_16x16x32_bf16 v[148:151], a[84:87], a[36:39], v[148:151]
    buffer_load_dwordx4 v198, s[16:19], s28 offen offset:2048 nt lds
    v_mfma_f32_16x16x32_bf16 v[148:151], a[88:91], a[40:43], v[148:151]
    ds_read_b128 a[72:75], v182 offset:40960
    v_mfma_f32_16x16x32_bf16 v[148:151], a[92:95], a[44:47], v[148:151]
    v_exp_f32 v135, v135
    v_mfma_f32_16x16x32_bf16 v[156:159], a[80:83], a[48:51], 0
    ds_read_b128 a[76:79], v183 offset:40960
    v_cvt_pk_bf16_f32 v163, v134, v135
    v_mfma_f32_16x16x32_bf16 v[156:159], a[84:87], a[52:55], v[156:159]
    v_exp_f32 v136, v136
    v_mfma_f32_16x16x32_bf16 v[156:159], a[88:91], a[56:59], v[156:159]
    ds_read_b128 a[80:83], v180 offset:45056
    v_mfma_f32_16x16x32_bf16 v[156:159], a[92:95], a[60:63], v[156:159]
    v_exp_f32 v137, v137
    v_mfma_f32_16x16x32_bf16 v[222:225], v[242:245], v[168:171], v[222:225]
    ds_read_b128 a[84:87], v181 offset:45056
    v_cvt_pk_bf16_f32 v164, v136, v137
    v_mfma_f32_16x16x32_bf16 v[246:249], v[242:245], v[172:175], v[246:249]
    v_exp_f32 v138, v138
    v_mfma_f32_16x16x32_bf16 v[64:67], a[96:99], v[168:171], v[64:67]
    ds_read_b128 a[88:91], v182 offset:45056
    v_mfma_f32_16x16x32_bf16 v[96:99], a[96:99], v[172:175], v[96:99]
    v_exp_f32 v139, v139
    v_mfma_f32_16x16x32_bf16 v[68:71], a[100:103], v[168:171], v[68:71]
    ds_read_b128 a[92:95], v183 offset:45056
    v_cvt_pk_bf16_f32 v165, v138, v139
    v_mfma_f32_16x16x32_bf16 v[100:103], a[100:103], v[172:175], v[100:103]
    v_exp_f32 v140, v140
    v_mfma_f32_16x16x32_bf16 v[72:75], a[104:107], v[168:171], v[72:75]
    v_exp_f32 v141, v141
    v_mfma_f32_16x16x32_bf16 v[104:107], a[104:107], v[172:175], v[104:107]
    v_exp_f32 v142, v142
    v_mfma_f32_16x16x32_bf16 v[76:79], a[108:111], v[168:171], v[76:79]
    v_exp_f32 v143, v143
    v_mfma_f32_16x16x32_bf16 v[108:111], a[108:111], v[172:175], v[108:111]
    v_cvt_pk_bf16_f32 v166, v140, v141
    v_cvt_pk_bf16_f32 v167, v142, v143
    v_mfma_f32_16x16x32_bf16 v[80:83], a[112:115], v[168:171], v[80:83]
    v_mfma_f32_16x16x32_bf16 v[112:115], a[112:115], v[172:175], v[112:115]
    buffer_load_dwordx4 v199, s[16:19], s28 offen offset:3072 nt lds
    s_add_u32 s28, s28, 16384
    v_mfma_f32_16x16x32_bf16 v[84:87], a[116:119], v[168:171], v[84:87]
    v_mfma_f32_16x16x32_bf16 v[116:119], a[116:119], v[172:175], v[116:119]
    v_mfma_f32_16x16x32_bf16 v[88:91], a[120:123], v[168:171], v[88:91]
    v_mfma_f32_16x16x32_bf16 v[120:123], a[120:123], v[172:175], v[120:123]
    v_mfma_f32_16x16x32_bf16 v[92:95], a[124:127], v[168:171], v[92:95]
    v_mfma_f32_16x16x32_bf16 v[124:127], a[124:127], v[172:175], v[124:127]
    s_waitcnt lgkmcnt(0)
    v_mfma_f32_16x16x32_bf16 v[128:131], a[64:67], a[0:3], 0
    s_waitcnt vmcnt(16)
    s_barrier
    ds_read_b64_tr_b16 a[96:97], v188 offset:32768
    v_mfma_f32_16x16x32_bf16 v[128:131], a[68:71], a[4:7], v[128:131]
    v_exp_f32 v144, v144
    v_mfma_f32_16x16x32_bf16 v[128:131], a[72:75], a[8:11], v[128:131]
    v_exp_f32 v145, v145
    ds_read_b64_tr_b16 a[98:99], v188 offset:36864
    v_mfma_f32_16x16x32_bf16 v[128:131], a[76:79], a[12:15], v[128:131]
    v_exp_f32 v146, v146
    v_mfma_f32_16x16x32_bf16 v[136:139], a[64:67], a[16:19], 0
    v_exp_f32 v147, v147
    ds_read_b64_tr_b16 a[100:101], v189 offset:32768
    v_mfma_f32_16x16x32_bf16 v[136:139], a[68:71], a[20:23], v[136:139]
    v_exp_f32 v148, v148
    v_cvt_pk_bf16_f32 v168, v144, v145
    v_mfma_f32_16x16x32_bf16 v[136:139], a[72:75], a[24:27], v[136:139]
    v_exp_f32 v149, v149
    ds_read_b64_tr_b16 a[102:103], v189 offset:36864
    v_mfma_f32_16x16x32_bf16 v[136:139], a[76:79], a[28:31], v[136:139]
    v_exp_f32 v150, v150
    v_cvt_pk_bf16_f32 v169, v146, v147
    v_mfma_f32_16x16x32_bf16 v[132:135], a[80:83], a[0:3], 0
    v_exp_f32 v151, v151
    ds_read_b64_tr_b16 a[104:105], v190 offset:32768
    v_mfma_f32_16x16x32_bf16 v[132:135], a[84:87], a[4:7], v[132:135]
    s_add_u32 m0, s30, 81920
    s_nop 0
    buffer_load_dwordx4 v200, s[20:23], s29 offen offset:0 nt lds
    v_mfma_f32_16x16x32_bf16 v[132:135], a[88:91], a[8:11], v[132:135]
    v_exp_f32 v152, v152
    ds_read_b64_tr_b16 a[106:107], v190 offset:36864
    v_mfma_f32_16x16x32_bf16 v[132:135], a[92:95], a[12:15], v[132:135]
    v_exp_f32 v153, v153
    v_cvt_pk_bf16_f32 v170, v148, v149
    v_mfma_f32_16x16x32_bf16 v[140:143], a[80:83], a[16:19], 0
    v_exp_f32 v154, v154
    ds_read_b64_tr_b16 a[108:109], v191 offset:32768
    v_mfma_f32_16x16x32_bf16 v[140:143], a[84:87], a[20:23], v[140:143]
    v_exp_f32 v155, v155
    v_cvt_pk_bf16_f32 v171, v150, v151
    v_mfma_f32_16x16x32_bf16 v[140:143], a[88:91], a[24:27], v[140:143]
    v_cvt_pk_bf16_f32 v172, v152, v153
    ds_read_b64_tr_b16 a[110:111], v191 offset:36864
    v_mfma_f32_16x16x32_bf16 v[140:143], a[92:95], a[28:31], v[140:143]
    v_exp_f32 v156, v156
    v_mfma_f32_16x16x32_bf16 v[176:179], v[242:245], v[160:163], v[176:179]
    v_cvt_pk_bf16_f32 v173, v154, v155
    ds_read_b64_tr_b16 a[112:113], v192 offset:32768
    v_mfma_f32_16x16x32_bf16 v[184:187], v[242:245], v[164:167], v[184:187]
    ds_read_b64_tr_b16 a[114:115], v192 offset:36864
    s_waitcnt lgkmcnt(8)
    v_mfma_f32_16x16x32_bf16 v[0:3], a[96:99], v[160:163], v[0:3]
    v_exp_f32 v157, v157
    v_mfma_f32_16x16x32_bf16 v[32:35], a[96:99], v[164:167], v[32:35]
    ds_read_b64_tr_b16 a[116:117], v193 offset:32768
    s_waitcnt lgkmcnt(7)
    v_mfma_f32_16x16x32_bf16 v[4:7], a[100:103], v[160:163], v[4:7]
    v_cvt_pk_bf16_f32 v174, v156, v157
    ds_read_b64_tr_b16 a[118:119], v193 offset:36864
    v_mfma_f32_16x16x32_bf16 v[36:39], a[100:103], v[164:167], v[36:39]
    s_waitcnt lgkmcnt(6)
    v_mfma_f32_16x16x32_bf16 v[8:11], a[104:107], v[160:163], v[8:11]
    ds_read_b64_tr_b16 a[120:121], v194 offset:32768
    v_mfma_f32_16x16x32_bf16 v[40:43], a[104:107], v[164:167], v[40:43]
    ds_read_b64_tr_b16 a[122:123], v194 offset:36864
    s_waitcnt lgkmcnt(6)
    v_mfma_f32_16x16x32_bf16 v[12:15], a[108:111], v[160:163], v[12:15]
    v_exp_f32 v158, v158
    v_mfma_f32_16x16x32_bf16 v[44:47], a[108:111], v[164:167], v[44:47]
    ds_read_b64_tr_b16 a[124:125], v195 offset:32768
    s_waitcnt lgkmcnt(5)
    v_mfma_f32_16x16x32_bf16 v[16:19], a[112:115], v[160:163], v[16:19]
    ds_read_b64_tr_b16 a[126:127], v195 offset:36864
    v_mfma_f32_16x16x32_bf16 v[48:51], a[112:115], v[164:167], v[48:51]
    s_waitcnt lgkmcnt(4)
    v_mfma_f32_16x16x32_bf16 v[20:23], a[116:119], v[160:163], v[20:23]
    buffer_load_dwordx4 v201, s[20:23], s29 offen offset:1024 nt lds
    v_mfma_f32_16x16x32_bf16 v[52:55], a[116:119], v[164:167], v[52:55]
    s_waitcnt lgkmcnt(2)
    v_mfma_f32_16x16x32_bf16 v[24:27], a[120:123], v[160:163], v[24:27]
    v_exp_f32 v159, v159
    v_mfma_f32_16x16x32_bf16 v[56:59], a[120:123], v[164:167], v[56:59]
    v_cvt_pk_bf16_f32 v175, v158, v159
    s_waitcnt lgkmcnt(0)
    v_mfma_f32_16x16x32_bf16 v[28:31], a[124:127], v[160:163], v[28:31]
    v_mfma_f32_16x16x32_bf16 v[60:63], a[124:127], v[164:167], v[60:63]
    v_mfma_f32_16x16x32_bf16 v[144:147], a[64:67], a[32:35], 0
    v_exp_f32 v128, v128
    v_mfma_f32_16x16x32_bf16 v[144:147], a[68:71], a[36:39], v[144:147]
    v_exp_f32 v129, v129
    v_mfma_f32_16x16x32_bf16 v[144:147], a[72:75], a[40:43], v[144:147]
    v_exp_f32 v130, v130
    v_mfma_f32_16x16x32_bf16 v[144:147], a[76:79], a[44:47], v[144:147]
    v_exp_f32 v131, v131
    v_mfma_f32_16x16x32_bf16 v[152:155], a[64:67], a[48:51], 0
    v_exp_f32 v132, v132
    v_cvt_pk_bf16_f32 v160, v128, v129
    v_mfma_f32_16x16x32_bf16 v[152:155], a[68:71], a[52:55], v[152:155]
    v_exp_f32 v133, v133
    v_mfma_f32_16x16x32_bf16 v[152:155], a[72:75], a[56:59], v[152:155]
    v_cvt_pk_bf16_f32 v161, v130, v131
    ds_read_b128 a[64:67], v180 offset:49152
    v_mfma_f32_16x16x32_bf16 v[152:155], a[76:79], a[60:63], v[152:155]
    v_exp_f32 v134, v134
    v_mfma_f32_16x16x32_bf16 v[148:151], a[80:83], a[32:35], 0
    v_cvt_pk_bf16_f32 v162, v132, v133
    ds_read_b128 a[68:71], v181 offset:49152
    v_mfma_f32_16x16x32_bf16 v[148:151], a[84:87], a[36:39], v[148:151]
    buffer_load_dwordx4 v200, s[20:23], s29 offen offset:2048 nt lds
    v_mfma_f32_16x16x32_bf16 v[148:151], a[88:91], a[40:43], v[148:151]
    ds_read_b128 a[72:75], v182 offset:49152
    v_mfma_f32_16x16x32_bf16 v[148:151], a[92:95], a[44:47], v[148:151]
    v_exp_f32 v135, v135
    v_mfma_f32_16x16x32_bf16 v[156:159], a[80:83], a[48:51], 0
    v_cvt_pk_bf16_f32 v163, v134, v135
    ds_read_b128 a[76:79], v183 offset:49152
    v_mfma_f32_16x16x32_bf16 v[156:159], a[84:87], a[52:55], v[156:159]
    v_exp_f32 v136, v136
    v_mfma_f32_16x16x32_bf16 v[156:159], a[88:91], a[56:59], v[156:159]
    ds_read_b128 a[80:83], v180 offset:53248
    v_mfma_f32_16x16x32_bf16 v[156:159], a[92:95], a[60:63], v[156:159]
    v_exp_f32 v137, v137
    v_mfma_f32_16x16x32_bf16 v[222:225], v[242:245], v[168:171], v[222:225]
    v_cvt_pk_bf16_f32 v164, v136, v137
    ds_read_b128 a[84:87], v181 offset:53248
    v_mfma_f32_16x16x32_bf16 v[246:249], v[242:245], v[172:175], v[246:249]
    v_exp_f32 v138, v138
    v_mfma_f32_16x16x32_bf16 v[64:67], a[96:99], v[168:171], v[64:67]
    ds_read_b128 a[88:91], v182 offset:53248
    v_mfma_f32_16x16x32_bf16 v[96:99], a[96:99], v[172:175], v[96:99]
    v_exp_f32 v139, v139
    v_mfma_f32_16x16x32_bf16 v[68:71], a[100:103], v[168:171], v[68:71]
    v_cvt_pk_bf16_f32 v165, v138, v139
    ds_read_b128 a[92:95], v183 offset:53248
    v_mfma_f32_16x16x32_bf16 v[100:103], a[100:103], v[172:175], v[100:103]
    v_exp_f32 v140, v140
    v_mfma_f32_16x16x32_bf16 v[72:75], a[104:107], v[168:171], v[72:75]
    v_exp_f32 v141, v141
    v_mfma_f32_16x16x32_bf16 v[104:107], a[104:107], v[172:175], v[104:107]
    v_exp_f32 v142, v142
    v_mfma_f32_16x16x32_bf16 v[76:79], a[108:111], v[168:171], v[76:79]
    v_exp_f32 v143, v143
    v_mfma_f32_16x16x32_bf16 v[108:111], a[108:111], v[172:175], v[108:111]
    v_cvt_pk_bf16_f32 v166, v140, v141
    v_cvt_pk_bf16_f32 v167, v142, v143
    v_mfma_f32_16x16x32_bf16 v[80:83], a[112:115], v[168:171], v[80:83]
    v_mfma_f32_16x16x32_bf16 v[112:115], a[112:115], v[172:175], v[112:115]
    buffer_load_dwordx4 v201, s[20:23], s29 offen offset:3072 nt lds
    s_add_u32 s29, s29, 16384
    v_mfma_f32_16x16x32_bf16 v[84:87], a[116:119], v[168:171], v[84:87]
    v_mfma_f32_16x16x32_bf16 v[116:119], a[116:119], v[172:175], v[116:119]
    v_mfma_f32_16x16x32_bf16 v[88:91], a[120:123], v[168:171], v[88:91]
    v_mfma_f32_16x16x32_bf16 v[120:123], a[120:123], v[172:175], v[120:123]
    v_mfma_f32_16x16x32_bf16 v[92:95], a[124:127], v[168:171], v[92:95]
    v_mfma_f32_16x16x32_bf16 v[124:127], a[124:127], v[172:175], v[124:127]
    s_waitcnt lgkmcnt(7)
    v_mfma_f32_16x16x32_bf16 v[128:131], a[64:67], a[0:3], 0
    ds_read_b64_tr_b16 a[96:97], v188 offset:40960
    s_waitcnt lgkmcnt(7)
    v_mfma_f32_16x16x32_bf16 v[128:131], a[68:71], a[4:7], v[128:131]
    v_exp_f32 v144, v144
    s_waitcnt lgkmcnt(6)
    v_mfma_f32_16x16x32_bf16 v[128:131], a[72:75], a[8:11], v[128:131]
    ds_read_b64_tr_b16 a[98:99], v188 offset:45056
    s_waitcnt lgkmcnt(6)
    v_mfma_f32_16x16x32_bf16 v[128:131], a[76:79], a[12:15], v[128:131]
    v_exp_f32 v145, v145
    v_mfma_f32_16x16x32_bf16 v[136:139], a[64:67], a[16:19], 0
    v_exp_f32 v146, v146
    ds_read_b64_tr_b16 a[100:101], v189 offset:40960
    v_mfma_f32_16x16x32_bf16 v[136:139], a[68:71], a[20:23], v[136:139]
    v_exp_f32 v147, v147
    v_mfma_f32_16x16x32_bf16 v[136:139], a[72:75], a[24:27], v[136:139]
    v_exp_f32 v148, v148
    ds_read_b64_tr_b16 a[102:103], v189 offset:45056
    v_mfma_f32_16x16x32_bf16 v[136:139], a[76:79], a[28:31], v[136:139]
    v_exp_f32 v149, v149
    s_waitcnt lgkmcnt(7)
    v_mfma_f32_16x16x32_bf16 v[132:135], a[80:83], a[0:3], 0
    v_cvt_pk_bf16_f32 v168, v144, v145
    ds_read_b64_tr_b16 a[104:105], v190 offset:40960
    s_waitcnt lgkmcnt(7)
    v_mfma_f32_16x16x32_bf16 v[132:135], a[84:87], a[4:7], v[132:135]
    s_add_u32 m0, s30, 32768
    s_nop 0
    buffer_load_dwordx4 v196, s[16:19], s28 offen offset:0 nt lds
    s_waitcnt lgkmcnt(6)
    v_mfma_f32_16x16x32_bf16 v[132:135], a[88:91], a[8:11], v[132:135]
    v_cvt_pk_bf16_f32 v169, v146, v147
    ds_read_b64_tr_b16 a[106:107], v190 offset:45056
    s_waitcnt lgkmcnt(6)
    v_mfma_f32_16x16x32_bf16 v[132:135], a[92:95], a[12:15], v[132:135]
    v_exp_f32 v150, v150
    v_cvt_pk_bf16_f32 v170, v148, v149
    v_mfma_f32_16x16x32_bf16 v[140:143], a[80:83], a[16:19], 0
    v_exp_f32 v151, v151
    ds_read_b64_tr_b16 a[108:109], v191 offset:40960
    v_mfma_f32_16x16x32_bf16 v[140:143], a[84:87], a[20:23], v[140:143]
    v_exp_f32 v152, v152
    v_mfma_f32_16x16x32_bf16 v[140:143], a[88:91], a[24:27], v[140:143]
    v_exp_f32 v153, v153
    ds_read_b64_tr_b16 a[110:111], v191 offset:45056
    v_mfma_f32_16x16x32_bf16 v[140:143], a[92:95], a[28:31], v[140:143]
    v_exp_f32 v154, v154
    v_cvt_pk_bf16_f32 v171, v150, v151
    v_mfma_f32_16x16x32_bf16 v[176:179], v[242:245], v[160:163], v[176:179]
    v_exp_f32 v155, v155
    ds_read_b64_tr_b16 a[112:113], v192 offset:40960
    v_mfma_f32_16x16x32_bf16 v[184:187], v[242:245], v[164:167], v[184:187]
    v_cvt_pk_bf16_f32 v172, v152, v153
    ds_read_b64_tr_b16 a[114:115], v192 offset:45056
    s_waitcnt lgkmcnt(8)
    v_mfma_f32_16x16x32_bf16 v[0:3], a[96:99], v[160:163], v[0:3]
    v_exp_f32 v156, v156
    v_mfma_f32_16x16x32_bf16 v[32:35], a[96:99], v[164:167], v[32:35]
    v_cvt_pk_bf16_f32 v173, v154, v155
    ds_read_b64_tr_b16 a[116:117], v193 offset:40960
    s_waitcnt lgkmcnt(7)
    v_mfma_f32_16x16x32_bf16 v[4:7], a[100:103], v[160:163], v[4:7]
    v_exp_f32 v157, v157
    ds_read_b64_tr_b16 a[118:119], v193 offset:45056
    v_mfma_f32_16x16x32_bf16 v[36:39], a[100:103], v[164:167], v[36:39]
    v_cvt_pk_bf16_f32 v174, v156, v157
    s_waitcnt lgkmcnt(6)
    v_mfma_f32_16x16x32_bf16 v[8:11], a[104:107], v[160:163], v[8:11]
    ds_read_b64_tr_b16 a[120:121], v194 offset:40960
    v_mfma_f32_16x16x32_bf16 v[40:43], a[104:107], v[164:167], v[40:43]
    ds_read_b64_tr_b16 a[122:123], v194 offset:45056
    s_waitcnt lgkmcnt(6)
    v_mfma_f32_16x16x32_bf16 v[12:15], a[108:111], v[160:163], v[12:15]
    v_exp_f32 v158, v158
    v_mfma_f32_16x16x32_bf16 v[44:47], a[108:111], v[164:167], v[44:47]
    ds_read_b64_tr_b16 a[124:125], v195 offset:40960
    s_waitcnt lgkmcnt(5)
    v_mfma_f32_16x16x32_bf16 v[16:19], a[112:115], v[160:163], v[16:19]
    ds_read_b64_tr_b16 a[126:127], v195 offset:45056
    v_mfma_f32_16x16x32_bf16 v[48:51], a[112:115], v[164:167], v[48:51]
    s_waitcnt lgkmcnt(4)
    v_mfma_f32_16x16x32_bf16 v[20:23], a[116:119], v[160:163], v[20:23]
    buffer_load_dwordx4 v197, s[16:19], s28 offen offset:1024 nt lds
    v_mfma_f32_16x16x32_bf16 v[52:55], a[116:119], v[164:167], v[52:55]
    s_waitcnt lgkmcnt(2)
    v_mfma_f32_16x16x32_bf16 v[24:27], a[120:123], v[160:163], v[24:27]
    v_exp_f32 v159, v159
    v_mfma_f32_16x16x32_bf16 v[56:59], a[120:123], v[164:167], v[56:59]
    v_cvt_pk_bf16_f32 v175, v158, v159
    s_waitcnt lgkmcnt(0)
    v_mfma_f32_16x16x32_bf16 v[28:31], a[124:127], v[160:163], v[28:31]
    v_mfma_f32_16x16x32_bf16 v[60:63], a[124:127], v[164:167], v[60:63]
    v_mfma_f32_16x16x32_bf16 v[144:147], a[64:67], a[32:35], 0
    v_exp_f32 v128, v128
    v_mfma_f32_16x16x32_bf16 v[144:147], a[68:71], a[36:39], v[144:147]
    v_exp_f32 v129, v129
    v_mfma_f32_16x16x32_bf16 v[144:147], a[72:75], a[40:43], v[144:147]
    v_exp_f32 v130, v130
    v_mfma_f32_16x16x32_bf16 v[144:147], a[76:79], a[44:47], v[144:147]
    v_exp_f32 v131, v131
    v_mfma_f32_16x16x32_bf16 v[152:155], a[64:67], a[48:51], 0
    v_exp_f32 v132, v132
    v_cvt_pk_bf16_f32 v160, v128, v129
    v_mfma_f32_16x16x32_bf16 v[152:155], a[68:71], a[52:55], v[152:155]
    v_exp_f32 v133, v133
    v_mfma_f32_16x16x32_bf16 v[152:155], a[72:75], a[56:59], v[152:155]
    v_cvt_pk_bf16_f32 v161, v130, v131
    ds_read_b128 a[64:67], v180 offset:57344
    v_mfma_f32_16x16x32_bf16 v[152:155], a[76:79], a[60:63], v[152:155]
    v_exp_f32 v134, v134
    v_mfma_f32_16x16x32_bf16 v[148:151], a[80:83], a[32:35], 0
    v_cvt_pk_bf16_f32 v162, v132, v133
    ds_read_b128 a[68:71], v181 offset:57344
    v_mfma_f32_16x16x32_bf16 v[148:151], a[84:87], a[36:39], v[148:151]
    buffer_load_dwordx4 v198, s[16:19], s28 offen offset:2048 nt lds
    v_mfma_f32_16x16x32_bf16 v[148:151], a[88:91], a[40:43], v[148:151]
    ds_read_b128 a[72:75], v182 offset:57344
    v_mfma_f32_16x16x32_bf16 v[148:151], a[92:95], a[44:47], v[148:151]
    v_exp_f32 v135, v135
    v_mfma_f32_16x16x32_bf16 v[156:159], a[80:83], a[48:51], 0
    v_cvt_pk_bf16_f32 v163, v134, v135
    ds_read_b128 a[76:79], v183 offset:57344
    v_mfma_f32_16x16x32_bf16 v[156:159], a[84:87], a[52:55], v[156:159]
    v_exp_f32 v136, v136
    v_mfma_f32_16x16x32_bf16 v[156:159], a[88:91], a[56:59], v[156:159]
    ds_read_b128 a[80:83], v180 offset:61440
    v_mfma_f32_16x16x32_bf16 v[156:159], a[92:95], a[60:63], v[156:159]
    v_exp_f32 v137, v137
    v_mfma_f32_16x16x32_bf16 v[222:225], v[242:245], v[168:171], v[222:225]
    v_cvt_pk_bf16_f32 v164, v136, v137
    ds_read_b128 a[84:87], v181 offset:61440
    v_mfma_f32_16x16x32_bf16 v[246:249], v[242:245], v[172:175], v[246:249]
    v_exp_f32 v138, v138
    v_mfma_f32_16x16x32_bf16 v[64:67], a[96:99], v[168:171], v[64:67]
    ds_read_b128 a[88:91], v182 offset:61440
    v_mfma_f32_16x16x32_bf16 v[96:99], a[96:99], v[172:175], v[96:99]
    v_exp_f32 v139, v139
    v_mfma_f32_16x16x32_bf16 v[68:71], a[100:103], v[168:171], v[68:71]
    v_cvt_pk_bf16_f32 v165, v138, v139
    ds_read_b128 a[92:95], v183 offset:61440
    v_mfma_f32_16x16x32_bf16 v[100:103], a[100:103], v[172:175], v[100:103]
    v_exp_f32 v140, v140
    v_mfma_f32_16x16x32_bf16 v[72:75], a[104:107], v[168:171], v[72:75]
    v_exp_f32 v141, v141
    v_mfma_f32_16x16x32_bf16 v[104:107], a[104:107], v[172:175], v[104:107]
    v_exp_f32 v142, v142
    v_mfma_f32_16x16x32_bf16 v[76:79], a[108:111], v[168:171], v[76:79]
    v_exp_f32 v143, v143
    v_mfma_f32_16x16x32_bf16 v[108:111], a[108:111], v[172:175], v[108:111]
    v_cvt_pk_bf16_f32 v166, v140, v141
    v_cvt_pk_bf16_f32 v167, v142, v143
    v_mfma_f32_16x16x32_bf16 v[80:83], a[112:115], v[168:171], v[80:83]
    v_mfma_f32_16x16x32_bf16 v[112:115], a[112:115], v[172:175], v[112:115]
    buffer_load_dwordx4 v199, s[16:19], s28 offen offset:3072 nt lds
    s_add_u32 s28, s28, 16384
    v_mfma_f32_16x16x32_bf16 v[84:87], a[116:119], v[168:171], v[84:87]
    v_mfma_f32_16x16x32_bf16 v[116:119], a[116:119], v[172:175], v[116:119]
    v_mfma_f32_16x16x32_bf16 v[88:91], a[120:123], v[168:171], v[88:91]
    v_mfma_f32_16x16x32_bf16 v[120:123], a[120:123], v[172:175], v[120:123]
    v_mfma_f32_16x16x32_bf16 v[92:95], a[124:127], v[168:171], v[92:95]
    v_mfma_f32_16x16x32_bf16 v[124:127], a[124:127], v[172:175], v[124:127]
    s_waitcnt lgkmcnt(0)
    v_mfma_f32_16x16x32_bf16 v[128:131], a[64:67], a[0:3], 0
    s_waitcnt vmcnt(16)
    s_barrier
    ds_read_b64_tr_b16 a[96:97], v188 offset:49152
    v_mfma_f32_16x16x32_bf16 v[128:131], a[68:71], a[4:7], v[128:131]
    v_exp_f32 v144, v144
    v_mfma_f32_16x16x32_bf16 v[128:131], a[72:75], a[8:11], v[128:131]
    ds_read_b64_tr_b16 a[98:99], v188 offset:53248
    v_exp_f32 v145, v145
    v_mfma_f32_16x16x32_bf16 v[128:131], a[76:79], a[12:15], v[128:131]
    v_exp_f32 v146, v146
    v_mfma_f32_16x16x32_bf16 v[136:139], a[64:67], a[16:19], 0
    ds_read_b64_tr_b16 a[100:101], v189 offset:49152
    v_exp_f32 v147, v147
    v_mfma_f32_16x16x32_bf16 v[136:139], a[68:71], a[20:23], v[136:139]
    v_exp_f32 v148, v148
    v_cvt_pk_bf16_f32 v168, v144, v145
    v_mfma_f32_16x16x32_bf16 v[136:139], a[72:75], a[24:27], v[136:139]
    ds_read_b64_tr_b16 a[102:103], v189 offset:53248
    v_exp_f32 v149, v149
    v_mfma_f32_16x16x32_bf16 v[136:139], a[76:79], a[28:31], v[136:139]
    v_exp_f32 v150, v150
    v_cvt_pk_bf16_f32 v169, v146, v147
    v_mfma_f32_16x16x32_bf16 v[132:135], a[80:83], a[0:3], 0
    ds_read_b64_tr_b16 a[104:105], v190 offset:49152
    v_exp_f32 v151, v151
    v_mfma_f32_16x16x32_bf16 v[132:135], a[84:87], a[4:7], v[132:135]
    s_add_u32 m0, s30, 98304
    s_nop 0
    buffer_load_dwordx4 v200, s[20:23], s29 offen offset:0 nt lds
    v_mfma_f32_16x16x32_bf16 v[132:135], a[88:91], a[8:11], v[132:135]
    ds_read_b64_tr_b16 a[106:107], v190 offset:53248
    v_cvt_pk_bf16_f32 v170, v148, v149
    v_mfma_f32_16x16x32_bf16 v[132:135], a[92:95], a[12:15], v[132:135]
    v_exp_f32 v152, v152
    v_cvt_pk_bf16_f32 v171, v150, v151
    v_mfma_f32_16x16x32_bf16 v[140:143], a[80:83], a[16:19], 0
    ds_read_b64_tr_b16 a[108:109], v191 offset:49152
    v_mfma_f32_16x16x32_bf16 v[140:143], a[84:87], a[20:23], v[140:143]
    v_exp_f32 v153, v153
    v_mfma_f32_16x16x32_bf16 v[140:143], a[88:91], a[24:27], v[140:143]
    ds_read_b64_tr_b16 a[110:111], v191 offset:53248
    v_cvt_pk_bf16_f32 v172, v152, v153
    v_mfma_f32_16x16x32_bf16 v[140:143], a[92:95], a[28:31], v[140:143]
    v_exp_f32 v154, v154
    v_mfma_f32_16x16x32_bf16 v[176:179], v[242:245], v[160:163], v[176:179]
    ds_read_b64_tr_b16 a[112:113], v192 offset:49152
    v_mfma_f32_16x16x32_bf16 v[184:187], v[242:245], v[164:167], v[184:187]
    ds_read_b64_tr_b16 a[114:115], v192 offset:53248
    s_waitcnt lgkmcnt(6)
    v_mfma_f32_16x16x32_bf16 v[0:3], a[96:99], v[160:163], v[0:3]
    v_exp_f32 v155, v155
    v_mfma_f32_16x16x32_bf16 v[32:35], a[96:99], v[164:167], v[32:35]
    ds_read_b64_tr_b16 a[116:117], v193 offset:49152
    v_cvt_pk_bf16_f32 v173, v154, v155
    v_mfma_f32_16x16x32_bf16 v[4:7], a[100:103], v[160:163], v[4:7]
    ds_read_b64_tr_b16 a[118:119], v193 offset:53248
    v_mfma_f32_16x16x32_bf16 v[36:39], a[100:103], v[164:167], v[36:39]
    s_waitcnt lgkmcnt(4)
    v_mfma_f32_16x16x32_bf16 v[8:11], a[104:107], v[160:163], v[8:11]
    ds_read_b64_tr_b16 a[120:121], v194 offset:49152
    v_mfma_f32_16x16x32_bf16 v[40:43], a[104:107], v[164:167], v[40:43]
    ds_read_b64_tr_b16 a[122:123], v194 offset:53248
    v_mfma_f32_16x16x32_bf16 v[12:15], a[108:111], v[160:163], v[12:15]
    v_exp_f32 v156, v156
    v_mfma_f32_16x16x32_bf16 v[44:47], a[108:111], v[164:167], v[44:47]
    ds_read_b64_tr_b16 a[124:125], v195 offset:49152
    s_waitcnt lgkmcnt(3)
    v_mfma_f32_16x16x32_bf16 v[16:19], a[112:115], v[160:163], v[16:19]
    ds_read_b64_tr_b16 a[126:127], v195 offset:53248
    v_mfma_f32_16x16x32_bf16 v[48:51], a[112:115], v[164:167], v[48:51]
    v_exp_f32 v157, v157
    v_mfma_f32_16x16x32_bf16 v[20:23], a[116:119], v[160:163], v[20:23]
    buffer_load_dwordx4 v201, s[20:23], s29 offen offset:1024 nt lds
    v_cvt_pk_bf16_f32 v174, v156, v157
    v_mfma_f32_16x16x32_bf16 v[52:55], a[116:119], v[164:167], v[52:55]
    s_waitcnt lgkmcnt(0)
    v_mfma_f32_16x16x32_bf16 v[24:27], a[120:123], v[160:163], v[24:27]
    v_exp_f32 v158, v158
    v_mfma_f32_16x16x32_bf16 v[56:59], a[120:123], v[164:167], v[56:59]
    v_exp_f32 v159, v159
    v_mfma_f32_16x16x32_bf16 v[28:31], a[124:127], v[160:163], v[28:31]
    v_cvt_pk_bf16_f32 v175, v158, v159
    v_mfma_f32_16x16x32_bf16 v[60:63], a[124:127], v[164:167], v[60:63]
    v_mfma_f32_16x16x32_bf16 v[144:147], a[64:67], a[32:35], 0
    v_exp_f32 v128, v128
    v_mfma_f32_16x16x32_bf16 v[144:147], a[68:71], a[36:39], v[144:147]
    v_exp_f32 v129, v129
    v_mfma_f32_16x16x32_bf16 v[144:147], a[72:75], a[40:43], v[144:147]
    v_exp_f32 v130, v130
    v_mfma_f32_16x16x32_bf16 v[144:147], a[76:79], a[44:47], v[144:147]
    v_exp_f32 v131, v131
    v_mfma_f32_16x16x32_bf16 v[152:155], a[64:67], a[48:51], 0
    v_exp_f32 v132, v132
    v_cvt_pk_bf16_f32 v160, v128, v129
    v_mfma_f32_16x16x32_bf16 v[152:155], a[68:71], a[52:55], v[152:155]
    v_exp_f32 v133, v133
    v_mfma_f32_16x16x32_bf16 v[152:155], a[72:75], a[56:59], v[152:155]
    ds_read_b128 a[64:67], v180 offset:0
    v_cvt_pk_bf16_f32 v161, v130, v131
    v_mfma_f32_16x16x32_bf16 v[152:155], a[76:79], a[60:63], v[152:155]
    v_exp_f32 v134, v134
    v_mfma_f32_16x16x32_bf16 v[148:151], a[80:83], a[32:35], 0
    ds_read_b128 a[68:71], v181 offset:0
    v_cvt_pk_bf16_f32 v162, v132, v133
    v_mfma_f32_16x16x32_bf16 v[148:151], a[84:87], a[36:39], v[148:151]
    buffer_load_dwordx4 v200, s[20:23], s29 offen offset:2048 nt lds
    v_mfma_f32_16x16x32_bf16 v[148:151], a[88:91], a[40:43], v[148:151]
    ds_read_b128 a[72:75], v182 offset:0
    v_mfma_f32_16x16x32_bf16 v[148:151], a[92:95], a[44:47], v[148:151]
    v_exp_f32 v135, v135
    v_mfma_f32_16x16x32_bf16 v[156:159], a[80:83], a[48:51], 0
    ds_read_b128 a[76:79], v183 offset:0
    v_cvt_pk_bf16_f32 v163, v134, v135
    v_mfma_f32_16x16x32_bf16 v[156:159], a[84:87], a[52:55], v[156:159]
    v_exp_f32 v136, v136
    v_mfma_f32_16x16x32_bf16 v[156:159], a[88:91], a[56:59], v[156:159]
    ds_read_b128 a[80:83], v180 offset:4096
    v_mfma_f32_16x16x32_bf16 v[156:159], a[92:95], a[60:63], v[156:159]
    v_exp_f32 v137, v137
    v_mfma_f32_16x16x32_bf16 v[222:225], v[242:245], v[168:171], v[222:225]
    ds_read_b128 a[84:87], v181 offset:4096
    v_cvt_pk_bf16_f32 v164, v136, v137
    v_mfma_f32_16x16x32_bf16 v[246:249], v[242:245], v[172:175], v[246:249]
    v_exp_f32 v138, v138
    v_mfma_f32_16x16x32_bf16 v[64:67], a[96:99], v[168:171], v[64:67]
    ds_read_b128 a[88:91], v182 offset:4096
    v_mfma_f32_16x16x32_bf16 v[96:99], a[96:99], v[172:175], v[96:99]
    v_exp_f32 v139, v139
    v_mfma_f32_16x16x32_bf16 v[68:71], a[100:103], v[168:171], v[68:71]
    ds_read_b128 a[92:95], v183 offset:4096
    v_cvt_pk_bf16_f32 v165, v138, v139
    v_mfma_f32_16x16x32_bf16 v[100:103], a[100:103], v[172:175], v[100:103]
    v_exp_f32 v140, v140
    v_mfma_f32_16x16x32_bf16 v[72:75], a[104:107], v[168:171], v[72:75]
    v_exp_f32 v141, v141
    v_mfma_f32_16x16x32_bf16 v[104:107], a[104:107], v[172:175], v[104:107]
    v_exp_f32 v142, v142
    v_mfma_f32_16x16x32_bf16 v[76:79], a[108:111], v[168:171], v[76:79]
    v_exp_f32 v143, v143
    v_mfma_f32_16x16x32_bf16 v[108:111], a[108:111], v[172:175], v[108:111]
    v_cvt_pk_bf16_f32 v166, v140, v141
    v_cvt_pk_bf16_f32 v167, v142, v143
    v_mfma_f32_16x16x32_bf16 v[80:83], a[112:115], v[168:171], v[80:83]
    v_mfma_f32_16x16x32_bf16 v[112:115], a[112:115], v[172:175], v[112:115]
    buffer_load_dwordx4 v201, s[20:23], s29 offen offset:3072 nt lds
    s_add_u32 s29, s29, 16384
    v_mfma_f32_16x16x32_bf16 v[84:87], a[116:119], v[168:171], v[84:87]
    v_mfma_f32_16x16x32_bf16 v[116:119], a[116:119], v[172:175], v[116:119]
    v_mfma_f32_16x16x32_bf16 v[88:91], a[120:123], v[168:171], v[88:91]
    v_mfma_f32_16x16x32_bf16 v[120:123], a[120:123], v[172:175], v[120:123]
    v_mfma_f32_16x16x32_bf16 v[92:95], a[124:127], v[168:171], v[92:95]
    v_mfma_f32_16x16x32_bf16 v[124:127], a[124:127], v[172:175], v[124:127]
    s_waitcnt lgkmcnt(0)
    v_mfma_f32_16x16x32_bf16 v[128:131], a[64:67], a[128:131], 0
    ds_read_b64_tr_b16 a[96:97], v188 offset:57344
    v_exp_f32 v144, v144
    v_mfma_f32_16x16x32_bf16 v[128:131], a[68:71], a[132:135], v[128:131]
    v_exp_f32 v145, v145
    v_mfma_f32_16x16x32_bf16 v[128:131], a[72:75], a[136:139], v[128:131]
    ds_read_b64_tr_b16 a[98:99], v188 offset:61440
    v_exp_f32 v146, v146
    v_mfma_f32_16x16x32_bf16 v[128:131], a[76:79], a[140:143], v[128:131]
    v_exp_f32 v147, v147
    v_mfma_f32_16x16x32_bf16 v[136:139], a[64:67], a[144:147], 0
    ds_read_b64_tr_b16 a[100:101], v189 offset:57344
    v_exp_f32 v148, v148
    v_mfma_f32_16x16x32_bf16 v[136:139], a[68:71], a[148:151], v[136:139]
    v_exp_f32 v149, v149
    v_cvt_pk_bf16_f32 v168, v144, v145
    v_mfma_f32_16x16x32_bf16 v[136:139], a[72:75], a[152:155], v[136:139]
    ds_read_b64_tr_b16 a[102:103], v189 offset:61440
    v_exp_f32 v150, v150
    v_mfma_f32_16x16x32_bf16 v[136:139], a[76:79], a[156:159], v[136:139]
    v_exp_f32 v151, v151
    v_cvt_pk_bf16_f32 v169, v146, v147
    v_mfma_f32_16x16x32_bf16 v[132:135], a[80:83], a[128:131], 0
    ds_read_b64_tr_b16 a[104:105], v190 offset:57344
    v_cvt_pk_bf16_f32 v170, v148, v149
    v_mfma_f32_16x16x32_bf16 v[132:135], a[84:87], a[132:135], v[132:135]
    s_add_u32 m0, s30, 49152
    s_nop 0
    buffer_load_dwordx4 v196, s[16:19], s28 offen offset:0 nt lds
    v_mfma_f32_16x16x32_bf16 v[132:135], a[88:91], a[136:139], v[132:135]
    ds_read_b64_tr_b16 a[106:107], v190 offset:61440
    v_cvt_pk_bf16_f32 v171, v150, v151
    v_mfma_f32_16x16x32_bf16 v[132:135], a[92:95], a[140:143], v[132:135]
    v_exp_f32 v152, v152
    v_mfma_f32_16x16x32_bf16 v[140:143], a[80:83], a[144:147], 0
    ds_read_b64_tr_b16 a[108:109], v191 offset:57344
    v_mfma_f32_16x16x32_bf16 v[140:143], a[84:87], a[148:151], v[140:143]
    v_exp_f32 v153, v153
    v_mfma_f32_16x16x32_bf16 v[140:143], a[88:91], a[152:155], v[140:143]
    ds_read_b64_tr_b16 a[110:111], v191 offset:61440
    v_cvt_pk_bf16_f32 v172, v152, v153
    v_mfma_f32_16x16x32_bf16 v[140:143], a[92:95], a[156:159], v[140:143]
    v_exp_f32 v154, v154
    v_mfma_f32_16x16x32_bf16 v[176:179], v[242:245], v[160:163], v[176:179]
    ds_read_b64_tr_b16 a[112:113], v192 offset:57344
    v_mfma_f32_16x16x32_bf16 v[184:187], v[242:245], v[164:167], v[184:187]
    ds_read_b64_tr_b16 a[114:115], v192 offset:61440
    s_waitcnt lgkmcnt(6)
    v_mfma_f32_16x16x32_bf16 v[0:3], a[96:99], v[160:163], v[0:3]
    v_exp_f32 v155, v155
    v_mfma_f32_16x16x32_bf16 v[32:35], a[96:99], v[164:167], v[32:35]
    ds_read_b64_tr_b16 a[116:117], v193 offset:57344
    v_cvt_pk_bf16_f32 v173, v154, v155
    v_mfma_f32_16x16x32_bf16 v[4:7], a[100:103], v[160:163], v[4:7]
    ds_read_b64_tr_b16 a[118:119], v193 offset:61440
    v_mfma_f32_16x16x32_bf16 v[36:39], a[100:103], v[164:167], v[36:39]
    s_waitcnt lgkmcnt(4)
    v_mfma_f32_16x16x32_bf16 v[8:11], a[104:107], v[160:163], v[8:11]
    ds_read_b64_tr_b16 a[120:121], v194 offset:57344
    v_mfma_f32_16x16x32_bf16 v[40:43], a[104:107], v[164:167], v[40:43]
    ds_read_b64_tr_b16 a[122:123], v194 offset:61440
    v_mfma_f32_16x16x32_bf16 v[12:15], a[108:111], v[160:163], v[12:15]
    v_exp_f32 v156, v156
    v_mfma_f32_16x16x32_bf16 v[44:47], a[108:111], v[164:167], v[44:47]
    ds_read_b64_tr_b16 a[124:125], v195 offset:57344
    s_waitcnt lgkmcnt(3)
    v_mfma_f32_16x16x32_bf16 v[16:19], a[112:115], v[160:163], v[16:19]
    ds_read_b64_tr_b16 a[126:127], v195 offset:61440
    v_mfma_f32_16x16x32_bf16 v[48:51], a[112:115], v[164:167], v[48:51]
    v_exp_f32 v157, v157
    v_mfma_f32_16x16x32_bf16 v[20:23], a[116:119], v[160:163], v[20:23]
    buffer_load_dwordx4 v197, s[16:19], s28 offen offset:1024 nt lds
    v_cvt_pk_bf16_f32 v174, v156, v157
    v_mfma_f32_16x16x32_bf16 v[52:55], a[116:119], v[164:167], v[52:55]
    s_waitcnt lgkmcnt(0)
    v_mfma_f32_16x16x32_bf16 v[24:27], a[120:123], v[160:163], v[24:27]
    v_exp_f32 v158, v158
    v_mfma_f32_16x16x32_bf16 v[56:59], a[120:123], v[164:167], v[56:59]
    v_exp_f32 v159, v159
    v_mfma_f32_16x16x32_bf16 v[28:31], a[124:127], v[160:163], v[28:31]
    v_cvt_pk_bf16_f32 v175, v158, v159
    v_mfma_f32_16x16x32_bf16 v[60:63], a[124:127], v[164:167], v[60:63]
    v_mfma_f32_16x16x32_bf16 v[144:147], a[64:67], a[160:163], 0
    v_exp_f32 v128, v128
    v_cmp_nle_f32 vcc, s48, v176
    v_mfma_f32_16x16x32_bf16 v[144:147], a[68:71], a[164:167], v[144:147]
    s_mov_b64 s[42:43], vcc
    v_exp_f32 v129, v129
    v_cmp_nge_f32 vcc, s49, v176
    v_mfma_f32_16x16x32_bf16 v[144:147], a[72:75], a[168:171], v[144:147]
    s_or_b64 s[42:43], s[42:43], vcc
    v_exp_f32 v130, v130
    v_cmp_nle_f32 vcc, s48, v184
    v_mfma_f32_16x16x32_bf16 v[144:147], a[76:79], a[172:175], v[144:147]
    s_or_b64 s[42:43], s[42:43], vcc
    v_exp_f32 v131, v131
    v_cmp_nge_f32 vcc, s49, v184
    v_mfma_f32_16x16x32_bf16 v[152:155], a[64:67], a[176:179], 0
    s_or_b64 s[42:43], s[42:43], vcc
    s_cselect_b32 s42, 1, 0
    s_or_b32 s50, s50, s42
    v_exp_f32 v132, v132
    v_cvt_pk_bf16_f32 v160, v128, v129
    v_rcp_f32 v218, v176
    v_rcp_f32 v219, v184
    v_mul_f32 v0, v0, v218
    v_mul_f32 v1, v1, v218
    v_mul_f32 v2, v2, v218
    v_mul_f32 v3, v3, v218
    v_mul_f32 v4, v4, v218
    v_mul_f32 v5, v5, v218
    v_mul_f32 v6, v6, v218
    v_mul_f32 v7, v7, v218
    v_mul_f32 v8, v8, v218
    v_mul_f32 v9, v9, v218
    v_mfma_f32_16x16x32_bf16 v[152:155], a[68:71], a[180:183], v[152:155]
    v_exp_f32 v133, v133
    v_mul_f32 v10, v10, v218
    v_mul_f32 v11, v11, v218
    v_mul_f32 v12, v12, v218
    v_mul_f32 v13, v13, v218
    v_mfma_f32_16x16x32_bf16 v[152:155], a[72:75], a[184:187], v[152:155]
    ds_read_b128 a[64:67], v180 offset:8192
    v_cvt_pk_bf16_f32 v161, v130, v131
    v_mul_f32 v14, v14, v218
    v_mul_f32 v15, v15, v218
    v_cvt_pk_bf16_f32 v0, v0, v1
    v_cvt_pk_bf16_f32 v1, v2, v3
    v_mfma_f32_16x16x32_bf16 v[152:155], a[76:79], a[188:191], v[152:155]
    v_exp_f32 v134, v134
    v_cvt_pk_bf16_f32 v2, v4, v5
    v_cvt_pk_bf16_f32 v3, v6, v7
    v_cvt_pk_bf16_f32 v4, v8, v9
    v_cvt_pk_bf16_f32 v5, v10, v11
    v_mfma_f32_16x16x32_bf16 v[148:151], a[80:83], a[160:163], 0
    ds_read_b128 a[68:71], v181 offset:8192
    v_cvt_pk_bf16_f32 v162, v132, v133
    v_cvt_pk_bf16_f32 v6, v12, v13
    v_cvt_pk_bf16_f32 v7, v14, v15
    v_mfma_f32_16x16x32_bf16 v[148:151], a[84:87], a[164:167], v[148:151]
    buffer_load_dwordx4 v198, s[16:19], s28 offen offset:2048 nt lds
    ds_write_b64 v206, v[0:1] offset:0
    ds_write_b64 v207, v[2:3] offset:0
    v_mfma_f32_16x16x32_bf16 v[148:151], a[88:91], a[168:171], v[148:151]
    ds_read_b128 a[72:75], v182 offset:8192
    ds_write_b64 v208, v[4:5] offset:0
    ds_write_b64 v209, v[6:7] offset:0
    v_mfma_f32_16x16x32_bf16 v[148:151], a[92:95], a[172:175], v[148:151]
    v_mfma_f32_16x16x32_bf16 v[226:229], v[242:245], v[0:3], 0
    v_mfma_f32_16x16x32_bf16 v[226:229], v[242:245], v[4:7], v[226:229]
    v_exp_f32 v135, v135
    v_mul_f32 v16, v16, v218
    v_mul_f32 v17, v17, v218
    v_mul_f32 v18, v18, v218
    v_mul_f32 v19, v19, v218
    v_mul_f32 v20, v20, v218
    v_mul_f32 v21, v21, v218
    v_mul_f32 v22, v22, v218
    v_mfma_f32_16x16x32_bf16 v[156:159], a[80:83], a[176:179], 0
    ds_read_b128 a[76:79], v183 offset:8192
    v_cvt_pk_bf16_f32 v163, v134, v135
    v_mul_f32 v23, v23, v218
    v_mul_f32 v24, v24, v218
    v_mul_f32 v25, v25, v218
    v_mul_f32 v26, v26, v218
    v_mfma_f32_16x16x32_bf16 v[156:159], a[84:87], a[180:183], v[156:159]
    v_exp_f32 v136, v136
    v_mul_f32 v27, v27, v218
    v_mul_f32 v28, v28, v218
    v_mul_f32 v29, v29, v218
    v_mul_f32 v30, v30, v218
    v_mfma_f32_16x16x32_bf16 v[156:159], a[88:91], a[184:187], v[156:159]
    ds_read_b128 a[80:83], v180 offset:12288
    v_mul_f32 v31, v31, v218
    v_cvt_pk_bf16_f32 v16, v16, v17
    v_cvt_pk_bf16_f32 v17, v18, v19
    v_cvt_pk_bf16_f32 v18, v20, v21
    v_mfma_f32_16x16x32_bf16 v[156:159], a[92:95], a[188:191], v[156:159]
    v_exp_f32 v137, v137
    v_cvt_pk_bf16_f32 v19, v22, v23
    v_cvt_pk_bf16_f32 v20, v24, v25
    v_cvt_pk_bf16_f32 v21, v26, v27
    v_cvt_pk_bf16_f32 v22, v28, v29
    v_mfma_f32_16x16x32_bf16 v[222:225], v[242:245], v[168:171], v[222:225]
    ds_read_b128 a[84:87], v181 offset:12288
    v_cvt_pk_bf16_f32 v164, v136, v137
    v_cvt_pk_bf16_f32 v23, v30, v31
    v_mfma_f32_16x16x32_bf16 v[246:249], v[242:245], v[172:175], v[246:249]
    ds_write_b64 v210, v[16:17] offset:0
    ds_write_b64 v211, v[18:19] offset:0
    v_exp_f32 v138, v138
    v_mfma_f32_16x16x32_bf16 v[64:67], a[96:99], v[168:171], v[64:67]
    ds_read_b128 a[88:91], v182 offset:12288
    ds_write_b64 v212, v[20:21] offset:0
    ds_write_b64 v213, v[22:23] offset:0
    v_mfma_f32_16x16x32_bf16 v[96:99], a[96:99], v[172:175], v[96:99]
    v_mfma_f32_16x16x32_bf16 v[226:229], v[242:245], v[16:19], v[226:229]
    v_mfma_f32_16x16x32_bf16 v[226:229], v[242:245], v[20:23], v[226:229]
    v_exp_f32 v139, v139
    v_mul_f32 v32, v32, v219
    v_mul_f32 v33, v33, v219
    v_mul_f32 v34, v34, v219
    v_mul_f32 v35, v35, v219
    v_mul_f32 v36, v36, v219
    v_mul_f32 v37, v37, v219
    v_mul_f32 v38, v38, v219
    v_mul_f32 v39, v39, v219
    v_mul_f32 v40, v40, v219
    v_mfma_f32_16x16x32_bf16 v[68:71], a[100:103], v[168:171], v[68:71]
    ds_read_b128 a[92:95], v183 offset:12288
    v_cvt_pk_bf16_f32 v165, v138, v139
    v_mul_f32 v41, v41, v219
    v_mul_f32 v42, v42, v219
    v_mul_f32 v43, v43, v219
    v_mul_f32 v44, v44, v219
    v_mfma_f32_16x16x32_bf16 v[100:103], a[100:103], v[172:175], v[100:103]
    v_exp_f32 v140, v140
    v_mul_f32 v45, v45, v219
    v_mul_f32 v46, v46, v219
    v_mul_f32 v47, v47, v219
    v_cvt_pk_bf16_f32 v32, v32, v33
    v_mfma_f32_16x16x32_bf16 v[72:75], a[104:107], v[168:171], v[72:75]
    v_exp_f32 v141, v141
    v_cvt_pk_bf16_f32 v33, v34, v35
    v_cvt_pk_bf16_f32 v34, v36, v37
    v_cvt_pk_bf16_f32 v35, v38, v39
    v_cvt_pk_bf16_f32 v36, v40, v41
    v_mfma_f32_16x16x32_bf16 v[104:107], a[104:107], v[172:175], v[104:107]
    v_exp_f32 v142, v142
    v_cvt_pk_bf16_f32 v37, v42, v43
    v_cvt_pk_bf16_f32 v38, v44, v45
    v_cvt_pk_bf16_f32 v39, v46, v47
    v_mfma_f32_16x16x32_bf16 v[76:79], a[108:111], v[168:171], v[76:79]
    ds_write_b64 v206, v[32:33] offset:4096
    ds_write_b64 v207, v[34:35] offset:4096
    v_exp_f32 v143, v143
    v_mfma_f32_16x16x32_bf16 v[108:111], a[108:111], v[172:175], v[108:111]
    ds_write_b64 v208, v[36:37] offset:4096
    ds_write_b64 v209, v[38:39] offset:4096
    v_cvt_pk_bf16_f32 v166, v140, v141
    v_cvt_pk_bf16_f32 v167, v142, v143
    v_mfma_f32_16x16x32_bf16 v[80:83], a[112:115], v[168:171], v[80:83]
    v_mfma_f32_16x16x32_bf16 v[226:229], v[242:245], v[32:35], v[226:229]
    v_mfma_f32_16x16x32_bf16 v[226:229], v[242:245], v[36:39], v[226:229]
    v_mul_f32 v48, v48, v219
    v_mul_f32 v49, v49, v219
    v_mul_f32 v50, v50, v219
    v_mul_f32 v51, v51, v219
    v_mul_f32 v52, v52, v219
    v_mul_f32 v53, v53, v219
    v_mfma_f32_16x16x32_bf16 v[112:115], a[112:115], v[172:175], v[112:115]
    buffer_load_dwordx4 v199, s[16:19], s28 offen offset:3072 nt lds
    s_add_u32 s28, s28, 16384
    v_mul_f32 v54, v54, v219
    v_mul_f32 v55, v55, v219
    v_mul_f32 v56, v56, v219
    v_mul_f32 v57, v57, v219
    v_mfma_f32_16x16x32_bf16 v[84:87], a[116:119], v[168:171], v[84:87]
    v_mul_f32 v58, v58, v219
    v_mul_f32 v59, v59, v219
    v_mul_f32 v60, v60, v219
    v_mul_f32 v61, v61, v219
    v_mfma_f32_16x16x32_bf16 v[116:119], a[116:119], v[172:175], v[116:119]
    v_mul_f32 v62, v62, v219
    v_mul_f32 v63, v63, v219
    v_cvt_pk_bf16_f32 v48, v48, v49
    v_cvt_pk_bf16_f32 v49, v50, v51
    v_mfma_f32_16x16x32_bf16 v[88:91], a[120:123], v[168:171], v[88:91]
    v_cvt_pk_bf16_f32 v50, v52, v53
    v_cvt_pk_bf16_f32 v51, v54, v55
    v_cvt_pk_bf16_f32 v52, v56, v57
    v_cvt_pk_bf16_f32 v53, v58, v59
    v_mfma_f32_16x16x32_bf16 v[120:123], a[120:123], v[172:175], v[120:123]
    v_cvt_pk_bf16_f32 v54, v60, v61
    v_cvt_pk_bf16_f32 v55, v62, v63
    v_mfma_f32_16x16x32_bf16 v[92:95], a[124:127], v[168:171], v[92:95]
    ds_write_b64 v210, v[48:49] offset:4096
    ds_write_b64 v211, v[50:51] offset:4096
    v_mfma_f32_16x16x32_bf16 v[124:127], a[124:127], v[172:175], v[124:127]
    ds_write_b64 v212, v[52:53] offset:4096
    ds_write_b64 v213, v[54:55] offset:4096
    v_mfma_f32_16x16x32_bf16 v[226:229], v[242:245], v[48:51], v[226:229]
    v_mfma_f32_16x16x32_bf16 v[226:229], v[242:245], v[52:55], v[226:229]
    s_waitcnt lgkmcnt(8)
    v_mfma_f32_16x16x32_bf16 v[128:131], a[64:67], a[128:131], 0
    s_waitcnt vmcnt(16)
    s_barrier
    ds_read_b64_tr_b16 a[96:97], v188 offset:0
    v_mfma_f32_16x16x32_bf16 v[128:131], a[68:71], a[132:135], v[128:131]
    ds_read_b128 a[192:195], v205 offset:0
    ds_read_b128 a[196:199], v205 offset:1024
    v_exp_f32 v144, v144
    v_mfma_f32_16x16x32_bf16 v[128:131], a[72:75], a[136:139], v[128:131]
    ds_read_b64_tr_b16 a[98:99], v188 offset:4096
    ds_read_b128 a[200:203], v205 offset:2048
    ds_read_b128 a[204:207], v205 offset:3072
    v_exp_f32 v145, v145
    v_mfma_f32_16x16x32_bf16 v[128:131], a[76:79], a[140:143], v[128:131]
    ds_read_b128 a[208:211], v205 offset:4096
    ds_read_b128 a[212:215], v205 offset:5120
    v_exp_f32 v146, v146
    v_mfma_f32_16x16x32_bf16 v[136:139], a[64:67], a[144:147], 0
    ds_read_b64_tr_b16 a[100:101], v189 offset:0
    ds_read_b128 a[216:219], v205 offset:6144
    ds_read_b128 a[220:223], v205 offset:7168
    v_exp_f32 v147, v147
    v_cmp_class_f32 vcc, v226, v250
    v_mfma_f32_16x16x32_bf16 v[136:139], a[68:71], a[148:151], v[136:139]
    s_cmp_lg_u64 vcc, 0
    s_cselect_b32 s42, 1, 0
    s_or_b32 s50, s50, s42
    v_exp_f32 v148, v148
    v_cvt_pk_bf16_f32 v168, v144, v145
    v_cmp_nle_f32 vcc, s48, v222
    v_mfma_f32_16x16x32_bf16 v[136:139], a[72:75], a[152:155], v[136:139]
    ds_read_b64_tr_b16 a[102:103], v189 offset:4096
    s_mov_b64 s[42:43], vcc
    v_exp_f32 v149, v149
    v_cmp_nge_f32 vcc, s49, v222
    v_mfma_f32_16x16x32_bf16 v[136:139], a[76:79], a[156:159], v[136:139]
    s_or_b64 s[42:43], s[42:43], vcc
    v_exp_f32 v150, v150
    v_cvt_pk_bf16_f32 v169, v146, v147
    v_cmp_nle_f32 vcc, s48, v246
    v_mfma_f32_16x16x32_bf16 v[132:135], a[80:83], a[128:131], 0
    ds_read_b64_tr_b16 a[104:105], v190 offset:0
    s_or_b64 s[42:43], s[42:43], vcc
    v_exp_f32 v151, v151
    v_cmp_nge_f32 vcc, s49, v246
    v_mfma_f32_16x16x32_bf16 v[132:135], a[84:87], a[132:135], v[132:135]
    s_add_u32 m0, s30, 114688
    s_nop 0
    buffer_load_dwordx4 v200, s[20:23], s29 offen offset:0 nt lds
    s_or_b64 s[42:43], s[42:43], vcc
    s_cselect_b32 s42, 1, 0
    s_or_b32 s50, s50, s42
    v_rcp_f32 v220, v222
    v_rcp_f32 v221, v246
    v_mul_f32 v64, v64, v220
    v_mul_f32 v65, v65, v220
    v_mul_f32 v66, v66, v220
    v_mul_f32 v67, v67, v220
    v_mul_f32 v68, v68, v220
    v_mul_f32 v69, v69, v220
    v_mul_f32 v70, v70, v220
    v_mul_f32 v71, v71, v220
    v_mul_f32 v72, v72, v220
    v_mul_f32 v73, v73, v220
    v_mul_f32 v74, v74, v220
    v_mul_f32 v75, v75, v220
    v_mul_f32 v76, v76, v220
    v_mul_f32 v77, v77, v220
    v_mul_f32 v78, v78, v220
    v_mul_f32 v79, v79, v220
    v_cvt_pk_bf16_f32 v64, v64, v65
    v_cvt_pk_bf16_f32 v65, v66, v67
    v_cvt_pk_bf16_f32 v66, v68, v69
    v_mfma_f32_16x16x32_bf16 v[132:135], a[88:91], a[136:139], v[132:135]
    ds_read_b64_tr_b16 a[106:107], v190 offset:4096
    v_cvt_pk_bf16_f32 v170, v148, v149
    v_cvt_pk_bf16_f32 v67, v70, v71
    v_cvt_pk_bf16_f32 v68, v72, v73
    v_cvt_pk_bf16_f32 v69, v74, v75
    v_cvt_pk_bf16_f32 v70, v76, v77
    v_cvt_pk_bf16_f32 v71, v78, v79
    v_mfma_f32_16x16x32_bf16 v[132:135], a[92:95], a[140:143], v[132:135]
    ds_write_b64 v206, v[64:65] offset:0
    ds_write_b64 v207, v[66:67] offset:0
    v_exp_f32 v152, v152
    v_cvt_pk_bf16_f32 v171, v150, v151
    v_mfma_f32_16x16x32_bf16 v[140:143], a[80:83], a[144:147], 0
    ds_read_b64_tr_b16 a[108:109], v191 offset:0
    ds_write_b64 v208, v[68:69] offset:0
    ds_write_b64 v209, v[70:71] offset:0
    v_mfma_f32_16x16x32_bf16 v[140:143], a[84:87], a[148:151], v[140:143]
    v_mfma_f32_16x16x32_bf16 v[230:233], v[242:245], v[64:67], 0
    v_mfma_f32_16x16x32_bf16 v[230:233], v[242:245], v[68:71], v[230:233]
    v_exp_f32 v153, v153
    v_mul_f32 v80, v80, v220
    v_mul_f32 v81, v81, v220
    v_mul_f32 v82, v82, v220
    v_mul_f32 v83, v83, v220
    v_mul_f32 v84, v84, v220
    v_mul_f32 v85, v85, v220
    v_mul_f32 v86, v86, v220
    v_mfma_f32_16x16x32_bf16 v[140:143], a[88:91], a[152:155], v[140:143]
    ds_read_b64_tr_b16 a[110:111], v191 offset:4096
    v_cvt_pk_bf16_f32 v172, v152, v153
    v_mul_f32 v87, v87, v220
    v_mul_f32 v88, v88, v220
    v_mul_f32 v89, v89, v220
    v_mul_f32 v90, v90, v220
    v_mfma_f32_16x16x32_bf16 v[140:143], a[92:95], a[156:159], v[140:143]
    v_exp_f32 v154, v154
    v_mul_f32 v91, v91, v220
    v_mul_f32 v92, v92, v220
    v_mul_f32 v93, v93, v220
    v_mul_f32 v94, v94, v220
    v_mul_f32 v95, v95, v220
    v_mfma_f32_16x16x32_bf16 v[176:179], v[242:245], v[160:163], 0
    ds_read_b64_tr_b16 a[112:113], v192 offset:0
    v_cvt_pk_bf16_f32 v80, v80, v81
    v_cvt_pk_bf16_f32 v81, v82, v83
    v_cvt_pk_bf16_f32 v82, v84, v85
    v_cvt_pk_bf16_f32 v83, v86, v87
    v_mfma_f32_16x16x32_bf16 v[184:187], v[242:245], v[164:167], 0
    ds_read_b64_tr_b16 a[114:115], v192 offset:4096
    v_cvt_pk_bf16_f32 v84, v88, v89
    v_cvt_pk_bf16_f32 v85, v90, v91
    v_cvt_pk_bf16_f32 v86, v92, v93
    v_cvt_pk_bf16_f32 v87, v94, v95
    s_waitcnt lgkmcnt(10)
    v_mfma_f32_16x16x32_bf16 v[0:3], a[96:99], v[160:163], 0
    ds_write_b64 v210, v[80:81] offset:0
    ds_write_b64 v211, v[82:83] offset:0
    v_exp_f32 v155, v155
    v_mfma_f32_16x16x32_bf16 v[32:35], a[96:99], v[164:167], 0
    ds_read_b64_tr_b16 a[116:117], v193 offset:0
    ds_write_b64 v212, v[84:85] offset:0
    ds_write_b64 v213, v[86:87] offset:0
    v_cvt_pk_bf16_f32 v173, v154, v155
    v_mfma_f32_16x16x32_bf16 v[4:7], a[100:103], v[160:163], 0
    ds_read_b64_tr_b16 a[118:119], v193 offset:4096
    v_mfma_f32_16x16x32_bf16 v[230:233], v[242:245], v[80:83], v[230:233]
    v_mfma_f32_16x16x32_bf16 v[230:233], v[242:245], v[84:87], v[230:233]
    v_mul_f32 v96, v96, v221
    v_mul_f32 v97, v97, v221
    v_mul_f32 v98, v98, v221
    v_mul_f32 v99, v99, v221
    v_mul_f32 v100, v100, v221
    v_mul_f32 v101, v101, v221
    v_mul_f32 v102, v102, v221
    v_mul_f32 v103, v103, v221
    v_mfma_f32_16x16x32_bf16 v[36:39], a[100:103], v[164:167], 0
    v_mul_f32 v104, v104, v221
    v_mul_f32 v105, v105, v221
    v_mul_f32 v106, v106, v221
    v_mul_f32 v107, v107, v221
    s_waitcnt lgkmcnt(8)
    v_mfma_f32_16x16x32_bf16 v[8:11], a[104:107], v[160:163], 0
    ds_read_b64_tr_b16 a[120:121], v194 offset:0
    v_mul_f32 v108, v108, v221
    v_mul_f32 v109, v109, v221
    v_mul_f32 v110, v110, v221
    v_mul_f32 v111, v111, v221
    v_mfma_f32_16x16x32_bf16 v[40:43], a[104:107], v[164:167], 0
    ds_read_b64_tr_b16 a[122:123], v194 offset:4096
    v_cvt_pk_bf16_f32 v96, v96, v97
    v_cvt_pk_bf16_f32 v97, v98, v99
    v_cvt_pk_bf16_f32 v98, v100, v101
    v_cvt_pk_bf16_f32 v99, v102, v103
    v_cvt_pk_bf16_f32 v100, v104, v105
    v_mfma_f32_16x16x32_bf16 v[12:15], a[108:111], v[160:163], 0
    v_exp_f32 v156, v156
    v_cvt_pk_bf16_f32 v101, v106, v107
    v_cvt_pk_bf16_f32 v102, v108, v109
    v_cvt_pk_bf16_f32 v103, v110, v111
    v_mfma_f32_16x16x32_bf16 v[44:47], a[108:111], v[164:167], 0
    ds_read_b64_tr_b16 a[124:125], v195 offset:0
    ds_write_b64 v206, v[96:97] offset:4096
    ds_write_b64 v207, v[98:99] offset:4096
    s_waitcnt lgkmcnt(5)
    v_mfma_f32_16x16x32_bf16 v[16:19], a[112:115], v[160:163], 0
    ds_read_b64_tr_b16 a[126:127], v195 offset:4096
    ds_write_b64 v208, v[100:101] offset:4096
    ds_write_b64 v209, v[102:103] offset:4096
    v_mfma_f32_16x16x32_bf16 v[48:51], a[112:115], v[164:167], 0
    v_mfma_f32_16x16x32_bf16 v[230:233], v[242:245], v[96:99], v[230:233]
    v_mfma_f32_16x16x32_bf16 v[230:233], v[242:245], v[100:103], v[230:233]
    v_exp_f32 v157, v157
    v_mul_f32 v112, v112, v221
    v_mul_f32 v113, v113, v221
    v_mul_f32 v114, v114, v221
    v_mul_f32 v115, v115, v221
    v_mul_f32 v116, v116, v221
    v_mul_f32 v117, v117, v221
    v_mul_f32 v118, v118, v221
    v_mul_f32 v119, v119, v221
    v_mfma_f32_16x16x32_bf16 v[20:23], a[116:119], v[160:163], 0
    buffer_load_dwordx4 v201, s[20:23], s29 offen offset:1024 nt lds
    v_cvt_pk_bf16_f32 v174, v156, v157
    v_mul_f32 v120, v120, v221
    v_mul_f32 v121, v121, v221
    v_mul_f32 v122, v122, v221
    v_mul_f32 v123, v123, v221
    v_mfma_f32_16x16x32_bf16 v[52:55], a[116:119], v[164:167], 0
    v_mul_f32 v124, v124, v221
    v_mul_f32 v125, v125, v221
    v_mul_f32 v126, v126, v221
    v_mul_f32 v127, v127, v221
    v_cvt_pk_bf16_f32 v112, v112, v113
    s_waitcnt lgkmcnt(2)
    v_mfma_f32_16x16x32_bf16 v[24:27], a[120:123], v[160:163], 0
    v_exp_f32 v158, v158
    v_cvt_pk_bf16_f32 v113, v114, v115
    v_cvt_pk_bf16_f32 v114, v116, v117
    v_cvt_pk_bf16_f32 v115, v118, v119
    v_cvt_pk_bf16_f32 v116, v120, v121
    v_mfma_f32_16x16x32_bf16 v[56:59], a[120:123], v[164:167], 0
    v_exp_f32 v159, v159
    v_cvt_pk_bf16_f32 v117, v122, v123
    v_cvt_pk_bf16_f32 v118, v124, v125
    v_cvt_pk_bf16_f32 v119, v126, v127
    v_mfma_f32_16x16x32_bf16 v[28:31], a[124:127], v[160:163], 0
    ds_write_b64 v210, v[112:113] offset:4096
    ds_write_b64 v211, v[114:115] offset:4096
    v_cvt_pk_bf16_f32 v175, v158, v159
    v_mfma_f32_16x16x32_bf16 v[60:63], a[124:127], v[164:167], 0
    ds_write_b64 v212, v[116:117] offset:4096
    ds_write_b64 v213, v[118:119] offset:4096
    v_mfma_f32_16x16x32_bf16 v[230:233], v[242:245], v[112:115], v[230:233]
    v_mfma_f32_16x16x32_bf16 v[230:233], v[242:245], v[116:119], v[230:233]
    v_mfma_f32_16x16x32_bf16 v[144:147], a[64:67], a[160:163], 0
    ds_read_b128 a[224:227], v205 offset:0
    v_exp_f32 v128, v128
    v_mfma_f32_16x16x32_bf16 v[144:147], a[68:71], a[164:167], v[144:147]
    v_exp_f32 v129, v129
    v_mfma_f32_16x16x32_bf16 v[144:147], a[72:75], a[168:171], v[144:147]
    ds_read_b128 a[228:231], v205 offset:1024
    v_exp_f32 v130, v130
    v_mfma_f32_16x16x32_bf16 v[144:147], a[76:79], a[172:175], v[144:147]
    ds_read_b128 a[232:235], v205 offset:2048
    v_exp_f32 v131, v131
    v_mfma_f32_16x16x32_bf16 v[152:155], a[64:67], a[176:179], 0
    v_exp_f32 v132, v132
    v_cvt_pk_bf16_f32 v160, v128, v129
    v_mfma_f32_16x16x32_bf16 v[152:155], a[68:71], a[180:183], v[152:155]
    ds_read_b128 a[236:239], v205 offset:3072
    v_exp_f32 v133, v133
    v_mfma_f32_16x16x32_bf16 v[152:155], a[72:75], a[184:187], v[152:155]
    ds_read_b128 a[64:67], v180 offset:16384
    ds_read_b128 a[240:243], v205 offset:4096
    v_cvt_pk_bf16_f32 v161, v130, v131
    v_mfma_f32_16x16x32_bf16 v[152:155], a[76:79], a[188:191], v[152:155]
    v_exp_f32 v134, v134
    v_mfma_f32_16x16x32_bf16 v[148:151], a[80:83], a[160:163], 0
    ds_read_b128 a[68:71], v181 offset:16384
    ds_read_b128 a[244:247], v205 offset:5120
    v_cvt_pk_bf16_f32 v162, v132, v133
    v_mfma_f32_16x16x32_bf16 v[148:151], a[84:87], a[164:167], v[148:151]
    buffer_load_dwordx4 v200, s[20:23], s29 offen offset:2048 nt lds
    ds_read_b128 a[248:251], v205 offset:6144
    v_mfma_f32_16x16x32_bf16 v[148:151], a[88:91], a[168:171], v[148:151]
    ds_read_b128 a[72:75], v182 offset:16384
    v_mfma_f32_16x16x32_bf16 v[148:151], a[92:95], a[172:175], v[148:151]
    ds_read_b128 a[252:255], v205 offset:7168
    v_exp_f32 v135, v135
    v_mfma_f32_16x16x32_bf16 v[156:159], a[80:83], a[176:179], 0
    ds_read_b128 a[76:79], v183 offset:16384
    v_cvt_pk_bf16_f32 v163, v134, v135
    v_cmp_class_f32 vcc, v230, v250
    v_mfma_f32_16x16x32_bf16 v[156:159], a[84:87], a[180:183], v[156:159]
    v_exp_f32 v136, v136
    v_mfma_f32_16x16x32_bf16 v[156:159], a[88:91], a[184:187], v[156:159]
    ds_read_b128 a[80:83], v180 offset:20480
    s_cmp_lg_u64 vcc, 0
    s_cselect_b32 s42, 1, 0
    s_or_b32 s50, s50, s42
    v_mfma_f32_16x16x32_bf16 v[156:159], a[92:95], a[188:191], v[156:159]
    v_exp_f32 v137, v137
    v_mfma_f32_16x16x32_bf16 v[222:225], v[242:245], v[168:171], 0
    ds_read_b128 a[84:87], v181 offset:20480
    v_cvt_pk_bf16_f32 v164, v136, v137
    v_mfma_f32_16x16x32_bf16 v[246:249], v[242:245], v[172:175], 0
    v_exp_f32 v138, v138
    v_mfma_f32_16x16x32_bf16 v[64:67], a[96:99], v[168:171], 0
    ds_read_b128 a[88:91], v182 offset:20480
    v_mfma_f32_16x16x32_bf16 v[96:99], a[96:99], v[172:175], 0
    v_exp_f32 v139, v139
    v_mfma_f32_16x16x32_bf16 v[68:71], a[100:103], v[168:171], 0
    ds_read_b128 a[92:95], v183 offset:20480
    v_cvt_pk_bf16_f32 v165, v138, v139
    v_mfma_f32_16x16x32_bf16 v[100:103], a[100:103], v[172:175], 0
    v_exp_f32 v140, v140
    v_mfma_f32_16x16x32_bf16 v[72:75], a[104:107], v[168:171], 0
    v_exp_f32 v141, v141
    v_mfma_f32_16x16x32_bf16 v[104:107], a[104:107], v[172:175], 0
    v_exp_f32 v142, v142
    v_mfma_f32_16x16x32_bf16 v[76:79], a[108:111], v[168:171], 0
    v_exp_f32 v143, v143
    v_mfma_f32_16x16x32_bf16 v[108:111], a[108:111], v[172:175], 0
    v_cvt_pk_bf16_f32 v166, v140, v141
    v_cvt_pk_bf16_f32 v167, v142, v143
    v_mfma_f32_16x16x32_bf16 v[80:83], a[112:115], v[168:171], 0
    v_mfma_f32_16x16x32_bf16 v[112:115], a[112:115], v[172:175], 0
    buffer_load_dwordx4 v201, s[20:23], s29 offen offset:3072 nt lds
    s_add_u32 s29, s29, 16384
    v_mfma_f32_16x16x32_bf16 v[84:87], a[116:119], v[168:171], 0
    v_mfma_f32_16x16x32_bf16 v[116:119], a[116:119], v[172:175], 0
    v_mfma_f32_16x16x32_bf16 v[88:91], a[120:123], v[168:171], 0
    v_mfma_f32_16x16x32_bf16 v[120:123], a[120:123], v[172:175], 0
    v_mfma_f32_16x16x32_bf16 v[92:95], a[124:127], v[168:171], 0
    v_mfma_f32_16x16x32_bf16 v[124:127], a[124:127], v[172:175], 0
    s_waitcnt lgkmcnt(0)
    v_mfma_f32_16x16x32_bf16 v[128:131], a[64:67], a[128:131], 0
    ds_read_b64_tr_b16 a[96:97], v188 offset:8192
    v_exp_f32 v144, v144
    v_mfma_f32_16x16x32_bf16 v[128:131], a[68:71], a[132:135], v[128:131]
    v_exp_f32 v145, v145
    v_mfma_f32_16x16x32_bf16 v[128:131], a[72:75], a[136:139], v[128:131]
    ds_read_b64_tr_b16 a[98:99], v188 offset:12288
    v_exp_f32 v146, v146
    v_mfma_f32_16x16x32_bf16 v[128:131], a[76:79], a[140:143], v[128:131]
    v_exp_f32 v147, v147
    v_mfma_f32_16x16x32_bf16 v[136:139], a[64:67], a[144:147], 0
    ds_read_b64_tr_b16 a[100:101], v189 offset:8192
    v_exp_f32 v148, v148
    v_mfma_f32_16x16x32_bf16 v[136:139], a[68:71], a[148:151], v[136:139]
    v_exp_f32 v149, v149
    v_cvt_pk_bf16_f32 v168, v144, v145
    v_mfma_f32_16x16x32_bf16 v[136:139], a[72:75], a[152:155], v[136:139]
    ds_read_b64_tr_b16 a[102:103], v189 offset:12288
    v_exp_f32 v150, v150
    v_mfma_f32_16x16x32_bf16 v[136:139], a[76:79], a[156:159], v[136:139]
    v_exp_f32 v151, v151
    v_cvt_pk_bf16_f32 v169, v146, v147
    v_mfma_f32_16x16x32_bf16 v[132:135], a[80:83], a[128:131], 0
    ds_read_b64_tr_b16 a[104:105], v190 offset:8192
    v_cvt_pk_bf16_f32 v170, v148, v149
    v_mfma_f32_16x16x32_bf16 v[132:135], a[84:87], a[132:135], v[132:135]
    s_add_u32 m0, s30, 0
    s_nop 0
    buffer_load_dwordx4 v196, s[16:19], s28 offen offset:0 nt lds
    v_mfma_f32_16x16x32_bf16 v[132:135], a[88:91], a[136:139], v[132:135]
    ds_read_b64_tr_b16 a[106:107], v190 offset:12288
    v_cvt_pk_bf16_f32 v171, v150, v151
    v_mfma_f32_16x16x32_bf16 v[132:135], a[92:95], a[140:143], v[132:135]
    v_exp_f32 v152, v152
    v_mfma_f32_16x16x32_bf16 v[140:143], a[80:83], a[144:147], 0
    ds_read_b64_tr_b16 a[108:109], v191 offset:8192
    v_mfma_f32_16x16x32_bf16 v[140:143], a[84:87], a[148:151], v[140:143]
    v_exp_f32 v153, v153
    v_mfma_f32_16x16x32_bf16 v[140:143], a[88:91], a[152:155], v[140:143]
    ds_read_b64_tr_b16 a[110:111], v191 offset:12288
    v_cvt_pk_bf16_f32 v172, v152, v153
    v_mfma_f32_16x16x32_bf16 v[140:143], a[92:95], a[156:159], v[140:143]
    v_exp_f32 v154, v154
    v_mfma_f32_16x16x32_bf16 v[176:179], v[242:245], v[160:163], v[176:179]
    ds_read_b64_tr_b16 a[112:113], v192 offset:8192
    v_mfma_f32_16x16x32_bf16 v[184:187], v[242:245], v[164:167], v[184:187]
    ds_read_b64_tr_b16 a[114:115], v192 offset:12288
    s_waitcnt lgkmcnt(6)
    v_mfma_f32_16x16x32_bf16 v[0:3], a[96:99], v[160:163], v[0:3]
    v_exp_f32 v155, v155
    v_mfma_f32_16x16x32_bf16 v[32:35], a[96:99], v[164:167], v[32:35]
    ds_read_b64_tr_b16 a[116:117], v193 offset:8192
    v_cvt_pk_bf16_f32 v173, v154, v155
    v_mfma_f32_16x16x32_bf16 v[4:7], a[100:103], v[160:163], v[4:7]
    ds_read_b64_tr_b16 a[118:119], v193 offset:12288
    v_mfma_f32_16x16x32_bf16 v[36:39], a[100:103], v[164:167], v[36:39]
    s_waitcnt lgkmcnt(4)
    v_mfma_f32_16x16x32_bf16 v[8:11], a[104:107], v[160:163], v[8:11]
    ds_read_b64_tr_b16 a[120:121], v194 offset:8192
    v_mfma_f32_16x16x32_bf16 v[40:43], a[104:107], v[164:167], v[40:43]
    ds_read_b64_tr_b16 a[122:123], v194 offset:12288
    v_mfma_f32_16x16x32_bf16 v[12:15], a[108:111], v[160:163], v[12:15]
    v_exp_f32 v156, v156
    v_mfma_f32_16x16x32_bf16 v[44:47], a[108:111], v[164:167], v[44:47]
    ds_read_b64_tr_b16 a[124:125], v195 offset:8192
    s_waitcnt lgkmcnt(3)
    v_mfma_f32_16x16x32_bf16 v[16:19], a[112:115], v[160:163], v[16:19]
    ds_read_b64_tr_b16 a[126:127], v195 offset:12288
    v_mfma_f32_16x16x32_bf16 v[48:51], a[112:115], v[164:167], v[48:51]
    v_exp_f32 v157, v157
    v_mfma_f32_16x16x32_bf16 v[20:23], a[116:119], v[160:163], v[20:23]
    buffer_load_dwordx4 v197, s[16:19], s28 offen offset:1024 nt lds
    v_cvt_pk_bf16_f32 v174, v156, v157
    v_mfma_f32_16x16x32_bf16 v[52:55], a[116:119], v[164:167], v[52:55]
    s_waitcnt lgkmcnt(0)
    v_mfma_f32_16x16x32_bf16 v[24:27], a[120:123], v[160:163], v[24:27]
    v_exp_f32 v158, v158
    v_mfma_f32_16x16x32_bf16 v[56:59], a[120:123], v[164:167], v[56:59]
    v_exp_f32 v159, v159
    v_mfma_f32_16x16x32_bf16 v[28:31], a[124:127], v[160:163], v[28:31]
    v_cvt_pk_bf16_f32 v175, v158, v159
    v_mfma_f32_16x16x32_bf16 v[60:63], a[124:127], v[164:167], v[60:63]
    v_mfma_f32_16x16x32_bf16 v[144:147], a[64:67], a[160:163], 0
    v_exp_f32 v128, v128
    v_mfma_f32_16x16x32_bf16 v[144:147], a[68:71], a[164:167], v[144:147]
    v_exp_f32 v129, v129
    v_mfma_f32_16x16x32_bf16 v[144:147], a[72:75], a[168:171], v[144:147]
    v_exp_f32 v130, v130
    v_mfma_f32_16x16x32_bf16 v[144:147], a[76:79], a[172:175], v[144:147]
    v_exp_f32 v131, v131
    v_mfma_f32_16x16x32_bf16 v[152:155], a[64:67], a[176:179], 0
    v_exp_f32 v132, v132
    v_cvt_pk_bf16_f32 v160, v128, v129
    v_mfma_f32_16x16x32_bf16 v[152:155], a[68:71], a[180:183], v[152:155]
    v_exp_f32 v133, v133
    v_mfma_f32_16x16x32_bf16 v[152:155], a[72:75], a[184:187], v[152:155]
    ds_read_b128 a[64:67], v180 offset:24576
    v_cvt_pk_bf16_f32 v161, v130, v131
    v_mfma_f32_16x16x32_bf16 v[152:155], a[76:79], a[188:191], v[152:155]
    v_exp_f32 v134, v134
    v_mfma_f32_16x16x32_bf16 v[148:151], a[80:83], a[160:163], 0
    ds_read_b128 a[68:71], v181 offset:24576
    v_cvt_pk_bf16_f32 v162, v132, v133
    v_mfma_f32_16x16x32_bf16 v[148:151], a[84:87], a[164:167], v[148:151]
    buffer_load_dwordx4 v198, s[16:19], s28 offen offset:2048 nt lds
    v_mfma_f32_16x16x32_bf16 v[148:151], a[88:91], a[168:171], v[148:151]
    ds_read_b128 a[72:75], v182 offset:24576
    v_mfma_f32_16x16x32_bf16 v[148:151], a[92:95], a[172:175], v[148:151]
    v_exp_f32 v135, v135
    v_mfma_f32_16x16x32_bf16 v[156:159], a[80:83], a[176:179], 0
    ds_read_b128 a[76:79], v183 offset:24576
    v_cvt_pk_bf16_f32 v163, v134, v135
    v_mfma_f32_16x16x32_bf16 v[156:159], a[84:87], a[180:183], v[156:159]
    v_exp_f32 v136, v136
    v_mfma_f32_16x16x32_bf16 v[156:159], a[88:91], a[184:187], v[156:159]
    ds_read_b128 a[80:83], v180 offset:28672
    v_mfma_f32_16x16x32_bf16 v[156:159], a[92:95], a[188:191], v[156:159]
    v_exp_f32 v137, v137
    v_mfma_f32_16x16x32_bf16 v[222:225], v[242:245], v[168:171], v[222:225]
    ds_read_b128 a[84:87], v181 offset:28672
    v_cvt_pk_bf16_f32 v164, v136, v137
    v_mfma_f32_16x16x32_bf16 v[246:249], v[242:245], v[172:175], v[246:249]
    v_exp_f32 v138, v138
    v_mfma_f32_16x16x32_bf16 v[64:67], a[96:99], v[168:171], v[64:67]
    ds_read_b128 a[88:91], v182 offset:28672
    v_mfma_f32_16x16x32_bf16 v[96:99], a[96:99], v[172:175], v[96:99]
    v_exp_f32 v139, v139
    v_mfma_f32_16x16x32_bf16 v[68:71], a[100:103], v[168:171], v[68:71]
    ds_read_b128 a[92:95], v183 offset:28672
    v_cvt_pk_bf16_f32 v165, v138, v139
    v_mfma_f32_16x16x32_bf16 v[100:103], a[100:103], v[172:175], v[100:103]
    v_exp_f32 v140, v140
    v_mfma_f32_16x16x32_bf16 v[72:75], a[104:107], v[168:171], v[72:75]
    v_exp_f32 v141, v141
    v_mfma_f32_16x16x32_bf16 v[104:107], a[104:107], v[172:175], v[104:107]
    v_exp_f32 v142, v142
    v_mfma_f32_16x16x32_bf16 v[76:79], a[108:111], v[168:171], v[76:79]
    v_exp_f32 v143, v143
    v_mfma_f32_16x16x32_bf16 v[108:111], a[108:111], v[172:175], v[108:111]
    v_cvt_pk_bf16_f32 v166, v140, v141
    v_cvt_pk_bf16_f32 v167, v142, v143
    v_mfma_f32_16x16x32_bf16 v[80:83], a[112:115], v[168:171], v[80:83]
    v_mfma_f32_16x16x32_bf16 v[112:115], a[112:115], v[172:175], v[112:115]
    buffer_load_dwordx4 v199, s[16:19], s28 offen offset:3072 nt lds
    s_add_u32 s28, s28, 16384
    v_mfma_f32_16x16x32_bf16 v[84:87], a[116:119], v[168:171], v[84:87]
    v_mfma_f32_16x16x32_bf16 v[116:119], a[116:119], v[172:175], v[116:119]
    v_mfma_f32_16x16x32_bf16 v[88:91], a[120:123], v[168:171], v[88:91]
    v_mfma_f32_16x16x32_bf16 v[120:123], a[120:123], v[172:175], v[120:123]
    v_mfma_f32_16x16x32_bf16 v[92:95], a[124:127], v[168:171], v[92:95]
    v_mfma_f32_16x16x32_bf16 v[124:127], a[124:127], v[172:175], v[124:127]
    s_waitcnt lgkmcnt(0)
    v_mfma_f32_16x16x32_bf16 v[128:131], a[64:67], a[128:131], 0
    s_waitcnt vmcnt(16)
    s_barrier
    ds_read_b64_tr_b16 a[96:97], v188 offset:16384
    v_mfma_f32_16x16x32_bf16 v[128:131], a[68:71], a[132:135], v[128:131]
    v_exp_f32 v144, v144
    v_mfma_f32_16x16x32_bf16 v[128:131], a[72:75], a[136:139], v[128:131]
    v_exp_f32 v145, v145
    ds_read_b64_tr_b16 a[98:99], v188 offset:20480
    v_mfma_f32_16x16x32_bf16 v[128:131], a[76:79], a[140:143], v[128:131]
    v_exp_f32 v146, v146
    v_mfma_f32_16x16x32_bf16 v[136:139], a[64:67], a[144:147], 0
    v_exp_f32 v147, v147
    ds_read_b64_tr_b16 a[100:101], v189 offset:16384
    v_mfma_f32_16x16x32_bf16 v[136:139], a[68:71], a[148:151], v[136:139]
    v_exp_f32 v148, v148
    v_cvt_pk_bf16_f32 v168, v144, v145
    v_mfma_f32_16x16x32_bf16 v[136:139], a[72:75], a[152:155], v[136:139]
    v_exp_f32 v149, v149
    ds_read_b64_tr_b16 a[102:103], v189 offset:20480
    v_mfma_f32_16x16x32_bf16 v[136:139], a[76:79], a[156:159], v[136:139]
    v_exp_f32 v150, v150
    v_cvt_pk_bf16_f32 v169, v146, v147
    v_mfma_f32_16x16x32_bf16 v[132:135], a[80:83], a[128:131], 0
    v_exp_f32 v151, v151
    ds_read_b64_tr_b16 a[104:105], v190 offset:16384
    v_mfma_f32_16x16x32_bf16 v[132:135], a[84:87], a[132:135], v[132:135]
    s_add_u32 m0, s30, 65536
    s_nop 0
    buffer_load_dwordx4 v200, s[20:23], s29 offen offset:0 nt lds
    v_mfma_f32_16x16x32_bf16 v[132:135], a[88:91], a[136:139], v[132:135]
    v_exp_f32 v152, v152
    ds_read_b64_tr_b16 a[106:107], v190 offset:20480
    v_mfma_f32_16x16x32_bf16 v[132:135], a[92:95], a[140:143], v[132:135]
    v_exp_f32 v153, v153
    v_cvt_pk_bf16_f32 v170, v148, v149
    v_mfma_f32_16x16x32_bf16 v[140:143], a[80:83], a[144:147], 0
    v_exp_f32 v154, v154
    ds_read_b64_tr_b16 a[108:109], v191 offset:16384
    v_mfma_f32_16x16x32_bf16 v[140:143], a[84:87], a[148:151], v[140:143]
    v_exp_f32 v155, v155
    v_cvt_pk_bf16_f32 v171, v150, v151
    v_mfma_f32_16x16x32_bf16 v[140:143], a[88:91], a[152:155], v[140:143]
    v_cvt_pk_bf16_f32 v172, v152, v153
    ds_read_b64_tr_b16 a[110:111], v191 offset:20480
    v_mfma_f32_16x16x32_bf16 v[140:143], a[92:95], a[156:159], v[140:143]
    v_exp_f32 v156, v156
    v_mfma_f32_16x16x32_bf16 v[176:179], v[242:245], v[160:163], v[176:179]
    v_cvt_pk_bf16_f32 v173, v154, v155
    ds_read_b64_tr_b16 a[112:113], v192 offset:16384
    v_mfma_f32_16x16x32_bf16 v[184:187], v[242:245], v[164:167], v[184:187]
    ds_read_b64_tr_b16 a[114:115], v192 offset:20480
    s_waitcnt lgkmcnt(8)
    v_mfma_f32_16x16x32_bf16 v[0:3], a[96:99], v[160:163], v[0:3]
    v_exp_f32 v157, v157
    v_mfma_f32_16x16x32_bf16 v[32:35], a[96:99], v[164:167], v[32:35]
    ds_read_b64_tr_b16 a[116:117], v193 offset:16384
    s_waitcnt lgkmcnt(7)
    v_mfma_f32_16x16x32_bf16 v[4:7], a[100:103], v[160:163], v[4:7]
    v_cvt_pk_bf16_f32 v174, v156, v157
    ds_read_b64_tr_b16 a[118:119], v193 offset:20480
    v_mfma_f32_16x16x32_bf16 v[36:39], a[100:103], v[164:167], v[36:39]
    s_waitcnt lgkmcnt(6)
    v_mfma_f32_16x16x32_bf16 v[8:11], a[104:107], v[160:163], v[8:11]
    ds_read_b64_tr_b16 a[120:121], v194 offset:16384
    v_mfma_f32_16x16x32_bf16 v[40:43], a[104:107], v[164:167], v[40:43]
    ds_read_b64_tr_b16 a[122:123], v194 offset:20480
    s_waitcnt lgkmcnt(6)
    v_mfma_f32_16x16x32_bf16 v[12:15], a[108:111], v[160:163], v[12:15]
    v_exp_f32 v158, v158
    v_mfma_f32_16x16x32_bf16 v[44:47], a[108:111], v[164:167], v[44:47]
    ds_read_b64_tr_b16 a[124:125], v195 offset:16384
    s_waitcnt lgkmcnt(5)
    v_mfma_f32_16x16x32_bf16 v[16:19], a[112:115], v[160:163], v[16:19]
    ds_read_b64_tr_b16 a[126:127], v195 offset:20480
    v_mfma_f32_16x16x32_bf16 v[48:51], a[112:115], v[164:167], v[48:51]
    s_waitcnt lgkmcnt(4)
    v_mfma_f32_16x16x32_bf16 v[20:23], a[116:119], v[160:163], v[20:23]
    buffer_load_dwordx4 v201, s[20:23], s29 offen offset:1024 nt lds
    v_mfma_f32_16x16x32_bf16 v[52:55], a[116:119], v[164:167], v[52:55]
    s_waitcnt lgkmcnt(2)
    v_mfma_f32_16x16x32_bf16 v[24:27], a[120:123], v[160:163], v[24:27]
    v_exp_f32 v159, v159
    v_mfma_f32_16x16x32_bf16 v[56:59], a[120:123], v[164:167], v[56:59]
    v_cvt_pk_bf16_f32 v175, v158, v159
    s_waitcnt lgkmcnt(0)
    v_mfma_f32_16x16x32_bf16 v[28:31], a[124:127], v[160:163], v[28:31]
    v_mfma_f32_16x16x32_bf16 v[60:63], a[124:127], v[164:167], v[60:63]
    v_mfma_f32_16x16x32_bf16 v[144:147], a[64:67], a[160:163], 0
    v_exp_f32 v128, v128
    v_mfma_f32_16x16x32_bf16 v[144:147], a[68:71], a[164:167], v[144:147]
    v_exp_f32 v129, v129
    v_mfma_f32_16x16x32_bf16 v[144:147], a[72:75], a[168:171], v[144:147]
    v_exp_f32 v130, v130
    v_mfma_f32_16x16x32_bf16 v[144:147], a[76:79], a[172:175], v[144:147]
    v_exp_f32 v131, v131
    v_mfma_f32_16x16x32_bf16 v[152:155], a[64:67], a[176:179], 0
    v_exp_f32 v132, v132
    v_cvt_pk_bf16_f32 v160, v128, v129
    v_mfma_f32_16x16x32_bf16 v[152:155], a[68:71], a[180:183], v[152:155]
    v_exp_f32 v133, v133
    v_mfma_f32_16x16x32_bf16 v[152:155], a[72:75], a[184:187], v[152:155]
    v_cvt_pk_bf16_f32 v161, v130, v131
    ds_read_b128 a[64:67], v180 offset:32768
    v_mfma_f32_16x16x32_bf16 v[152:155], a[76:79], a[188:191], v[152:155]
    v_exp_f32 v134, v134
    v_mfma_f32_16x16x32_bf16 v[148:151], a[80:83], a[160:163], 0
    v_cvt_pk_bf16_f32 v162, v132, v133
    ds_read_b128 a[68:71], v181 offset:32768
    v_mfma_f32_16x16x32_bf16 v[148:151], a[84:87], a[164:167], v[148:151]
    buffer_load_dwordx4 v200, s[20:23], s29 offen offset:2048 nt lds
    v_mfma_f32_16x16x32_bf16 v[148:151], a[88:91], a[168:171], v[148:151]
    ds_read_b128 a[72:75], v182 offset:32768
    v_mfma_f32_16x16x32_bf16 v[148:151], a[92:95], a[172:175], v[148:151]
    v_exp_f32 v135, v135
    v_mfma_f32_16x16x32_bf16 v[156:159], a[80:83], a[176:179], 0
    v_cvt_pk_bf16_f32 v163, v134, v135
    ds_read_b128 a[76:79], v183 offset:32768
    v_mfma_f32_16x16x32_bf16 v[156:159], a[84:87], a[180:183], v[156:159]
    v_exp_f32 v136, v136
    v_mfma_f32_16x16x32_bf16 v[156:159], a[88:91], a[184:187], v[156:159]
    ds_read_b128 a[80:83], v180 offset:36864
    v_mfma_f32_16x16x32_bf16 v[156:159], a[92:95], a[188:191], v[156:159]
    v_exp_f32 v137, v137
    v_mfma_f32_16x16x32_bf16 v[222:225], v[242:245], v[168:171], v[222:225]
    v_cvt_pk_bf16_f32 v164, v136, v137
    ds_read_b128 a[84:87], v181 offset:36864
    v_mfma_f32_16x16x32_bf16 v[246:249], v[242:245], v[172:175], v[246:249]
    v_exp_f32 v138, v138
    v_mfma_f32_16x16x32_bf16 v[64:67], a[96:99], v[168:171], v[64:67]
    ds_read_b128 a[88:91], v182 offset:36864
    v_mfma_f32_16x16x32_bf16 v[96:99], a[96:99], v[172:175], v[96:99]
    v_exp_f32 v139, v139
    v_mfma_f32_16x16x32_bf16 v[68:71], a[100:103], v[168:171], v[68:71]
    v_cvt_pk_bf16_f32 v165, v138, v139
    ds_read_b128 a[92:95], v183 offset:36864
    v_mfma_f32_16x16x32_bf16 v[100:103], a[100:103], v[172:175], v[100:103]
    v_exp_f32 v140, v140
    v_mfma_f32_16x16x32_bf16 v[72:75], a[104:107], v[168:171], v[72:75]
    v_exp_f32 v141, v141
    v_mfma_f32_16x16x32_bf16 v[104:107], a[104:107], v[172:175], v[104:107]
    v_exp_f32 v142, v142
    v_mfma_f32_16x16x32_bf16 v[76:79], a[108:111], v[168:171], v[76:79]
    v_exp_f32 v143, v143
    v_mfma_f32_16x16x32_bf16 v[108:111], a[108:111], v[172:175], v[108:111]
    v_cvt_pk_bf16_f32 v166, v140, v141
    v_cvt_pk_bf16_f32 v167, v142, v143
    v_mfma_f32_16x16x32_bf16 v[80:83], a[112:115], v[168:171], v[80:83]
    v_mfma_f32_16x16x32_bf16 v[112:115], a[112:115], v[172:175], v[112:115]
    buffer_load_dwordx4 v201, s[20:23], s29 offen offset:3072 nt lds
    s_add_u32 s29, s29, 16384
    v_mfma_f32_16x16x32_bf16 v[84:87], a[116:119], v[168:171], v[84:87]
    v_mfma_f32_16x16x32_bf16 v[116:119], a[116:119], v[172:175], v[116:119]
    v_mfma_f32_16x16x32_bf16 v[88:91], a[120:123], v[168:171], v[88:91]
    v_mfma_f32_16x16x32_bf16 v[120:123], a[120:123], v[172:175], v[120:123]
    v_mfma_f32_16x16x32_bf16 v[92:95], a[124:127], v[168:171], v[92:95]
    v_mfma_f32_16x16x32_bf16 v[124:127], a[124:127], v[172:175], v[124:127]
    s_waitcnt lgkmcnt(7)
    v_mfma_f32_16x16x32_bf16 v[128:131], a[64:67], a[128:131], 0
    ds_read_b64_tr_b16 a[96:97], v188 offset:24576
    s_waitcnt lgkmcnt(7)
    v_mfma_f32_16x16x32_bf16 v[128:131], a[68:71], a[132:135], v[128:131]
    v_exp_f32 v144, v144
    s_waitcnt lgkmcnt(6)
    v_mfma_f32_16x16x32_bf16 v[128:131], a[72:75], a[136:139], v[128:131]
    ds_read_b64_tr_b16 a[98:99], v188 offset:28672
    s_waitcnt lgkmcnt(6)
    v_mfma_f32_16x16x32_bf16 v[128:131], a[76:79], a[140:143], v[128:131]
    v_exp_f32 v145, v145
    v_mfma_f32_16x16x32_bf16 v[136:139], a[64:67], a[144:147], 0
    v_exp_f32 v146, v146
    ds_read_b64_tr_b16 a[100:101], v189 offset:24576
    v_mfma_f32_16x16x32_bf16 v[136:139], a[68:71], a[148:151], v[136:139]
    v_exp_f32 v147, v147
    v_mfma_f32_16x16x32_bf16 v[136:139], a[72:75], a[152:155], v[136:139]
    v_exp_f32 v148, v148
    ds_read_b64_tr_b16 a[102:103], v189 offset:28672
    v_mfma_f32_16x16x32_bf16 v[136:139], a[76:79], a[156:159], v[136:139]
    v_exp_f32 v149, v149
    s_waitcnt lgkmcnt(7)
    v_mfma_f32_16x16x32_bf16 v[132:135], a[80:83], a[128:131], 0
    v_cvt_pk_bf16_f32 v168, v144, v145
    ds_read_b64_tr_b16 a[104:105], v190 offset:24576
    s_waitcnt lgkmcnt(7)
    v_mfma_f32_16x16x32_bf16 v[132:135], a[84:87], a[132:135], v[132:135]
    s_add_u32 m0, s30, 16384
    s_nop 0
    buffer_load_dwordx4 v196, s[16:19], s28 offen offset:0 nt lds
    s_waitcnt lgkmcnt(6)
    v_mfma_f32_16x16x32_bf16 v[132:135], a[88:91], a[136:139], v[132:135]
    v_cvt_pk_bf16_f32 v169, v146, v147
    ds_read_b64_tr_b16 a[106:107], v190 offset:28672
    s_waitcnt lgkmcnt(6)
    v_mfma_f32_16x16x32_bf16 v[132:135], a[92:95], a[140:143], v[132:135]
    v_exp_f32 v150, v150
    v_cvt_pk_bf16_f32 v170, v148, v149
    v_mfma_f32_16x16x32_bf16 v[140:143], a[80:83], a[144:147], 0
    v_exp_f32 v151, v151
    ds_read_b64_tr_b16 a[108:109], v191 offset:24576
    v_mfma_f32_16x16x32_bf16 v[140:143], a[84:87], a[148:151], v[140:143]
    v_exp_f32 v152, v152
    v_mfma_f32_16x16x32_bf16 v[140:143], a[88:91], a[152:155], v[140:143]
    v_exp_f32 v153, v153
    ds_read_b64_tr_b16 a[110:111], v191 offset:28672
    v_mfma_f32_16x16x32_bf16 v[140:143], a[92:95], a[156:159], v[140:143]
    v_exp_f32 v154, v154
    v_cvt_pk_bf16_f32 v171, v150, v151
    v_mfma_f32_16x16x32_bf16 v[176:179], v[242:245], v[160:163], v[176:179]
    v_exp_f32 v155, v155
    ds_read_b64_tr_b16 a[112:113], v192 offset:24576
    v_mfma_f32_16x16x32_bf16 v[184:187], v[242:245], v[164:167], v[184:187]
    v_cvt_pk_bf16_f32 v172, v152, v153
    ds_read_b64_tr_b16 a[114:115], v192 offset:28672
    s_waitcnt lgkmcnt(8)
    v_mfma_f32_16x16x32_bf16 v[0:3], a[96:99], v[160:163], v[0:3]
    v_exp_f32 v156, v156
    v_mfma_f32_16x16x32_bf16 v[32:35], a[96:99], v[164:167], v[32:35]
    v_cvt_pk_bf16_f32 v173, v154, v155
    ds_read_b64_tr_b16 a[116:117], v193 offset:24576
    s_waitcnt lgkmcnt(7)
    v_mfma_f32_16x16x32_bf16 v[4:7], a[100:103], v[160:163], v[4:7]
    v_exp_f32 v157, v157
    ds_read_b64_tr_b16 a[118:119], v193 offset:28672
    v_mfma_f32_16x16x32_bf16 v[36:39], a[100:103], v[164:167], v[36:39]
    v_cvt_pk_bf16_f32 v174, v156, v157
    s_waitcnt lgkmcnt(6)
    v_mfma_f32_16x16x32_bf16 v[8:11], a[104:107], v[160:163], v[8:11]
    ds_read_b64_tr_b16 a[120:121], v194 offset:24576
    v_mfma_f32_16x16x32_bf16 v[40:43], a[104:107], v[164:167], v[40:43]
    ds_read_b64_tr_b16 a[122:123], v194 offset:28672
    s_waitcnt lgkmcnt(6)
    v_mfma_f32_16x16x32_bf16 v[12:15], a[108:111], v[160:163], v[12:15]
    v_exp_f32 v158, v158
    v_mfma_f32_16x16x32_bf16 v[44:47], a[108:111], v[164:167], v[44:47]
    ds_read_b64_tr_b16 a[124:125], v195 offset:24576
    s_waitcnt lgkmcnt(5)
    v_mfma_f32_16x16x32_bf16 v[16:19], a[112:115], v[160:163], v[16:19]
    ds_read_b64_tr_b16 a[126:127], v195 offset:28672
    v_mfma_f32_16x16x32_bf16 v[48:51], a[112:115], v[164:167], v[48:51]
    s_waitcnt lgkmcnt(4)
    v_mfma_f32_16x16x32_bf16 v[20:23], a[116:119], v[160:163], v[20:23]
    buffer_load_dwordx4 v197, s[16:19], s28 offen offset:1024 nt lds
    v_mfma_f32_16x16x32_bf16 v[52:55], a[116:119], v[164:167], v[52:55]
    s_waitcnt lgkmcnt(2)
    v_mfma_f32_16x16x32_bf16 v[24:27], a[120:123], v[160:163], v[24:27]
    v_exp_f32 v159, v159
    v_mfma_f32_16x16x32_bf16 v[56:59], a[120:123], v[164:167], v[56:59]
    v_cvt_pk_bf16_f32 v175, v158, v159
    s_waitcnt lgkmcnt(0)
    v_mfma_f32_16x16x32_bf16 v[28:31], a[124:127], v[160:163], v[28:31]
    v_mfma_f32_16x16x32_bf16 v[60:63], a[124:127], v[164:167], v[60:63]
    v_mfma_f32_16x16x32_bf16 v[144:147], a[64:67], a[160:163], 0
    v_exp_f32 v128, v128
    v_mfma_f32_16x16x32_bf16 v[144:147], a[68:71], a[164:167], v[144:147]
    v_exp_f32 v129, v129
    v_mfma_f32_16x16x32_bf16 v[144:147], a[72:75], a[168:171], v[144:147]
    v_exp_f32 v130, v130
    v_mfma_f32_16x16x32_bf16 v[144:147], a[76:79], a[172:175], v[144:147]
    v_exp_f32 v131, v131
    v_mfma_f32_16x16x32_bf16 v[152:155], a[64:67], a[176:179], 0
    v_exp_f32 v132, v132
    v_cvt_pk_bf16_f32 v160, v128, v129
    v_mfma_f32_16x16x32_bf16 v[152:155], a[68:71], a[180:183], v[152:155]
    v_exp_f32 v133, v133
    v_mfma_f32_16x16x32_bf16 v[152:155], a[72:75], a[184:187], v[152:155]
    v_cvt_pk_bf16_f32 v161, v130, v131
    ds_read_b128 a[64:67], v180 offset:40960
    v_mfma_f32_16x16x32_bf16 v[152:155], a[76:79], a[188:191], v[152:155]
    v_exp_f32 v134, v134
    v_mfma_f32_16x16x32_bf16 v[148:151], a[80:83], a[160:163], 0
    v_cvt_pk_bf16_f32 v162, v132, v133
    ds_read_b128 a[68:71], v181 offset:40960
    v_mfma_f32_16x16x32_bf16 v[148:151], a[84:87], a[164:167], v[148:151]
    buffer_load_dwordx4 v198, s[16:19], s28 offen offset:2048 nt lds
    v_mfma_f32_16x16x32_bf16 v[148:151], a[88:91], a[168:171], v[148:151]
    ds_read_b128 a[72:75], v182 offset:40960
    v_mfma_f32_16x16x32_bf16 v[148:151], a[92:95], a[172:175], v[148:151]
    v_exp_f32 v135, v135
    v_mfma_f32_16x16x32_bf16 v[156:159], a[80:83], a[176:179], 0
    v_cvt_pk_bf16_f32 v163, v134, v135
    ds_read_b128 a[76:79], v183 offset:40960
    v_mfma_f32_16x16x32_bf16 v[156:159], a[84:87], a[180:183], v[156:159]
    v_exp_f32 v136, v136
    v_mfma_f32_16x16x32_bf16 v[156:159], a[88:91], a[184:187], v[156:159]
    ds_read_b128 a[80:83], v180 offset:45056
    v_mfma_f32_16x16x32_bf16 v[156:159], a[92:95], a[188:191], v[156:159]
    v_exp_f32 v137, v137
    v_mfma_f32_16x16x32_bf16 v[222:225], v[242:245], v[168:171], v[222:225]
    v_cvt_pk_bf16_f32 v164, v136, v137
    ds_read_b128 a[84:87], v181 offset:45056
    v_mfma_f32_16x16x32_bf16 v[246:249], v[242:245], v[172:175], v[246:249]
    v_exp_f32 v138, v138
    v_mfma_f32_16x16x32_bf16 v[64:67], a[96:99], v[168:171], v[64:67]
    ds_read_b128 a[88:91], v182 offset:45056
    v_mfma_f32_16x16x32_bf16 v[96:99], a[96:99], v[172:175], v[96:99]
    v_exp_f32 v139, v139
    v_mfma_f32_16x16x32_bf16 v[68:71], a[100:103], v[168:171], v[68:71]
    v_cvt_pk_bf16_f32 v165, v138, v139
    ds_read_b128 a[92:95], v183 offset:45056
    v_mfma_f32_16x16x32_bf16 v[100:103], a[100:103], v[172:175], v[100:103]
    v_exp_f32 v140, v140
    v_mfma_f32_16x16x32_bf16 v[72:75], a[104:107], v[168:171], v[72:75]
    v_exp_f32 v141, v141
    v_mfma_f32_16x16x32_bf16 v[104:107], a[104:107], v[172:175], v[104:107]
    v_exp_f32 v142, v142
    v_mfma_f32_16x16x32_bf16 v[76:79], a[108:111], v[168:171], v[76:79]
    v_exp_f32 v143, v143
    v_mfma_f32_16x16x32_bf16 v[108:111], a[108:111], v[172:175], v[108:111]
    v_cvt_pk_bf16_f32 v166, v140, v141
    v_cvt_pk_bf16_f32 v167, v142, v143
    v_mfma_f32_16x16x32_bf16 v[80:83], a[112:115], v[168:171], v[80:83]
    v_mfma_f32_16x16x32_bf16 v[112:115], a[112:115], v[172:175], v[112:115]
    buffer_load_dwordx4 v199, s[16:19], s28 offen offset:3072 nt lds
    s_add_u32 s28, s28, 16384
    v_mfma_f32_16x16x32_bf16 v[84:87], a[116:119], v[168:171], v[84:87]
    v_mfma_f32_16x16x32_bf16 v[116:119], a[116:119], v[172:175], v[116:119]
    v_mfma_f32_16x16x32_bf16 v[88:91], a[120:123], v[168:171], v[88:91]
    v_mfma_f32_16x16x32_bf16 v[120:123], a[120:123], v[172:175], v[120:123]
    v_mfma_f32_16x16x32_bf16 v[92:95], a[124:127], v[168:171], v[92:95]
    v_mfma_f32_16x16x32_bf16 v[124:127], a[124:127], v[172:175], v[124:127]
    s_waitcnt lgkmcnt(0)
    v_mfma_f32_16x16x32_bf16 v[128:131], a[64:67], a[128:131], 0
    s_waitcnt vmcnt(16)
    s_barrier
    ds_read_b64_tr_b16 a[96:97], v188 offset:32768
    v_mfma_f32_16x16x32_bf16 v[128:131], a[68:71], a[132:135], v[128:131]
    v_exp_f32 v144, v144
    v_mfma_f32_16x16x32_bf16 v[128:131], a[72:75], a[136:139], v[128:131]
    v_exp_f32 v145, v145
    ds_read_b64_tr_b16 a[98:99], v188 offset:36864
    v_mfma_f32_16x16x32_bf16 v[128:131], a[76:79], a[140:143], v[128:131]
    v_exp_f32 v146, v146
    v_mfma_f32_16x16x32_bf16 v[136:139], a[64:67], a[144:147], 0
    v_exp_f32 v147, v147
    ds_read_b64_tr_b16 a[100:101], v189 offset:32768
    v_mfma_f32_16x16x32_bf16 v[136:139], a[68:71], a[148:151], v[136:139]
    v_exp_f32 v148, v148
    v_cvt_pk_bf16_f32 v168, v144, v145
    v_mfma_f32_16x16x32_bf16 v[136:139], a[72:75], a[152:155], v[136:139]
    v_exp_f32 v149, v149
    ds_read_b64_tr_b16 a[102:103], v189 offset:36864
    v_mfma_f32_16x16x32_bf16 v[136:139], a[76:79], a[156:159], v[136:139]
    v_exp_f32 v150, v150
    v_cvt_pk_bf16_f32 v169, v146, v147
    v_mfma_f32_16x16x32_bf16 v[132:135], a[80:83], a[128:131], 0
    v_exp_f32 v151, v151
    ds_read_b64_tr_b16 a[104:105], v190 offset:32768
    v_mfma_f32_16x16x32_bf16 v[132:135], a[84:87], a[132:135], v[132:135]
    s_add_u32 m0, s30, 81920
    s_nop 0
    buffer_load_dwordx4 v200, s[20:23], s29 offen offset:0 nt lds
    v_mfma_f32_16x16x32_bf16 v[132:135], a[88:91], a[136:139], v[132:135]
    v_exp_f32 v152, v152
    ds_read_b64_tr_b16 a[106:107], v190 offset:36864
    v_mfma_f32_16x16x32_bf16 v[132:135], a[92:95], a[140:143], v[132:135]
    v_exp_f32 v153, v153
    v_cvt_pk_bf16_f32 v170, v148, v149
    v_mfma_f32_16x16x32_bf16 v[140:143], a[80:83], a[144:147], 0
    v_exp_f32 v154, v154
    ds_read_b64_tr_b16 a[108:109], v191 offset:32768
    v_mfma_f32_16x16x32_bf16 v[140:143], a[84:87], a[148:151], v[140:143]
    v_exp_f32 v155, v155
    v_cvt_pk_bf16_f32 v171, v150, v151
    v_mfma_f32_16x16x32_bf16 v[140:143], a[88:91], a[152:155], v[140:143]
    v_cvt_pk_bf16_f32 v172, v152, v153
    ds_read_b64_tr_b16 a[110:111], v191 offset:36864
    v_mfma_f32_16x16x32_bf16 v[140:143], a[92:95], a[156:159], v[140:143]
    v_exp_f32 v156, v156
    v_mfma_f32_16x16x32_bf16 v[176:179], v[242:245], v[160:163], v[176:179]
    v_cvt_pk_bf16_f32 v173, v154, v155
    ds_read_b64_tr_b16 a[112:113], v192 offset:32768
    v_mfma_f32_16x16x32_bf16 v[184:187], v[242:245], v[164:167], v[184:187]
    ds_read_b64_tr_b16 a[114:115], v192 offset:36864
    s_waitcnt lgkmcnt(8)
    v_mfma_f32_16x16x32_bf16 v[0:3], a[96:99], v[160:163], v[0:3]
    v_exp_f32 v157, v157
    v_mfma_f32_16x16x32_bf16 v[32:35], a[96:99], v[164:167], v[32:35]
    ds_read_b64_tr_b16 a[116:117], v193 offset:32768
    s_waitcnt lgkmcnt(7)
    v_mfma_f32_16x16x32_bf16 v[4:7], a[100:103], v[160:163], v[4:7]
    v_cvt_pk_bf16_f32 v174, v156, v157
    ds_read_b64_tr_b16 a[118:119], v193 offset:36864
    v_mfma_f32_16x16x32_bf16 v[36:39], a[100:103], v[164:167], v[36:39]
    s_waitcnt lgkmcnt(6)
    v_mfma_f32_16x16x32_bf16 v[8:11], a[104:107], v[160:163], v[8:11]
    ds_read_b64_tr_b16 a[120:121], v194 offset:32768
    v_mfma_f32_16x16x32_bf16 v[40:43], a[104:107], v[164:167], v[40:43]
    ds_read_b64_tr_b16 a[122:123], v194 offset:36864
    s_waitcnt lgkmcnt(6)
    v_mfma_f32_16x16x32_bf16 v[12:15], a[108:111], v[160:163], v[12:15]
    v_exp_f32 v158, v158
    v_mfma_f32_16x16x32_bf16 v[44:47], a[108:111], v[164:167], v[44:47]
    ds_read_b64_tr_b16 a[124:125], v195 offset:32768
    s_waitcnt lgkmcnt(5)
    v_mfma_f32_16x16x32_bf16 v[16:19], a[112:115], v[160:163], v[16:19]
    ds_read_b64_tr_b16 a[126:127], v195 offset:36864
    v_mfma_f32_16x16x32_bf16 v[48:51], a[112:115], v[164:167], v[48:51]
    s_waitcnt lgkmcnt(4)
    v_mfma_f32_16x16x32_bf16 v[20:23], a[116:119], v[160:163], v[20:23]
    buffer_load_dwordx4 v201, s[20:23], s29 offen offset:1024 nt lds
    v_mfma_f32_16x16x32_bf16 v[52:55], a[116:119], v[164:167], v[52:55]
    s_waitcnt lgkmcnt(2)
    v_mfma_f32_16x16x32_bf16 v[24:27], a[120:123], v[160:163], v[24:27]
    v_exp_f32 v159, v159
    v_mfma_f32_16x16x32_bf16 v[56:59], a[120:123], v[164:167], v[56:59]
    v_cvt_pk_bf16_f32 v175, v158, v159
    s_waitcnt lgkmcnt(0)
    v_mfma_f32_16x16x32_bf16 v[28:31], a[124:127], v[160:163], v[28:31]
    v_mfma_f32_16x16x32_bf16 v[60:63], a[124:127], v[164:167], v[60:63]
    v_mfma_f32_16x16x32_bf16 v[144:147], a[64:67], a[160:163], 0
    v_exp_f32 v128, v128
    v_mfma_f32_16x16x32_bf16 v[144:147], a[68:71], a[164:167], v[144:147]
    v_exp_f32 v129, v129
    v_mfma_f32_16x16x32_bf16 v[144:147], a[72:75], a[168:171], v[144:147]
    v_exp_f32 v130, v130
    v_mfma_f32_16x16x32_bf16 v[144:147], a[76:79], a[172:175], v[144:147]
    v_exp_f32 v131, v131
    v_mfma_f32_16x16x32_bf16 v[152:155], a[64:67], a[176:179], 0
    v_exp_f32 v132, v132
    v_cvt_pk_bf16_f32 v160, v128, v129
    v_mfma_f32_16x16x32_bf16 v[152:155], a[68:71], a[180:183], v[152:155]
    v_exp_f32 v133, v133
    v_mfma_f32_16x16x32_bf16 v[152:155], a[72:75], a[184:187], v[152:155]
    v_cvt_pk_bf16_f32 v161, v130, v131
    ds_read_b128 a[64:67], v180 offset:49152
    v_mfma_f32_16x16x32_bf16 v[152:155], a[76:79], a[188:191], v[152:155]
    v_exp_f32 v134, v134
    v_mfma_f32_16x16x32_bf16 v[148:151], a[80:83], a[160:163], 0
    v_cvt_pk_bf16_f32 v162, v132, v133
    ds_read_b128 a[68:71], v181 offset:49152
    v_mfma_f32_16x16x32_bf16 v[148:151], a[84:87], a[164:167], v[148:151]
    buffer_load_dwordx4 v200, s[20:23], s29 offen offset:2048 nt lds
    v_mfma_f32_16x16x32_bf16 v[148:151], a[88:91], a[168:171], v[148:151]
    ds_read_b128 a[72:75], v182 offset:49152
    v_mfma_f32_16x16x32_bf16 v[148:151], a[92:95], a[172:175], v[148:151]
    v_exp_f32 v135, v135
    v_mfma_f32_16x16x32_bf16 v[156:159], a[80:83], a[176:179], 0
    v_cvt_pk_bf16_f32 v163, v134, v135
    ds_read_b128 a[76:79], v183 offset:49152
    v_mfma_f32_16x16x32_bf16 v[156:159], a[84:87], a[180:183], v[156:159]
    v_exp_f32 v136, v136
    v_mfma_f32_16x16x32_bf16 v[156:159], a[88:91], a[184:187], v[156:159]
    ds_read_b128 a[80:83], v180 offset:53248
    v_mfma_f32_16x16x32_bf16 v[156:159], a[92:95], a[188:191], v[156:159]
    v_exp_f32 v137, v137
    v_mfma_f32_16x16x32_bf16 v[222:225], v[242:245], v[168:171], v[222:225]
    v_cvt_pk_bf16_f32 v164, v136, v137
    ds_read_b128 a[84:87], v181 offset:53248
    v_mfma_f32_16x16x32_bf16 v[246:249], v[242:245], v[172:175], v[246:249]
    v_exp_f32 v138, v138
    v_mfma_f32_16x16x32_bf16 v[64:67], a[96:99], v[168:171], v[64:67]
    ds_read_b128 a[88:91], v182 offset:53248
    v_mfma_f32_16x16x32_bf16 v[96:99], a[96:99], v[172:175], v[96:99]
    v_exp_f32 v139, v139
    v_mfma_f32_16x16x32_bf16 v[68:71], a[100:103], v[168:171], v[68:71]
    v_cvt_pk_bf16_f32 v165, v138, v139
    ds_read_b128 a[92:95], v183 offset:53248
    v_mfma_f32_16x16x32_bf16 v[100:103], a[100:103], v[172:175], v[100:103]
    v_exp_f32 v140, v140
    v_mfma_f32_16x16x32_bf16 v[72:75], a[104:107], v[168:171], v[72:75]
    v_exp_f32 v141, v141
    v_mfma_f32_16x16x32_bf16 v[104:107], a[104:107], v[172:175], v[104:107]
    v_exp_f32 v142, v142
    v_mfma_f32_16x16x32_bf16 v[76:79], a[108:111], v[168:171], v[76:79]
    v_exp_f32 v143, v143
    v_mfma_f32_16x16x32_bf16 v[108:111], a[108:111], v[172:175], v[108:111]
    v_cvt_pk_bf16_f32 v166, v140, v141
    v_cvt_pk_bf16_f32 v167, v142, v143
    v_mfma_f32_16x16x32_bf16 v[80:83], a[112:115], v[168:171], v[80:83]
    v_mfma_f32_16x16x32_bf16 v[112:115], a[112:115], v[172:175], v[112:115]
    buffer_load_dwordx4 v201, s[20:23], s29 offen offset:3072 nt lds
    s_add_u32 s29, s29, 16384
    v_mfma_f32_16x16x32_bf16 v[84:87], a[116:119], v[168:171], v[84:87]
    v_mfma_f32_16x16x32_bf16 v[116:119], a[116:119], v[172:175], v[116:119]
    v_mfma_f32_16x16x32_bf16 v[88:91], a[120:123], v[168:171], v[88:91]
    v_mfma_f32_16x16x32_bf16 v[120:123], a[120:123], v[172:175], v[120:123]
    v_mfma_f32_16x16x32_bf16 v[92:95], a[124:127], v[168:171], v[92:95]
    v_mfma_f32_16x16x32_bf16 v[124:127], a[124:127], v[172:175], v[124:127]
    s_waitcnt lgkmcnt(7)
    v_mfma_f32_16x16x32_bf16 v[128:131], a[64:67], a[128:131], 0
    ds_read_b64_tr_b16 a[96:97], v188 offset:40960
    s_waitcnt lgkmcnt(7)
    v_mfma_f32_16x16x32_bf16 v[128:131], a[68:71], a[132:135], v[128:131]
    v_exp_f32 v144, v144
    s_waitcnt lgkmcnt(6)
    v_mfma_f32_16x16x32_bf16 v[128:131], a[72:75], a[136:139], v[128:131]
    ds_read_b64_tr_b16 a[98:99], v188 offset:45056
    s_waitcnt lgkmcnt(6)
    v_mfma_f32_16x16x32_bf16 v[128:131], a[76:79], a[140:143], v[128:131]
    v_exp_f32 v145, v145
    v_mfma_f32_16x16x32_bf16 v[136:139], a[64:67], a[144:147], 0
    v_exp_f32 v146, v146
    ds_read_b64_tr_b16 a[100:101], v189 offset:40960
    v_mfma_f32_16x16x32_bf16 v[136:139], a[68:71], a[148:151], v[136:139]
    v_exp_f32 v147, v147
    v_mfma_f32_16x16x32_bf16 v[136:139], a[72:75], a[152:155], v[136:139]
    v_exp_f32 v148, v148
    ds_read_b64_tr_b16 a[102:103], v189 offset:45056
    v_mfma_f32_16x16x32_bf16 v[136:139], a[76:79], a[156:159], v[136:139]
    v_exp_f32 v149, v149
    s_waitcnt lgkmcnt(7)
    v_mfma_f32_16x16x32_bf16 v[132:135], a[80:83], a[128:131], 0
    v_cvt_pk_bf16_f32 v168, v144, v145
    ds_read_b64_tr_b16 a[104:105], v190 offset:40960
    s_waitcnt lgkmcnt(7)
    v_mfma_f32_16x16x32_bf16 v[132:135], a[84:87], a[132:135], v[132:135]
    s_add_u32 m0, s30, 32768
    s_nop 0
    buffer_load_dwordx4 v196, s[16:19], s28 offen offset:0 nt lds
    s_waitcnt lgkmcnt(6)
    v_mfma_f32_16x16x32_bf16 v[132:135], a[88:91], a[136:139], v[132:135]
    v_cvt_pk_bf16_f32 v169, v146, v147
    ds_read_b64_tr_b16 a[106:107], v190 offset:45056
    s_waitcnt lgkmcnt(6)
    v_mfma_f32_16x16x32_bf16 v[132:135], a[92:95], a[140:143], v[132:135]
    v_exp_f32 v150, v150
    v_cvt_pk_bf16_f32 v170, v148, v149
    v_mfma_f32_16x16x32_bf16 v[140:143], a[80:83], a[144:147], 0
    v_exp_f32 v151, v151
    ds_read_b64_tr_b16 a[108:109], v191 offset:40960
    v_mfma_f32_16x16x32_bf16 v[140:143], a[84:87], a[148:151], v[140:143]
    v_exp_f32 v152, v152
    v_mfma_f32_16x16x32_bf16 v[140:143], a[88:91], a[152:155], v[140:143]
    v_exp_f32 v153, v153
    ds_read_b64_tr_b16 a[110:111], v191 offset:45056
    v_mfma_f32_16x16x32_bf16 v[140:143], a[92:95], a[156:159], v[140:143]
    v_exp_f32 v154, v154
    v_cvt_pk_bf16_f32 v171, v150, v151
    v_mfma_f32_16x16x32_bf16 v[176:179], v[242:245], v[160:163], v[176:179]
    v_exp_f32 v155, v155
    ds_read_b64_tr_b16 a[112:113], v192 offset:40960
    v_mfma_f32_16x16x32_bf16 v[184:187], v[242:245], v[164:167], v[184:187]
    v_cvt_pk_bf16_f32 v172, v152, v153
    ds_read_b64_tr_b16 a[114:115], v192 offset:45056
    s_waitcnt lgkmcnt(8)
    v_mfma_f32_16x16x32_bf16 v[0:3], a[96:99], v[160:163], v[0:3]
    v_exp_f32 v156, v156
    v_mfma_f32_16x16x32_bf16 v[32:35], a[96:99], v[164:167], v[32:35]
    v_cvt_pk_bf16_f32 v173, v154, v155
    ds_read_b64_tr_b16 a[116:117], v193 offset:40960
    s_waitcnt lgkmcnt(7)
    v_mfma_f32_16x16x32_bf16 v[4:7], a[100:103], v[160:163], v[4:7]
    v_exp_f32 v157, v157
    ds_read_b64_tr_b16 a[118:119], v193 offset:45056
    v_mfma_f32_16x16x32_bf16 v[36:39], a[100:103], v[164:167], v[36:39]
    v_cvt_pk_bf16_f32 v174, v156, v157
    s_waitcnt lgkmcnt(6)
    v_mfma_f32_16x16x32_bf16 v[8:11], a[104:107], v[160:163], v[8:11]
    ds_read_b64_tr_b16 a[120:121], v194 offset:40960
    v_mfma_f32_16x16x32_bf16 v[40:43], a[104:107], v[164:167], v[40:43]
    ds_read_b64_tr_b16 a[122:123], v194 offset:45056
    s_waitcnt lgkmcnt(6)
    v_mfma_f32_16x16x32_bf16 v[12:15], a[108:111], v[160:163], v[12:15]
    v_exp_f32 v158, v158
    v_mfma_f32_16x16x32_bf16 v[44:47], a[108:111], v[164:167], v[44:47]
    ds_read_b64_tr_b16 a[124:125], v195 offset:40960
    s_waitcnt lgkmcnt(5)
    v_mfma_f32_16x16x32_bf16 v[16:19], a[112:115], v[160:163], v[16:19]
    ds_read_b64_tr_b16 a[126:127], v195 offset:45056
    v_mfma_f32_16x16x32_bf16 v[48:51], a[112:115], v[164:167], v[48:51]
    s_waitcnt lgkmcnt(4)
    v_mfma_f32_16x16x32_bf16 v[20:23], a[116:119], v[160:163], v[20:23]
    buffer_load_dwordx4 v197, s[16:19], s28 offen offset:1024 nt lds
    v_mfma_f32_16x16x32_bf16 v[52:55], a[116:119], v[164:167], v[52:55]
    s_waitcnt lgkmcnt(2)
    v_mfma_f32_16x16x32_bf16 v[24:27], a[120:123], v[160:163], v[24:27]
    v_exp_f32 v159, v159
    v_mfma_f32_16x16x32_bf16 v[56:59], a[120:123], v[164:167], v[56:59]
    v_cvt_pk_bf16_f32 v175, v158, v159
    s_waitcnt lgkmcnt(0)
    v_mfma_f32_16x16x32_bf16 v[28:31], a[124:127], v[160:163], v[28:31]
    v_mfma_f32_16x16x32_bf16 v[60:63], a[124:127], v[164:167], v[60:63]
    v_mfma_f32_16x16x32_bf16 v[144:147], a[64:67], a[160:163], 0
    v_exp_f32 v128, v128
    v_mfma_f32_16x16x32_bf16 v[144:147], a[68:71], a[164:167], v[144:147]
    v_exp_f32 v129, v129
    v_mfma_f32_16x16x32_bf16 v[144:147], a[72:75], a[168:171], v[144:147]
    v_exp_f32 v130, v130
    v_mfma_f32_16x16x32_bf16 v[144:147], a[76:79], a[172:175], v[144:147]
    v_exp_f32 v131, v131
    v_mfma_f32_16x16x32_bf16 v[152:155], a[64:67], a[176:179], 0
    v_exp_f32 v132, v132
    v_cvt_pk_bf16_f32 v160, v128, v129
    v_mfma_f32_16x16x32_bf16 v[152:155], a[68:71], a[180:183], v[152:155]
    v_exp_f32 v133, v133
    v_mfma_f32_16x16x32_bf16 v[152:155], a[72:75], a[184:187], v[152:155]
    v_cvt_pk_bf16_f32 v161, v130, v131
    ds_read_b128 a[64:67], v180 offset:57344
    v_mfma_f32_16x16x32_bf16 v[152:155], a[76:79], a[188:191], v[152:155]
    v_exp_f32 v134, v134
    v_mfma_f32_16x16x32_bf16 v[148:151], a[80:83], a[160:163], 0
    v_cvt_pk_bf16_f32 v162, v132, v133
    ds_read_b128 a[68:71], v181 offset:57344
    v_mfma_f32_16x16x32_bf16 v[148:151], a[84:87], a[164:167], v[148:151]
    buffer_load_dwordx4 v198, s[16:19], s28 offen offset:2048 nt lds
    v_mfma_f32_16x16x32_bf16 v[148:151], a[88:91], a[168:171], v[148:151]
    ds_read_b128 a[72:75], v182 offset:57344
    v_mfma_f32_16x16x32_bf16 v[148:151], a[92:95], a[172:175], v[148:151]
    v_exp_f32 v135, v135
    v_mfma_f32_16x16x32_bf16 v[156:159], a[80:83], a[176:179], 0
    v_cvt_pk_bf16_f32 v163, v134, v135
    ds_read_b128 a[76:79], v183 offset:57344
    v_mfma_f32_16x16x32_bf16 v[156:159], a[84:87], a[180:183], v[156:159]
    v_exp_f32 v136, v136
    v_mfma_f32_16x16x32_bf16 v[156:159], a[88:91], a[184:187], v[156:159]
    ds_read_b128 a[80:83], v180 offset:61440
    v_mfma_f32_16x16x32_bf16 v[156:159], a[92:95], a[188:191], v[156:159]
    v_exp_f32 v137, v137
    v_mfma_f32_16x16x32_bf16 v[222:225], v[242:245], v[168:171], v[222:225]
    v_cvt_pk_bf16_f32 v164, v136, v137
    ds_read_b128 a[84:87], v181 offset:61440
    v_mfma_f32_16x16x32_bf16 v[246:249], v[242:245], v[172:175], v[246:249]
    v_exp_f32 v138, v138
    v_mfma_f32_16x16x32_bf16 v[64:67], a[96:99], v[168:171], v[64:67]
    ds_read_b128 a[88:91], v182 offset:61440
    v_mfma_f32_16x16x32_bf16 v[96:99], a[96:99], v[172:175], v[96:99]
    v_exp_f32 v139, v139
    v_mfma_f32_16x16x32_bf16 v[68:71], a[100:103], v[168:171], v[68:71]
    v_cvt_pk_bf16_f32 v165, v138, v139
    ds_read_b128 a[92:95], v183 offset:61440
    v_mfma_f32_16x16x32_bf16 v[100:103], a[100:103], v[172:175], v[100:103]
    v_exp_f32 v140, v140
    v_mfma_f32_16x16x32_bf16 v[72:75], a[104:107], v[168:171], v[72:75]
    v_exp_f32 v141, v141
    v_mfma_f32_16x16x32_bf16 v[104:107], a[104:107], v[172:175], v[104:107]
    v_exp_f32 v142, v142
    v_mfma_f32_16x16x32_bf16 v[76:79], a[108:111], v[168:171], v[76:79]
    v_exp_f32 v143, v143
    v_mfma_f32_16x16x32_bf16 v[108:111], a[108:111], v[172:175], v[108:111]
    v_cvt_pk_bf16_f32 v166, v140, v141
    v_cvt_pk_bf16_f32 v167, v142, v143
    v_mfma_f32_16x16x32_bf16 v[80:83], a[112:115], v[168:171], v[80:83]
    v_mfma_f32_16x16x32_bf16 v[112:115], a[112:115], v[172:175], v[112:115]
    buffer_load_dwordx4 v199, s[16:19], s28 offen offset:3072 nt lds
    s_add_u32 s28, s28, 16384
    v_mfma_f32_16x16x32_bf16 v[84:87], a[116:119], v[168:171], v[84:87]
    v_mfma_f32_16x16x32_bf16 v[116:119], a[116:119], v[172:175], v[116:119]
    v_mfma_f32_16x16x32_bf16 v[88:91], a[120:123], v[168:171], v[88:91]
    v_mfma_f32_16x16x32_bf16 v[120:123], a[120:123], v[172:175], v[120:123]
    v_mfma_f32_16x16x32_bf16 v[92:95], a[124:127], v[168:171], v[92:95]
    v_mfma_f32_16x16x32_bf16 v[124:127], a[124:127], v[172:175], v[124:127]
    s_waitcnt lgkmcnt(0)
    v_mfma_f32_16x16x32_bf16 v[128:131], a[64:67], a[128:131], 0
    s_waitcnt vmcnt(16)
    s_barrier
    ds_read_b64_tr_b16 a[96:97], v188 offset:49152
    v_mfma_f32_16x16x32_bf16 v[128:131], a[68:71], a[132:135], v[128:131]
    v_exp_f32 v144, v144
    v_mfma_f32_16x16x32_bf16 v[128:131], a[72:75], a[136:139], v[128:131]
    v_exp_f32 v145, v145
    ds_read_b64_tr_b16 a[98:99], v188 offset:53248
    v_mfma_f32_16x16x32_bf16 v[128:131], a[76:79], a[140:143], v[128:131]
    v_exp_f32 v146, v146
    v_mfma_f32_16x16x32_bf16 v[136:139], a[64:67], a[144:147], 0
    v_exp_f32 v147, v147
    ds_read_b64_tr_b16 a[100:101], v189 offset:49152
    v_mfma_f32_16x16x32_bf16 v[136:139], a[68:71], a[148:151], v[136:139]
    v_exp_f32 v148, v148
    v_cvt_pk_bf16_f32 v168, v144, v145
    v_mfma_f32_16x16x32_bf16 v[136:139], a[72:75], a[152:155], v[136:139]
    v_exp_f32 v149, v149
    ds_read_b64_tr_b16 a[102:103], v189 offset:53248
    v_mfma_f32_16x16x32_bf16 v[136:139], a[76:79], a[156:159], v[136:139]
    v_exp_f32 v150, v150
    v_cvt_pk_bf16_f32 v169, v146, v147
    v_mfma_f32_16x16x32_bf16 v[132:135], a[80:83], a[128:131], 0
    v_exp_f32 v151, v151
    ds_read_b64_tr_b16 a[104:105], v190 offset:49152
    v_mfma_f32_16x16x32_bf16 v[132:135], a[84:87], a[132:135], v[132:135]
    s_add_u32 m0, s30, 98304
    s_nop 0
    buffer_load_dwordx4 v200, s[20:23], s29 offen offset:0 nt lds
    v_mfma_f32_16x16x32_bf16 v[132:135], a[88:91], a[136:139], v[132:135]
    v_exp_f32 v152, v152
    ds_read_b64_tr_b16 a[106:107], v190 offset:53248
    v_mfma_f32_16x16x32_bf16 v[132:135], a[92:95], a[140:143], v[132:135]
    v_exp_f32 v153, v153
    v_cvt_pk_bf16_f32 v170, v148, v149
    v_mfma_f32_16x16x32_bf16 v[140:143], a[80:83], a[144:147], 0
    v_exp_f32 v154, v154
    ds_read_b64_tr_b16 a[108:109], v191 offset:49152
    v_mfma_f32_16x16x32_bf16 v[140:143], a[84:87], a[148:151], v[140:143]
    v_exp_f32 v155, v155
    v_cvt_pk_bf16_f32 v171, v150, v151
    v_mfma_f32_16x16x32_bf16 v[140:143], a[88:91], a[152:155], v[140:143]
    v_cvt_pk_bf16_f32 v172, v152, v153
    ds_read_b64_tr_b16 a[110:111], v191 offset:53248
    v_mfma_f32_16x16x32_bf16 v[140:143], a[92:95], a[156:159], v[140:143]
    v_exp_f32 v156, v156
    v_mfma_f32_16x16x32_bf16 v[176:179], v[242:245], v[160:163], v[176:179]
    v_cvt_pk_bf16_f32 v173, v154, v155
    ds_read_b64_tr_b16 a[112:113], v192 offset:49152
    v_mfma_f32_16x16x32_bf16 v[184:187], v[242:245], v[164:167], v[184:187]
    ds_read_b64_tr_b16 a[114:115], v192 offset:53248
    s_waitcnt lgkmcnt(8)
    v_mfma_f32_16x16x32_bf16 v[0:3], a[96:99], v[160:163], v[0:3]
    v_exp_f32 v157, v157
    v_mfma_f32_16x16x32_bf16 v[32:35], a[96:99], v[164:167], v[32:35]
    ds_read_b64_tr_b16 a[116:117], v193 offset:49152
    s_waitcnt lgkmcnt(7)
    v_mfma_f32_16x16x32_bf16 v[4:7], a[100:103], v[160:163], v[4:7]
    v_cvt_pk_bf16_f32 v174, v156, v157
    ds_read_b64_tr_b16 a[118:119], v193 offset:53248
    v_mfma_f32_16x16x32_bf16 v[36:39], a[100:103], v[164:167], v[36:39]
    s_waitcnt lgkmcnt(6)
    v_mfma_f32_16x16x32_bf16 v[8:11], a[104:107], v[160:163], v[8:11]
    ds_read_b64_tr_b16 a[120:121], v194 offset:49152
    v_mfma_f32_16x16x32_bf16 v[40:43], a[104:107], v[164:167], v[40:43]
    ds_read_b64_tr_b16 a[122:123], v194 offset:53248
    s_waitcnt lgkmcnt(6)
    v_mfma_f32_16x16x32_bf16 v[12:15], a[108:111], v[160:163], v[12:15]
    v_exp_f32 v158, v158
    v_mfma_f32_16x16x32_bf16 v[44:47], a[108:111], v[164:167], v[44:47]
    ds_read_b64_tr_b16 a[124:125], v195 offset:49152
    s_waitcnt lgkmcnt(5)
    v_mfma_f32_16x16x32_bf16 v[16:19], a[112:115], v[160:163], v[16:19]
    ds_read_b64_tr_b16 a[126:127], v195 offset:53248
    v_mfma_f32_16x16x32_bf16 v[48:51], a[112:115], v[164:167], v[48:51]
    s_waitcnt lgkmcnt(4)
    v_mfma_f32_16x16x32_bf16 v[20:23], a[116:119], v[160:163], v[20:23]
    buffer_load_dwordx4 v201, s[20:23], s29 offen offset:1024 nt lds
    v_mfma_f32_16x16x32_bf16 v[52:55], a[116:119], v[164:167], v[52:55]
    s_waitcnt lgkmcnt(2)
    v_mfma_f32_16x16x32_bf16 v[24:27], a[120:123], v[160:163], v[24:27]
    v_exp_f32 v159, v159
    v_mfma_f32_16x16x32_bf16 v[56:59], a[120:123], v[164:167], v[56:59]
    v_cvt_pk_bf16_f32 v175, v158, v159
    s_waitcnt lgkmcnt(0)
    v_mfma_f32_16x16x32_bf16 v[28:31], a[124:127], v[160:163], v[28:31]
    v_mfma_f32_16x16x32_bf16 v[60:63], a[124:127], v[164:167], v[60:63]
    v_mfma_f32_16x16x32_bf16 v[144:147], a[64:67], a[160:163], 0
    v_exp_f32 v128, v128
    v_mfma_f32_16x16x32_bf16 v[144:147], a[68:71], a[164:167], v[144:147]
    v_exp_f32 v129, v129
    v_mfma_f32_16x16x32_bf16 v[144:147], a[72:75], a[168:171], v[144:147]
    v_exp_f32 v130, v130
    v_mfma_f32_16x16x32_bf16 v[144:147], a[76:79], a[172:175], v[144:147]
    v_exp_f32 v131, v131
    v_mfma_f32_16x16x32_bf16 v[152:155], a[64:67], a[176:179], 0
    v_exp_f32 v132, v132
    v_cvt_pk_bf16_f32 v160, v128, v129
    v_mfma_f32_16x16x32_bf16 v[152:155], a[68:71], a[180:183], v[152:155]
    v_exp_f32 v133, v133
    v_mfma_f32_16x16x32_bf16 v[152:155], a[72:75], a[184:187], v[152:155]
    v_cvt_pk_bf16_f32 v161, v130, v131
    ds_read_b128 a[64:67], v180 offset:0
    v_mfma_f32_16x16x32_bf16 v[152:155], a[76:79], a[188:191], v[152:155]
    v_exp_f32 v134, v134
    v_mfma_f32_16x16x32_bf16 v[148:151], a[80:83], a[160:163], 0
    v_cvt_pk_bf16_f32 v162, v132, v133
    ds_read_b128 a[68:71], v181 offset:0
    v_mfma_f32_16x16x32_bf16 v[148:151], a[84:87], a[164:167], v[148:151]
    buffer_load_dwordx4 v200, s[20:23], s29 offen offset:2048 nt lds
    v_mfma_f32_16x16x32_bf16 v[148:151], a[88:91], a[168:171], v[148:151]
    ds_read_b128 a[72:75], v182 offset:0
    v_mfma_f32_16x16x32_bf16 v[148:151], a[92:95], a[172:175], v[148:151]
    v_exp_f32 v135, v135
    v_mfma_f32_16x16x32_bf16 v[156:159], a[80:83], a[176:179], 0
    v_cvt_pk_bf16_f32 v163, v134, v135
    ds_read_b128 a[76:79], v183 offset:0
    v_mfma_f32_16x16x32_bf16 v[156:159], a[84:87], a[180:183], v[156:159]
    v_exp_f32 v136, v136
    v_mfma_f32_16x16x32_bf16 v[156:159], a[88:91], a[184:187], v[156:159]
    ds_read_b128 a[80:83], v180 offset:4096
    v_mfma_f32_16x16x32_bf16 v[156:159], a[92:95], a[188:191], v[156:159]
    v_exp_f32 v137, v137
    v_mfma_f32_16x16x32_bf16 v[222:225], v[242:245], v[168:171], v[222:225]
    v_cvt_pk_bf16_f32 v164, v136, v137
    ds_read_b128 a[84:87], v181 offset:4096
    v_mfma_f32_16x16x32_bf16 v[246:249], v[242:245], v[172:175], v[246:249]
    v_exp_f32 v138, v138
    v_mfma_f32_16x16x32_bf16 v[64:67], a[96:99], v[168:171], v[64:67]
    ds_read_b128 a[88:91], v182 offset:4096
    v_mfma_f32_16x16x32_bf16 v[96:99], a[96:99], v[172:175], v[96:99]
    v_exp_f32 v139, v139
    v_mfma_f32_16x16x32_bf16 v[68:71], a[100:103], v[168:171], v[68:71]
    v_cvt_pk_bf16_f32 v165, v138, v139
    ds_read_b128 a[92:95], v183 offset:4096
    v_mfma_f32_16x16x32_bf16 v[100:103], a[100:103], v[172:175], v[100:103]
    v_exp_f32 v140, v140
    v_mfma_f32_16x16x32_bf16 v[72:75], a[104:107], v[168:171], v[72:75]
    v_exp_f32 v141, v141
    v_mfma_f32_16x16x32_bf16 v[104:107], a[104:107], v[172:175], v[104:107]
    v_exp_f32 v142, v142
    v_mfma_f32_16x16x32_bf16 v[76:79], a[108:111], v[168:171], v[76:79]
    v_exp_f32 v143, v143
    v_mfma_f32_16x16x32_bf16 v[108:111], a[108:111], v[172:175], v[108:111]
    v_cvt_pk_bf16_f32 v166, v140, v141
    v_cvt_pk_bf16_f32 v167, v142, v143
    v_mfma_f32_16x16x32_bf16 v[80:83], a[112:115], v[168:171], v[80:83]
    v_mfma_f32_16x16x32_bf16 v[112:115], a[112:115], v[172:175], v[112:115]
    buffer_load_dwordx4 v201, s[20:23], s29 offen offset:3072 nt lds
    s_add_u32 s29, s29, 16384
    v_mfma_f32_16x16x32_bf16 v[84:87], a[116:119], v[168:171], v[84:87]
    v_mfma_f32_16x16x32_bf16 v[116:119], a[116:119], v[172:175], v[116:119]
    v_mfma_f32_16x16x32_bf16 v[88:91], a[120:123], v[168:171], v[88:91]
    v_mfma_f32_16x16x32_bf16 v[120:123], a[120:123], v[172:175], v[120:123]
    v_mfma_f32_16x16x32_bf16 v[92:95], a[124:127], v[168:171], v[92:95]
    v_mfma_f32_16x16x32_bf16 v[124:127], a[124:127], v[172:175], v[124:127]
    s_waitcnt lgkmcnt(7)
    v_mfma_f32_16x16x32_bf16 v[128:131], a[64:67], a[128:131], 0
    ds_read_b64_tr_b16 a[96:97], v188 offset:57344
    s_waitcnt lgkmcnt(7)
    v_mfma_f32_16x16x32_bf16 v[128:131], a[68:71], a[132:135], v[128:131]
    v_exp_f32 v144, v144
    s_waitcnt lgkmcnt(6)
    v_mfma_f32_16x16x32_bf16 v[128:131], a[72:75], a[136:139], v[128:131]
    ds_read_b64_tr_b16 a[98:99], v188 offset:61440
    s_waitcnt lgkmcnt(6)
    v_mfma_f32_16x16x32_bf16 v[128:131], a[76:79], a[140:143], v[128:131]
    v_exp_f32 v145, v145
    v_mfma_f32_16x16x32_bf16 v[136:139], a[64:67], a[144:147], 0
    v_exp_f32 v146, v146
    ds_read_b64_tr_b16 a[100:101], v189 offset:57344
    v_mfma_f32_16x16x32_bf16 v[136:139], a[68:71], a[148:151], v[136:139]
    v_exp_f32 v147, v147
    v_mfma_f32_16x16x32_bf16 v[136:139], a[72:75], a[152:155], v[136:139]
    v_exp_f32 v148, v148
    ds_read_b64_tr_b16 a[102:103], v189 offset:61440
    v_mfma_f32_16x16x32_bf16 v[136:139], a[76:79], a[156:159], v[136:139]
    v_exp_f32 v149, v149
    s_waitcnt lgkmcnt(7)
    v_mfma_f32_16x16x32_bf16 v[132:135], a[80:83], a[128:131], 0
    v_cvt_pk_bf16_f32 v168, v144, v145
    ds_read_b64_tr_b16 a[104:105], v190 offset:57344
    s_waitcnt lgkmcnt(7)
    v_mfma_f32_16x16x32_bf16 v[132:135], a[84:87], a[132:135], v[132:135]
    s_add_u32 m0, s30, 49152
    s_nop 0
    buffer_load_dwordx4 v196, s[16:19], s28 offen offset:0 nt lds
    s_waitcnt lgkmcnt(6)
    v_mfma_f32_16x16x32_bf16 v[132:135], a[88:91], a[136:139], v[132:135]
    v_cvt_pk_bf16_f32 v169, v146, v147
    ds_read_b64_tr_b16 a[106:107], v190 offset:61440
    s_waitcnt lgkmcnt(6)
    v_mfma_f32_16x16x32_bf16 v[132:135], a[92:95], a[140:143], v[132:135]
    v_exp_f32 v150, v150
    v_cvt_pk_bf16_f32 v170, v148, v149
    v_mfma_f32_16x16x32_bf16 v[140:143], a[80:83], a[144:147], 0
    v_exp_f32 v151, v151
    ds_read_b64_tr_b16 a[108:109], v191 offset:57344
    v_mfma_f32_16x16x32_bf16 v[140:143], a[84:87], a[148:151], v[140:143]
    v_exp_f32 v152, v152
    v_mfma_f32_16x16x32_bf16 v[140:143], a[88:91], a[152:155], v[140:143]
    v_exp_f32 v153, v153
    ds_read_b64_tr_b16 a[110:111], v191 offset:61440
    v_mfma_f32_16x16x32_bf16 v[140:143], a[92:95], a[156:159], v[140:143]
    v_exp_f32 v154, v154
    v_cvt_pk_bf16_f32 v171, v150, v151
    v_mfma_f32_16x16x32_bf16 v[176:179], v[242:245], v[160:163], v[176:179]
    v_exp_f32 v155, v155
    ds_read_b64_tr_b16 a[112:113], v192 offset:57344
    v_mfma_f32_16x16x32_bf16 v[184:187], v[242:245], v[164:167], v[184:187]
    v_cvt_pk_bf16_f32 v172, v152, v153
    ds_read_b64_tr_b16 a[114:115], v192 offset:61440
    s_waitcnt lgkmcnt(8)
    v_mfma_f32_16x16x32_bf16 v[0:3], a[96:99], v[160:163], v[0:3]
    v_exp_f32 v156, v156
    v_mfma_f32_16x16x32_bf16 v[32:35], a[96:99], v[164:167], v[32:35]
    v_cvt_pk_bf16_f32 v173, v154, v155
    ds_read_b64_tr_b16 a[116:117], v193 offset:57344
    s_waitcnt lgkmcnt(7)
    v_mfma_f32_16x16x32_bf16 v[4:7], a[100:103], v[160:163], v[4:7]
    v_exp_f32 v157, v157
    ds_read_b64_tr_b16 a[118:119], v193 offset:61440
    v_mfma_f32_16x16x32_bf16 v[36:39], a[100:103], v[164:167], v[36:39]
    v_cvt_pk_bf16_f32 v174, v156, v157
    s_waitcnt lgkmcnt(6)
    v_mfma_f32_16x16x32_bf16 v[8:11], a[104:107], v[160:163], v[8:11]
    ds_read_b64_tr_b16 a[120:121], v194 offset:57344
    v_mfma_f32_16x16x32_bf16 v[40:43], a[104:107], v[164:167], v[40:43]
    ds_read_b64_tr_b16 a[122:123], v194 offset:61440
    s_waitcnt lgkmcnt(6)
    v_mfma_f32_16x16x32_bf16 v[12:15], a[108:111], v[160:163], v[12:15]
    v_exp_f32 v158, v158
    v_mfma_f32_16x16x32_bf16 v[44:47], a[108:111], v[164:167], v[44:47]
    ds_read_b64_tr_b16 a[124:125], v195 offset:57344
    s_waitcnt lgkmcnt(5)
    v_mfma_f32_16x16x32_bf16 v[16:19], a[112:115], v[160:163], v[16:19]
    ds_read_b64_tr_b16 a[126:127], v195 offset:61440
    v_mfma_f32_16x16x32_bf16 v[48:51], a[112:115], v[164:167], v[48:51]
    s_waitcnt lgkmcnt(4)
    v_mfma_f32_16x16x32_bf16 v[20:23], a[116:119], v[160:163], v[20:23]
    buffer_load_dwordx4 v197, s[16:19], s28 offen offset:1024 nt lds
    v_mfma_f32_16x16x32_bf16 v[52:55], a[116:119], v[164:167], v[52:55]
    s_waitcnt lgkmcnt(2)
    v_mfma_f32_16x16x32_bf16 v[24:27], a[120:123], v[160:163], v[24:27]
    v_exp_f32 v159, v159
    v_mfma_f32_16x16x32_bf16 v[56:59], a[120:123], v[164:167], v[56:59]
    v_cvt_pk_bf16_f32 v175, v158, v159
    s_waitcnt lgkmcnt(0)
    v_mfma_f32_16x16x32_bf16 v[28:31], a[124:127], v[160:163], v[28:31]
    v_mfma_f32_16x16x32_bf16 v[60:63], a[124:127], v[164:167], v[60:63]
    v_mfma_f32_16x16x32_bf16 v[144:147], a[64:67], a[160:163], 0
    v_exp_f32 v128, v128
    v_mfma_f32_16x16x32_bf16 v[144:147], a[68:71], a[164:167], v[144:147]
    v_exp_f32 v129, v129
    v_mfma_f32_16x16x32_bf16 v[144:147], a[72:75], a[168:171], v[144:147]
    v_exp_f32 v130, v130
    v_mfma_f32_16x16x32_bf16 v[144:147], a[76:79], a[172:175], v[144:147]
    v_exp_f32 v131, v131
    v_mfma_f32_16x16x32_bf16 v[152:155], a[64:67], a[176:179], 0
    v_exp_f32 v132, v132
    v_cvt_pk_bf16_f32 v160, v128, v129
    v_mfma_f32_16x16x32_bf16 v[152:155], a[68:71], a[180:183], v[152:155]
    v_exp_f32 v133, v133
    v_mfma_f32_16x16x32_bf16 v[152:155], a[72:75], a[184:187], v[152:155]
    v_cvt_pk_bf16_f32 v161, v130, v131
    ds_read_b128 a[64:67], v180 offset:8192
    v_mfma_f32_16x16x32_bf16 v[152:155], a[76:79], a[188:191], v[152:155]
    v_exp_f32 v134, v134
    v_mfma_f32_16x16x32_bf16 v[148:151], a[80:83], a[160:163], 0
    v_cvt_pk_bf16_f32 v162, v132, v133
    ds_read_b128 a[68:71], v181 offset:8192
    v_mfma_f32_16x16x32_bf16 v[148:151], a[84:87], a[164:167], v[148:151]
    buffer_load_dwordx4 v198, s[16:19], s28 offen offset:2048 nt lds
    v_mfma_f32_16x16x32_bf16 v[148:151], a[88:91], a[168:171], v[148:151]
    ds_read_b128 a[72:75], v182 offset:8192
    v_mfma_f32_16x16x32_bf16 v[148:151], a[92:95], a[172:175], v[148:151]
    v_exp_f32 v135, v135
    v_mfma_f32_16x16x32_bf16 v[156:159], a[80:83], a[176:179], 0
    v_cvt_pk_bf16_f32 v163, v134, v135
    ds_read_b128 a[76:79], v183 offset:8192
    v_mfma_f32_16x16x32_bf16 v[156:159], a[84:87], a[180:183], v[156:159]
    v_exp_f32 v136, v136
    v_mfma_f32_16x16x32_bf16 v[156:159], a[88:91], a[184:187], v[156:159]
    ds_read_b128 a[80:83], v180 offset:12288
    v_mfma_f32_16x16x32_bf16 v[156:159], a[92:95], a[188:191], v[156:159]
    v_exp_f32 v137, v137
    v_mfma_f32_16x16x32_bf16 v[222:225], v[242:245], v[168:171], v[222:225]
    v_cvt_pk_bf16_f32 v164, v136, v137
    ds_read_b128 a[84:87], v181 offset:12288
    v_mfma_f32_16x16x32_bf16 v[246:249], v[242:245], v[172:175], v[246:249]
    v_exp_f32 v138, v138
    v_mfma_f32_16x16x32_bf16 v[64:67], a[96:99], v[168:171], v[64:67]
    ds_read_b128 a[88:91], v182 offset:12288
    v_mfma_f32_16x16x32_bf16 v[96:99], a[96:99], v[172:175], v[96:99]
    v_exp_f32 v139, v139
    v_mfma_f32_16x16x32_bf16 v[68:71], a[100:103], v[168:171], v[68:71]
    v_cvt_pk_bf16_f32 v165, v138, v139
    ds_read_b128 a[92:95], v183 offset:12288
    v_mfma_f32_16x16x32_bf16 v[100:103], a[100:103], v[172:175], v[100:103]
    v_exp_f32 v140, v140
    v_mfma_f32_16x16x32_bf16 v[72:75], a[104:107], v[168:171], v[72:75]
    v_exp_f32 v141, v141
    v_mfma_f32_16x16x32_bf16 v[104:107], a[104:107], v[172:175], v[104:107]
    v_exp_f32 v142, v142
    v_mfma_f32_16x16x32_bf16 v[76:79], a[108:111], v[168:171], v[76:79]
    v_exp_f32 v143, v143
    v_mfma_f32_16x16x32_bf16 v[108:111], a[108:111], v[172:175], v[108:111]
    v_cvt_pk_bf16_f32 v166, v140, v141
    v_cvt_pk_bf16_f32 v167, v142, v143
    v_mfma_f32_16x16x32_bf16 v[80:83], a[112:115], v[168:171], v[80:83]
    v_mfma_f32_16x16x32_bf16 v[112:115], a[112:115], v[172:175], v[112:115]
    buffer_load_dwordx4 v199, s[16:19], s28 offen offset:3072 nt lds
    s_add_u32 s28, s28, 16384
    v_mfma_f32_16x16x32_bf16 v[84:87], a[116:119], v[168:171], v[84:87]
    v_mfma_f32_16x16x32_bf16 v[116:119], a[116:119], v[172:175], v[116:119]
    v_mfma_f32_16x16x32_bf16 v[88:91], a[120:123], v[168:171], v[88:91]
    v_mfma_f32_16x16x32_bf16 v[120:123], a[120:123], v[172:175], v[120:123]
    v_mfma_f32_16x16x32_bf16 v[92:95], a[124:127], v[168:171], v[92:95]
    v_mfma_f32_16x16x32_bf16 v[124:127], a[124:127], v[172:175], v[124:127]
    s_waitcnt lgkmcnt(0)
    v_mfma_f32_16x16x32_bf16 v[128:131], a[64:67], a[128:131], 0
    s_waitcnt vmcnt(16)
    s_barrier
    ds_read_b64_tr_b16 a[96:97], v188 offset:0
    v_mfma_f32_16x16x32_bf16 v[128:131], a[68:71], a[132:135], v[128:131]
    v_exp_f32 v144, v144
    v_mfma_f32_16x16x32_bf16 v[128:131], a[72:75], a[136:139], v[128:131]
    ds_read_b64_tr_b16 a[98:99], v188 offset:4096
    v_exp_f32 v145, v145
    v_mfma_f32_16x16x32_bf16 v[128:131], a[76:79], a[140:143], v[128:131]
    v_exp_f32 v146, v146
    v_mfma_f32_16x16x32_bf16 v[136:139], a[64:67], a[144:147], 0
    ds_read_b64_tr_b16 a[100:101], v189 offset:0
    v_exp_f32 v147, v147
    v_mfma_f32_16x16x32_bf16 v[136:139], a[68:71], a[148:151], v[136:139]
    v_exp_f32 v148, v148
    v_cvt_pk_bf16_f32 v168, v144, v145
    v_mfma_f32_16x16x32_bf16 v[136:139], a[72:75], a[152:155], v[136:139]
    ds_read_b64_tr_b16 a[102:103], v189 offset:4096
    v_exp_f32 v149, v149
    v_mfma_f32_16x16x32_bf16 v[136:139], a[76:79], a[156:159], v[136:139]
    v_exp_f32 v150, v150
    v_cvt_pk_bf16_f32 v169, v146, v147
    v_mfma_f32_16x16x32_bf16 v[132:135], a[80:83], a[128:131], 0
    ds_read_b64_tr_b16 a[104:105], v190 offset:0
    v_exp_f32 v151, v151
    v_mfma_f32_16x16x32_bf16 v[132:135], a[84:87], a[132:135], v[132:135]
    s_add_u32 m0, s30, 114688
    s_nop 0
    buffer_load_dwordx4 v200, s[20:23], s29 offen offset:0 nt lds
    v_mfma_f32_16x16x32_bf16 v[132:135], a[88:91], a[136:139], v[132:135]
    ds_read_b64_tr_b16 a[106:107], v190 offset:4096
    v_cvt_pk_bf16_f32 v170, v148, v149
    v_mfma_f32_16x16x32_bf16 v[132:135], a[92:95], a[140:143], v[132:135]
    v_exp_f32 v152, v152
    v_cvt_pk_bf16_f32 v171, v150, v151
    v_mfma_f32_16x16x32_bf16 v[140:143], a[80:83], a[144:147], 0
    ds_read_b64_tr_b16 a[108:109], v191 offset:0
    v_mfma_f32_16x16x32_bf16 v[140:143], a[84:87], a[148:151], v[140:143]
    v_exp_f32 v153, v153
    v_mfma_f32_16x16x32_bf16 v[140:143], a[88:91], a[152:155], v[140:143]
    ds_read_b64_tr_b16 a[110:111], v191 offset:4096
    v_cvt_pk_bf16_f32 v172, v152, v153
    v_mfma_f32_16x16x32_bf16 v[140:143], a[92:95], a[156:159], v[140:143]
    v_exp_f32 v154, v154
    v_mfma_f32_16x16x32_bf16 v[176:179], v[242:245], v[160:163], v[176:179]
    ds_read_b64_tr_b16 a[112:113], v192 offset:0
    v_mfma_f32_16x16x32_bf16 v[184:187], v[242:245], v[164:167], v[184:187]
    ds_read_b64_tr_b16 a[114:115], v192 offset:4096
    s_waitcnt lgkmcnt(6)
    v_mfma_f32_16x16x32_bf16 v[0:3], a[96:99], v[160:163], v[0:3]
    v_exp_f32 v155, v155
    v_mfma_f32_16x16x32_bf16 v[32:35], a[96:99], v[164:167], v[32:35]
    ds_read_b64_tr_b16 a[116:117], v193 offset:0
    v_cvt_pk_bf16_f32 v173, v154, v155
    v_mfma_f32_16x16x32_bf16 v[4:7], a[100:103], v[160:163], v[4:7]
    ds_read_b64_tr_b16 a[118:119], v193 offset:4096
    v_mfma_f32_16x16x32_bf16 v[36:39], a[100:103], v[164:167], v[36:39]
    s_waitcnt lgkmcnt(4)
    v_mfma_f32_16x16x32_bf16 v[8:11], a[104:107], v[160:163], v[8:11]
    ds_read_b64_tr_b16 a[120:121], v194 offset:0
    v_mfma_f32_16x16x32_bf16 v[40:43], a[104:107], v[164:167], v[40:43]
    ds_read_b64_tr_b16 a[122:123], v194 offset:4096
    v_mfma_f32_16x16x32_bf16 v[12:15], a[108:111], v[160:163], v[12:15]
    v_exp_f32 v156, v156
    v_mfma_f32_16x16x32_bf16 v[44:47], a[108:111], v[164:167], v[44:47]
    ds_read_b64_tr_b16 a[124:125], v195 offset:0
    s_waitcnt lgkmcnt(3)
    v_mfma_f32_16x16x32_bf16 v[16:19], a[112:115], v[160:163], v[16:19]
    ds_read_b64_tr_b16 a[126:127], v195 offset:4096
    v_mfma_f32_16x16x32_bf16 v[48:51], a[112:115], v[164:167], v[48:51]
    v_exp_f32 v157, v157
    v_mfma_f32_16x16x32_bf16 v[20:23], a[116:119], v[160:163], v[20:23]
    buffer_load_dwordx4 v201, s[20:23], s29 offen offset:1024 nt lds
    v_cvt_pk_bf16_f32 v174, v156, v157
    v_mfma_f32_16x16x32_bf16 v[52:55], a[116:119], v[164:167], v[52:55]
    s_waitcnt lgkmcnt(0)
    v_mfma_f32_16x16x32_bf16 v[24:27], a[120:123], v[160:163], v[24:27]
    v_exp_f32 v158, v158
    v_mfma_f32_16x16x32_bf16 v[56:59], a[120:123], v[164:167], v[56:59]
    v_exp_f32 v159, v159
    v_mfma_f32_16x16x32_bf16 v[28:31], a[124:127], v[160:163], v[28:31]
    v_cvt_pk_bf16_f32 v175, v158, v159
    v_mfma_f32_16x16x32_bf16 v[60:63], a[124:127], v[164:167], v[60:63]
    v_mfma_f32_16x16x32_bf16 v[144:147], a[64:67], a[160:163], 0
    v_exp_f32 v128, v128
    v_mfma_f32_16x16x32_bf16 v[144:147], a[68:71], a[164:167], v[144:147]
    v_exp_f32 v129, v129
    v_mfma_f32_16x16x32_bf16 v[144:147], a[72:75], a[168:171], v[144:147]
    v_exp_f32 v130, v130
    v_mfma_f32_16x16x32_bf16 v[144:147], a[76:79], a[172:175], v[144:147]
    v_exp_f32 v131, v131
    v_mfma_f32_16x16x32_bf16 v[152:155], a[64:67], a[176:179], 0
    v_exp_f32 v132, v132
    v_cvt_pk_bf16_f32 v160, v128, v129
    v_mfma_f32_16x16x32_bf16 v[152:155], a[68:71], a[180:183], v[152:155]
    v_exp_f32 v133, v133
    v_mfma_f32_16x16x32_bf16 v[152:155], a[72:75], a[184:187], v[152:155]
    ds_read_b128 a[64:67], v180 offset:16384
    v_cvt_pk_bf16_f32 v161, v130, v131
    v_mfma_f32_16x16x32_bf16 v[152:155], a[76:79], a[188:191], v[152:155]
    v_exp_f32 v134, v134
    v_mfma_f32_16x16x32_bf16 v[148:151], a[80:83], a[160:163], 0
    ds_read_b128 a[68:71], v181 offset:16384
    v_cvt_pk_bf16_f32 v162, v132, v133
    v_mfma_f32_16x16x32_bf16 v[148:151], a[84:87], a[164:167], v[148:151]
    buffer_load_dwordx4 v200, s[20:23], s29 offen offset:2048 nt lds
    v_mfma_f32_16x16x32_bf16 v[148:151], a[88:91], a[168:171], v[148:151]
    ds_read_b128 a[72:75], v182 offset:16384
    v_mfma_f32_16x16x32_bf16 v[148:151], a[92:95], a[172:175], v[148:151]
    v_exp_f32 v135, v135
    v_mfma_f32_16x16x32_bf16 v[156:159], a[80:83], a[176:179], 0
    ds_read_b128 a[76:79], v183 offset:16384
    v_cvt_pk_bf16_f32 v163, v134, v135
    v_mfma_f32_16x16x32_bf16 v[156:159], a[84:87], a[180:183], v[156:159]
    v_exp_f32 v136, v136
    v_mfma_f32_16x16x32_bf16 v[156:159], a[88:91], a[184:187], v[156:159]
    ds_read_b128 a[80:83], v180 offset:20480
    v_mfma_f32_16x16x32_bf16 v[156:159], a[92:95], a[188:191], v[156:159]
    v_exp_f32 v137, v137
    v_mfma_f32_16x16x32_bf16 v[222:225], v[242:245], v[168:171], v[222:225]
    ds_read_b128 a[84:87], v181 offset:20480
    v_cvt_pk_bf16_f32 v164, v136, v137
    v_mfma_f32_16x16x32_bf16 v[246:249], v[242:245], v[172:175], v[246:249]
    v_exp_f32 v138, v138
    v_mfma_f32_16x16x32_bf16 v[64:67], a[96:99], v[168:171], v[64:67]
    ds_read_b128 a[88:91], v182 offset:20480
    v_mfma_f32_16x16x32_bf16 v[96:99], a[96:99], v[172:175], v[96:99]
    v_exp_f32 v139, v139
    v_mfma_f32_16x16x32_bf16 v[68:71], a[100:103], v[168:171], v[68:71]
    ds_read_b128 a[92:95], v183 offset:20480
    v_cvt_pk_bf16_f32 v165, v138, v139
    v_mfma_f32_16x16x32_bf16 v[100:103], a[100:103], v[172:175], v[100:103]
    v_exp_f32 v140, v140
    v_mfma_f32_16x16x32_bf16 v[72:75], a[104:107], v[168:171], v[72:75]
    v_exp_f32 v141, v141
    v_mfma_f32_16x16x32_bf16 v[104:107], a[104:107], v[172:175], v[104:107]
    v_exp_f32 v142, v142
    v_mfma_f32_16x16x32_bf16 v[76:79], a[108:111], v[168:171], v[76:79]
    v_exp_f32 v143, v143
    v_mfma_f32_16x16x32_bf16 v[108:111], a[108:111], v[172:175], v[108:111]
    v_cvt_pk_bf16_f32 v166, v140, v141
    v_cvt_pk_bf16_f32 v167, v142, v143
    v_mfma_f32_16x16x32_bf16 v[80:83], a[112:115], v[168:171], v[80:83]
    v_mfma_f32_16x16x32_bf16 v[112:115], a[112:115], v[172:175], v[112:115]
    buffer_load_dwordx4 v201, s[20:23], s29 offen offset:3072 nt lds
    s_add_u32 s29, s29, 16384
    v_mfma_f32_16x16x32_bf16 v[84:87], a[116:119], v[168:171], v[84:87]
    v_mfma_f32_16x16x32_bf16 v[116:119], a[116:119], v[172:175], v[116:119]
    v_mfma_f32_16x16x32_bf16 v[88:91], a[120:123], v[168:171], v[88:91]
    v_mfma_f32_16x16x32_bf16 v[120:123], a[120:123], v[172:175], v[120:123]
    v_mfma_f32_16x16x32_bf16 v[92:95], a[124:127], v[168:171], v[92:95]
    v_mfma_f32_16x16x32_bf16 v[124:127], a[124:127], v[172:175], v[124:127]
    s_waitcnt lgkmcnt(0)
    v_mfma_f32_16x16x32_bf16 v[128:131], a[64:67], a[128:131], 0
    ds_read_b64_tr_b16 a[96:97], v188 offset:8192
    v_exp_f32 v144, v144
    v_mfma_f32_16x16x32_bf16 v[128:131], a[68:71], a[132:135], v[128:131]
    v_exp_f32 v145, v145
    v_mfma_f32_16x16x32_bf16 v[128:131], a[72:75], a[136:139], v[128:131]
    ds_read_b64_tr_b16 a[98:99], v188 offset:12288
    v_exp_f32 v146, v146
    v_mfma_f32_16x16x32_bf16 v[128:131], a[76:79], a[140:143], v[128:131]
    v_exp_f32 v147, v147
    v_mfma_f32_16x16x32_bf16 v[136:139], a[64:67], a[144:147], 0
    ds_read_b64_tr_b16 a[100:101], v189 offset:8192
    v_exp_f32 v148, v148
    v_mfma_f32_16x16x32_bf16 v[136:139], a[68:71], a[148:151], v[136:139]
    v_exp_f32 v149, v149
    v_cvt_pk_bf16_f32 v168, v144, v145
    v_mfma_f32_16x16x32_bf16 v[136:139], a[72:75], a[152:155], v[136:139]
    ds_read_b64_tr_b16 a[102:103], v189 offset:12288
    v_exp_f32 v150, v150
    v_mfma_f32_16x16x32_bf16 v[136:139], a[76:79], a[156:159], v[136:139]
    v_exp_f32 v151, v151
    v_cvt_pk_bf16_f32 v169, v146, v147
    v_mfma_f32_16x16x32_bf16 v[132:135], a[80:83], a[128:131], 0
    ds_read_b64_tr_b16 a[104:105], v190 offset:8192
    v_cvt_pk_bf16_f32 v170, v148, v149
    v_mfma_f32_16x16x32_bf16 v[132:135], a[84:87], a[132:135], v[132:135]
    s_add_u32 m0, s30, 0
    s_nop 0
    buffer_load_dwordx4 v196, s[16:19], s28 offen offset:0 nt lds
    v_mfma_f32_16x16x32_bf16 v[132:135], a[88:91], a[136:139], v[132:135]
    ds_read_b64_tr_b16 a[106:107], v190 offset:12288
    v_cvt_pk_bf16_f32 v171, v150, v151
    v_mfma_f32_16x16x32_bf16 v[132:135], a[92:95], a[140:143], v[132:135]
    v_exp_f32 v152, v152
    v_mfma_f32_16x16x32_bf16 v[140:143], a[80:83], a[144:147], 0
    ds_read_b64_tr_b16 a[108:109], v191 offset:8192
    v_mfma_f32_16x16x32_bf16 v[140:143], a[84:87], a[148:151], v[140:143]
    v_exp_f32 v153, v153
    v_mfma_f32_16x16x32_bf16 v[140:143], a[88:91], a[152:155], v[140:143]
    ds_read_b64_tr_b16 a[110:111], v191 offset:12288
    v_cvt_pk_bf16_f32 v172, v152, v153
    v_mfma_f32_16x16x32_bf16 v[140:143], a[92:95], a[156:159], v[140:143]
    v_exp_f32 v154, v154
    v_mfma_f32_16x16x32_bf16 v[176:179], v[242:245], v[160:163], v[176:179]
    ds_read_b64_tr_b16 a[112:113], v192 offset:8192
    v_mfma_f32_16x16x32_bf16 v[184:187], v[242:245], v[164:167], v[184:187]
    ds_read_b64_tr_b16 a[114:115], v192 offset:12288
    s_waitcnt lgkmcnt(6)
    v_mfma_f32_16x16x32_bf16 v[0:3], a[96:99], v[160:163], v[0:3]
    v_exp_f32 v155, v155
    v_mfma_f32_16x16x32_bf16 v[32:35], a[96:99], v[164:167], v[32:35]
    ds_read_b64_tr_b16 a[116:117], v193 offset:8192
    v_cvt_pk_bf16_f32 v173, v154, v155
    v_mfma_f32_16x16x32_bf16 v[4:7], a[100:103], v[160:163], v[4:7]
    ds_read_b64_tr_b16 a[118:119], v193 offset:12288
    v_mfma_f32_16x16x32_bf16 v[36:39], a[100:103], v[164:167], v[36:39]
    s_waitcnt lgkmcnt(4)
    v_mfma_f32_16x16x32_bf16 v[8:11], a[104:107], v[160:163], v[8:11]
    ds_read_b64_tr_b16 a[120:121], v194 offset:8192
    v_mfma_f32_16x16x32_bf16 v[40:43], a[104:107], v[164:167], v[40:43]
    ds_read_b64_tr_b16 a[122:123], v194 offset:12288
    v_mfma_f32_16x16x32_bf16 v[12:15], a[108:111], v[160:163], v[12:15]
    v_exp_f32 v156, v156
    v_mfma_f32_16x16x32_bf16 v[44:47], a[108:111], v[164:167], v[44:47]
    ds_read_b64_tr_b16 a[124:125], v195 offset:8192
    s_waitcnt lgkmcnt(3)
    v_mfma_f32_16x16x32_bf16 v[16:19], a[112:115], v[160:163], v[16:19]
    ds_read_b64_tr_b16 a[126:127], v195 offset:12288
    v_mfma_f32_16x16x32_bf16 v[48:51], a[112:115], v[164:167], v[48:51]
    v_exp_f32 v157, v157
    v_mfma_f32_16x16x32_bf16 v[20:23], a[116:119], v[160:163], v[20:23]
    buffer_load_dwordx4 v197, s[16:19], s28 offen offset:1024 nt lds
    v_cvt_pk_bf16_f32 v174, v156, v157
    v_mfma_f32_16x16x32_bf16 v[52:55], a[116:119], v[164:167], v[52:55]
    s_waitcnt lgkmcnt(0)
    v_mfma_f32_16x16x32_bf16 v[24:27], a[120:123], v[160:163], v[24:27]
    v_exp_f32 v158, v158
    v_mfma_f32_16x16x32_bf16 v[56:59], a[120:123], v[164:167], v[56:59]
    v_exp_f32 v159, v159
    v_mfma_f32_16x16x32_bf16 v[28:31], a[124:127], v[160:163], v[28:31]
    v_cvt_pk_bf16_f32 v175, v158, v159
    v_mfma_f32_16x16x32_bf16 v[60:63], a[124:127], v[164:167], v[60:63]
    v_mfma_f32_16x16x32_bf16 v[144:147], a[64:67], a[160:163], 0
    v_exp_f32 v128, v128
    v_mfma_f32_16x16x32_bf16 v[144:147], a[68:71], a[164:167], v[144:147]
    v_exp_f32 v129, v129
    v_mfma_f32_16x16x32_bf16 v[144:147], a[72:75], a[168:171], v[144:147]
    v_exp_f32 v130, v130
    v_mfma_f32_16x16x32_bf16 v[144:147], a[76:79], a[172:175], v[144:147]
    v_exp_f32 v131, v131
    v_mfma_f32_16x16x32_bf16 v[152:155], a[64:67], a[176:179], 0
    v_exp_f32 v132, v132
    v_cvt_pk_bf16_f32 v160, v128, v129
    v_mfma_f32_16x16x32_bf16 v[152:155], a[68:71], a[180:183], v[152:155]
    v_exp_f32 v133, v133
    v_mfma_f32_16x16x32_bf16 v[152:155], a[72:75], a[184:187], v[152:155]
    ds_read_b128 a[64:67], v180 offset:24576
    v_cvt_pk_bf16_f32 v161, v130, v131
    v_mfma_f32_16x16x32_bf16 v[152:155], a[76:79], a[188:191], v[152:155]
    v_exp_f32 v134, v134
    v_mfma_f32_16x16x32_bf16 v[148:151], a[80:83], a[160:163], 0
    ds_read_b128 a[68:71], v181 offset:24576
    v_cvt_pk_bf16_f32 v162, v132, v133
    v_mfma_f32_16x16x32_bf16 v[148:151], a[84:87], a[164:167], v[148:151]
    buffer_load_dwordx4 v198, s[16:19], s28 offen offset:2048 nt lds
    v_mfma_f32_16x16x32_bf16 v[148:151], a[88:91], a[168:171], v[148:151]
    ds_read_b128 a[72:75], v182 offset:24576
    v_mfma_f32_16x16x32_bf16 v[148:151], a[92:95], a[172:175], v[148:151]
    v_exp_f32 v135, v135
    v_mfma_f32_16x16x32_bf16 v[156:159], a[80:83], a[176:179], 0
    ds_read_b128 a[76:79], v183 offset:24576
    v_cvt_pk_bf16_f32 v163, v134, v135
    v_mfma_f32_16x16x32_bf16 v[156:159], a[84:87], a[180:183], v[156:159]
    v_exp_f32 v136, v136
    v_mfma_f32_16x16x32_bf16 v[156:159], a[88:91], a[184:187], v[156:159]
    ds_read_b128 a[80:83], v180 offset:28672
    v_mfma_f32_16x16x32_bf16 v[156:159], a[92:95], a[188:191], v[156:159]
    v_exp_f32 v137, v137
    v_mfma_f32_16x16x32_bf16 v[222:225], v[242:245], v[168:171], v[222:225]
    ds_read_b128 a[84:87], v181 offset:28672
    v_cvt_pk_bf16_f32 v164, v136, v137
    v_mfma_f32_16x16x32_bf16 v[246:249], v[242:245], v[172:175], v[246:249]
    v_exp_f32 v138, v138
    v_mfma_f32_16x16x32_bf16 v[64:67], a[96:99], v[168:171], v[64:67]
    ds_read_b128 a[88:91], v182 offset:28672
    v_mfma_f32_16x16x32_bf16 v[96:99], a[96:99], v[172:175], v[96:99]
    v_exp_f32 v139, v139
    v_mfma_f32_16x16x32_bf16 v[68:71], a[100:103], v[168:171], v[68:71]
    ds_read_b128 a[92:95], v183 offset:28672
    v_cvt_pk_bf16_f32 v165, v138, v139
    v_mfma_f32_16x16x32_bf16 v[100:103], a[100:103], v[172:175], v[100:103]
    v_exp_f32 v140, v140
    v_mfma_f32_16x16x32_bf16 v[72:75], a[104:107], v[168:171], v[72:75]
    v_exp_f32 v141, v141
    v_mfma_f32_16x16x32_bf16 v[104:107], a[104:107], v[172:175], v[104:107]
    v_exp_f32 v142, v142
    v_mfma_f32_16x16x32_bf16 v[76:79], a[108:111], v[168:171], v[76:79]
    v_exp_f32 v143, v143
    v_mfma_f32_16x16x32_bf16 v[108:111], a[108:111], v[172:175], v[108:111]
    v_cvt_pk_bf16_f32 v166, v140, v141
    v_cvt_pk_bf16_f32 v167, v142, v143
    v_mfma_f32_16x16x32_bf16 v[80:83], a[112:115], v[168:171], v[80:83]
    v_mfma_f32_16x16x32_bf16 v[112:115], a[112:115], v[172:175], v[112:115]
    buffer_load_dwordx4 v199, s[16:19], s28 offen offset:3072 nt lds
    s_add_u32 s28, s28, 16384
    v_mfma_f32_16x16x32_bf16 v[84:87], a[116:119], v[168:171], v[84:87]
    v_mfma_f32_16x16x32_bf16 v[116:119], a[116:119], v[172:175], v[116:119]
    v_mfma_f32_16x16x32_bf16 v[88:91], a[120:123], v[168:171], v[88:91]
    v_mfma_f32_16x16x32_bf16 v[120:123], a[120:123], v[172:175], v[120:123]
    v_mfma_f32_16x16x32_bf16 v[92:95], a[124:127], v[168:171], v[92:95]
    v_mfma_f32_16x16x32_bf16 v[124:127], a[124:127], v[172:175], v[124:127]
    s_waitcnt lgkmcnt(0)
    v_mfma_f32_16x16x32_bf16 v[128:131], a[64:67], a[128:131], 0
    s_waitcnt vmcnt(16)
    s_barrier
    ds_read_b64_tr_b16 a[96:97], v188 offset:16384
    v_mfma_f32_16x16x32_bf16 v[128:131], a[68:71], a[132:135], v[128:131]
    v_exp_f32 v144, v144
    v_mfma_f32_16x16x32_bf16 v[128:131], a[72:75], a[136:139], v[128:131]
    ds_read_b64_tr_b16 a[98:99], v188 offset:20480
    v_exp_f32 v145, v145
    v_mfma_f32_16x16x32_bf16 v[128:131], a[76:79], a[140:143], v[128:131]
    v_exp_f32 v146, v146
    v_mfma_f32_16x16x32_bf16 v[136:139], a[64:67], a[144:147], 0
    ds_read_b64_tr_b16 a[100:101], v189 offset:16384
    v_exp_f32 v147, v147
    v_mfma_f32_16x16x32_bf16 v[136:139], a[68:71], a[148:151], v[136:139]
    v_exp_f32 v148, v148
    v_cvt_pk_bf16_f32 v168, v144, v145
    v_mfma_f32_16x16x32_bf16 v[136:139], a[72:75], a[152:155], v[136:139]
    ds_read_b64_tr_b16 a[102:103], v189 offset:20480
    v_exp_f32 v149, v149
    v_mfma_f32_16x16x32_bf16 v[136:139], a[76:79], a[156:159], v[136:139]
    v_exp_f32 v150, v150
    v_cvt_pk_bf16_f32 v169, v146, v147
    v_mfma_f32_16x16x32_bf16 v[132:135], a[80:83], a[128:131], 0
    ds_read_b64_tr_b16 a[104:105], v190 offset:16384
    v_exp_f32 v151, v151
    v_mfma_f32_16x16x32_bf16 v[132:135], a[84:87], a[132:135], v[132:135]
    s_add_u32 m0, s30, 65536
    s_nop 0
    buffer_load_dwordx4 v200, s[20:23], s29 offen offset:0 nt lds
    v_mfma_f32_16x16x32_bf16 v[132:135], a[88:91], a[136:139], v[132:135]
    ds_read_b64_tr_b16 a[106:107], v190 offset:20480
    v_cvt_pk_bf16_f32 v170, v148, v149
    v_mfma_f32_16x16x32_bf16 v[132:135], a[92:95], a[140:143], v[132:135]
    v_exp_f32 v152, v152
    v_cvt_pk_bf16_f32 v171, v150, v151
    v_mfma_f32_16x16x32_bf16 v[140:143], a[80:83], a[144:147], 0
    ds_read_b64_tr_b16 a[108:109], v191 offset:16384
    v_mfma_f32_16x16x32_bf16 v[140:143], a[84:87], a[148:151], v[140:143]
    v_exp_f32 v153, v153
    v_mfma_f32_16x16x32_bf16 v[140:143], a[88:91], a[152:155], v[140:143]
    ds_read_b64_tr_b16 a[110:111], v191 offset:20480
    v_cvt_pk_bf16_f32 v172, v152, v153
    v_mfma_f32_16x16x32_bf16 v[140:143], a[92:95], a[156:159], v[140:143]
    v_exp_f32 v154, v154
    v_mfma_f32_16x16x32_bf16 v[176:179], v[242:245], v[160:163], v[176:179]
    ds_read_b64_tr_b16 a[112:113], v192 offset:16384
    v_mfma_f32_16x16x32_bf16 v[184:187], v[242:245], v[164:167], v[184:187]
    ds_read_b64_tr_b16 a[114:115], v192 offset:20480
    s_waitcnt lgkmcnt(6)
    v_mfma_f32_16x16x32_bf16 v[0:3], a[96:99], v[160:163], v[0:3]
    v_exp_f32 v155, v155
    v_mfma_f32_16x16x32_bf16 v[32:35], a[96:99], v[164:167], v[32:35]
    ds_read_b64_tr_b16 a[116:117], v193 offset:16384
    v_cvt_pk_bf16_f32 v173, v154, v155
    v_mfma_f32_16x16x32_bf16 v[4:7], a[100:103], v[160:163], v[4:7]
    ds_read_b64_tr_b16 a[118:119], v193 offset:20480
    v_mfma_f32_16x16x32_bf16 v[36:39], a[100:103], v[164:167], v[36:39]
    s_waitcnt lgkmcnt(4)
    v_mfma_f32_16x16x32_bf16 v[8:11], a[104:107], v[160:163], v[8:11]
    ds_read_b64_tr_b16 a[120:121], v194 offset:16384
    v_mfma_f32_16x16x32_bf16 v[40:43], a[104:107], v[164:167], v[40:43]
    ds_read_b64_tr_b16 a[122:123], v194 offset:20480
    v_mfma_f32_16x16x32_bf16 v[12:15], a[108:111], v[160:163], v[12:15]
    v_exp_f32 v156, v156
    v_mfma_f32_16x16x32_bf16 v[44:47], a[108:111], v[164:167], v[44:47]
    ds_read_b64_tr_b16 a[124:125], v195 offset:16384
    s_waitcnt lgkmcnt(3)
    v_mfma_f32_16x16x32_bf16 v[16:19], a[112:115], v[160:163], v[16:19]
    ds_read_b64_tr_b16 a[126:127], v195 offset:20480
    v_mfma_f32_16x16x32_bf16 v[48:51], a[112:115], v[164:167], v[48:51]
    v_exp_f32 v157, v157
    v_mfma_f32_16x16x32_bf16 v[20:23], a[116:119], v[160:163], v[20:23]
    buffer_load_dwordx4 v201, s[20:23], s29 offen offset:1024 nt lds
    v_cvt_pk_bf16_f32 v174, v156, v157
    v_mfma_f32_16x16x32_bf16 v[52:55], a[116:119], v[164:167], v[52:55]
    s_waitcnt lgkmcnt(0)
    v_mfma_f32_16x16x32_bf16 v[24:27], a[120:123], v[160:163], v[24:27]
    v_exp_f32 v158, v158
    v_mfma_f32_16x16x32_bf16 v[56:59], a[120:123], v[164:167], v[56:59]
    v_exp_f32 v159, v159
    v_mfma_f32_16x16x32_bf16 v[28:31], a[124:127], v[160:163], v[28:31]
    v_cvt_pk_bf16_f32 v175, v158, v159
    v_mfma_f32_16x16x32_bf16 v[60:63], a[124:127], v[164:167], v[60:63]
    v_mfma_f32_16x16x32_bf16 v[144:147], a[64:67], a[160:163], 0
    v_exp_f32 v128, v128
    v_mfma_f32_16x16x32_bf16 v[144:147], a[68:71], a[164:167], v[144:147]
    v_exp_f32 v129, v129
    v_mfma_f32_16x16x32_bf16 v[144:147], a[72:75], a[168:171], v[144:147]
    v_exp_f32 v130, v130
    v_mfma_f32_16x16x32_bf16 v[144:147], a[76:79], a[172:175], v[144:147]
    v_exp_f32 v131, v131
    v_mfma_f32_16x16x32_bf16 v[152:155], a[64:67], a[176:179], 0
    v_exp_f32 v132, v132
    v_cvt_pk_bf16_f32 v160, v128, v129
    v_mfma_f32_16x16x32_bf16 v[152:155], a[68:71], a[180:183], v[152:155]
    v_exp_f32 v133, v133
    v_mfma_f32_16x16x32_bf16 v[152:155], a[72:75], a[184:187], v[152:155]
    ds_read_b128 a[64:67], v180 offset:32768
    v_cvt_pk_bf16_f32 v161, v130, v131
    v_mfma_f32_16x16x32_bf16 v[152:155], a[76:79], a[188:191], v[152:155]
    v_exp_f32 v134, v134
    v_mfma_f32_16x16x32_bf16 v[148:151], a[80:83], a[160:163], 0
    ds_read_b128 a[68:71], v181 offset:32768
    v_cvt_pk_bf16_f32 v162, v132, v133
    v_mfma_f32_16x16x32_bf16 v[148:151], a[84:87], a[164:167], v[148:151]
    buffer_load_dwordx4 v200, s[20:23], s29 offen offset:2048 nt lds
    v_mfma_f32_16x16x32_bf16 v[148:151], a[88:91], a[168:171], v[148:151]
    ds_read_b128 a[72:75], v182 offset:32768
    v_mfma_f32_16x16x32_bf16 v[148:151], a[92:95], a[172:175], v[148:151]
    v_exp_f32 v135, v135
    v_mfma_f32_16x16x32_bf16 v[156:159], a[80:83], a[176:179], 0
    ds_read_b128 a[76:79], v183 offset:32768
    v_cvt_pk_bf16_f32 v163, v134, v135
    v_mfma_f32_16x16x32_bf16 v[156:159], a[84:87], a[180:183], v[156:159]
    v_exp_f32 v136, v136
    v_mfma_f32_16x16x32_bf16 v[156:159], a[88:91], a[184:187], v[156:159]
    ds_read_b128 a[80:83], v180 offset:36864
    v_mfma_f32_16x16x32_bf16 v[156:159], a[92:95], a[188:191], v[156:159]
    v_exp_f32 v137, v137
    v_mfma_f32_16x16x32_bf16 v[222:225], v[242:245], v[168:171], v[222:225]
    ds_read_b128 a[84:87], v181 offset:36864
    v_cvt_pk_bf16_f32 v164, v136, v137
    v_mfma_f32_16x16x32_bf16 v[246:249], v[242:245], v[172:175], v[246:249]
    v_exp_f32 v138, v138
    v_mfma_f32_16x16x32_bf16 v[64:67], a[96:99], v[168:171], v[64:67]
    ds_read_b128 a[88:91], v182 offset:36864
    v_mfma_f32_16x16x32_bf16 v[96:99], a[96:99], v[172:175], v[96:99]
    v_exp_f32 v139, v139
    v_mfma_f32_16x16x32_bf16 v[68:71], a[100:103], v[168:171], v[68:71]
    ds_read_b128 a[92:95], v183 offset:36864
    v_cvt_pk_bf16_f32 v165, v138, v139
    v_mfma_f32_16x16x32_bf16 v[100:103], a[100:103], v[172:175], v[100:103]
    v_exp_f32 v140, v140
    v_mfma_f32_16x16x32_bf16 v[72:75], a[104:107], v[168:171], v[72:75]
    v_exp_f32 v141, v141
    v_mfma_f32_16x16x32_bf16 v[104:107], a[104:107], v[172:175], v[104:107]
    v_exp_f32 v142, v142
    v_mfma_f32_16x16x32_bf16 v[76:79], a[108:111], v[168:171], v[76:79]
    v_exp_f32 v143, v143
    v_mfma_f32_16x16x32_bf16 v[108:111], a[108:111], v[172:175], v[108:111]
    v_cvt_pk_bf16_f32 v166, v140, v141
    v_cvt_pk_bf16_f32 v167, v142, v143
    v_mfma_f32_16x16x32_bf16 v[80:83], a[112:115], v[168:171], v[80:83]
    v_mfma_f32_16x16x32_bf16 v[112:115], a[112:115], v[172:175], v[112:115]
    buffer_load_dwordx4 v201, s[20:23], s29 offen offset:3072 nt lds
    s_add_u32 s29, s29, 16384
    v_mfma_f32_16x16x32_bf16 v[84:87], a[116:119], v[168:171], v[84:87]
    v_mfma_f32_16x16x32_bf16 v[116:119], a[116:119], v[172:175], v[116:119]
    v_mfma_f32_16x16x32_bf16 v[88:91], a[120:123], v[168:171], v[88:91]
    v_mfma_f32_16x16x32_bf16 v[120:123], a[120:123], v[172:175], v[120:123]
    v_mfma_f32_16x16x32_bf16 v[92:95], a[124:127], v[168:171], v[92:95]
    v_mfma_f32_16x16x32_bf16 v[124:127], a[124:127], v[172:175], v[124:127]
    s_waitcnt lgkmcnt(0)
    v_mfma_f32_16x16x32_bf16 v[128:131], a[64:67], a[128:131], 0
    ds_read_b64_tr_b16 a[96:97], v188 offset:24576
    v_exp_f32 v144, v144
    v_mfma_f32_16x16x32_bf16 v[128:131], a[68:71], a[132:135], v[128:131]
    v_exp_f32 v145, v145
    v_mfma_f32_16x16x32_bf16 v[128:131], a[72:75], a[136:139], v[128:131]
    ds_read_b64_tr_b16 a[98:99], v188 offset:28672
    v_exp_f32 v146, v146
    v_mfma_f32_16x16x32_bf16 v[128:131], a[76:79], a[140:143], v[128:131]
    v_exp_f32 v147, v147
    v_mfma_f32_16x16x32_bf16 v[136:139], a[64:67], a[144:147], 0
    ds_read_b64_tr_b16 a[100:101], v189 offset:24576
    v_exp_f32 v148, v148
    v_mfma_f32_16x16x32_bf16 v[136:139], a[68:71], a[148:151], v[136:139]
    v_exp_f32 v149, v149
    v_cvt_pk_bf16_f32 v168, v144, v145
    v_mfma_f32_16x16x32_bf16 v[136:139], a[72:75], a[152:155], v[136:139]
    ds_read_b64_tr_b16 a[102:103], v189 offset:28672
    v_exp_f32 v150, v150
    v_mfma_f32_16x16x32_bf16 v[136:139], a[76:79], a[156:159], v[136:139]
    v_exp_f32 v151, v151
    v_cvt_pk_bf16_f32 v169, v146, v147
    v_mfma_f32_16x16x32_bf16 v[132:135], a[80:83], a[128:131], 0
    ds_read_b64_tr_b16 a[104:105], v190 offset:24576
    v_cvt_pk_bf16_f32 v170, v148, v149
    v_mfma_f32_16x16x32_bf16 v[132:135], a[84:87], a[132:135], v[132:135]
    s_add_u32 m0, s30, 16384
    s_nop 0
    buffer_load_dwordx4 v196, s[16:19], s28 offen offset:0 nt lds
    v_mfma_f32_16x16x32_bf16 v[132:135], a[88:91], a[136:139], v[132:135]
    ds_read_b64_tr_b16 a[106:107], v190 offset:28672
    v_cvt_pk_bf16_f32 v171, v150, v151
    v_mfma_f32_16x16x32_bf16 v[132:135], a[92:95], a[140:143], v[132:135]
    v_exp_f32 v152, v152
    v_mfma_f32_16x16x32_bf16 v[140:143], a[80:83], a[144:147], 0
    ds_read_b64_tr_b16 a[108:109], v191 offset:24576
    v_mfma_f32_16x16x32_bf16 v[140:143], a[84:87], a[148:151], v[140:143]
    v_exp_f32 v153, v153
    v_mfma_f32_16x16x32_bf16 v[140:143], a[88:91], a[152:155], v[140:143]
    ds_read_b64_tr_b16 a[110:111], v191 offset:28672
    v_cvt_pk_bf16_f32 v172, v152, v153
    v_mfma_f32_16x16x32_bf16 v[140:143], a[92:95], a[156:159], v[140:143]
    v_exp_f32 v154, v154
    v_mfma_f32_16x16x32_bf16 v[176:179], v[242:245], v[160:163], v[176:179]
    ds_read_b64_tr_b16 a[112:113], v192 offset:24576
    v_mfma_f32_16x16x32_bf16 v[184:187], v[242:245], v[164:167], v[184:187]
    ds_read_b64_tr_b16 a[114:115], v192 offset:28672
    s_waitcnt lgkmcnt(6)
    v_mfma_f32_16x16x32_bf16 v[0:3], a[96:99], v[160:163], v[0:3]
    v_exp_f32 v155, v155
    v_mfma_f32_16x16x32_bf16 v[32:35], a[96:99], v[164:167], v[32:35]
    ds_read_b64_tr_b16 a[116:117], v193 offset:24576
    v_cvt_pk_bf16_f32 v173, v154, v155
    v_mfma_f32_16x16x32_bf16 v[4:7], a[100:103], v[160:163], v[4:7]
    ds_read_b64_tr_b16 a[118:119], v193 offset:28672
    v_mfma_f32_16x16x32_bf16 v[36:39], a[100:103], v[164:167], v[36:39]
    s_waitcnt lgkmcnt(4)
    v_mfma_f32_16x16x32_bf16 v[8:11], a[104:107], v[160:163], v[8:11]
    ds_read_b64_tr_b16 a[120:121], v194 offset:24576
    v_mfma_f32_16x16x32_bf16 v[40:43], a[104:107], v[164:167], v[40:43]
    ds_read_b64_tr_b16 a[122:123], v194 offset:28672
    v_mfma_f32_16x16x32_bf16 v[12:15], a[108:111], v[160:163], v[12:15]
    v_exp_f32 v156, v156
    v_mfma_f32_16x16x32_bf16 v[44:47], a[108:111], v[164:167], v[44:47]
    ds_read_b64_tr_b16 a[124:125], v195 offset:24576
    s_waitcnt lgkmcnt(3)
    v_mfma_f32_16x16x32_bf16 v[16:19], a[112:115], v[160:163], v[16:19]
    ds_read_b64_tr_b16 a[126:127], v195 offset:28672
    v_mfma_f32_16x16x32_bf16 v[48:51], a[112:115], v[164:167], v[48:51]
    v_exp_f32 v157, v157
    v_mfma_f32_16x16x32_bf16 v[20:23], a[116:119], v[160:163], v[20:23]
    buffer_load_dwordx4 v197, s[16:19], s28 offen offset:1024 nt lds
    v_cvt_pk_bf16_f32 v174, v156, v157
    v_mfma_f32_16x16x32_bf16 v[52:55], a[116:119], v[164:167], v[52:55]
    s_waitcnt lgkmcnt(0)
    v_mfma_f32_16x16x32_bf16 v[24:27], a[120:123], v[160:163], v[24:27]
    v_exp_f32 v158, v158
    v_mfma_f32_16x16x32_bf16 v[56:59], a[120:123], v[164:167], v[56:59]
    v_exp_f32 v159, v159
    v_mfma_f32_16x16x32_bf16 v[28:31], a[124:127], v[160:163], v[28:31]
    v_cvt_pk_bf16_f32 v175, v158, v159
    v_mfma_f32_16x16x32_bf16 v[60:63], a[124:127], v[164:167], v[60:63]
    v_mfma_f32_16x16x32_bf16 v[144:147], a[64:67], a[160:163], 0
    v_exp_f32 v128, v128
    v_mfma_f32_16x16x32_bf16 v[144:147], a[68:71], a[164:167], v[144:147]
    v_exp_f32 v129, v129
    v_mfma_f32_16x16x32_bf16 v[144:147], a[72:75], a[168:171], v[144:147]
    v_exp_f32 v130, v130
    v_mfma_f32_16x16x32_bf16 v[144:147], a[76:79], a[172:175], v[144:147]
    v_exp_f32 v131, v131
    v_mfma_f32_16x16x32_bf16 v[152:155], a[64:67], a[176:179], 0
    v_exp_f32 v132, v132
    v_cvt_pk_bf16_f32 v160, v128, v129
    v_mfma_f32_16x16x32_bf16 v[152:155], a[68:71], a[180:183], v[152:155]
    v_exp_f32 v133, v133
    v_mfma_f32_16x16x32_bf16 v[152:155], a[72:75], a[184:187], v[152:155]
    ds_read_b128 a[64:67], v180 offset:40960
    v_cvt_pk_bf16_f32 v161, v130, v131
    v_mfma_f32_16x16x32_bf16 v[152:155], a[76:79], a[188:191], v[152:155]
    v_exp_f32 v134, v134
    v_mfma_f32_16x16x32_bf16 v[148:151], a[80:83], a[160:163], 0
    ds_read_b128 a[68:71], v181 offset:40960
    v_cvt_pk_bf16_f32 v162, v132, v133
    v_mfma_f32_16x16x32_bf16 v[148:151], a[84:87], a[164:167], v[148:151]
    buffer_load_dwordx4 v198, s[16:19], s28 offen offset:2048 nt lds
    v_mfma_f32_16x16x32_bf16 v[148:151], a[88:91], a[168:171], v[148:151]
    ds_read_b128 a[72:75], v182 offset:40960
    v_mfma_f32_16x16x32_bf16 v[148:151], a[92:95], a[172:175], v[148:151]
    v_exp_f32 v135, v135
    v_mfma_f32_16x16x32_bf16 v[156:159], a[80:83], a[176:179], 0
    ds_read_b128 a[76:79], v183 offset:40960
    v_cvt_pk_bf16_f32 v163, v134, v135
    v_mfma_f32_16x16x32_bf16 v[156:159], a[84:87], a[180:183], v[156:159]
    v_exp_f32 v136, v136
    v_mfma_f32_16x16x32_bf16 v[156:159], a[88:91], a[184:187], v[156:159]
    ds_read_b128 a[80:83], v180 offset:45056
    v_mfma_f32_16x16x32_bf16 v[156:159], a[92:95], a[188:191], v[156:159]
    v_exp_f32 v137, v137
    v_mfma_f32_16x16x32_bf16 v[222:225], v[242:245], v[168:171], v[222:225]
    ds_read_b128 a[84:87], v181 offset:45056
    v_cvt_pk_bf16_f32 v164, v136, v137
    v_mfma_f32_16x16x32_bf16 v[246:249], v[242:245], v[172:175], v[246:249]
    v_exp_f32 v138, v138
    v_mfma_f32_16x16x32_bf16 v[64:67], a[96:99], v[168:171], v[64:67]
    ds_read_b128 a[88:91], v182 offset:45056
    v_mfma_f32_16x16x32_bf16 v[96:99], a[96:99], v[172:175], v[96:99]
    v_exp_f32 v139, v139
    v_mfma_f32_16x16x32_bf16 v[68:71], a[100:103], v[168:171], v[68:71]
    ds_read_b128 a[92:95], v183 offset:45056
    v_cvt_pk_bf16_f32 v165, v138, v139
    v_mfma_f32_16x16x32_bf16 v[100:103], a[100:103], v[172:175], v[100:103]
    v_exp_f32 v140, v140
    v_mfma_f32_16x16x32_bf16 v[72:75], a[104:107], v[168:171], v[72:75]
    v_exp_f32 v141, v141
    v_mfma_f32_16x16x32_bf16 v[104:107], a[104:107], v[172:175], v[104:107]
    v_exp_f32 v142, v142
    v_mfma_f32_16x16x32_bf16 v[76:79], a[108:111], v[168:171], v[76:79]
    v_exp_f32 v143, v143
    v_mfma_f32_16x16x32_bf16 v[108:111], a[108:111], v[172:175], v[108:111]
    v_cvt_pk_bf16_f32 v166, v140, v141
    v_cvt_pk_bf16_f32 v167, v142, v143
    v_mfma_f32_16x16x32_bf16 v[80:83], a[112:115], v[168:171], v[80:83]
    v_mfma_f32_16x16x32_bf16 v[112:115], a[112:115], v[172:175], v[112:115]
    buffer_load_dwordx4 v199, s[16:19], s28 offen offset:3072 nt lds
    s_add_u32 s28, s28, 16384
    v_mfma_f32_16x16x32_bf16 v[84:87], a[116:119], v[168:171], v[84:87]
    v_mfma_f32_16x16x32_bf16 v[116:119], a[116:119], v[172:175], v[116:119]
    v_mfma_f32_16x16x32_bf16 v[88:91], a[120:123], v[168:171], v[88:91]
    v_mfma_f32_16x16x32_bf16 v[120:123], a[120:123], v[172:175], v[120:123]
    v_mfma_f32_16x16x32_bf16 v[92:95], a[124:127], v[168:171], v[92:95]
    v_mfma_f32_16x16x32_bf16 v[124:127], a[124:127], v[172:175], v[124:127]
    s_waitcnt lgkmcnt(0)
    v_mfma_f32_16x16x32_bf16 v[128:131], a[64:67], a[128:131], 0
    s_waitcnt vmcnt(16)
    s_barrier
    ds_read_b64_tr_b16 a[96:97], v188 offset:32768
    v_mfma_f32_16x16x32_bf16 v[128:131], a[68:71], a[132:135], v[128:131]
    v_exp_f32 v144, v144
    v_mfma_f32_16x16x32_bf16 v[128:131], a[72:75], a[136:139], v[128:131]
    ds_read_b64_tr_b16 a[98:99], v188 offset:36864
    v_exp_f32 v145, v145
    v_mfma_f32_16x16x32_bf16 v[128:131], a[76:79], a[140:143], v[128:131]
    v_exp_f32 v146, v146
    v_mfma_f32_16x16x32_bf16 v[136:139], a[64:67], a[144:147], 0
    ds_read_b64_tr_b16 a[100:101], v189 offset:32768
    v_exp_f32 v147, v147
    v_mfma_f32_16x16x32_bf16 v[136:139], a[68:71], a[148:151], v[136:139]
    v_exp_f32 v148, v148
    v_cvt_pk_bf16_f32 v168, v144, v145
    v_mfma_f32_16x16x32_bf16 v[136:139], a[72:75], a[152:155], v[136:139]
    ds_read_b64_tr_b16 a[102:103], v189 offset:36864
    v_exp_f32 v149, v149
    v_mfma_f32_16x16x32_bf16 v[136:139], a[76:79], a[156:159], v[136:139]
    v_exp_f32 v150, v150
    v_cvt_pk_bf16_f32 v169, v146, v147
    v_mfma_f32_16x16x32_bf16 v[132:135], a[80:83], a[128:131], 0
    ds_read_b64_tr_b16 a[104:105], v190 offset:32768
    v_exp_f32 v151, v151
    v_mfma_f32_16x16x32_bf16 v[132:135], a[84:87], a[132:135], v[132:135]
    s_add_u32 m0, s30, 81920
    s_nop 0
    buffer_load_dwordx4 v200, s[20:23], s29 offen offset:0 nt lds
    v_mfma_f32_16x16x32_bf16 v[132:135], a[88:91], a[136:139], v[132:135]
    ds_read_b64_tr_b16 a[106:107], v190 offset:36864
    v_cvt_pk_bf16_f32 v170, v148, v149
    v_mfma_f32_16x16x32_bf16 v[132:135], a[92:95], a[140:143], v[132:135]
    v_exp_f32 v152, v152
    v_cvt_pk_bf16_f32 v171, v150, v151
    v_mfma_f32_16x16x32_bf16 v[140:143], a[80:83], a[144:147], 0
    ds_read_b64_tr_b16 a[108:109], v191 offset:32768
    v_mfma_f32_16x16x32_bf16 v[140:143], a[84:87], a[148:151], v[140:143]
    v_exp_f32 v153, v153
    v_mfma_f32_16x16x32_bf16 v[140:143], a[88:91], a[152:155], v[140:143]
    ds_read_b64_tr_b16 a[110:111], v191 offset:36864
    v_cvt_pk_bf16_f32 v172, v152, v153
    v_mfma_f32_16x16x32_bf16 v[140:143], a[92:95], a[156:159], v[140:143]
    v_exp_f32 v154, v154
    v_mfma_f32_16x16x32_bf16 v[176:179], v[242:245], v[160:163], v[176:179]
    ds_read_b64_tr_b16 a[112:113], v192 offset:32768
    v_mfma_f32_16x16x32_bf16 v[184:187], v[242:245], v[164:167], v[184:187]
    ds_read_b64_tr_b16 a[114:115], v192 offset:36864
    s_waitcnt lgkmcnt(6)
    v_mfma_f32_16x16x32_bf16 v[0:3], a[96:99], v[160:163], v[0:3]
    v_exp_f32 v155, v155
    v_mfma_f32_16x16x32_bf16 v[32:35], a[96:99], v[164:167], v[32:35]
    ds_read_b64_tr_b16 a[116:117], v193 offset:32768
    v_cvt_pk_bf16_f32 v173, v154, v155
    v_mfma_f32_16x16x32_bf16 v[4:7], a[100:103], v[160:163], v[4:7]
    ds_read_b64_tr_b16 a[118:119], v193 offset:36864
    v_mfma_f32_16x16x32_bf16 v[36:39], a[100:103], v[164:167], v[36:39]
    s_waitcnt lgkmcnt(4)
    v_mfma_f32_16x16x32_bf16 v[8:11], a[104:107], v[160:163], v[8:11]
    ds_read_b64_tr_b16 a[120:121], v194 offset:32768
    v_mfma_f32_16x16x32_bf16 v[40:43], a[104:107], v[164:167], v[40:43]
    ds_read_b64_tr_b16 a[122:123], v194 offset:36864
    v_mfma_f32_16x16x32_bf16 v[12:15], a[108:111], v[160:163], v[12:15]
    v_exp_f32 v156, v156
    v_mfma_f32_16x16x32_bf16 v[44:47], a[108:111], v[164:167], v[44:47]
    ds_read_b64_tr_b16 a[124:125], v195 offset:32768
    s_waitcnt lgkmcnt(3)
    v_mfma_f32_16x16x32_bf16 v[16:19], a[112:115], v[160:163], v[16:19]
    ds_read_b64_tr_b16 a[126:127], v195 offset:36864
    v_mfma_f32_16x16x32_bf16 v[48:51], a[112:115], v[164:167], v[48:51]
    v_exp_f32 v157, v157
    v_mfma_f32_16x16x32_bf16 v[20:23], a[116:119], v[160:163], v[20:23]
    buffer_load_dwordx4 v201, s[20:23], s29 offen offset:1024 nt lds
    v_cvt_pk_bf16_f32 v174, v156, v157
    v_mfma_f32_16x16x32_bf16 v[52:55], a[116:119], v[164:167], v[52:55]
    s_waitcnt lgkmcnt(0)
    v_mfma_f32_16x16x32_bf16 v[24:27], a[120:123], v[160:163], v[24:27]
    v_exp_f32 v158, v158
    v_mfma_f32_16x16x32_bf16 v[56:59], a[120:123], v[164:167], v[56:59]
    v_exp_f32 v159, v159
    v_mfma_f32_16x16x32_bf16 v[28:31], a[124:127], v[160:163], v[28:31]
    v_cvt_pk_bf16_f32 v175, v158, v159
    v_mfma_f32_16x16x32_bf16 v[60:63], a[124:127], v[164:167], v[60:63]
    v_mfma_f32_16x16x32_bf16 v[144:147], a[64:67], a[160:163], 0
    v_exp_f32 v128, v128
    v_mfma_f32_16x16x32_bf16 v[144:147], a[68:71], a[164:167], v[144:147]
    v_exp_f32 v129, v129
    v_mfma_f32_16x16x32_bf16 v[144:147], a[72:75], a[168:171], v[144:147]
    v_exp_f32 v130, v130
    v_mfma_f32_16x16x32_bf16 v[144:147], a[76:79], a[172:175], v[144:147]
    v_exp_f32 v131, v131
    v_mfma_f32_16x16x32_bf16 v[152:155], a[64:67], a[176:179], 0
    v_exp_f32 v132, v132
    v_cvt_pk_bf16_f32 v160, v128, v129
    v_mfma_f32_16x16x32_bf16 v[152:155], a[68:71], a[180:183], v[152:155]
    v_exp_f32 v133, v133
    v_mfma_f32_16x16x32_bf16 v[152:155], a[72:75], a[184:187], v[152:155]
    ds_read_b128 a[64:67], v180 offset:49152
    v_cvt_pk_bf16_f32 v161, v130, v131
    v_mfma_f32_16x16x32_bf16 v[152:155], a[76:79], a[188:191], v[152:155]
    v_exp_f32 v134, v134
    v_mfma_f32_16x16x32_bf16 v[148:151], a[80:83], a[160:163], 0
    ds_read_b128 a[68:71], v181 offset:49152
    v_cvt_pk_bf16_f32 v162, v132, v133
    v_mfma_f32_16x16x32_bf16 v[148:151], a[84:87], a[164:167], v[148:151]
    buffer_load_dwordx4 v200, s[20:23], s29 offen offset:2048 nt lds
    v_mfma_f32_16x16x32_bf16 v[148:151], a[88:91], a[168:171], v[148:151]
    ds_read_b128 a[72:75], v182 offset:49152
    v_mfma_f32_16x16x32_bf16 v[148:151], a[92:95], a[172:175], v[148:151]
    v_exp_f32 v135, v135
    v_mfma_f32_16x16x32_bf16 v[156:159], a[80:83], a[176:179], 0
    ds_read_b128 a[76:79], v183 offset:49152
    v_cvt_pk_bf16_f32 v163, v134, v135
    v_mfma_f32_16x16x32_bf16 v[156:159], a[84:87], a[180:183], v[156:159]
    v_exp_f32 v136, v136
    v_mfma_f32_16x16x32_bf16 v[156:159], a[88:91], a[184:187], v[156:159]
    ds_read_b128 a[80:83], v180 offset:53248
    v_mfma_f32_16x16x32_bf16 v[156:159], a[92:95], a[188:191], v[156:159]
    v_exp_f32 v137, v137
    v_mfma_f32_16x16x32_bf16 v[222:225], v[242:245], v[168:171], v[222:225]
    ds_read_b128 a[84:87], v181 offset:53248
    v_cvt_pk_bf16_f32 v164, v136, v137
    v_mfma_f32_16x16x32_bf16 v[246:249], v[242:245], v[172:175], v[246:249]
    v_exp_f32 v138, v138
    v_mfma_f32_16x16x32_bf16 v[64:67], a[96:99], v[168:171], v[64:67]
    ds_read_b128 a[88:91], v182 offset:53248
    v_mfma_f32_16x16x32_bf16 v[96:99], a[96:99], v[172:175], v[96:99]
    v_exp_f32 v139, v139
    v_mfma_f32_16x16x32_bf16 v[68:71], a[100:103], v[168:171], v[68:71]
    ds_read_b128 a[92:95], v183 offset:53248
    v_cvt_pk_bf16_f32 v165, v138, v139
    v_mfma_f32_16x16x32_bf16 v[100:103], a[100:103], v[172:175], v[100:103]
    v_exp_f32 v140, v140
    v_mfma_f32_16x16x32_bf16 v[72:75], a[104:107], v[168:171], v[72:75]
    v_exp_f32 v141, v141
    v_mfma_f32_16x16x32_bf16 v[104:107], a[104:107], v[172:175], v[104:107]
    v_exp_f32 v142, v142
    v_mfma_f32_16x16x32_bf16 v[76:79], a[108:111], v[168:171], v[76:79]
    v_exp_f32 v143, v143
    v_mfma_f32_16x16x32_bf16 v[108:111], a[108:111], v[172:175], v[108:111]
    v_cvt_pk_bf16_f32 v166, v140, v141
    v_cvt_pk_bf16_f32 v167, v142, v143
    v_mfma_f32_16x16x32_bf16 v[80:83], a[112:115], v[168:171], v[80:83]
    v_mfma_f32_16x16x32_bf16 v[112:115], a[112:115], v[172:175], v[112:115]
    buffer_load_dwordx4 v201, s[20:23], s29 offen offset:3072 nt lds
    s_add_u32 s29, s29, 16384
    v_mfma_f32_16x16x32_bf16 v[84:87], a[116:119], v[168:171], v[84:87]
    v_mfma_f32_16x16x32_bf16 v[116:119], a[116:119], v[172:175], v[116:119]
    v_mfma_f32_16x16x32_bf16 v[88:91], a[120:123], v[168:171], v[88:91]
    v_mfma_f32_16x16x32_bf16 v[120:123], a[120:123], v[172:175], v[120:123]
    v_mfma_f32_16x16x32_bf16 v[92:95], a[124:127], v[168:171], v[92:95]
    v_mfma_f32_16x16x32_bf16 v[124:127], a[124:127], v[172:175], v[124:127]
    s_waitcnt lgkmcnt(0)
    v_mfma_f32_16x16x32_bf16 v[128:131], a[64:67], a[128:131], 0
    ds_read_b64_tr_b16 a[96:97], v188 offset:40960
    v_exp_f32 v144, v144
    v_mfma_f32_16x16x32_bf16 v[128:131], a[68:71], a[132:135], v[128:131]
    v_exp_f32 v145, v145
    v_mfma_f32_16x16x32_bf16 v[128:131], a[72:75], a[136:139], v[128:131]
    ds_read_b64_tr_b16 a[98:99], v188 offset:45056
    v_exp_f32 v146, v146
    v_mfma_f32_16x16x32_bf16 v[128:131], a[76:79], a[140:143], v[128:131]
    v_exp_f32 v147, v147
    v_mfma_f32_16x16x32_bf16 v[136:139], a[64:67], a[144:147], 0
    ds_read_b64_tr_b16 a[100:101], v189 offset:40960
    v_exp_f32 v148, v148
    v_mfma_f32_16x16x32_bf16 v[136:139], a[68:71], a[148:151], v[136:139]
    v_exp_f32 v149, v149
    v_cvt_pk_bf16_f32 v168, v144, v145
    v_mfma_f32_16x16x32_bf16 v[136:139], a[72:75], a[152:155], v[136:139]
    ds_read_b64_tr_b16 a[102:103], v189 offset:45056
    v_exp_f32 v150, v150
    v_mfma_f32_16x16x32_bf16 v[136:139], a[76:79], a[156:159], v[136:139]
    v_exp_f32 v151, v151
    v_cvt_pk_bf16_f32 v169, v146, v147
    v_mfma_f32_16x16x32_bf16 v[132:135], a[80:83], a[128:131], 0
    ds_read_b64_tr_b16 a[104:105], v190 offset:40960
    v_cvt_pk_bf16_f32 v170, v148, v149
    v_mfma_f32_16x16x32_bf16 v[132:135], a[84:87], a[132:135], v[132:135]
    s_add_u32 m0, s30, 32768
    s_nop 0
    buffer_load_dwordx4 v196, s[16:19], s28 offen offset:0 nt lds
    v_mfma_f32_16x16x32_bf16 v[132:135], a[88:91], a[136:139], v[132:135]
    ds_read_b64_tr_b16 a[106:107], v190 offset:45056
    v_cvt_pk_bf16_f32 v171, v150, v151
    v_mfma_f32_16x16x32_bf16 v[132:135], a[92:95], a[140:143], v[132:135]
    v_exp_f32 v152, v152
    v_mfma_f32_16x16x32_bf16 v[140:143], a[80:83], a[144:147], 0
    ds_read_b64_tr_b16 a[108:109], v191 offset:40960
    v_mfma_f32_16x16x32_bf16 v[140:143], a[84:87], a[148:151], v[140:143]
    v_exp_f32 v153, v153
    v_mfma_f32_16x16x32_bf16 v[140:143], a[88:91], a[152:155], v[140:143]
    ds_read_b64_tr_b16 a[110:111], v191 offset:45056
    v_cvt_pk_bf16_f32 v172, v152, v153
    v_mfma_f32_16x16x32_bf16 v[140:143], a[92:95], a[156:159], v[140:143]
    v_exp_f32 v154, v154
    v_mfma_f32_16x16x32_bf16 v[176:179], v[242:245], v[160:163], v[176:179]
    ds_read_b64_tr_b16 a[112:113], v192 offset:40960
    v_mfma_f32_16x16x32_bf16 v[184:187], v[242:245], v[164:167], v[184:187]
    ds_read_b64_tr_b16 a[114:115], v192 offset:45056
    s_waitcnt lgkmcnt(6)
    v_mfma_f32_16x16x32_bf16 v[0:3], a[96:99], v[160:163], v[0:3]
    v_exp_f32 v155, v155
    v_mfma_f32_16x16x32_bf16 v[32:35], a[96:99], v[164:167], v[32:35]
    ds_read_b64_tr_b16 a[116:117], v193 offset:40960
    v_cvt_pk_bf16_f32 v173, v154, v155
    v_mfma_f32_16x16x32_bf16 v[4:7], a[100:103], v[160:163], v[4:7]
    ds_read_b64_tr_b16 a[118:119], v193 offset:45056
    v_mfma_f32_16x16x32_bf16 v[36:39], a[100:103], v[164:167], v[36:39]
    s_waitcnt lgkmcnt(4)
    v_mfma_f32_16x16x32_bf16 v[8:11], a[104:107], v[160:163], v[8:11]
    ds_read_b64_tr_b16 a[120:121], v194 offset:40960
    v_mfma_f32_16x16x32_bf16 v[40:43], a[104:107], v[164:167], v[40:43]
    ds_read_b64_tr_b16 a[122:123], v194 offset:45056
    v_mfma_f32_16x16x32_bf16 v[12:15], a[108:111], v[160:163], v[12:15]
    v_exp_f32 v156, v156
    v_mfma_f32_16x16x32_bf16 v[44:47], a[108:111], v[164:167], v[44:47]
    ds_read_b64_tr_b16 a[124:125], v195 offset:40960
    s_waitcnt lgkmcnt(3)
    v_mfma_f32_16x16x32_bf16 v[16:19], a[112:115], v[160:163], v[16:19]
    ds_read_b64_tr_b16 a[126:127], v195 offset:45056
    v_mfma_f32_16x16x32_bf16 v[48:51], a[112:115], v[164:167], v[48:51]
    v_exp_f32 v157, v157
    v_mfma_f32_16x16x32_bf16 v[20:23], a[116:119], v[160:163], v[20:23]
    buffer_load_dwordx4 v197, s[16:19], s28 offen offset:1024 nt lds
    v_cvt_pk_bf16_f32 v174, v156, v157
    v_mfma_f32_16x16x32_bf16 v[52:55], a[116:119], v[164:167], v[52:55]
    s_waitcnt lgkmcnt(0)
    v_mfma_f32_16x16x32_bf16 v[24:27], a[120:123], v[160:163], v[24:27]
    v_exp_f32 v158, v158
    v_mfma_f32_16x16x32_bf16 v[56:59], a[120:123], v[164:167], v[56:59]
    v_exp_f32 v159, v159
    v_mfma_f32_16x16x32_bf16 v[28:31], a[124:127], v[160:163], v[28:31]
    v_cvt_pk_bf16_f32 v175, v158, v159
    v_mfma_f32_16x16x32_bf16 v[60:63], a[124:127], v[164:167], v[60:63]
    v_mfma_f32_16x16x32_bf16 v[144:147], a[64:67], a[160:163], 0
    v_exp_f32 v128, v128
    v_mfma_f32_16x16x32_bf16 v[144:147], a[68:71], a[164:167], v[144:147]
    v_exp_f32 v129, v129
    v_mfma_f32_16x16x32_bf16 v[144:147], a[72:75], a[168:171], v[144:147]
    v_exp_f32 v130, v130
    v_mfma_f32_16x16x32_bf16 v[144:147], a[76:79], a[172:175], v[144:147]
    v_exp_f32 v131, v131
    v_mfma_f32_16x16x32_bf16 v[152:155], a[64:67], a[176:179], 0
    v_exp_f32 v132, v132
    v_cvt_pk_bf16_f32 v160, v128, v129
    v_mfma_f32_16x16x32_bf16 v[152:155], a[68:71], a[180:183], v[152:155]
    v_exp_f32 v133, v133
    v_mfma_f32_16x16x32_bf16 v[152:155], a[72:75], a[184:187], v[152:155]
    ds_read_b128 a[64:67], v180 offset:57344
    v_cvt_pk_bf16_f32 v161, v130, v131
    v_mfma_f32_16x16x32_bf16 v[152:155], a[76:79], a[188:191], v[152:155]
    v_exp_f32 v134, v134
    v_mfma_f32_16x16x32_bf16 v[148:151], a[80:83], a[160:163], 0
    ds_read_b128 a[68:71], v181 offset:57344
    v_cvt_pk_bf16_f32 v162, v132, v133
    v_mfma_f32_16x16x32_bf16 v[148:151], a[84:87], a[164:167], v[148:151]
    buffer_load_dwordx4 v198, s[16:19], s28 offen offset:2048 nt lds
    v_mfma_f32_16x16x32_bf16 v[148:151], a[88:91], a[168:171], v[148:151]
    ds_read_b128 a[72:75], v182 offset:57344
    v_mfma_f32_16x16x32_bf16 v[148:151], a[92:95], a[172:175], v[148:151]
    v_exp_f32 v135, v135
    v_mfma_f32_16x16x32_bf16 v[156:159], a[80:83], a[176:179], 0
    ds_read_b128 a[76:79], v183 offset:57344
    v_cvt_pk_bf16_f32 v163, v134, v135
    v_mfma_f32_16x16x32_bf16 v[156:159], a[84:87], a[180:183], v[156:159]
    v_exp_f32 v136, v136
    v_mfma_f32_16x16x32_bf16 v[156:159], a[88:91], a[184:187], v[156:159]
    ds_read_b128 a[80:83], v180 offset:61440
    v_mfma_f32_16x16x32_bf16 v[156:159], a[92:95], a[188:191], v[156:159]
    v_exp_f32 v137, v137
    v_mfma_f32_16x16x32_bf16 v[222:225], v[242:245], v[168:171], v[222:225]
    ds_read_b128 a[84:87], v181 offset:61440
    v_cvt_pk_bf16_f32 v164, v136, v137
    v_mfma_f32_16x16x32_bf16 v[246:249], v[242:245], v[172:175], v[246:249]
    v_exp_f32 v138, v138
    v_mfma_f32_16x16x32_bf16 v[64:67], a[96:99], v[168:171], v[64:67]
    ds_read_b128 a[88:91], v182 offset:61440
    v_mfma_f32_16x16x32_bf16 v[96:99], a[96:99], v[172:175], v[96:99]
    v_exp_f32 v139, v139
    v_mfma_f32_16x16x32_bf16 v[68:71], a[100:103], v[168:171], v[68:71]
    ds_read_b128 a[92:95], v183 offset:61440
    v_cvt_pk_bf16_f32 v165, v138, v139
    v_mfma_f32_16x16x32_bf16 v[100:103], a[100:103], v[172:175], v[100:103]
    v_exp_f32 v140, v140
    v_mfma_f32_16x16x32_bf16 v[72:75], a[104:107], v[168:171], v[72:75]
    v_exp_f32 v141, v141
    v_mfma_f32_16x16x32_bf16 v[104:107], a[104:107], v[172:175], v[104:107]
    v_exp_f32 v142, v142
    v_mfma_f32_16x16x32_bf16 v[76:79], a[108:111], v[168:171], v[76:79]
    v_exp_f32 v143, v143
    v_mfma_f32_16x16x32_bf16 v[108:111], a[108:111], v[172:175], v[108:111]
    v_cvt_pk_bf16_f32 v166, v140, v141
    v_cvt_pk_bf16_f32 v167, v142, v143
    v_mfma_f32_16x16x32_bf16 v[80:83], a[112:115], v[168:171], v[80:83]
    v_mfma_f32_16x16x32_bf16 v[112:115], a[112:115], v[172:175], v[112:115]
    buffer_load_dwordx4 v199, s[16:19], s28 offen offset:3072 nt lds
    s_add_u32 s28, s28, 16384
    v_mfma_f32_16x16x32_bf16 v[84:87], a[116:119], v[168:171], v[84:87]
    v_mfma_f32_16x16x32_bf16 v[116:119], a[116:119], v[172:175], v[116:119]
    v_mfma_f32_16x16x32_bf16 v[88:91], a[120:123], v[168:171], v[88:91]
    v_mfma_f32_16x16x32_bf16 v[120:123], a[120:123], v[172:175], v[120:123]
    v_mfma_f32_16x16x32_bf16 v[92:95], a[124:127], v[168:171], v[92:95]
    v_mfma_f32_16x16x32_bf16 v[124:127], a[124:127], v[172:175], v[124:127]
    s_waitcnt lgkmcnt(0)
    v_mfma_f32_16x16x32_bf16 v[128:131], a[64:67], a[128:131], 0
    s_waitcnt vmcnt(16)
    s_barrier
    ds_read_b64_tr_b16 a[96:97], v188 offset:49152
    v_mfma_f32_16x16x32_bf16 v[128:131], a[68:71], a[132:135], v[128:131]
    v_exp_f32 v144, v144
    v_mfma_f32_16x16x32_bf16 v[128:131], a[72:75], a[136:139], v[128:131]
    ds_read_b64_tr_b16 a[98:99], v188 offset:53248
    v_exp_f32 v145, v145
    v_mfma_f32_16x16x32_bf16 v[128:131], a[76:79], a[140:143], v[128:131]
    v_exp_f32 v146, v146
    v_mfma_f32_16x16x32_bf16 v[136:139], a[64:67], a[144:147], 0
    ds_read_b64_tr_b16 a[100:101], v189 offset:49152
    v_exp_f32 v147, v147
    v_mfma_f32_16x16x32_bf16 v[136:139], a[68:71], a[148:151], v[136:139]
    v_exp_f32 v148, v148
    v_cvt_pk_bf16_f32 v168, v144, v145
    v_mfma_f32_16x16x32_bf16 v[136:139], a[72:75], a[152:155], v[136:139]
    ds_read_b64_tr_b16 a[102:103], v189 offset:53248
    v_exp_f32 v149, v149
    v_mfma_f32_16x16x32_bf16 v[136:139], a[76:79], a[156:159], v[136:139]
    v_exp_f32 v150, v150
    v_cvt_pk_bf16_f32 v169, v146, v147
    v_mfma_f32_16x16x32_bf16 v[132:135], a[80:83], a[128:131], 0
    ds_read_b64_tr_b16 a[104:105], v190 offset:49152
    v_exp_f32 v151, v151
    v_mfma_f32_16x16x32_bf16 v[132:135], a[84:87], a[132:135], v[132:135]
    s_add_u32 m0, s30, 98304
    s_nop 0
    buffer_load_dwordx4 v200, s[20:23], s29 offen offset:0 nt lds
    v_mfma_f32_16x16x32_bf16 v[132:135], a[88:91], a[136:139], v[132:135]
    ds_read_b64_tr_b16 a[106:107], v190 offset:53248
    v_cvt_pk_bf16_f32 v170, v148, v149
    v_mfma_f32_16x16x32_bf16 v[132:135], a[92:95], a[140:143], v[132:135]
    v_exp_f32 v152, v152
    v_cvt_pk_bf16_f32 v171, v150, v151
    v_mfma_f32_16x16x32_bf16 v[140:143], a[80:83], a[144:147], 0
    ds_read_b64_tr_b16 a[108:109], v191 offset:49152
    v_mfma_f32_16x16x32_bf16 v[140:143], a[84:87], a[148:151], v[140:143]
    v_exp_f32 v153, v153
    v_mfma_f32_16x16x32_bf16 v[140:143], a[88:91], a[152:155], v[140:143]
    ds_read_b64_tr_b16 a[110:111], v191 offset:53248
    v_cvt_pk_bf16_f32 v172, v152, v153
    v_mfma_f32_16x16x32_bf16 v[140:143], a[92:95], a[156:159], v[140:143]
    v_exp_f32 v154, v154
    v_mfma_f32_16x16x32_bf16 v[176:179], v[242:245], v[160:163], v[176:179]
    ds_read_b64_tr_b16 a[112:113], v192 offset:49152
    v_mfma_f32_16x16x32_bf16 v[184:187], v[242:245], v[164:167], v[184:187]
    ds_read_b64_tr_b16 a[114:115], v192 offset:53248
    s_waitcnt lgkmcnt(6)
    v_mfma_f32_16x16x32_bf16 v[0:3], a[96:99], v[160:163], v[0:3]
    v_exp_f32 v155, v155
    v_mfma_f32_16x16x32_bf16 v[32:35], a[96:99], v[164:167], v[32:35]
    ds_read_b64_tr_b16 a[116:117], v193 offset:49152
    v_cvt_pk_bf16_f32 v173, v154, v155
    v_mfma_f32_16x16x32_bf16 v[4:7], a[100:103], v[160:163], v[4:7]
    ds_read_b64_tr_b16 a[118:119], v193 offset:53248
    v_mfma_f32_16x16x32_bf16 v[36:39], a[100:103], v[164:167], v[36:39]
    s_waitcnt lgkmcnt(4)
    v_mfma_f32_16x16x32_bf16 v[8:11], a[104:107], v[160:163], v[8:11]
    ds_read_b64_tr_b16 a[120:121], v194 offset:49152
    v_mfma_f32_16x16x32_bf16 v[40:43], a[104:107], v[164:167], v[40:43]
    ds_read_b64_tr_b16 a[122:123], v194 offset:53248
    v_mfma_f32_16x16x32_bf16 v[12:15], a[108:111], v[160:163], v[12:15]
    v_exp_f32 v156, v156
    v_mfma_f32_16x16x32_bf16 v[44:47], a[108:111], v[164:167], v[44:47]
    ds_read_b64_tr_b16 a[124:125], v195 offset:49152
    s_waitcnt lgkmcnt(3)
    v_mfma_f32_16x16x32_bf16 v[16:19], a[112:115], v[160:163], v[16:19]
    ds_read_b64_tr_b16 a[126:127], v195 offset:53248
    v_mfma_f32_16x16x32_bf16 v[48:51], a[112:115], v[164:167], v[48:51]
    v_exp_f32 v157, v157
    v_mfma_f32_16x16x32_bf16 v[20:23], a[116:119], v[160:163], v[20:23]
    buffer_load_dwordx4 v201, s[20:23], s29 offen offset:1024 nt lds
    v_cvt_pk_bf16_f32 v174, v156, v157
    v_mfma_f32_16x16x32_bf16 v[52:55], a[116:119], v[164:167], v[52:55]
    s_waitcnt lgkmcnt(0)
    v_mfma_f32_16x16x32_bf16 v[24:27], a[120:123], v[160:163], v[24:27]
    v_exp_f32 v158, v158
    v_mfma_f32_16x16x32_bf16 v[56:59], a[120:123], v[164:167], v[56:59]
    v_exp_f32 v159, v159
    v_mfma_f32_16x16x32_bf16 v[28:31], a[124:127], v[160:163], v[28:31]
    v_cvt_pk_bf16_f32 v175, v158, v159
    v_mfma_f32_16x16x32_bf16 v[60:63], a[124:127], v[164:167], v[60:63]
    v_mfma_f32_16x16x32_bf16 v[144:147], a[64:67], a[160:163], 0
    v_exp_f32 v128, v128
    v_mfma_f32_16x16x32_bf16 v[144:147], a[68:71], a[164:167], v[144:147]
    v_exp_f32 v129, v129
    v_mfma_f32_16x16x32_bf16 v[144:147], a[72:75], a[168:171], v[144:147]
    v_exp_f32 v130, v130
    v_mfma_f32_16x16x32_bf16 v[144:147], a[76:79], a[172:175], v[144:147]
    v_exp_f32 v131, v131
    v_mfma_f32_16x16x32_bf16 v[152:155], a[64:67], a[176:179], 0
    v_exp_f32 v132, v132
    v_cvt_pk_bf16_f32 v160, v128, v129
    v_mfma_f32_16x16x32_bf16 v[152:155], a[68:71], a[180:183], v[152:155]
    v_exp_f32 v133, v133
    v_mfma_f32_16x16x32_bf16 v[152:155], a[72:75], a[184:187], v[152:155]
    ds_read_b128 a[64:67], v180 offset:0
    v_cvt_pk_bf16_f32 v161, v130, v131
    v_mfma_f32_16x16x32_bf16 v[152:155], a[76:79], a[188:191], v[152:155]
    v_exp_f32 v134, v134
    v_mfma_f32_16x16x32_bf16 v[148:151], a[80:83], a[160:163], 0
    ds_read_b128 a[68:71], v181 offset:0
    v_cvt_pk_bf16_f32 v162, v132, v133
    v_mfma_f32_16x16x32_bf16 v[148:151], a[84:87], a[164:167], v[148:151]
    buffer_load_dwordx4 v200, s[20:23], s29 offen offset:2048 nt lds
    v_mfma_f32_16x16x32_bf16 v[148:151], a[88:91], a[168:171], v[148:151]
    ds_read_b128 a[72:75], v182 offset:0
    v_mfma_f32_16x16x32_bf16 v[148:151], a[92:95], a[172:175], v[148:151]
    v_exp_f32 v135, v135
    v_mfma_f32_16x16x32_bf16 v[156:159], a[80:83], a[176:179], 0
    ds_read_b128 a[76:79], v183 offset:0
    v_cvt_pk_bf16_f32 v163, v134, v135
    v_mfma_f32_16x16x32_bf16 v[156:159], a[84:87], a[180:183], v[156:159]
    v_exp_f32 v136, v136
    v_mfma_f32_16x16x32_bf16 v[156:159], a[88:91], a[184:187], v[156:159]
    ds_read_b128 a[80:83], v180 offset:4096
    v_mfma_f32_16x16x32_bf16 v[156:159], a[92:95], a[188:191], v[156:159]
    v_exp_f32 v137, v137
    v_mfma_f32_16x16x32_bf16 v[222:225], v[242:245], v[168:171], v[222:225]
    ds_read_b128 a[84:87], v181 offset:4096
    v_cvt_pk_bf16_f32 v164, v136, v137
    v_mfma_f32_16x16x32_bf16 v[246:249], v[242:245], v[172:175], v[246:249]
    v_exp_f32 v138, v138
    v_mfma_f32_16x16x32_bf16 v[64:67], a[96:99], v[168:171], v[64:67]
    ds_read_b128 a[88:91], v182 offset:4096
    v_mfma_f32_16x16x32_bf16 v[96:99], a[96:99], v[172:175], v[96:99]
    v_exp_f32 v139, v139
    v_mfma_f32_16x16x32_bf16 v[68:71], a[100:103], v[168:171], v[68:71]
    ds_read_b128 a[92:95], v183 offset:4096
    v_cvt_pk_bf16_f32 v165, v138, v139
    v_mfma_f32_16x16x32_bf16 v[100:103], a[100:103], v[172:175], v[100:103]
    v_exp_f32 v140, v140
    v_mfma_f32_16x16x32_bf16 v[72:75], a[104:107], v[168:171], v[72:75]
    v_exp_f32 v141, v141
    v_mfma_f32_16x16x32_bf16 v[104:107], a[104:107], v[172:175], v[104:107]
    v_exp_f32 v142, v142
    v_mfma_f32_16x16x32_bf16 v[76:79], a[108:111], v[168:171], v[76:79]
    v_exp_f32 v143, v143
    v_mfma_f32_16x16x32_bf16 v[108:111], a[108:111], v[172:175], v[108:111]
    v_cvt_pk_bf16_f32 v166, v140, v141
    v_cvt_pk_bf16_f32 v167, v142, v143
    v_mfma_f32_16x16x32_bf16 v[80:83], a[112:115], v[168:171], v[80:83]
    v_mfma_f32_16x16x32_bf16 v[112:115], a[112:115], v[172:175], v[112:115]
    buffer_load_dwordx4 v201, s[20:23], s29 offen offset:3072 nt lds
    s_add_u32 s29, s29, 16384
    v_mfma_f32_16x16x32_bf16 v[84:87], a[116:119], v[168:171], v[84:87]
    v_mfma_f32_16x16x32_bf16 v[116:119], a[116:119], v[172:175], v[116:119]
    v_mfma_f32_16x16x32_bf16 v[88:91], a[120:123], v[168:171], v[88:91]
    v_mfma_f32_16x16x32_bf16 v[120:123], a[120:123], v[172:175], v[120:123]
    v_mfma_f32_16x16x32_bf16 v[92:95], a[124:127], v[168:171], v[92:95]
    v_mfma_f32_16x16x32_bf16 v[124:127], a[124:127], v[172:175], v[124:127]
    s_waitcnt lgkmcnt(0)
    v_mfma_f32_16x16x32_bf16 v[128:131], a[64:67], a[128:131], 0
    ds_read_b64_tr_b16 a[96:97], v188 offset:57344
    v_exp_f32 v144, v144
    v_mfma_f32_16x16x32_bf16 v[128:131], a[68:71], a[132:135], v[128:131]
    v_exp_f32 v145, v145
    v_mfma_f32_16x16x32_bf16 v[128:131], a[72:75], a[136:139], v[128:131]
    ds_read_b64_tr_b16 a[98:99], v188 offset:61440
    v_exp_f32 v146, v146
    v_mfma_f32_16x16x32_bf16 v[128:131], a[76:79], a[140:143], v[128:131]
    v_exp_f32 v147, v147
    v_mfma_f32_16x16x32_bf16 v[136:139], a[64:67], a[144:147], 0
    ds_read_b64_tr_b16 a[100:101], v189 offset:57344
    v_exp_f32 v148, v148
    v_mfma_f32_16x16x32_bf16 v[136:139], a[68:71], a[148:151], v[136:139]
    v_exp_f32 v149, v149
    v_cvt_pk_bf16_f32 v168, v144, v145
    v_mfma_f32_16x16x32_bf16 v[136:139], a[72:75], a[152:155], v[136:139]
    ds_read_b64_tr_b16 a[102:103], v189 offset:61440
    v_exp_f32 v150, v150
    v_mfma_f32_16x16x32_bf16 v[136:139], a[76:79], a[156:159], v[136:139]
    v_exp_f32 v151, v151
    v_cvt_pk_bf16_f32 v169, v146, v147
    v_mfma_f32_16x16x32_bf16 v[132:135], a[80:83], a[128:131], 0
    ds_read_b64_tr_b16 a[104:105], v190 offset:57344
    v_cvt_pk_bf16_f32 v170, v148, v149
    v_mfma_f32_16x16x32_bf16 v[132:135], a[84:87], a[132:135], v[132:135]
    s_add_u32 m0, s30, 49152
    s_nop 0
    buffer_load_dwordx4 v196, s[16:19], s28 offen offset:0 nt lds
    v_mfma_f32_16x16x32_bf16 v[132:135], a[88:91], a[136:139], v[132:135]
    ds_read_b64_tr_b16 a[106:107], v190 offset:61440
    v_cvt_pk_bf16_f32 v171, v150, v151
    v_mfma_f32_16x16x32_bf16 v[132:135], a[92:95], a[140:143], v[132:135]
    v_exp_f32 v152, v152
    v_mfma_f32_16x16x32_bf16 v[140:143], a[80:83], a[144:147], 0
    ds_read_b64_tr_b16 a[108:109], v191 offset:57344
    v_mfma_f32_16x16x32_bf16 v[140:143], a[84:87], a[148:151], v[140:143]
    v_exp_f32 v153, v153
    v_mfma_f32_16x16x32_bf16 v[140:143], a[88:91], a[152:155], v[140:143]
    ds_read_b64_tr_b16 a[110:111], v191 offset:61440
    v_cvt_pk_bf16_f32 v172, v152, v153
    v_mfma_f32_16x16x32_bf16 v[140:143], a[92:95], a[156:159], v[140:143]
    v_exp_f32 v154, v154
    v_mfma_f32_16x16x32_bf16 v[176:179], v[242:245], v[160:163], v[176:179]
    ds_read_b64_tr_b16 a[112:113], v192 offset:57344
    v_mfma_f32_16x16x32_bf16 v[184:187], v[242:245], v[164:167], v[184:187]
    ds_read_b64_tr_b16 a[114:115], v192 offset:61440
    s_waitcnt lgkmcnt(6)
    v_mfma_f32_16x16x32_bf16 v[0:3], a[96:99], v[160:163], v[0:3]
    v_exp_f32 v155, v155
    v_mfma_f32_16x16x32_bf16 v[32:35], a[96:99], v[164:167], v[32:35]
    ds_read_b64_tr_b16 a[116:117], v193 offset:57344
    v_cvt_pk_bf16_f32 v173, v154, v155
    v_mfma_f32_16x16x32_bf16 v[4:7], a[100:103], v[160:163], v[4:7]
    ds_read_b64_tr_b16 a[118:119], v193 offset:61440
    v_mfma_f32_16x16x32_bf16 v[36:39], a[100:103], v[164:167], v[36:39]
    s_waitcnt lgkmcnt(4)
    v_mfma_f32_16x16x32_bf16 v[8:11], a[104:107], v[160:163], v[8:11]
    ds_read_b64_tr_b16 a[120:121], v194 offset:57344
    v_mfma_f32_16x16x32_bf16 v[40:43], a[104:107], v[164:167], v[40:43]
    ds_read_b64_tr_b16 a[122:123], v194 offset:61440
    v_mfma_f32_16x16x32_bf16 v[12:15], a[108:111], v[160:163], v[12:15]
    v_exp_f32 v156, v156
    v_mfma_f32_16x16x32_bf16 v[44:47], a[108:111], v[164:167], v[44:47]
    ds_read_b64_tr_b16 a[124:125], v195 offset:57344
    s_waitcnt lgkmcnt(3)
    v_mfma_f32_16x16x32_bf16 v[16:19], a[112:115], v[160:163], v[16:19]
    ds_read_b64_tr_b16 a[126:127], v195 offset:61440
    v_mfma_f32_16x16x32_bf16 v[48:51], a[112:115], v[164:167], v[48:51]
    v_exp_f32 v157, v157
    v_mfma_f32_16x16x32_bf16 v[20:23], a[116:119], v[160:163], v[20:23]
    buffer_load_dwordx4 v197, s[16:19], s28 offen offset:1024 nt lds
    v_cvt_pk_bf16_f32 v174, v156, v157
    v_mfma_f32_16x16x32_bf16 v[52:55], a[116:119], v[164:167], v[52:55]
    s_waitcnt lgkmcnt(0)
    v_mfma_f32_16x16x32_bf16 v[24:27], a[120:123], v[160:163], v[24:27]
    v_exp_f32 v158, v158
    v_mfma_f32_16x16x32_bf16 v[56:59], a[120:123], v[164:167], v[56:59]
    v_exp_f32 v159, v159
    v_mfma_f32_16x16x32_bf16 v[28:31], a[124:127], v[160:163], v[28:31]
    v_cvt_pk_bf16_f32 v175, v158, v159
    v_mfma_f32_16x16x32_bf16 v[60:63], a[124:127], v[164:167], v[60:63]
    v_mfma_f32_16x16x32_bf16 v[144:147], a[64:67], a[160:163], 0
    v_exp_f32 v128, v128
    v_mfma_f32_16x16x32_bf16 v[144:147], a[68:71], a[164:167], v[144:147]
    v_exp_f32 v129, v129
    v_mfma_f32_16x16x32_bf16 v[144:147], a[72:75], a[168:171], v[144:147]
    v_exp_f32 v130, v130
    v_mfma_f32_16x16x32_bf16 v[144:147], a[76:79], a[172:175], v[144:147]
    v_exp_f32 v131, v131
    v_mfma_f32_16x16x32_bf16 v[152:155], a[64:67], a[176:179], 0
    v_exp_f32 v132, v132
    v_cvt_pk_bf16_f32 v160, v128, v129
    v_mfma_f32_16x16x32_bf16 v[152:155], a[68:71], a[180:183], v[152:155]
    v_exp_f32 v133, v133
    v_mfma_f32_16x16x32_bf16 v[152:155], a[72:75], a[184:187], v[152:155]
    ds_read_b128 a[64:67], v180 offset:8192
    v_cvt_pk_bf16_f32 v161, v130, v131
    v_mfma_f32_16x16x32_bf16 v[152:155], a[76:79], a[188:191], v[152:155]
    v_exp_f32 v134, v134
    v_mfma_f32_16x16x32_bf16 v[148:151], a[80:83], a[160:163], 0
    ds_read_b128 a[68:71], v181 offset:8192
    v_cvt_pk_bf16_f32 v162, v132, v133
    v_mfma_f32_16x16x32_bf16 v[148:151], a[84:87], a[164:167], v[148:151]
    buffer_load_dwordx4 v198, s[16:19], s28 offen offset:2048 nt lds
    v_mfma_f32_16x16x32_bf16 v[148:151], a[88:91], a[168:171], v[148:151]
    ds_read_b128 a[72:75], v182 offset:8192
    v_mfma_f32_16x16x32_bf16 v[148:151], a[92:95], a[172:175], v[148:151]
    v_exp_f32 v135, v135
    v_mfma_f32_16x16x32_bf16 v[156:159], a[80:83], a[176:179], 0
    ds_read_b128 a[76:79], v183 offset:8192
    v_cvt_pk_bf16_f32 v163, v134, v135
    v_mfma_f32_16x16x32_bf16 v[156:159], a[84:87], a[180:183], v[156:159]
    v_exp_f32 v136, v136
    v_mfma_f32_16x16x32_bf16 v[156:159], a[88:91], a[184:187], v[156:159]
    ds_read_b128 a[80:83], v180 offset:12288
    v_mfma_f32_16x16x32_bf16 v[156:159], a[92:95], a[188:191], v[156:159]
    v_exp_f32 v137, v137
    v_mfma_f32_16x16x32_bf16 v[222:225], v[242:245], v[168:171], v[222:225]
    ds_read_b128 a[84:87], v181 offset:12288
    v_cvt_pk_bf16_f32 v164, v136, v137
    v_mfma_f32_16x16x32_bf16 v[246:249], v[242:245], v[172:175], v[246:249]
    v_exp_f32 v138, v138
    v_mfma_f32_16x16x32_bf16 v[64:67], a[96:99], v[168:171], v[64:67]
    ds_read_b128 a[88:91], v182 offset:12288
    v_mfma_f32_16x16x32_bf16 v[96:99], a[96:99], v[172:175], v[96:99]
    v_exp_f32 v139, v139
    v_mfma_f32_16x16x32_bf16 v[68:71], a[100:103], v[168:171], v[68:71]
    ds_read_b128 a[92:95], v183 offset:12288
    v_cvt_pk_bf16_f32 v165, v138, v139
    v_mfma_f32_16x16x32_bf16 v[100:103], a[100:103], v[172:175], v[100:103]
    v_exp_f32 v140, v140
    v_mfma_f32_16x16x32_bf16 v[72:75], a[104:107], v[168:171], v[72:75]
    v_exp_f32 v141, v141
    v_mfma_f32_16x16x32_bf16 v[104:107], a[104:107], v[172:175], v[104:107]
    v_exp_f32 v142, v142
    v_mfma_f32_16x16x32_bf16 v[76:79], a[108:111], v[168:171], v[76:79]
    v_exp_f32 v143, v143
    v_mfma_f32_16x16x32_bf16 v[108:111], a[108:111], v[172:175], v[108:111]
    v_cvt_pk_bf16_f32 v166, v140, v141
    v_cvt_pk_bf16_f32 v167, v142, v143
    v_mfma_f32_16x16x32_bf16 v[80:83], a[112:115], v[168:171], v[80:83]
    v_mfma_f32_16x16x32_bf16 v[112:115], a[112:115], v[172:175], v[112:115]
    buffer_load_dwordx4 v199, s[16:19], s28 offen offset:3072 nt lds
    s_add_u32 s28, s28, 16384
    v_mfma_f32_16x16x32_bf16 v[84:87], a[116:119], v[168:171], v[84:87]
    v_mfma_f32_16x16x32_bf16 v[116:119], a[116:119], v[172:175], v[116:119]
    v_mfma_f32_16x16x32_bf16 v[88:91], a[120:123], v[168:171], v[88:91]
    v_mfma_f32_16x16x32_bf16 v[120:123], a[120:123], v[172:175], v[120:123]
    v_mfma_f32_16x16x32_bf16 v[92:95], a[124:127], v[168:171], v[92:95]
    v_mfma_f32_16x16x32_bf16 v[124:127], a[124:127], v[172:175], v[124:127]
    s_waitcnt lgkmcnt(0)
    v_mfma_f32_16x16x32_bf16 v[128:131], a[64:67], a[128:131], 0
    s_waitcnt vmcnt(16)
    s_barrier
    ds_read_b64_tr_b16 a[96:97], v188 offset:0
    v_mfma_f32_16x16x32_bf16 v[128:131], a[68:71], a[132:135], v[128:131]
    v_exp_f32 v144, v144
    v_mfma_f32_16x16x32_bf16 v[128:131], a[72:75], a[136:139], v[128:131]
    ds_read_b64_tr_b16 a[98:99], v188 offset:4096
    v_exp_f32 v145, v145
    v_mfma_f32_16x16x32_bf16 v[128:131], a[76:79], a[140:143], v[128:131]
    v_exp_f32 v146, v146
    v_mfma_f32_16x16x32_bf16 v[136:139], a[64:67], a[144:147], 0
    ds_read_b64_tr_b16 a[100:101], v189 offset:0
    v_exp_f32 v147, v147
    v_mfma_f32_16x16x32_bf16 v[136:139], a[68:71], a[148:151], v[136:139]
    v_exp_f32 v148, v148
    v_cvt_pk_bf16_f32 v168, v144, v145
    v_mfma_f32_16x16x32_bf16 v[136:139], a[72:75], a[152:155], v[136:139]
    ds_read_b64_tr_b16 a[102:103], v189 offset:4096
    v_exp_f32 v149, v149
    v_mfma_f32_16x16x32_bf16 v[136:139], a[76:79], a[156:159], v[136:139]
    v_exp_f32 v150, v150
    v_cvt_pk_bf16_f32 v169, v146, v147
    v_mfma_f32_16x16x32_bf16 v[132:135], a[80:83], a[128:131], 0
    ds_read_b64_tr_b16 a[104:105], v190 offset:0
    v_exp_f32 v151, v151
    v_mfma_f32_16x16x32_bf16 v[132:135], a[84:87], a[132:135], v[132:135]
    s_add_u32 m0, s30, 114688
    s_nop 0
    buffer_load_dwordx4 v200, s[20:23], s29 offen offset:0 nt lds
    v_mfma_f32_16x16x32_bf16 v[132:135], a[88:91], a[136:139], v[132:135]
    ds_read_b64_tr_b16 a[106:107], v190 offset:4096
    v_cvt_pk_bf16_f32 v170, v148, v149
    v_mfma_f32_16x16x32_bf16 v[132:135], a[92:95], a[140:143], v[132:135]
    v_exp_f32 v152, v152
    v_cvt_pk_bf16_f32 v171, v150, v151
    v_mfma_f32_16x16x32_bf16 v[140:143], a[80:83], a[144:147], 0
    ds_read_b64_tr_b16 a[108:109], v191 offset:0
    v_mfma_f32_16x16x32_bf16 v[140:143], a[84:87], a[148:151], v[140:143]
    v_exp_f32 v153, v153
    v_mfma_f32_16x16x32_bf16 v[140:143], a[88:91], a[152:155], v[140:143]
    ds_read_b64_tr_b16 a[110:111], v191 offset:4096
    v_cvt_pk_bf16_f32 v172, v152, v153
    v_mfma_f32_16x16x32_bf16 v[140:143], a[92:95], a[156:159], v[140:143]
    v_exp_f32 v154, v154
    v_mfma_f32_16x16x32_bf16 v[176:179], v[242:245], v[160:163], v[176:179]
    ds_read_b64_tr_b16 a[112:113], v192 offset:0
    v_mfma_f32_16x16x32_bf16 v[184:187], v[242:245], v[164:167], v[184:187]
    ds_read_b64_tr_b16 a[114:115], v192 offset:4096
    s_waitcnt lgkmcnt(6)
    v_mfma_f32_16x16x32_bf16 v[0:3], a[96:99], v[160:163], v[0:3]
    v_exp_f32 v155, v155
    v_mfma_f32_16x16x32_bf16 v[32:35], a[96:99], v[164:167], v[32:35]
    ds_read_b64_tr_b16 a[116:117], v193 offset:0
    v_cvt_pk_bf16_f32 v173, v154, v155
    v_mfma_f32_16x16x32_bf16 v[4:7], a[100:103], v[160:163], v[4:7]
    ds_read_b64_tr_b16 a[118:119], v193 offset:4096
    v_mfma_f32_16x16x32_bf16 v[36:39], a[100:103], v[164:167], v[36:39]
    s_waitcnt lgkmcnt(4)
    v_mfma_f32_16x16x32_bf16 v[8:11], a[104:107], v[160:163], v[8:11]
    ds_read_b64_tr_b16 a[120:121], v194 offset:0
    v_mfma_f32_16x16x32_bf16 v[40:43], a[104:107], v[164:167], v[40:43]
    ds_read_b64_tr_b16 a[122:123], v194 offset:4096
    v_mfma_f32_16x16x32_bf16 v[12:15], a[108:111], v[160:163], v[12:15]
    v_exp_f32 v156, v156
    v_mfma_f32_16x16x32_bf16 v[44:47], a[108:111], v[164:167], v[44:47]
    ds_read_b64_tr_b16 a[124:125], v195 offset:0
    s_waitcnt lgkmcnt(3)
    v_mfma_f32_16x16x32_bf16 v[16:19], a[112:115], v[160:163], v[16:19]
    ds_read_b64_tr_b16 a[126:127], v195 offset:4096
    v_mfma_f32_16x16x32_bf16 v[48:51], a[112:115], v[164:167], v[48:51]
    v_exp_f32 v157, v157
    v_mfma_f32_16x16x32_bf16 v[20:23], a[116:119], v[160:163], v[20:23]
    buffer_load_dwordx4 v201, s[20:23], s29 offen offset:1024 nt lds
    v_cvt_pk_bf16_f32 v174, v156, v157
    v_mfma_f32_16x16x32_bf16 v[52:55], a[116:119], v[164:167], v[52:55]
    s_waitcnt lgkmcnt(0)
    v_mfma_f32_16x16x32_bf16 v[24:27], a[120:123], v[160:163], v[24:27]
    v_exp_f32 v158, v158
    v_mfma_f32_16x16x32_bf16 v[56:59], a[120:123], v[164:167], v[56:59]
    v_exp_f32 v159, v159
    v_mfma_f32_16x16x32_bf16 v[28:31], a[124:127], v[160:163], v[28:31]
    v_cvt_pk_bf16_f32 v175, v158, v159
    v_mfma_f32_16x16x32_bf16 v[60:63], a[124:127], v[164:167], v[60:63]
    v_mfma_f32_16x16x32_bf16 v[144:147], a[64:67], a[160:163], 0
    v_exp_f32 v128, v128
    v_mfma_f32_16x16x32_bf16 v[144:147], a[68:71], a[164:167], v[144:147]
    v_exp_f32 v129, v129
    v_mfma_f32_16x16x32_bf16 v[144:147], a[72:75], a[168:171], v[144:147]
    v_exp_f32 v130, v130
    v_mfma_f32_16x16x32_bf16 v[144:147], a[76:79], a[172:175], v[144:147]
    v_exp_f32 v131, v131
    v_mfma_f32_16x16x32_bf16 v[152:155], a[64:67], a[176:179], 0
    s_add_u32 s39, s52, 0
    buffer_store_dwordx4 a[192:195], v202, s[24:27], s39 offen offset:0 sc0 sc1 nt
    v_cvt_pk_bf16_f32 v160, v128, v129
    v_mfma_f32_16x16x32_bf16 v[152:155], a[68:71], a[180:183], v[152:155]
    v_exp_f32 v132, v132
    v_mfma_f32_16x16x32_bf16 v[152:155], a[72:75], a[184:187], v[152:155]
    ds_read_b128 a[64:67], v180 offset:16384
    v_cvt_pk_bf16_f32 v161, v130, v131
    v_mfma_f32_16x16x32_bf16 v[152:155], a[76:79], a[188:191], v[152:155]
    v_exp_f32 v133, v133
    v_mfma_f32_16x16x32_bf16 v[148:151], a[80:83], a[160:163], 0
    ds_read_b128 a[68:71], v181 offset:16384
    v_cvt_pk_bf16_f32 v162, v132, v133
    v_mfma_f32_16x16x32_bf16 v[148:151], a[84:87], a[164:167], v[148:151]
    v_exp_f32 v134, v134
    v_mfma_f32_16x16x32_bf16 v[148:151], a[88:91], a[168:171], v[148:151]
    ds_read_b128 a[72:75], v182 offset:16384
    v_mfma_f32_16x16x32_bf16 v[148:151], a[92:95], a[172:175], v[148:151]
    v_exp_f32 v135, v135
    v_mfma_f32_16x16x32_bf16 v[156:159], a[80:83], a[176:179], 0
    ds_read_b128 a[76:79], v183 offset:16384
    v_cvt_pk_bf16_f32 v163, v134, v135
    v_mfma_f32_16x16x32_bf16 v[156:159], a[84:87], a[180:183], v[156:159]
    v_exp_f32 v136, v136
    v_mfma_f32_16x16x32_bf16 v[156:159], a[88:91], a[184:187], v[156:159]
    ds_read_b128 a[80:83], v180 offset:20480
    v_mfma_f32_16x16x32_bf16 v[156:159], a[92:95], a[188:191], v[156:159]
    v_exp_f32 v137, v137
    v_mfma_f32_16x16x32_bf16 v[222:225], v[242:245], v[168:171], v[222:225]
    ds_read_b128 a[84:87], v181 offset:20480
    v_cvt_pk_bf16_f32 v164, v136, v137
    v_mfma_f32_16x16x32_bf16 v[246:249], v[242:245], v[172:175], v[246:249]
    v_exp_f32 v138, v138
    v_mfma_f32_16x16x32_bf16 v[64:67], a[96:99], v[168:171], v[64:67]
    ds_read_b128 a[88:91], v182 offset:20480
    v_mfma_f32_16x16x32_bf16 v[96:99], a[96:99], v[172:175], v[96:99]
    v_exp_f32 v139, v139
    v_mfma_f32_16x16x32_bf16 v[68:71], a[100:103], v[168:171], v[68:71]
    ds_read_b128 a[92:95], v183 offset:20480
    v_cvt_pk_bf16_f32 v165, v138, v139
    v_mfma_f32_16x16x32_bf16 v[100:103], a[100:103], v[172:175], v[100:103]
    buffer_load_dwordx4 v200, s[20:23], s29 offen offset:2048 nt lds
    v_mfma_f32_16x16x32_bf16 v[72:75], a[104:107], v[168:171], v[72:75]
    v_exp_f32 v140, v140
    v_mfma_f32_16x16x32_bf16 v[104:107], a[104:107], v[172:175], v[104:107]
    v_exp_f32 v141, v141
    v_mfma_f32_16x16x32_bf16 v[76:79], a[108:111], v[168:171], v[76:79]
    v_exp_f32 v142, v142
    v_mfma_f32_16x16x32_bf16 v[108:111], a[108:111], v[172:175], v[108:111]
    v_exp_f32 v143, v143
    v_mfma_f32_16x16x32_bf16 v[80:83], a[112:115], v[168:171], v[80:83]
    v_cvt_pk_bf16_f32 v166, v140, v141
    v_cvt_pk_bf16_f32 v167, v142, v143
    v_mfma_f32_16x16x32_bf16 v[112:115], a[112:115], v[172:175], v[112:115]
    v_mfma_f32_16x16x32_bf16 v[84:87], a[116:119], v[168:171], v[84:87]
    v_mfma_f32_16x16x32_bf16 v[116:119], a[116:119], v[172:175], v[116:119]
    buffer_load_dwordx4 v201, s[20:23], s29 offen offset:3072 nt lds
    s_add_u32 s29, s29, 16384
    v_mfma_f32_16x16x32_bf16 v[88:91], a[120:123], v[168:171], v[88:91]
    v_mfma_f32_16x16x32_bf16 v[120:123], a[120:123], v[172:175], v[120:123]
    v_mfma_f32_16x16x32_bf16 v[92:95], a[124:127], v[168:171], v[92:95]
    v_mfma_f32_16x16x32_bf16 v[124:127], a[124:127], v[172:175], v[124:127]
    s_waitcnt lgkmcnt(0)
    v_mfma_f32_16x16x32_bf16 v[128:131], a[64:67], a[128:131], 0
    ds_read_b64_tr_b16 a[96:97], v188 offset:8192
    v_exp_f32 v144, v144
    v_mfma_f32_16x16x32_bf16 v[128:131], a[68:71], a[132:135], v[128:131]
    v_exp_f32 v145, v145
    v_mfma_f32_16x16x32_bf16 v[128:131], a[72:75], a[136:139], v[128:131]
    ds_read_b64_tr_b16 a[98:99], v188 offset:12288
    v_exp_f32 v146, v146
    v_mfma_f32_16x16x32_bf16 v[128:131], a[76:79], a[140:143], v[128:131]
    v_exp_f32 v147, v147
    v_mfma_f32_16x16x32_bf16 v[136:139], a[64:67], a[144:147], 0
    ds_read_b64_tr_b16 a[100:101], v189 offset:8192
    v_exp_f32 v148, v148
    v_mfma_f32_16x16x32_bf16 v[136:139], a[68:71], a[148:151], v[136:139]
    v_exp_f32 v149, v149
    v_cvt_pk_bf16_f32 v168, v144, v145
    v_mfma_f32_16x16x32_bf16 v[136:139], a[72:75], a[152:155], v[136:139]
    ds_read_b64_tr_b16 a[102:103], v189 offset:12288
    v_exp_f32 v150, v150
    v_mfma_f32_16x16x32_bf16 v[136:139], a[76:79], a[156:159], v[136:139]
    v_exp_f32 v151, v151
    v_cvt_pk_bf16_f32 v169, v146, v147
    v_mfma_f32_16x16x32_bf16 v[132:135], a[80:83], a[128:131], 0
    ds_read_b64_tr_b16 a[104:105], v190 offset:8192
    v_cvt_pk_bf16_f32 v170, v148, v149
    v_mfma_f32_16x16x32_bf16 v[132:135], a[84:87], a[132:135], v[132:135]
    s_add_u32 m0, s30, 0
    s_nop 0
    buffer_load_dwordx4 v196, s[16:19], s28 offen offset:0 nt lds
    v_mfma_f32_16x16x32_bf16 v[132:135], a[88:91], a[136:139], v[132:135]
    ds_read_b64_tr_b16 a[106:107], v190 offset:12288
    v_cvt_pk_bf16_f32 v171, v150, v151
    v_mfma_f32_16x16x32_bf16 v[132:135], a[92:95], a[140:143], v[132:135]
    v_exp_f32 v152, v152
    v_mfma_f32_16x16x32_bf16 v[140:143], a[80:83], a[144:147], 0
    ds_read_b64_tr_b16 a[108:109], v191 offset:8192
    v_mfma_f32_16x16x32_bf16 v[140:143], a[84:87], a[148:151], v[140:143]
    v_exp_f32 v153, v153
    v_mfma_f32_16x16x32_bf16 v[140:143], a[88:91], a[152:155], v[140:143]
    ds_read_b64_tr_b16 a[110:111], v191 offset:12288
    v_cvt_pk_bf16_f32 v172, v152, v153
    v_mfma_f32_16x16x32_bf16 v[140:143], a[92:95], a[156:159], v[140:143]
    v_exp_f32 v154, v154
    v_mfma_f32_16x16x32_bf16 v[176:179], v[242:245], v[160:163], v[176:179]
    ds_read_b64_tr_b16 a[112:113], v192 offset:8192
    v_mfma_f32_16x16x32_bf16 v[184:187], v[242:245], v[164:167], v[184:187]
    ds_read_b64_tr_b16 a[114:115], v192 offset:12288
    s_waitcnt lgkmcnt(6)
    v_mfma_f32_16x16x32_bf16 v[0:3], a[96:99], v[160:163], v[0:3]
    v_exp_f32 v155, v155
    v_mfma_f32_16x16x32_bf16 v[32:35], a[96:99], v[164:167], v[32:35]
    ds_read_b64_tr_b16 a[116:117], v193 offset:8192
    v_cvt_pk_bf16_f32 v173, v154, v155
    v_mfma_f32_16x16x32_bf16 v[4:7], a[100:103], v[160:163], v[4:7]
    ds_read_b64_tr_b16 a[118:119], v193 offset:12288
    v_mfma_f32_16x16x32_bf16 v[36:39], a[100:103], v[164:167], v[36:39]
    s_waitcnt lgkmcnt(4)
    v_mfma_f32_16x16x32_bf16 v[8:11], a[104:107], v[160:163], v[8:11]
    ds_read_b64_tr_b16 a[120:121], v194 offset:8192
    v_mfma_f32_16x16x32_bf16 v[40:43], a[104:107], v[164:167], v[40:43]
    ds_read_b64_tr_b16 a[122:123], v194 offset:12288
    v_mfma_f32_16x16x32_bf16 v[12:15], a[108:111], v[160:163], v[12:15]
    v_exp_f32 v156, v156
    v_mfma_f32_16x16x32_bf16 v[44:47], a[108:111], v[164:167], v[44:47]
    ds_read_b64_tr_b16 a[124:125], v195 offset:8192
    s_waitcnt lgkmcnt(3)
    v_mfma_f32_16x16x32_bf16 v[16:19], a[112:115], v[160:163], v[16:19]
    ds_read_b64_tr_b16 a[126:127], v195 offset:12288
    v_mfma_f32_16x16x32_bf16 v[48:51], a[112:115], v[164:167], v[48:51]
    v_exp_f32 v157, v157
    v_mfma_f32_16x16x32_bf16 v[20:23], a[116:119], v[160:163], v[20:23]
    buffer_load_dwordx4 v197, s[16:19], s28 offen offset:1024 nt lds
    v_cvt_pk_bf16_f32 v174, v156, v157
    v_mfma_f32_16x16x32_bf16 v[52:55], a[116:119], v[164:167], v[52:55]
    s_waitcnt lgkmcnt(0)
    v_mfma_f32_16x16x32_bf16 v[24:27], a[120:123], v[160:163], v[24:27]
    v_exp_f32 v158, v158
    v_mfma_f32_16x16x32_bf16 v[56:59], a[120:123], v[164:167], v[56:59]
    v_exp_f32 v159, v159
    v_mfma_f32_16x16x32_bf16 v[28:31], a[124:127], v[160:163], v[28:31]
    v_cvt_pk_bf16_f32 v175, v158, v159
    v_mfma_f32_16x16x32_bf16 v[60:63], a[124:127], v[164:167], v[60:63]
    v_mfma_f32_16x16x32_bf16 v[144:147], a[64:67], a[160:163], 0
    v_exp_f32 v128, v128
    v_mfma_f32_16x16x32_bf16 v[144:147], a[68:71], a[164:167], v[144:147]
    v_exp_f32 v129, v129
    v_mfma_f32_16x16x32_bf16 v[144:147], a[72:75], a[168:171], v[144:147]
    v_exp_f32 v130, v130
    v_mfma_f32_16x16x32_bf16 v[144:147], a[76:79], a[172:175], v[144:147]
    v_exp_f32 v131, v131
    v_mfma_f32_16x16x32_bf16 v[152:155], a[64:67], a[176:179], 0
    s_add_u32 s39, s52, 0
    buffer_store_dwordx4 a[196:199], v203, s[24:27], s39 offen offset:1024 sc0 sc1 nt
    v_cvt_pk_bf16_f32 v160, v128, v129
    v_mfma_f32_16x16x32_bf16 v[152:155], a[68:71], a[180:183], v[152:155]
    v_exp_f32 v132, v132
    v_mfma_f32_16x16x32_bf16 v[152:155], a[72:75], a[184:187], v[152:155]
    ds_read_b128 a[64:67], v180 offset:24576
    v_cvt_pk_bf16_f32 v161, v130, v131
    v_mfma_f32_16x16x32_bf16 v[152:155], a[76:79], a[188:191], v[152:155]
    v_exp_f32 v133, v133
    v_mfma_f32_16x16x32_bf16 v[148:151], a[80:83], a[160:163], 0
    ds_read_b128 a[68:71], v181 offset:24576
    v_cvt_pk_bf16_f32 v162, v132, v133
    v_mfma_f32_16x16x32_bf16 v[148:151], a[84:87], a[164:167], v[148:151]
    v_exp_f32 v134, v134
    v_mfma_f32_16x16x32_bf16 v[148:151], a[88:91], a[168:171], v[148:151]
    ds_read_b128 a[72:75], v182 offset:24576
    v_mfma_f32_16x16x32_bf16 v[148:151], a[92:95], a[172:175], v[148:151]
    v_exp_f32 v135, v135
    v_mfma_f32_16x16x32_bf16 v[156:159], a[80:83], a[176:179], 0
    ds_read_b128 a[76:79], v183 offset:24576
    v_cvt_pk_bf16_f32 v163, v134, v135
    v_mfma_f32_16x16x32_bf16 v[156:159], a[84:87], a[180:183], v[156:159]
    v_exp_f32 v136, v136
    v_mfma_f32_16x16x32_bf16 v[156:159], a[88:91], a[184:187], v[156:159]
    ds_read_b128 a[80:83], v180 offset:28672
    v_mfma_f32_16x16x32_bf16 v[156:159], a[92:95], a[188:191], v[156:159]
    v_exp_f32 v137, v137
    v_mfma_f32_16x16x32_bf16 v[222:225], v[242:245], v[168:171], v[222:225]
    ds_read_b128 a[84:87], v181 offset:28672
    v_cvt_pk_bf16_f32 v164, v136, v137
    v_mfma_f32_16x16x32_bf16 v[246:249], v[242:245], v[172:175], v[246:249]
    v_exp_f32 v138, v138
    v_mfma_f32_16x16x32_bf16 v[64:67], a[96:99], v[168:171], v[64:67]
    ds_read_b128 a[88:91], v182 offset:28672
    v_mfma_f32_16x16x32_bf16 v[96:99], a[96:99], v[172:175], v[96:99]
    v_exp_f32 v139, v139
    v_mfma_f32_16x16x32_bf16 v[68:71], a[100:103], v[168:171], v[68:71]
    ds_read_b128 a[92:95], v183 offset:28672
    v_cvt_pk_bf16_f32 v165, v138, v139
    v_mfma_f32_16x16x32_bf16 v[100:103], a[100:103], v[172:175], v[100:103]
    buffer_load_dwordx4 v198, s[16:19], s28 offen offset:2048 nt lds
    v_mfma_f32_16x16x32_bf16 v[72:75], a[104:107], v[168:171], v[72:75]
    v_exp_f32 v140, v140
    v_mfma_f32_16x16x32_bf16 v[104:107], a[104:107], v[172:175], v[104:107]
    v_exp_f32 v141, v141
    v_mfma_f32_16x16x32_bf16 v[76:79], a[108:111], v[168:171], v[76:79]
    v_exp_f32 v142, v142
    v_mfma_f32_16x16x32_bf16 v[108:111], a[108:111], v[172:175], v[108:111]
    v_exp_f32 v143, v143
    v_mfma_f32_16x16x32_bf16 v[80:83], a[112:115], v[168:171], v[80:83]
    v_cvt_pk_bf16_f32 v166, v140, v141
    v_cvt_pk_bf16_f32 v167, v142, v143
    v_mfma_f32_16x16x32_bf16 v[112:115], a[112:115], v[172:175], v[112:115]
    v_mfma_f32_16x16x32_bf16 v[84:87], a[116:119], v[168:171], v[84:87]
    v_mfma_f32_16x16x32_bf16 v[116:119], a[116:119], v[172:175], v[116:119]
    buffer_load_dwordx4 v199, s[16:19], s28 offen offset:3072 nt lds
    s_add_u32 s28, s28, 16384
    v_mfma_f32_16x16x32_bf16 v[88:91], a[120:123], v[168:171], v[88:91]
    v_mfma_f32_16x16x32_bf16 v[120:123], a[120:123], v[172:175], v[120:123]
    v_mfma_f32_16x16x32_bf16 v[92:95], a[124:127], v[168:171], v[92:95]
    v_mfma_f32_16x16x32_bf16 v[124:127], a[124:127], v[172:175], v[124:127]
    s_waitcnt lgkmcnt(0)
    v_mfma_f32_16x16x32_bf16 v[128:131], a[64:67], a[128:131], 0
    s_waitcnt vmcnt(18)
    s_barrier
    ds_read_b64_tr_b16 a[96:97], v188 offset:16384
    v_mfma_f32_16x16x32_bf16 v[128:131], a[68:71], a[132:135], v[128:131]
    v_exp_f32 v144, v144
    v_mfma_f32_16x16x32_bf16 v[128:131], a[72:75], a[136:139], v[128:131]
    ds_read_b64_tr_b16 a[98:99], v188 offset:20480
    v_exp_f32 v145, v145
    v_mfma_f32_16x16x32_bf16 v[128:131], a[76:79], a[140:143], v[128:131]
    v_exp_f32 v146, v146
    v_mfma_f32_16x16x32_bf16 v[136:139], a[64:67], a[144:147], 0
    ds_read_b64_tr_b16 a[100:101], v189 offset:16384
    v_exp_f32 v147, v147
    v_mfma_f32_16x16x32_bf16 v[136:139], a[68:71], a[148:151], v[136:139]
    v_exp_f32 v148, v148
    v_cvt_pk_bf16_f32 v168, v144, v145
    v_mfma_f32_16x16x32_bf16 v[136:139], a[72:75], a[152:155], v[136:139]
    ds_read_b64_tr_b16 a[102:103], v189 offset:20480
    v_exp_f32 v149, v149
    v_mfma_f32_16x16x32_bf16 v[136:139], a[76:79], a[156:159], v[136:139]
    v_exp_f32 v150, v150
    v_cvt_pk_bf16_f32 v169, v146, v147
    v_mfma_f32_16x16x32_bf16 v[132:135], a[80:83], a[128:131], 0
    ds_read_b64_tr_b16 a[104:105], v190 offset:16384
    v_exp_f32 v151, v151
    v_mfma_f32_16x16x32_bf16 v[132:135], a[84:87], a[132:135], v[132:135]
    s_add_u32 m0, s30, 65536
    s_nop 0
    buffer_load_dwordx4 v200, s[20:23], s29 offen offset:0 nt lds
    v_mfma_f32_16x16x32_bf16 v[132:135], a[88:91], a[136:139], v[132:135]
    ds_read_b64_tr_b16 a[106:107], v190 offset:20480
    v_cvt_pk_bf16_f32 v170, v148, v149
    v_mfma_f32_16x16x32_bf16 v[132:135], a[92:95], a[140:143], v[132:135]
    v_exp_f32 v152, v152
    v_cvt_pk_bf16_f32 v171, v150, v151
    v_mfma_f32_16x16x32_bf16 v[140:143], a[80:83], a[144:147], 0
    ds_read_b64_tr_b16 a[108:109], v191 offset:16384
    v_mfma_f32_16x16x32_bf16 v[140:143], a[84:87], a[148:151], v[140:143]
    v_exp_f32 v153, v153
    v_mfma_f32_16x16x32_bf16 v[140:143], a[88:91], a[152:155], v[140:143]
    ds_read_b64_tr_b16 a[110:111], v191 offset:20480
    v_cvt_pk_bf16_f32 v172, v152, v153
    v_mfma_f32_16x16x32_bf16 v[140:143], a[92:95], a[156:159], v[140:143]
    v_exp_f32 v154, v154
    v_mfma_f32_16x16x32_bf16 v[176:179], v[242:245], v[160:163], v[176:179]
    ds_read_b64_tr_b16 a[112:113], v192 offset:16384
    v_mfma_f32_16x16x32_bf16 v[184:187], v[242:245], v[164:167], v[184:187]
    ds_read_b64_tr_b16 a[114:115], v192 offset:20480
    s_waitcnt lgkmcnt(6)
    v_mfma_f32_16x16x32_bf16 v[0:3], a[96:99], v[160:163], v[0:3]
    v_exp_f32 v155, v155
    v_mfma_f32_16x16x32_bf16 v[32:35], a[96:99], v[164:167], v[32:35]
    ds_read_b64_tr_b16 a[116:117], v193 offset:16384
    v_cvt_pk_bf16_f32 v173, v154, v155
    v_mfma_f32_16x16x32_bf16 v[4:7], a[100:103], v[160:163], v[4:7]
    ds_read_b64_tr_b16 a[118:119], v193 offset:20480
    v_mfma_f32_16x16x32_bf16 v[36:39], a[100:103], v[164:167], v[36:39]
    s_waitcnt lgkmcnt(4)
    v_mfma_f32_16x16x32_bf16 v[8:11], a[104:107], v[160:163], v[8:11]
    ds_read_b64_tr_b16 a[120:121], v194 offset:16384
    v_mfma_f32_16x16x32_bf16 v[40:43], a[104:107], v[164:167], v[40:43]
    ds_read_b64_tr_b16 a[122:123], v194 offset:20480
    v_mfma_f32_16x16x32_bf16 v[12:15], a[108:111], v[160:163], v[12:15]
    v_exp_f32 v156, v156
    v_mfma_f32_16x16x32_bf16 v[44:47], a[108:111], v[164:167], v[44:47]
    ds_read_b64_tr_b16 a[124:125], v195 offset:16384
    s_waitcnt lgkmcnt(3)
    v_mfma_f32_16x16x32_bf16 v[16:19], a[112:115], v[160:163], v[16:19]
    ds_read_b64_tr_b16 a[126:127], v195 offset:20480
    v_mfma_f32_16x16x32_bf16 v[48:51], a[112:115], v[164:167], v[48:51]
    v_exp_f32 v157, v157
    v_mfma_f32_16x16x32_bf16 v[20:23], a[116:119], v[160:163], v[20:23]
    buffer_load_dwordx4 v201, s[20:23], s29 offen offset:1024 nt lds
    v_cvt_pk_bf16_f32 v174, v156, v157
    v_mfma_f32_16x16x32_bf16 v[52:55], a[116:119], v[164:167], v[52:55]
    s_waitcnt lgkmcnt(0)
    v_mfma_f32_16x16x32_bf16 v[24:27], a[120:123], v[160:163], v[24:27]
    v_exp_f32 v158, v158
    v_mfma_f32_16x16x32_bf16 v[56:59], a[120:123], v[164:167], v[56:59]
    v_exp_f32 v159, v159
    v_mfma_f32_16x16x32_bf16 v[28:31], a[124:127], v[160:163], v[28:31]
    v_cvt_pk_bf16_f32 v175, v158, v159
    v_mfma_f32_16x16x32_bf16 v[60:63], a[124:127], v[164:167], v[60:63]
    v_mfma_f32_16x16x32_bf16 v[144:147], a[64:67], a[160:163], 0
    v_exp_f32 v128, v128
    v_mfma_f32_16x16x32_bf16 v[144:147], a[68:71], a[164:167], v[144:147]
    v_exp_f32 v129, v129
    v_mfma_f32_16x16x32_bf16 v[144:147], a[72:75], a[168:171], v[144:147]
    v_exp_f32 v130, v130
    v_mfma_f32_16x16x32_bf16 v[144:147], a[76:79], a[172:175], v[144:147]
    v_exp_f32 v131, v131
    v_mfma_f32_16x16x32_bf16 v[152:155], a[64:67], a[176:179], 0
    s_add_u32 s39, s52, 0
    buffer_store_dwordx4 a[200:203], v202, s[24:27], s39 offen offset:2048 sc0 sc1 nt
    v_cvt_pk_bf16_f32 v160, v128, v129
    v_mfma_f32_16x16x32_bf16 v[152:155], a[68:71], a[180:183], v[152:155]
    v_exp_f32 v132, v132
    v_mfma_f32_16x16x32_bf16 v[152:155], a[72:75], a[184:187], v[152:155]
    ds_read_b128 a[64:67], v180 offset:32768
    v_cvt_pk_bf16_f32 v161, v130, v131
    v_mfma_f32_16x16x32_bf16 v[152:155], a[76:79], a[188:191], v[152:155]
    v_exp_f32 v133, v133
    v_mfma_f32_16x16x32_bf16 v[148:151], a[80:83], a[160:163], 0
    ds_read_b128 a[68:71], v181 offset:32768
    v_cvt_pk_bf16_f32 v162, v132, v133
    v_mfma_f32_16x16x32_bf16 v[148:151], a[84:87], a[164:167], v[148:151]
    v_exp_f32 v134, v134
    v_mfma_f32_16x16x32_bf16 v[148:151], a[88:91], a[168:171], v[148:151]
    ds_read_b128 a[72:75], v182 offset:32768
    v_mfma_f32_16x16x32_bf16 v[148:151], a[92:95], a[172:175], v[148:151]
    v_exp_f32 v135, v135
    v_mfma_f32_16x16x32_bf16 v[156:159], a[80:83], a[176:179], 0
    ds_read_b128 a[76:79], v183 offset:32768
    v_cvt_pk_bf16_f32 v163, v134, v135
    v_mfma_f32_16x16x32_bf16 v[156:159], a[84:87], a[180:183], v[156:159]
    v_exp_f32 v136, v136
    v_mfma_f32_16x16x32_bf16 v[156:159], a[88:91], a[184:187], v[156:159]
    ds_read_b128 a[80:83], v180 offset:36864
    v_mfma_f32_16x16x32_bf16 v[156:159], a[92:95], a[188:191], v[156:159]
    v_exp_f32 v137, v137
    v_mfma_f32_16x16x32_bf16 v[222:225], v[242:245], v[168:171], v[222:225]
    ds_read_b128 a[84:87], v181 offset:36864
    v_cvt_pk_bf16_f32 v164, v136, v137
    v_mfma_f32_16x16x32_bf16 v[246:249], v[242:245], v[172:175], v[246:249]
    v_exp_f32 v138, v138
    v_mfma_f32_16x16x32_bf16 v[64:67], a[96:99], v[168:171], v[64:67]
    ds_read_b128 a[88:91], v182 offset:36864
    v_mfma_f32_16x16x32_bf16 v[96:99], a[96:99], v[172:175], v[96:99]
    v_exp_f32 v139, v139
    v_mfma_f32_16x16x32_bf16 v[68:71], a[100:103], v[168:171], v[68:71]
    ds_read_b128 a[92:95], v183 offset:36864
    v_cvt_pk_bf16_f32 v165, v138, v139
    v_mfma_f32_16x16x32_bf16 v[100:103], a[100:103], v[172:175], v[100:103]
    buffer_load_dwordx4 v200, s[20:23], s29 offen offset:2048 nt lds
    v_mfma_f32_16x16x32_bf16 v[72:75], a[104:107], v[168:171], v[72:75]
    v_exp_f32 v140, v140
    v_mfma_f32_16x16x32_bf16 v[104:107], a[104:107], v[172:175], v[104:107]
    v_exp_f32 v141, v141
    v_mfma_f32_16x16x32_bf16 v[76:79], a[108:111], v[168:171], v[76:79]
    v_exp_f32 v142, v142
    v_mfma_f32_16x16x32_bf16 v[108:111], a[108:111], v[172:175], v[108:111]
    v_exp_f32 v143, v143
    v_mfma_f32_16x16x32_bf16 v[80:83], a[112:115], v[168:171], v[80:83]
    v_cvt_pk_bf16_f32 v166, v140, v141
    v_cvt_pk_bf16_f32 v167, v142, v143
    v_mfma_f32_16x16x32_bf16 v[112:115], a[112:115], v[172:175], v[112:115]
    v_mfma_f32_16x16x32_bf16 v[84:87], a[116:119], v[168:171], v[84:87]
    v_mfma_f32_16x16x32_bf16 v[116:119], a[116:119], v[172:175], v[116:119]
    buffer_load_dwordx4 v201, s[20:23], s29 offen offset:3072 nt lds
    s_add_u32 s29, s29, 16384
    v_mfma_f32_16x16x32_bf16 v[88:91], a[120:123], v[168:171], v[88:91]
    v_mfma_f32_16x16x32_bf16 v[120:123], a[120:123], v[172:175], v[120:123]
    v_mfma_f32_16x16x32_bf16 v[92:95], a[124:127], v[168:171], v[92:95]
    v_mfma_f32_16x16x32_bf16 v[124:127], a[124:127], v[172:175], v[124:127]
    s_waitcnt lgkmcnt(0)
    v_mfma_f32_16x16x32_bf16 v[128:131], a[64:67], a[128:131], 0
    ds_read_b64_tr_b16 a[96:97], v188 offset:24576
    v_exp_f32 v144, v144
    v_mfma_f32_16x16x32_bf16 v[128:131], a[68:71], a[132:135], v[128:131]
    v_exp_f32 v145, v145
    v_mfma_f32_16x16x32_bf16 v[128:131], a[72:75], a[136:139], v[128:131]
    ds_read_b64_tr_b16 a[98:99], v188 offset:28672
    v_exp_f32 v146, v146
    v_mfma_f32_16x16x32_bf16 v[128:131], a[76:79], a[140:143], v[128:131]
    v_exp_f32 v147, v147
    v_mfma_f32_16x16x32_bf16 v[136:139], a[64:67], a[144:147], 0
    ds_read_b64_tr_b16 a[100:101], v189 offset:24576
    v_exp_f32 v148, v148
    v_mfma_f32_16x16x32_bf16 v[136:139], a[68:71], a[148:151], v[136:139]
    v_exp_f32 v149, v149
    v_cvt_pk_bf16_f32 v168, v144, v145
    v_mfma_f32_16x16x32_bf16 v[136:139], a[72:75], a[152:155], v[136:139]
    ds_read_b64_tr_b16 a[102:103], v189 offset:28672
    v_exp_f32 v150, v150
    v_mfma_f32_16x16x32_bf16 v[136:139], a[76:79], a[156:159], v[136:139]
    v_exp_f32 v151, v151
    v_cvt_pk_bf16_f32 v169, v146, v147
    v_mfma_f32_16x16x32_bf16 v[132:135], a[80:83], a[128:131], 0
    ds_read_b64_tr_b16 a[104:105], v190 offset:24576
    v_cvt_pk_bf16_f32 v170, v148, v149
    v_mfma_f32_16x16x32_bf16 v[132:135], a[84:87], a[132:135], v[132:135]
    s_add_u32 m0, s30, 16384
    s_nop 0
    buffer_load_dwordx4 v196, s[16:19], s28 offen offset:0 nt lds
    v_mfma_f32_16x16x32_bf16 v[132:135], a[88:91], a[136:139], v[132:135]
    ds_read_b64_tr_b16 a[106:107], v190 offset:28672
    v_cvt_pk_bf16_f32 v171, v150, v151
    v_mfma_f32_16x16x32_bf16 v[132:135], a[92:95], a[140:143], v[132:135]
    v_exp_f32 v152, v152
    v_mfma_f32_16x16x32_bf16 v[140:143], a[80:83], a[144:147], 0
    ds_read_b64_tr_b16 a[108:109], v191 offset:24576
    v_mfma_f32_16x16x32_bf16 v[140:143], a[84:87], a[148:151], v[140:143]
    v_exp_f32 v153, v153
    v_mfma_f32_16x16x32_bf16 v[140:143], a[88:91], a[152:155], v[140:143]
    ds_read_b64_tr_b16 a[110:111], v191 offset:28672
    v_cvt_pk_bf16_f32 v172, v152, v153
    v_mfma_f32_16x16x32_bf16 v[140:143], a[92:95], a[156:159], v[140:143]
    v_exp_f32 v154, v154
    v_mfma_f32_16x16x32_bf16 v[176:179], v[242:245], v[160:163], v[176:179]
    ds_read_b64_tr_b16 a[112:113], v192 offset:24576
    v_mfma_f32_16x16x32_bf16 v[184:187], v[242:245], v[164:167], v[184:187]
    ds_read_b64_tr_b16 a[114:115], v192 offset:28672
    s_waitcnt lgkmcnt(6)
    v_mfma_f32_16x16x32_bf16 v[0:3], a[96:99], v[160:163], v[0:3]
    v_exp_f32 v155, v155
    v_mfma_f32_16x16x32_bf16 v[32:35], a[96:99], v[164:167], v[32:35]
    ds_read_b64_tr_b16 a[116:117], v193 offset:24576
    v_cvt_pk_bf16_f32 v173, v154, v155
    v_mfma_f32_16x16x32_bf16 v[4:7], a[100:103], v[160:163], v[4:7]
    ds_read_b64_tr_b16 a[118:119], v193 offset:28672
    v_mfma_f32_16x16x32_bf16 v[36:39], a[100:103], v[164:167], v[36:39]
    s_waitcnt lgkmcnt(4)
    v_mfma_f32_16x16x32_bf16 v[8:11], a[104:107], v[160:163], v[8:11]
    ds_read_b64_tr_b16 a[120:121], v194 offset:24576
    v_mfma_f32_16x16x32_bf16 v[40:43], a[104:107], v[164:167], v[40:43]
    ds_read_b64_tr_b16 a[122:123], v194 offset:28672
    v_mfma_f32_16x16x32_bf16 v[12:15], a[108:111], v[160:163], v[12:15]
    v_exp_f32 v156, v156
    v_mfma_f32_16x16x32_bf16 v[44:47], a[108:111], v[164:167], v[44:47]
    ds_read_b64_tr_b16 a[124:125], v195 offset:24576
    s_waitcnt lgkmcnt(3)
    v_mfma_f32_16x16x32_bf16 v[16:19], a[112:115], v[160:163], v[16:19]
    ds_read_b64_tr_b16 a[126:127], v195 offset:28672
    v_mfma_f32_16x16x32_bf16 v[48:51], a[112:115], v[164:167], v[48:51]
    v_exp_f32 v157, v157
    v_mfma_f32_16x16x32_bf16 v[20:23], a[116:119], v[160:163], v[20:23]
    buffer_load_dwordx4 v197, s[16:19], s28 offen offset:1024 nt lds
    v_cvt_pk_bf16_f32 v174, v156, v157
    v_mfma_f32_16x16x32_bf16 v[52:55], a[116:119], v[164:167], v[52:55]
    s_waitcnt lgkmcnt(0)
    v_mfma_f32_16x16x32_bf16 v[24:27], a[120:123], v[160:163], v[24:27]
    v_exp_f32 v158, v158
    v_mfma_f32_16x16x32_bf16 v[56:59], a[120:123], v[164:167], v[56:59]
    v_exp_f32 v159, v159
    v_mfma_f32_16x16x32_bf16 v[28:31], a[124:127], v[160:163], v[28:31]
    v_cvt_pk_bf16_f32 v175, v158, v159
    v_mfma_f32_16x16x32_bf16 v[60:63], a[124:127], v[164:167], v[60:63]
    v_mfma_f32_16x16x32_bf16 v[144:147], a[64:67], a[160:163], 0
    v_exp_f32 v128, v128
    v_mfma_f32_16x16x32_bf16 v[144:147], a[68:71], a[164:167], v[144:147]
    v_exp_f32 v129, v129
    v_mfma_f32_16x16x32_bf16 v[144:147], a[72:75], a[168:171], v[144:147]
    v_exp_f32 v130, v130
    v_mfma_f32_16x16x32_bf16 v[144:147], a[76:79], a[172:175], v[144:147]
    v_exp_f32 v131, v131
    v_mfma_f32_16x16x32_bf16 v[152:155], a[64:67], a[176:179], 0
    s_add_u32 s39, s52, 0
    buffer_store_dwordx4 a[204:207], v203, s[24:27], s39 offen offset:3072 sc0 sc1 nt
    v_cvt_pk_bf16_f32 v160, v128, v129
    v_mfma_f32_16x16x32_bf16 v[152:155], a[68:71], a[180:183], v[152:155]
    v_exp_f32 v132, v132
    v_mfma_f32_16x16x32_bf16 v[152:155], a[72:75], a[184:187], v[152:155]
    ds_read_b128 a[64:67], v180 offset:40960
    v_cvt_pk_bf16_f32 v161, v130, v131
    v_mfma_f32_16x16x32_bf16 v[152:155], a[76:79], a[188:191], v[152:155]
    v_exp_f32 v133, v133
    v_mfma_f32_16x16x32_bf16 v[148:151], a[80:83], a[160:163], 0
    ds_read_b128 a[68:71], v181 offset:40960
    v_cvt_pk_bf16_f32 v162, v132, v133
    v_mfma_f32_16x16x32_bf16 v[148:151], a[84:87], a[164:167], v[148:151]
    v_exp_f32 v134, v134
    v_mfma_f32_16x16x32_bf16 v[148:151], a[88:91], a[168:171], v[148:151]
    ds_read_b128 a[72:75], v182 offset:40960
    v_mfma_f32_16x16x32_bf16 v[148:151], a[92:95], a[172:175], v[148:151]
    v_exp_f32 v135, v135
    v_mfma_f32_16x16x32_bf16 v[156:159], a[80:83], a[176:179], 0
    ds_read_b128 a[76:79], v183 offset:40960
    v_cvt_pk_bf16_f32 v163, v134, v135
    v_mfma_f32_16x16x32_bf16 v[156:159], a[84:87], a[180:183], v[156:159]
    v_exp_f32 v136, v136
    v_mfma_f32_16x16x32_bf16 v[156:159], a[88:91], a[184:187], v[156:159]
    ds_read_b128 a[80:83], v180 offset:45056
    v_mfma_f32_16x16x32_bf16 v[156:159], a[92:95], a[188:191], v[156:159]
    v_exp_f32 v137, v137
    v_mfma_f32_16x16x32_bf16 v[222:225], v[242:245], v[168:171], v[222:225]
    ds_read_b128 a[84:87], v181 offset:45056
    v_cvt_pk_bf16_f32 v164, v136, v137
    v_mfma_f32_16x16x32_bf16 v[246:249], v[242:245], v[172:175], v[246:249]
    v_exp_f32 v138, v138
    v_mfma_f32_16x16x32_bf16 v[64:67], a[96:99], v[168:171], v[64:67]
    ds_read_b128 a[88:91], v182 offset:45056
    v_mfma_f32_16x16x32_bf16 v[96:99], a[96:99], v[172:175], v[96:99]
    v_exp_f32 v139, v139
    v_mfma_f32_16x16x32_bf16 v[68:71], a[100:103], v[168:171], v[68:71]
    ds_read_b128 a[92:95], v183 offset:45056
    v_cvt_pk_bf16_f32 v165, v138, v139
    v_mfma_f32_16x16x32_bf16 v[100:103], a[100:103], v[172:175], v[100:103]
    buffer_load_dwordx4 v198, s[16:19], s28 offen offset:2048 nt lds
    v_mfma_f32_16x16x32_bf16 v[72:75], a[104:107], v[168:171], v[72:75]
    v_exp_f32 v140, v140
    v_mfma_f32_16x16x32_bf16 v[104:107], a[104:107], v[172:175], v[104:107]
    v_exp_f32 v141, v141
    v_mfma_f32_16x16x32_bf16 v[76:79], a[108:111], v[168:171], v[76:79]
    v_exp_f32 v142, v142
    v_mfma_f32_16x16x32_bf16 v[108:111], a[108:111], v[172:175], v[108:111]
    v_exp_f32 v143, v143
    v_mfma_f32_16x16x32_bf16 v[80:83], a[112:115], v[168:171], v[80:83]
    v_cvt_pk_bf16_f32 v166, v140, v141
    v_cvt_pk_bf16_f32 v167, v142, v143
    v_mfma_f32_16x16x32_bf16 v[112:115], a[112:115], v[172:175], v[112:115]
    v_mfma_f32_16x16x32_bf16 v[84:87], a[116:119], v[168:171], v[84:87]
    v_mfma_f32_16x16x32_bf16 v[116:119], a[116:119], v[172:175], v[116:119]
    buffer_load_dwordx4 v199, s[16:19], s28 offen offset:3072 nt lds
    s_add_u32 s28, s28, 16384
    v_mfma_f32_16x16x32_bf16 v[88:91], a[120:123], v[168:171], v[88:91]
    v_mfma_f32_16x16x32_bf16 v[120:123], a[120:123], v[172:175], v[120:123]
    v_mfma_f32_16x16x32_bf16 v[92:95], a[124:127], v[168:171], v[92:95]
    v_mfma_f32_16x16x32_bf16 v[124:127], a[124:127], v[172:175], v[124:127]
    s_waitcnt lgkmcnt(0)
    v_mfma_f32_16x16x32_bf16 v[128:131], a[64:67], a[128:131], 0
    s_waitcnt vmcnt(20)
    s_barrier
    ds_read_b64_tr_b16 a[96:97], v188 offset:32768
    v_mfma_f32_16x16x32_bf16 v[128:131], a[68:71], a[132:135], v[128:131]
    v_exp_f32 v144, v144
    v_mfma_f32_16x16x32_bf16 v[128:131], a[72:75], a[136:139], v[128:131]
    ds_read_b64_tr_b16 a[98:99], v188 offset:36864
    v_exp_f32 v145, v145
    v_mfma_f32_16x16x32_bf16 v[128:131], a[76:79], a[140:143], v[128:131]
    v_exp_f32 v146, v146
    v_mfma_f32_16x16x32_bf16 v[136:139], a[64:67], a[144:147], 0
    ds_read_b64_tr_b16 a[100:101], v189 offset:32768
    v_exp_f32 v147, v147
    v_mfma_f32_16x16x32_bf16 v[136:139], a[68:71], a[148:151], v[136:139]
    v_exp_f32 v148, v148
    v_cvt_pk_bf16_f32 v168, v144, v145
    v_mfma_f32_16x16x32_bf16 v[136:139], a[72:75], a[152:155], v[136:139]
    ds_read_b64_tr_b16 a[102:103], v189 offset:36864
    v_exp_f32 v149, v149
    v_mfma_f32_16x16x32_bf16 v[136:139], a[76:79], a[156:159], v[136:139]
    v_exp_f32 v150, v150
    v_cvt_pk_bf16_f32 v169, v146, v147
    v_mfma_f32_16x16x32_bf16 v[132:135], a[80:83], a[128:131], 0
    ds_read_b64_tr_b16 a[104:105], v190 offset:32768
    v_exp_f32 v151, v151
    v_mfma_f32_16x16x32_bf16 v[132:135], a[84:87], a[132:135], v[132:135]
    s_add_u32 m0, s30, 81920
    s_nop 0
    buffer_load_dwordx4 v200, s[20:23], s29 offen offset:0 nt lds
    v_mfma_f32_16x16x32_bf16 v[132:135], a[88:91], a[136:139], v[132:135]
    ds_read_b64_tr_b16 a[106:107], v190 offset:36864
    v_cvt_pk_bf16_f32 v170, v148, v149
    v_mfma_f32_16x16x32_bf16 v[132:135], a[92:95], a[140:143], v[132:135]
    v_exp_f32 v152, v152
    v_cvt_pk_bf16_f32 v171, v150, v151
    v_mfma_f32_16x16x32_bf16 v[140:143], a[80:83], a[144:147], 0
    ds_read_b64_tr_b16 a[108:109], v191 offset:32768
    v_mfma_f32_16x16x32_bf16 v[140:143], a[84:87], a[148:151], v[140:143]
    v_exp_f32 v153, v153
    v_mfma_f32_16x16x32_bf16 v[140:143], a[88:91], a[152:155], v[140:143]
    ds_read_b64_tr_b16 a[110:111], v191 offset:36864
    v_cvt_pk_bf16_f32 v172, v152, v153
    v_mfma_f32_16x16x32_bf16 v[140:143], a[92:95], a[156:159], v[140:143]
    v_exp_f32 v154, v154
    v_mfma_f32_16x16x32_bf16 v[176:179], v[242:245], v[160:163], v[176:179]
    ds_read_b64_tr_b16 a[112:113], v192 offset:32768
    v_mfma_f32_16x16x32_bf16 v[184:187], v[242:245], v[164:167], v[184:187]
    ds_read_b64_tr_b16 a[114:115], v192 offset:36864
    s_waitcnt lgkmcnt(6)
    v_mfma_f32_16x16x32_bf16 v[0:3], a[96:99], v[160:163], v[0:3]
    v_exp_f32 v155, v155
    v_mfma_f32_16x16x32_bf16 v[32:35], a[96:99], v[164:167], v[32:35]
    ds_read_b64_tr_b16 a[116:117], v193 offset:32768
    v_cvt_pk_bf16_f32 v173, v154, v155
    v_mfma_f32_16x16x32_bf16 v[4:7], a[100:103], v[160:163], v[4:7]
    ds_read_b64_tr_b16 a[118:119], v193 offset:36864
    v_mfma_f32_16x16x32_bf16 v[36:39], a[100:103], v[164:167], v[36:39]
    s_waitcnt lgkmcnt(4)
    v_mfma_f32_16x16x32_bf16 v[8:11], a[104:107], v[160:163], v[8:11]
    ds_read_b64_tr_b16 a[120:121], v194 offset:32768
    v_mfma_f32_16x16x32_bf16 v[40:43], a[104:107], v[164:167], v[40:43]
    ds_read_b64_tr_b16 a[122:123], v194 offset:36864
    v_mfma_f32_16x16x32_bf16 v[12:15], a[108:111], v[160:163], v[12:15]
    v_exp_f32 v156, v156
    v_mfma_f32_16x16x32_bf16 v[44:47], a[108:111], v[164:167], v[44:47]
    ds_read_b64_tr_b16 a[124:125], v195 offset:32768
    s_waitcnt lgkmcnt(3)
    v_mfma_f32_16x16x32_bf16 v[16:19], a[112:115], v[160:163], v[16:19]
    ds_read_b64_tr_b16 a[126:127], v195 offset:36864
    v_mfma_f32_16x16x32_bf16 v[48:51], a[112:115], v[164:167], v[48:51]
    v_exp_f32 v157, v157
    v_mfma_f32_16x16x32_bf16 v[20:23], a[116:119], v[160:163], v[20:23]
    buffer_load_dwordx4 v201, s[20:23], s29 offen offset:1024 nt lds
    v_cvt_pk_bf16_f32 v174, v156, v157
    v_mfma_f32_16x16x32_bf16 v[52:55], a[116:119], v[164:167], v[52:55]
    s_waitcnt lgkmcnt(0)
    v_mfma_f32_16x16x32_bf16 v[24:27], a[120:123], v[160:163], v[24:27]
    v_exp_f32 v158, v158
    v_mfma_f32_16x16x32_bf16 v[56:59], a[120:123], v[164:167], v[56:59]
    v_exp_f32 v159, v159
    v_mfma_f32_16x16x32_bf16 v[28:31], a[124:127], v[160:163], v[28:31]
    v_cvt_pk_bf16_f32 v175, v158, v159
    v_mfma_f32_16x16x32_bf16 v[60:63], a[124:127], v[164:167], v[60:63]
    v_mfma_f32_16x16x32_bf16 v[144:147], a[64:67], a[160:163], 0
    v_exp_f32 v128, v128
    v_mfma_f32_16x16x32_bf16 v[144:147], a[68:71], a[164:167], v[144:147]
    v_exp_f32 v129, v129
    v_mfma_f32_16x16x32_bf16 v[144:147], a[72:75], a[168:171], v[144:147]
    v_exp_f32 v130, v130
    v_mfma_f32_16x16x32_bf16 v[144:147], a[76:79], a[172:175], v[144:147]
    v_exp_f32 v131, v131
    v_mfma_f32_16x16x32_bf16 v[152:155], a[64:67], a[176:179], 0
    s_add_u32 s39, s52, 4096
    buffer_store_dwordx4 a[208:211], v202, s[24:27], s39 offen offset:0 sc0 sc1 nt
    v_cvt_pk_bf16_f32 v160, v128, v129
    v_mfma_f32_16x16x32_bf16 v[152:155], a[68:71], a[180:183], v[152:155]
    v_exp_f32 v132, v132
    v_mfma_f32_16x16x32_bf16 v[152:155], a[72:75], a[184:187], v[152:155]
    ds_read_b128 a[64:67], v180 offset:49152
    v_cvt_pk_bf16_f32 v161, v130, v131
    v_mfma_f32_16x16x32_bf16 v[152:155], a[76:79], a[188:191], v[152:155]
    v_exp_f32 v133, v133
    v_mfma_f32_16x16x32_bf16 v[148:151], a[80:83], a[160:163], 0
    ds_read_b128 a[68:71], v181 offset:49152
    v_cvt_pk_bf16_f32 v162, v132, v133
    v_mfma_f32_16x16x32_bf16 v[148:151], a[84:87], a[164:167], v[148:151]
    v_exp_f32 v134, v134
    v_mfma_f32_16x16x32_bf16 v[148:151], a[88:91], a[168:171], v[148:151]
    ds_read_b128 a[72:75], v182 offset:49152
    v_mfma_f32_16x16x32_bf16 v[148:151], a[92:95], a[172:175], v[148:151]
    v_exp_f32 v135, v135
    v_mfma_f32_16x16x32_bf16 v[156:159], a[80:83], a[176:179], 0
    ds_read_b128 a[76:79], v183 offset:49152
    v_cvt_pk_bf16_f32 v163, v134, v135
    v_mfma_f32_16x16x32_bf16 v[156:159], a[84:87], a[180:183], v[156:159]
    v_exp_f32 v136, v136
    v_mfma_f32_16x16x32_bf16 v[156:159], a[88:91], a[184:187], v[156:159]
    ds_read_b128 a[80:83], v180 offset:53248
    v_mfma_f32_16x16x32_bf16 v[156:159], a[92:95], a[188:191], v[156:159]
    v_exp_f32 v137, v137
    v_mfma_f32_16x16x32_bf16 v[222:225], v[242:245], v[168:171], v[222:225]
    ds_read_b128 a[84:87], v181 offset:53248
    v_cvt_pk_bf16_f32 v164, v136, v137
    v_mfma_f32_16x16x32_bf16 v[246:249], v[242:245], v[172:175], v[246:249]
    v_exp_f32 v138, v138
    v_mfma_f32_16x16x32_bf16 v[64:67], a[96:99], v[168:171], v[64:67]
    ds_read_b128 a[88:91], v182 offset:53248
    v_mfma_f32_16x16x32_bf16 v[96:99], a[96:99], v[172:175], v[96:99]
    v_exp_f32 v139, v139
    v_mfma_f32_16x16x32_bf16 v[68:71], a[100:103], v[168:171], v[68:71]
    ds_read_b128 a[92:95], v183 offset:53248
    v_cvt_pk_bf16_f32 v165, v138, v139
    v_mfma_f32_16x16x32_bf16 v[100:103], a[100:103], v[172:175], v[100:103]
    buffer_load_dwordx4 v200, s[20:23], s29 offen offset:2048 nt lds
    v_mfma_f32_16x16x32_bf16 v[72:75], a[104:107], v[168:171], v[72:75]
    v_exp_f32 v140, v140
    v_mfma_f32_16x16x32_bf16 v[104:107], a[104:107], v[172:175], v[104:107]
    v_exp_f32 v141, v141
    v_mfma_f32_16x16x32_bf16 v[76:79], a[108:111], v[168:171], v[76:79]
    v_exp_f32 v142, v142
    v_mfma_f32_16x16x32_bf16 v[108:111], a[108:111], v[172:175], v[108:111]
    v_exp_f32 v143, v143
    v_mfma_f32_16x16x32_bf16 v[80:83], a[112:115], v[168:171], v[80:83]
    v_cvt_pk_bf16_f32 v166, v140, v141
    v_cvt_pk_bf16_f32 v167, v142, v143
    v_mfma_f32_16x16x32_bf16 v[112:115], a[112:115], v[172:175], v[112:115]
    v_mfma_f32_16x16x32_bf16 v[84:87], a[116:119], v[168:171], v[84:87]
    v_mfma_f32_16x16x32_bf16 v[116:119], a[116:119], v[172:175], v[116:119]
    buffer_load_dwordx4 v201, s[20:23], s29 offen offset:3072 nt lds
    s_add_u32 s29, s29, 16384
    v_mfma_f32_16x16x32_bf16 v[88:91], a[120:123], v[168:171], v[88:91]
    v_mfma_f32_16x16x32_bf16 v[120:123], a[120:123], v[172:175], v[120:123]
    v_mfma_f32_16x16x32_bf16 v[92:95], a[124:127], v[168:171], v[92:95]
    v_mfma_f32_16x16x32_bf16 v[124:127], a[124:127], v[172:175], v[124:127]
    s_waitcnt lgkmcnt(0)
    v_mfma_f32_16x16x32_bf16 v[128:131], a[64:67], a[128:131], 0
    ds_read_b64_tr_b16 a[96:97], v188 offset:40960
    v_exp_f32 v144, v144
    v_mfma_f32_16x16x32_bf16 v[128:131], a[68:71], a[132:135], v[128:131]
    v_exp_f32 v145, v145
    v_mfma_f32_16x16x32_bf16 v[128:131], a[72:75], a[136:139], v[128:131]
    ds_read_b64_tr_b16 a[98:99], v188 offset:45056
    v_exp_f32 v146, v146
    v_mfma_f32_16x16x32_bf16 v[128:131], a[76:79], a[140:143], v[128:131]
    v_exp_f32 v147, v147
    v_mfma_f32_16x16x32_bf16 v[136:139], a[64:67], a[144:147], 0
    ds_read_b64_tr_b16 a[100:101], v189 offset:40960
    v_exp_f32 v148, v148
    v_mfma_f32_16x16x32_bf16 v[136:139], a[68:71], a[148:151], v[136:139]
    v_exp_f32 v149, v149
    v_cvt_pk_bf16_f32 v168, v144, v145
    v_mfma_f32_16x16x32_bf16 v[136:139], a[72:75], a[152:155], v[136:139]
    ds_read_b64_tr_b16 a[102:103], v189 offset:45056
    v_exp_f32 v150, v150
    v_mfma_f32_16x16x32_bf16 v[136:139], a[76:79], a[156:159], v[136:139]
    v_exp_f32 v151, v151
    v_cvt_pk_bf16_f32 v169, v146, v147
    v_mfma_f32_16x16x32_bf16 v[132:135], a[80:83], a[128:131], 0
    ds_read_b64_tr_b16 a[104:105], v190 offset:40960
    v_cvt_pk_bf16_f32 v170, v148, v149
    v_mfma_f32_16x16x32_bf16 v[132:135], a[84:87], a[132:135], v[132:135]
    s_add_u32 m0, s30, 32768
    s_nop 0
    buffer_load_dwordx4 v196, s[16:19], s28 offen offset:0 nt lds
    v_mfma_f32_16x16x32_bf16 v[132:135], a[88:91], a[136:139], v[132:135]
    ds_read_b64_tr_b16 a[106:107], v190 offset:45056
    v_cvt_pk_bf16_f32 v171, v150, v151
    v_mfma_f32_16x16x32_bf16 v[132:135], a[92:95], a[140:143], v[132:135]
    v_exp_f32 v152, v152
    v_mfma_f32_16x16x32_bf16 v[140:143], a[80:83], a[144:147], 0
    ds_read_b64_tr_b16 a[108:109], v191 offset:40960
    v_mfma_f32_16x16x32_bf16 v[140:143], a[84:87], a[148:151], v[140:143]
    v_exp_f32 v153, v153
    v_mfma_f32_16x16x32_bf16 v[140:143], a[88:91], a[152:155], v[140:143]
    ds_read_b64_tr_b16 a[110:111], v191 offset:45056
    v_cvt_pk_bf16_f32 v172, v152, v153
    v_mfma_f32_16x16x32_bf16 v[140:143], a[92:95], a[156:159], v[140:143]
    v_exp_f32 v154, v154
    v_mfma_f32_16x16x32_bf16 v[176:179], v[242:245], v[160:163], v[176:179]
    ds_read_b64_tr_b16 a[112:113], v192 offset:40960
    v_mfma_f32_16x16x32_bf16 v[184:187], v[242:245], v[164:167], v[184:187]
    ds_read_b64_tr_b16 a[114:115], v192 offset:45056
    s_waitcnt lgkmcnt(6)
    v_mfma_f32_16x16x32_bf16 v[0:3], a[96:99], v[160:163], v[0:3]
    v_exp_f32 v155, v155
    v_mfma_f32_16x16x32_bf16 v[32:35], a[96:99], v[164:167], v[32:35]
    ds_read_b64_tr_b16 a[116:117], v193 offset:40960
    v_cvt_pk_bf16_f32 v173, v154, v155
    v_mfma_f32_16x16x32_bf16 v[4:7], a[100:103], v[160:163], v[4:7]
    ds_read_b64_tr_b16 a[118:119], v193 offset:45056
    v_mfma_f32_16x16x32_bf16 v[36:39], a[100:103], v[164:167], v[36:39]
    s_waitcnt lgkmcnt(4)
    v_mfma_f32_16x16x32_bf16 v[8:11], a[104:107], v[160:163], v[8:11]
    ds_read_b64_tr_b16 a[120:121], v194 offset:40960
    v_mfma_f32_16x16x32_bf16 v[40:43], a[104:107], v[164:167], v[40:43]
    ds_read_b64_tr_b16 a[122:123], v194 offset:45056
    v_mfma_f32_16x16x32_bf16 v[12:15], a[108:111], v[160:163], v[12:15]
    v_exp_f32 v156, v156
    v_mfma_f32_16x16x32_bf16 v[44:47], a[108:111], v[164:167], v[44:47]
    ds_read_b64_tr_b16 a[124:125], v195 offset:40960
    s_waitcnt lgkmcnt(3)
    v_mfma_f32_16x16x32_bf16 v[16:19], a[112:115], v[160:163], v[16:19]
    ds_read_b64_tr_b16 a[126:127], v195 offset:45056
    v_mfma_f32_16x16x32_bf16 v[48:51], a[112:115], v[164:167], v[48:51]
    v_exp_f32 v157, v157
    v_mfma_f32_16x16x32_bf16 v[20:23], a[116:119], v[160:163], v[20:23]
    buffer_load_dwordx4 v197, s[16:19], s28 offen offset:1024 nt lds
    v_cvt_pk_bf16_f32 v174, v156, v157
    v_mfma_f32_16x16x32_bf16 v[52:55], a[116:119], v[164:167], v[52:55]
    s_waitcnt lgkmcnt(0)
    v_mfma_f32_16x16x32_bf16 v[24:27], a[120:123], v[160:163], v[24:27]
    v_exp_f32 v158, v158
    v_mfma_f32_16x16x32_bf16 v[56:59], a[120:123], v[164:167], v[56:59]
    v_exp_f32 v159, v159
    v_mfma_f32_16x16x32_bf16 v[28:31], a[124:127], v[160:163], v[28:31]
    v_cvt_pk_bf16_f32 v175, v158, v159
    v_mfma_f32_16x16x32_bf16 v[60:63], a[124:127], v[164:167], v[60:63]
    v_mfma_f32_16x16x32_bf16 v[144:147], a[64:67], a[160:163], 0
    v_exp_f32 v128, v128
    v_mfma_f32_16x16x32_bf16 v[144:147], a[68:71], a[164:167], v[144:147]
    v_exp_f32 v129, v129
    v_mfma_f32_16x16x32_bf16 v[144:147], a[72:75], a[168:171], v[144:147]
    v_exp_f32 v130, v130
    v_mfma_f32_16x16x32_bf16 v[144:147], a[76:79], a[172:175], v[144:147]
    v_exp_f32 v131, v131
    v_mfma_f32_16x16x32_bf16 v[152:155], a[64:67], a[176:179], 0
    s_add_u32 s39, s52, 4096
    buffer_store_dwordx4 a[212:215], v203, s[24:27], s39 offen offset:1024 sc0 sc1 nt
    v_cvt_pk_bf16_f32 v160, v128, v129
    v_mfma_f32_16x16x32_bf16 v[152:155], a[68:71], a[180:183], v[152:155]
    v_exp_f32 v132, v132
    v_mfma_f32_16x16x32_bf16 v[152:155], a[72:75], a[184:187], v[152:155]
    ds_read_b128 a[64:67], v180 offset:57344
    v_cvt_pk_bf16_f32 v161, v130, v131
    v_mfma_f32_16x16x32_bf16 v[152:155], a[76:79], a[188:191], v[152:155]
    v_exp_f32 v133, v133
    v_mfma_f32_16x16x32_bf16 v[148:151], a[80:83], a[160:163], 0
    ds_read_b128 a[68:71], v181 offset:57344
    v_cvt_pk_bf16_f32 v162, v132, v133
    v_mfma_f32_16x16x32_bf16 v[148:151], a[84:87], a[164:167], v[148:151]
    v_exp_f32 v134, v134
    v_mfma_f32_16x16x32_bf16 v[148:151], a[88:91], a[168:171], v[148:151]
    ds_read_b128 a[72:75], v182 offset:57344
    v_mfma_f32_16x16x32_bf16 v[148:151], a[92:95], a[172:175], v[148:151]
    v_exp_f32 v135, v135
    v_mfma_f32_16x16x32_bf16 v[156:159], a[80:83], a[176:179], 0
    ds_read_b128 a[76:79], v183 offset:57344
    v_cvt_pk_bf16_f32 v163, v134, v135
    v_mfma_f32_16x16x32_bf16 v[156:159], a[84:87], a[180:183], v[156:159]
    v_exp_f32 v136, v136
    v_mfma_f32_16x16x32_bf16 v[156:159], a[88:91], a[184:187], v[156:159]
    ds_read_b128 a[80:83], v180 offset:61440
    v_mfma_f32_16x16x32_bf16 v[156:159], a[92:95], a[188:191], v[156:159]
    v_exp_f32 v137, v137
    v_mfma_f32_16x16x32_bf16 v[222:225], v[242:245], v[168:171], v[222:225]
    ds_read_b128 a[84:87], v181 offset:61440
    v_cvt_pk_bf16_f32 v164, v136, v137
    v_mfma_f32_16x16x32_bf16 v[246:249], v[242:245], v[172:175], v[246:249]
    v_exp_f32 v138, v138
    v_mfma_f32_16x16x32_bf16 v[64:67], a[96:99], v[168:171], v[64:67]
    ds_read_b128 a[88:91], v182 offset:61440
    v_mfma_f32_16x16x32_bf16 v[96:99], a[96:99], v[172:175], v[96:99]
    v_exp_f32 v139, v139
    v_mfma_f32_16x16x32_bf16 v[68:71], a[100:103], v[168:171], v[68:71]
    ds_read_b128 a[92:95], v183 offset:61440
    v_cvt_pk_bf16_f32 v165, v138, v139
    v_mfma_f32_16x16x32_bf16 v[100:103], a[100:103], v[172:175], v[100:103]
    buffer_load_dwordx4 v198, s[16:19], s28 offen offset:2048 nt lds
    v_mfma_f32_16x16x32_bf16 v[72:75], a[104:107], v[168:171], v[72:75]
    v_exp_f32 v140, v140
    v_mfma_f32_16x16x32_bf16 v[104:107], a[104:107], v[172:175], v[104:107]
    v_exp_f32 v141, v141
    v_mfma_f32_16x16x32_bf16 v[76:79], a[108:111], v[168:171], v[76:79]
    v_exp_f32 v142, v142
    v_mfma_f32_16x16x32_bf16 v[108:111], a[108:111], v[172:175], v[108:111]
    v_exp_f32 v143, v143
    v_mfma_f32_16x16x32_bf16 v[80:83], a[112:115], v[168:171], v[80:83]
    v_cvt_pk_bf16_f32 v166, v140, v141
    v_cvt_pk_bf16_f32 v167, v142, v143
    v_mfma_f32_16x16x32_bf16 v[112:115], a[112:115], v[172:175], v[112:115]
    v_mfma_f32_16x16x32_bf16 v[84:87], a[116:119], v[168:171], v[84:87]
    v_mfma_f32_16x16x32_bf16 v[116:119], a[116:119], v[172:175], v[116:119]
    buffer_load_dwordx4 v199, s[16:19], s28 offen offset:3072 nt lds
    s_add_u32 s28, s28, 16384
    v_mfma_f32_16x16x32_bf16 v[88:91], a[120:123], v[168:171], v[88:91]
    v_mfma_f32_16x16x32_bf16 v[120:123], a[120:123], v[172:175], v[120:123]
    v_mfma_f32_16x16x32_bf16 v[92:95], a[124:127], v[168:171], v[92:95]
    v_mfma_f32_16x16x32_bf16 v[124:127], a[124:127], v[172:175], v[124:127]
    s_waitcnt lgkmcnt(0)
    v_mfma_f32_16x16x32_bf16 v[128:131], a[64:67], a[128:131], 0
    s_waitcnt vmcnt(20)
    s_barrier
    ds_read_b64_tr_b16 a[96:97], v188 offset:49152
    v_mfma_f32_16x16x32_bf16 v[128:131], a[68:71], a[132:135], v[128:131]
    v_exp_f32 v144, v144
    v_mfma_f32_16x16x32_bf16 v[128:131], a[72:75], a[136:139], v[128:131]
    ds_read_b64_tr_b16 a[98:99], v188 offset:53248
    v_exp_f32 v145, v145
    v_mfma_f32_16x16x32_bf16 v[128:131], a[76:79], a[140:143], v[128:131]
    v_exp_f32 v146, v146
    v_mfma_f32_16x16x32_bf16 v[136:139], a[64:67], a[144:147], 0
    ds_read_b64_tr_b16 a[100:101], v189 offset:49152
    v_exp_f32 v147, v147
    v_mfma_f32_16x16x32_bf16 v[136:139], a[68:71], a[148:151], v[136:139]
    v_exp_f32 v148, v148
    v_cvt_pk_bf16_f32 v168, v144, v145
    v_mfma_f32_16x16x32_bf16 v[136:139], a[72:75], a[152:155], v[136:139]
    ds_read_b64_tr_b16 a[102:103], v189 offset:53248
    v_exp_f32 v149, v149
    v_mfma_f32_16x16x32_bf16 v[136:139], a[76:79], a[156:159], v[136:139]
    v_exp_f32 v150, v150
    v_cvt_pk_bf16_f32 v169, v146, v147
    v_mfma_f32_16x16x32_bf16 v[132:135], a[80:83], a[128:131], 0
    ds_read_b64_tr_b16 a[104:105], v190 offset:49152
    v_exp_f32 v151, v151
    v_mfma_f32_16x16x32_bf16 v[132:135], a[84:87], a[132:135], v[132:135]
    s_add_u32 m0, s30, 98304
    s_nop 0
    buffer_load_dwordx4 v200, s[20:23], s29 offen offset:0 nt lds
    v_mfma_f32_16x16x32_bf16 v[132:135], a[88:91], a[136:139], v[132:135]
    ds_read_b64_tr_b16 a[106:107], v190 offset:53248
    v_cvt_pk_bf16_f32 v170, v148, v149
    v_mfma_f32_16x16x32_bf16 v[132:135], a[92:95], a[140:143], v[132:135]
    v_exp_f32 v152, v152
    v_cvt_pk_bf16_f32 v171, v150, v151
    v_mfma_f32_16x16x32_bf16 v[140:143], a[80:83], a[144:147], 0
    ds_read_b64_tr_b16 a[108:109], v191 offset:49152
    v_mfma_f32_16x16x32_bf16 v[140:143], a[84:87], a[148:151], v[140:143]
    v_exp_f32 v153, v153
    v_mfma_f32_16x16x32_bf16 v[140:143], a[88:91], a[152:155], v[140:143]
    ds_read_b64_tr_b16 a[110:111], v191 offset:53248
    v_cvt_pk_bf16_f32 v172, v152, v153
    v_mfma_f32_16x16x32_bf16 v[140:143], a[92:95], a[156:159], v[140:143]
    v_exp_f32 v154, v154
    v_mfma_f32_16x16x32_bf16 v[176:179], v[242:245], v[160:163], v[176:179]
    ds_read_b64_tr_b16 a[112:113], v192 offset:49152
    v_mfma_f32_16x16x32_bf16 v[184:187], v[242:245], v[164:167], v[184:187]
    ds_read_b64_tr_b16 a[114:115], v192 offset:53248
    s_waitcnt lgkmcnt(6)
    v_mfma_f32_16x16x32_bf16 v[0:3], a[96:99], v[160:163], v[0:3]
    v_exp_f32 v155, v155
    v_mfma_f32_16x16x32_bf16 v[32:35], a[96:99], v[164:167], v[32:35]
    ds_read_b64_tr_b16 a[116:117], v193 offset:49152
    v_cvt_pk_bf16_f32 v173, v154, v155
    v_mfma_f32_16x16x32_bf16 v[4:7], a[100:103], v[160:163], v[4:7]
    ds_read_b64_tr_b16 a[118:119], v193 offset:53248
    v_mfma_f32_16x16x32_bf16 v[36:39], a[100:103], v[164:167], v[36:39]
    s_waitcnt lgkmcnt(4)
    v_mfma_f32_16x16x32_bf16 v[8:11], a[104:107], v[160:163], v[8:11]
    ds_read_b64_tr_b16 a[120:121], v194 offset:49152
    v_mfma_f32_16x16x32_bf16 v[40:43], a[104:107], v[164:167], v[40:43]
    ds_read_b64_tr_b16 a[122:123], v194 offset:53248
    v_mfma_f32_16x16x32_bf16 v[12:15], a[108:111], v[160:163], v[12:15]
    v_exp_f32 v156, v156
    v_mfma_f32_16x16x32_bf16 v[44:47], a[108:111], v[164:167], v[44:47]
    ds_read_b64_tr_b16 a[124:125], v195 offset:49152
    s_waitcnt lgkmcnt(3)
    v_mfma_f32_16x16x32_bf16 v[16:19], a[112:115], v[160:163], v[16:19]
    ds_read_b64_tr_b16 a[126:127], v195 offset:53248
    v_mfma_f32_16x16x32_bf16 v[48:51], a[112:115], v[164:167], v[48:51]
    v_exp_f32 v157, v157
    v_mfma_f32_16x16x32_bf16 v[20:23], a[116:119], v[160:163], v[20:23]
    buffer_load_dwordx4 v201, s[20:23], s29 offen offset:1024 nt lds
    v_cvt_pk_bf16_f32 v174, v156, v157
    v_mfma_f32_16x16x32_bf16 v[52:55], a[116:119], v[164:167], v[52:55]
    s_waitcnt lgkmcnt(0)
    v_mfma_f32_16x16x32_bf16 v[24:27], a[120:123], v[160:163], v[24:27]
    v_exp_f32 v158, v158
    v_mfma_f32_16x16x32_bf16 v[56:59], a[120:123], v[164:167], v[56:59]
    v_exp_f32 v159, v159
    v_mfma_f32_16x16x32_bf16 v[28:31], a[124:127], v[160:163], v[28:31]
    v_cvt_pk_bf16_f32 v175, v158, v159
    v_mfma_f32_16x16x32_bf16 v[60:63], a[124:127], v[164:167], v[60:63]
    v_mfma_f32_16x16x32_bf16 v[144:147], a[64:67], a[160:163], 0
    v_exp_f32 v128, v128
    v_mfma_f32_16x16x32_bf16 v[144:147], a[68:71], a[164:167], v[144:147]
    v_exp_f32 v129, v129
    v_mfma_f32_16x16x32_bf16 v[144:147], a[72:75], a[168:171], v[144:147]
    v_exp_f32 v130, v130
    v_mfma_f32_16x16x32_bf16 v[144:147], a[76:79], a[172:175], v[144:147]
    v_exp_f32 v131, v131
    v_mfma_f32_16x16x32_bf16 v[152:155], a[64:67], a[176:179], 0
    s_add_u32 s39, s52, 4096
    buffer_store_dwordx4 a[216:219], v202, s[24:27], s39 offen offset:2048 sc0 sc1 nt
    v_cvt_pk_bf16_f32 v160, v128, v129
    v_mfma_f32_16x16x32_bf16 v[152:155], a[68:71], a[180:183], v[152:155]
    v_exp_f32 v132, v132
    v_mfma_f32_16x16x32_bf16 v[152:155], a[72:75], a[184:187], v[152:155]
    ds_read_b128 a[64:67], v180 offset:0
    v_cvt_pk_bf16_f32 v161, v130, v131
    v_mfma_f32_16x16x32_bf16 v[152:155], a[76:79], a[188:191], v[152:155]
    v_exp_f32 v133, v133
    v_mfma_f32_16x16x32_bf16 v[148:151], a[80:83], a[160:163], 0
    ds_read_b128 a[68:71], v181 offset:0
    v_cvt_pk_bf16_f32 v162, v132, v133
    v_mfma_f32_16x16x32_bf16 v[148:151], a[84:87], a[164:167], v[148:151]
    v_exp_f32 v134, v134
    v_mfma_f32_16x16x32_bf16 v[148:151], a[88:91], a[168:171], v[148:151]
    ds_read_b128 a[72:75], v182 offset:0
    v_mfma_f32_16x16x32_bf16 v[148:151], a[92:95], a[172:175], v[148:151]
    v_exp_f32 v135, v135
    v_mfma_f32_16x16x32_bf16 v[156:159], a[80:83], a[176:179], 0
    ds_read_b128 a[76:79], v183 offset:0
    v_cvt_pk_bf16_f32 v163, v134, v135
    v_mfma_f32_16x16x32_bf16 v[156:159], a[84:87], a[180:183], v[156:159]
    v_exp_f32 v136, v136
    v_mfma_f32_16x16x32_bf16 v[156:159], a[88:91], a[184:187], v[156:159]
    ds_read_b128 a[80:83], v180 offset:4096
    v_mfma_f32_16x16x32_bf16 v[156:159], a[92:95], a[188:191], v[156:159]
    v_exp_f32 v137, v137
    v_mfma_f32_16x16x32_bf16 v[222:225], v[242:245], v[168:171], v[222:225]
    ds_read_b128 a[84:87], v181 offset:4096
    v_cvt_pk_bf16_f32 v164, v136, v137
    v_mfma_f32_16x16x32_bf16 v[246:249], v[242:245], v[172:175], v[246:249]
    v_exp_f32 v138, v138
    v_mfma_f32_16x16x32_bf16 v[64:67], a[96:99], v[168:171], v[64:67]
    ds_read_b128 a[88:91], v182 offset:4096
    v_mfma_f32_16x16x32_bf16 v[96:99], a[96:99], v[172:175], v[96:99]
    v_exp_f32 v139, v139
    v_mfma_f32_16x16x32_bf16 v[68:71], a[100:103], v[168:171], v[68:71]
    ds_read_b128 a[92:95], v183 offset:4096
    v_cvt_pk_bf16_f32 v165, v138, v139
    v_mfma_f32_16x16x32_bf16 v[100:103], a[100:103], v[172:175], v[100:103]
    buffer_load_dwordx4 v200, s[20:23], s29 offen offset:2048 nt lds
    v_mfma_f32_16x16x32_bf16 v[72:75], a[104:107], v[168:171], v[72:75]
    v_exp_f32 v140, v140
    v_mfma_f32_16x16x32_bf16 v[104:107], a[104:107], v[172:175], v[104:107]
    v_exp_f32 v141, v141
    v_mfma_f32_16x16x32_bf16 v[76:79], a[108:111], v[168:171], v[76:79]
    v_exp_f32 v142, v142
    v_mfma_f32_16x16x32_bf16 v[108:111], a[108:111], v[172:175], v[108:111]
    v_exp_f32 v143, v143
    v_mfma_f32_16x16x32_bf16 v[80:83], a[112:115], v[168:171], v[80:83]
    v_cvt_pk_bf16_f32 v166, v140, v141
    v_cvt_pk_bf16_f32 v167, v142, v143
    v_mfma_f32_16x16x32_bf16 v[112:115], a[112:115], v[172:175], v[112:115]
    v_mfma_f32_16x16x32_bf16 v[84:87], a[116:119], v[168:171], v[84:87]
    v_mfma_f32_16x16x32_bf16 v[116:119], a[116:119], v[172:175], v[116:119]
    buffer_load_dwordx4 v201, s[20:23], s29 offen offset:3072 nt lds
    s_add_u32 s29, s29, 16384
    v_mfma_f32_16x16x32_bf16 v[88:91], a[120:123], v[168:171], v[88:91]
    v_mfma_f32_16x16x32_bf16 v[120:123], a[120:123], v[172:175], v[120:123]
    v_mfma_f32_16x16x32_bf16 v[92:95], a[124:127], v[168:171], v[92:95]
    v_mfma_f32_16x16x32_bf16 v[124:127], a[124:127], v[172:175], v[124:127]
    s_waitcnt lgkmcnt(0)
    v_mfma_f32_16x16x32_bf16 v[128:131], a[64:67], a[128:131], 0
    ds_read_b64_tr_b16 a[96:97], v188 offset:57344
    v_exp_f32 v144, v144
    v_mfma_f32_16x16x32_bf16 v[128:131], a[68:71], a[132:135], v[128:131]
    v_exp_f32 v145, v145
    v_mfma_f32_16x16x32_bf16 v[128:131], a[72:75], a[136:139], v[128:131]
    ds_read_b64_tr_b16 a[98:99], v188 offset:61440
    v_exp_f32 v146, v146
    v_mfma_f32_16x16x32_bf16 v[128:131], a[76:79], a[140:143], v[128:131]
    v_exp_f32 v147, v147
    v_mfma_f32_16x16x32_bf16 v[136:139], a[64:67], a[144:147], 0
    ds_read_b64_tr_b16 a[100:101], v189 offset:57344
    v_exp_f32 v148, v148
    v_mfma_f32_16x16x32_bf16 v[136:139], a[68:71], a[148:151], v[136:139]
    v_exp_f32 v149, v149
    v_cvt_pk_bf16_f32 v168, v144, v145
    v_mfma_f32_16x16x32_bf16 v[136:139], a[72:75], a[152:155], v[136:139]
    ds_read_b64_tr_b16 a[102:103], v189 offset:61440
    v_exp_f32 v150, v150
    v_mfma_f32_16x16x32_bf16 v[136:139], a[76:79], a[156:159], v[136:139]
    v_exp_f32 v151, v151
    v_cvt_pk_bf16_f32 v169, v146, v147
    v_mfma_f32_16x16x32_bf16 v[132:135], a[80:83], a[128:131], 0
    ds_read_b64_tr_b16 a[104:105], v190 offset:57344
    v_cvt_pk_bf16_f32 v170, v148, v149
    v_mfma_f32_16x16x32_bf16 v[132:135], a[84:87], a[132:135], v[132:135]
    s_add_u32 m0, s30, 49152
    s_nop 0
    buffer_load_dwordx4 v196, s[16:19], s28 offen offset:0 nt lds
    v_mfma_f32_16x16x32_bf16 v[132:135], a[88:91], a[136:139], v[132:135]
    ds_read_b64_tr_b16 a[106:107], v190 offset:61440
    v_cvt_pk_bf16_f32 v171, v150, v151
    v_mfma_f32_16x16x32_bf16 v[132:135], a[92:95], a[140:143], v[132:135]
    v_exp_f32 v152, v152
    v_mfma_f32_16x16x32_bf16 v[140:143], a[80:83], a[144:147], 0
    ds_read_b64_tr_b16 a[108:109], v191 offset:57344
    v_mfma_f32_16x16x32_bf16 v[140:143], a[84:87], a[148:151], v[140:143]
    v_exp_f32 v153, v153
    v_mfma_f32_16x16x32_bf16 v[140:143], a[88:91], a[152:155], v[140:143]
    ds_read_b64_tr_b16 a[110:111], v191 offset:61440
    v_cvt_pk_bf16_f32 v172, v152, v153
    v_mfma_f32_16x16x32_bf16 v[140:143], a[92:95], a[156:159], v[140:143]
    v_exp_f32 v154, v154
    v_mfma_f32_16x16x32_bf16 v[176:179], v[242:245], v[160:163], v[176:179]
    ds_read_b64_tr_b16 a[112:113], v192 offset:57344
    v_mfma_f32_16x16x32_bf16 v[184:187], v[242:245], v[164:167], v[184:187]
    ds_read_b64_tr_b16 a[114:115], v192 offset:61440
    s_waitcnt lgkmcnt(6)
    v_mfma_f32_16x16x32_bf16 v[0:3], a[96:99], v[160:163], v[0:3]
    v_exp_f32 v155, v155
    v_mfma_f32_16x16x32_bf16 v[32:35], a[96:99], v[164:167], v[32:35]
    ds_read_b64_tr_b16 a[116:117], v193 offset:57344
    v_cvt_pk_bf16_f32 v173, v154, v155
    v_mfma_f32_16x16x32_bf16 v[4:7], a[100:103], v[160:163], v[4:7]
    ds_read_b64_tr_b16 a[118:119], v193 offset:61440
    v_mfma_f32_16x16x32_bf16 v[36:39], a[100:103], v[164:167], v[36:39]
    s_waitcnt lgkmcnt(4)
    v_mfma_f32_16x16x32_bf16 v[8:11], a[104:107], v[160:163], v[8:11]
    ds_read_b64_tr_b16 a[120:121], v194 offset:57344
    v_mfma_f32_16x16x32_bf16 v[40:43], a[104:107], v[164:167], v[40:43]
    ds_read_b64_tr_b16 a[122:123], v194 offset:61440
    v_mfma_f32_16x16x32_bf16 v[12:15], a[108:111], v[160:163], v[12:15]
    v_exp_f32 v156, v156
    v_mfma_f32_16x16x32_bf16 v[44:47], a[108:111], v[164:167], v[44:47]
    ds_read_b64_tr_b16 a[124:125], v195 offset:57344
    s_waitcnt lgkmcnt(3)
    v_mfma_f32_16x16x32_bf16 v[16:19], a[112:115], v[160:163], v[16:19]
    ds_read_b64_tr_b16 a[126:127], v195 offset:61440
    v_mfma_f32_16x16x32_bf16 v[48:51], a[112:115], v[164:167], v[48:51]
    v_exp_f32 v157, v157
    v_mfma_f32_16x16x32_bf16 v[20:23], a[116:119], v[160:163], v[20:23]
    buffer_load_dwordx4 v197, s[16:19], s28 offen offset:1024 nt lds
    v_cvt_pk_bf16_f32 v174, v156, v157
    v_mfma_f32_16x16x32_bf16 v[52:55], a[116:119], v[164:167], v[52:55]
    s_waitcnt lgkmcnt(0)
    v_mfma_f32_16x16x32_bf16 v[24:27], a[120:123], v[160:163], v[24:27]
    v_exp_f32 v158, v158
    v_mfma_f32_16x16x32_bf16 v[56:59], a[120:123], v[164:167], v[56:59]
    v_exp_f32 v159, v159
    v_mfma_f32_16x16x32_bf16 v[28:31], a[124:127], v[160:163], v[28:31]
    v_cvt_pk_bf16_f32 v175, v158, v159
    v_mfma_f32_16x16x32_bf16 v[60:63], a[124:127], v[164:167], v[60:63]
    v_mfma_f32_16x16x32_bf16 v[144:147], a[64:67], a[160:163], 0
    v_exp_f32 v128, v128
    v_mfma_f32_16x16x32_bf16 v[144:147], a[68:71], a[164:167], v[144:147]
    v_exp_f32 v129, v129
    v_mfma_f32_16x16x32_bf16 v[144:147], a[72:75], a[168:171], v[144:147]
    v_exp_f32 v130, v130
    v_mfma_f32_16x16x32_bf16 v[144:147], a[76:79], a[172:175], v[144:147]
    v_exp_f32 v131, v131
    v_mfma_f32_16x16x32_bf16 v[152:155], a[64:67], a[176:179], 0
    s_add_u32 s39, s52, 4096
    buffer_store_dwordx4 a[220:223], v203, s[24:27], s39 offen offset:3072 sc0 sc1 nt
    v_cvt_pk_bf16_f32 v160, v128, v129
    v_mfma_f32_16x16x32_bf16 v[152:155], a[68:71], a[180:183], v[152:155]
    v_exp_f32 v132, v132
    v_mfma_f32_16x16x32_bf16 v[152:155], a[72:75], a[184:187], v[152:155]
    ds_read_b128 a[64:67], v180 offset:8192
    v_cvt_pk_bf16_f32 v161, v130, v131
    v_mfma_f32_16x16x32_bf16 v[152:155], a[76:79], a[188:191], v[152:155]
    v_exp_f32 v133, v133
    v_mfma_f32_16x16x32_bf16 v[148:151], a[80:83], a[160:163], 0
    ds_read_b128 a[68:71], v181 offset:8192
    v_cvt_pk_bf16_f32 v162, v132, v133
    v_mfma_f32_16x16x32_bf16 v[148:151], a[84:87], a[164:167], v[148:151]
    v_exp_f32 v134, v134
    v_mfma_f32_16x16x32_bf16 v[148:151], a[88:91], a[168:171], v[148:151]
    ds_read_b128 a[72:75], v182 offset:8192
    v_mfma_f32_16x16x32_bf16 v[148:151], a[92:95], a[172:175], v[148:151]
    v_exp_f32 v135, v135
    v_mfma_f32_16x16x32_bf16 v[156:159], a[80:83], a[176:179], 0
    ds_read_b128 a[76:79], v183 offset:8192
    v_cvt_pk_bf16_f32 v163, v134, v135
    v_mfma_f32_16x16x32_bf16 v[156:159], a[84:87], a[180:183], v[156:159]
    v_exp_f32 v136, v136
    v_mfma_f32_16x16x32_bf16 v[156:159], a[88:91], a[184:187], v[156:159]
    ds_read_b128 a[80:83], v180 offset:12288
    v_mfma_f32_16x16x32_bf16 v[156:159], a[92:95], a[188:191], v[156:159]
    v_exp_f32 v137, v137
    v_mfma_f32_16x16x32_bf16 v[222:225], v[242:245], v[168:171], v[222:225]
    ds_read_b128 a[84:87], v181 offset:12288
    v_cvt_pk_bf16_f32 v164, v136, v137
    v_mfma_f32_16x16x32_bf16 v[246:249], v[242:245], v[172:175], v[246:249]
    v_exp_f32 v138, v138
    v_mfma_f32_16x16x32_bf16 v[64:67], a[96:99], v[168:171], v[64:67]
    ds_read_b128 a[88:91], v182 offset:12288
    v_mfma_f32_16x16x32_bf16 v[96:99], a[96:99], v[172:175], v[96:99]
    v_exp_f32 v139, v139
    v_mfma_f32_16x16x32_bf16 v[68:71], a[100:103], v[168:171], v[68:71]
    ds_read_b128 a[92:95], v183 offset:12288
    v_cvt_pk_bf16_f32 v165, v138, v139
    v_mfma_f32_16x16x32_bf16 v[100:103], a[100:103], v[172:175], v[100:103]
    buffer_load_dwordx4 v198, s[16:19], s28 offen offset:2048 nt lds
    v_mfma_f32_16x16x32_bf16 v[72:75], a[104:107], v[168:171], v[72:75]
    v_exp_f32 v140, v140
    v_mfma_f32_16x16x32_bf16 v[104:107], a[104:107], v[172:175], v[104:107]
    v_exp_f32 v141, v141
    v_mfma_f32_16x16x32_bf16 v[76:79], a[108:111], v[168:171], v[76:79]
    v_exp_f32 v142, v142
    v_mfma_f32_16x16x32_bf16 v[108:111], a[108:111], v[172:175], v[108:111]
    v_exp_f32 v143, v143
    v_mfma_f32_16x16x32_bf16 v[80:83], a[112:115], v[168:171], v[80:83]
    v_cvt_pk_bf16_f32 v166, v140, v141
    v_cvt_pk_bf16_f32 v167, v142, v143
    v_mfma_f32_16x16x32_bf16 v[112:115], a[112:115], v[172:175], v[112:115]
    v_mfma_f32_16x16x32_bf16 v[84:87], a[116:119], v[168:171], v[84:87]
    v_mfma_f32_16x16x32_bf16 v[116:119], a[116:119], v[172:175], v[116:119]
    buffer_load_dwordx4 v199, s[16:19], s28 offen offset:3072 nt lds
    s_add_u32 s28, s28, 16384
    v_mfma_f32_16x16x32_bf16 v[88:91], a[120:123], v[168:171], v[88:91]
    v_mfma_f32_16x16x32_bf16 v[120:123], a[120:123], v[172:175], v[120:123]
    v_mfma_f32_16x16x32_bf16 v[92:95], a[124:127], v[168:171], v[92:95]
    v_mfma_f32_16x16x32_bf16 v[124:127], a[124:127], v[172:175], v[124:127]
    s_waitcnt lgkmcnt(0)
    v_mfma_f32_16x16x32_bf16 v[128:131], a[64:67], a[128:131], 0
    s_waitcnt vmcnt(20)
    s_barrier
    ds_read_b64_tr_b16 a[96:97], v188 offset:0
    v_mfma_f32_16x16x32_bf16 v[128:131], a[68:71], a[132:135], v[128:131]
    v_exp_f32 v144, v144
    v_mfma_f32_16x16x32_bf16 v[128:131], a[72:75], a[136:139], v[128:131]
    ds_read_b64_tr_b16 a[98:99], v188 offset:4096
    v_exp_f32 v145, v145
    v_mfma_f32_16x16x32_bf16 v[128:131], a[76:79], a[140:143], v[128:131]
    v_exp_f32 v146, v146
    v_mfma_f32_16x16x32_bf16 v[136:139], a[64:67], a[144:147], 0
    ds_read_b64_tr_b16 a[100:101], v189 offset:0
    v_exp_f32 v147, v147
    v_mfma_f32_16x16x32_bf16 v[136:139], a[68:71], a[148:151], v[136:139]
    v_exp_f32 v148, v148
    v_cvt_pk_bf16_f32 v168, v144, v145
    v_mfma_f32_16x16x32_bf16 v[136:139], a[72:75], a[152:155], v[136:139]
    ds_read_b64_tr_b16 a[102:103], v189 offset:4096
    v_exp_f32 v149, v149
    v_mfma_f32_16x16x32_bf16 v[136:139], a[76:79], a[156:159], v[136:139]
    v_exp_f32 v150, v150
    v_cvt_pk_bf16_f32 v169, v146, v147
    v_mfma_f32_16x16x32_bf16 v[132:135], a[80:83], a[128:131], 0
    ds_read_b64_tr_b16 a[104:105], v190 offset:0
    v_cvt_pk_bf16_f32 v170, v148, v149
    v_mfma_f32_16x16x32_bf16 v[132:135], a[84:87], a[132:135], v[132:135]
    v_exp_f32 v151, v151
    v_mfma_f32_16x16x32_bf16 v[132:135], a[88:91], a[136:139], v[132:135]
    ds_read_b64_tr_b16 a[106:107], v190 offset:4096
    v_cvt_pk_bf16_f32 v171, v150, v151
    v_mfma_f32_16x16x32_bf16 v[132:135], a[92:95], a[140:143], v[132:135]
    v_exp_f32 v152, v152
    v_mfma_f32_16x16x32_bf16 v[140:143], a[80:83], a[144:147], 0
    ds_read_b64_tr_b16 a[108:109], v191 offset:0
    v_mfma_f32_16x16x32_bf16 v[140:143], a[84:87], a[148:151], v[140:143]
    v_exp_f32 v153, v153
    v_mfma_f32_16x16x32_bf16 v[140:143], a[88:91], a[152:155], v[140:143]
    ds_read_b64_tr_b16 a[110:111], v191 offset:4096
    v_cvt_pk_bf16_f32 v172, v152, v153
    v_mfma_f32_16x16x32_bf16 v[140:143], a[92:95], a[156:159], v[140:143]
    v_exp_f32 v154, v154
    v_mfma_f32_16x16x32_bf16 v[176:179], v[242:245], v[160:163], v[176:179]
    ds_read_b64_tr_b16 a[112:113], v192 offset:0
    v_mfma_f32_16x16x32_bf16 v[184:187], v[242:245], v[164:167], v[184:187]
    ds_read_b64_tr_b16 a[114:115], v192 offset:4096
    s_waitcnt lgkmcnt(6)
    v_mfma_f32_16x16x32_bf16 v[0:3], a[96:99], v[160:163], v[0:3]
    s_add_u32 m0, s30, 114688
    s_nop 0
    buffer_load_dwordx4 v200, s[20:23], s29 offen offset:0 nt lds
    v_mfma_f32_16x16x32_bf16 v[32:35], a[96:99], v[164:167], v[32:35]
    ds_read_b64_tr_b16 a[116:117], v193 offset:0
    v_mfma_f32_16x16x32_bf16 v[4:7], a[100:103], v[160:163], v[4:7]
    ds_read_b64_tr_b16 a[118:119], v193 offset:4096
    v_mfma_f32_16x16x32_bf16 v[36:39], a[100:103], v[164:167], v[36:39]
    s_waitcnt lgkmcnt(4)
    v_mfma_f32_16x16x32_bf16 v[8:11], a[104:107], v[160:163], v[8:11]
    ds_read_b64_tr_b16 a[120:121], v194 offset:0
    v_mfma_f32_16x16x32_bf16 v[40:43], a[104:107], v[164:167], v[40:43]
    ds_read_b64_tr_b16 a[122:123], v194 offset:4096
    v_mfma_f32_16x16x32_bf16 v[12:15], a[108:111], v[160:163], v[12:15]
    v_exp_f32 v155, v155
    v_mfma_f32_16x16x32_bf16 v[44:47], a[108:111], v[164:167], v[44:47]
    ds_read_b64_tr_b16 a[124:125], v195 offset:0
    s_waitcnt lgkmcnt(3)
    v_mfma_f32_16x16x32_bf16 v[16:19], a[112:115], v[160:163], v[16:19]
    ds_read_b64_tr_b16 a[126:127], v195 offset:4096
    v_cvt_pk_bf16_f32 v173, v154, v155
    v_mfma_f32_16x16x32_bf16 v[48:51], a[112:115], v[164:167], v[48:51]
    v_exp_f32 v156, v156
    v_mfma_f32_16x16x32_bf16 v[20:23], a[116:119], v[160:163], v[20:23]
    v_exp_f32 v157, v157
    v_mfma_f32_16x16x32_bf16 v[52:55], a[116:119], v[164:167], v[52:55]
    v_cvt_pk_bf16_f32 v174, v156, v157
    s_waitcnt lgkmcnt(0)
    v_mfma_f32_16x16x32_bf16 v[24:27], a[120:123], v[160:163], v[24:27]
    v_exp_f32 v158, v158
    v_mfma_f32_16x16x32_bf16 v[56:59], a[120:123], v[164:167], v[56:59]
    v_exp_f32 v159, v159
    v_mfma_f32_16x16x32_bf16 v[28:31], a[124:127], v[160:163], v[28:31]
    v_cvt_pk_bf16_f32 v175, v158, v159
    v_mfma_f32_16x16x32_bf16 v[60:63], a[124:127], v[164:167], v[60:63]
    v_mfma_f32_16x16x32_bf16 v[144:147], a[64:67], a[160:163], 0
    v_exp_f32 v128, v128
    v_mfma_f32_16x16x32_bf16 v[144:147], a[68:71], a[164:167], v[144:147]
    v_exp_f32 v129, v129
    v_mfma_f32_16x16x32_bf16 v[144:147], a[72:75], a[168:171], v[144:147]
    v_exp_f32 v130, v130
    v_mfma_f32_16x16x32_bf16 v[144:147], a[76:79], a[172:175], v[144:147]
    v_exp_f32 v131, v131
    v_mfma_f32_16x16x32_bf16 v[152:155], a[64:67], a[176:179], 0
    v_exp_f32 v132, v132
    v_cvt_pk_bf16_f32 v160, v128, v129
    v_mfma_f32_16x16x32_bf16 v[152:155], a[68:71], a[180:183], v[152:155]
    v_exp_f32 v133, v133
    v_mfma_f32_16x16x32_bf16 v[152:155], a[72:75], a[184:187], v[152:155]
    ds_read_b128 a[64:67], v180 offset:16384
    v_cvt_pk_bf16_f32 v161, v130, v131
    v_mfma_f32_16x16x32_bf16 v[152:155], a[76:79], a[188:191], v[152:155]
    v_exp_f32 v134, v134
    v_mfma_f32_16x16x32_bf16 v[148:151], a[80:83], a[160:163], 0
    ds_read_b128 a[68:71], v181 offset:16384
    v_cvt_pk_bf16_f32 v162, v132, v133
    v_mfma_f32_16x16x32_bf16 v[148:151], a[84:87], a[164:167], v[148:151]
    s_add_u32 s39, s52, 8192
    buffer_store_dwordx4 a[224:227], v202, s[24:27], s39 offen offset:0 sc0 sc1 nt
    v_mfma_f32_16x16x32_bf16 v[148:151], a[88:91], a[168:171], v[148:151]
    ds_read_b128 a[72:75], v182 offset:16384
    v_mfma_f32_16x16x32_bf16 v[148:151], a[92:95], a[172:175], v[148:151]
    v_exp_f32 v135, v135
    v_mfma_f32_16x16x32_bf16 v[156:159], a[80:83], a[176:179], 0
    ds_read_b128 a[76:79], v183 offset:16384
    v_cvt_pk_bf16_f32 v163, v134, v135
    v_mfma_f32_16x16x32_bf16 v[156:159], a[84:87], a[180:183], v[156:159]
    v_exp_f32 v136, v136
    v_mfma_f32_16x16x32_bf16 v[156:159], a[88:91], a[184:187], v[156:159]
    ds_read_b128 a[80:83], v180 offset:20480
    v_mfma_f32_16x16x32_bf16 v[156:159], a[92:95], a[188:191], v[156:159]
    v_exp_f32 v137, v137
    v_mfma_f32_16x16x32_bf16 v[222:225], v[242:245], v[168:171], v[222:225]
    ds_read_b128 a[84:87], v181 offset:20480
    v_cvt_pk_bf16_f32 v164, v136, v137
    v_mfma_f32_16x16x32_bf16 v[246:249], v[242:245], v[172:175], v[246:249]
    v_exp_f32 v138, v138
    v_mfma_f32_16x16x32_bf16 v[64:67], a[96:99], v[168:171], v[64:67]
    ds_read_b128 a[88:91], v182 offset:20480
    v_mfma_f32_16x16x32_bf16 v[96:99], a[96:99], v[172:175], v[96:99]
    v_exp_f32 v139, v139
    v_mfma_f32_16x16x32_bf16 v[68:71], a[100:103], v[168:171], v[68:71]
    ds_read_b128 a[92:95], v183 offset:20480
    v_cvt_pk_bf16_f32 v165, v138, v139
    v_mfma_f32_16x16x32_bf16 v[100:103], a[100:103], v[172:175], v[100:103]
    v_exp_f32 v140, v140
    v_mfma_f32_16x16x32_bf16 v[72:75], a[104:107], v[168:171], v[72:75]
    v_exp_f32 v141, v141
    v_mfma_f32_16x16x32_bf16 v[104:107], a[104:107], v[172:175], v[104:107]
    v_exp_f32 v142, v142
    v_mfma_f32_16x16x32_bf16 v[76:79], a[108:111], v[168:171], v[76:79]
    v_exp_f32 v143, v143
    v_mfma_f32_16x16x32_bf16 v[108:111], a[108:111], v[172:175], v[108:111]
    v_cvt_pk_bf16_f32 v166, v140, v141
    v_cvt_pk_bf16_f32 v167, v142, v143
    v_mfma_f32_16x16x32_bf16 v[80:83], a[112:115], v[168:171], v[80:83]
    v_mfma_f32_16x16x32_bf16 v[112:115], a[112:115], v[172:175], v[112:115]
    buffer_load_dwordx4 v201, s[20:23], s29 offen offset:1024 nt lds
    v_mfma_f32_16x16x32_bf16 v[84:87], a[116:119], v[168:171], v[84:87]
    v_mfma_f32_16x16x32_bf16 v[116:119], a[116:119], v[172:175], v[116:119]
    v_mfma_f32_16x16x32_bf16 v[88:91], a[120:123], v[168:171], v[88:91]
    v_mfma_f32_16x16x32_bf16 v[120:123], a[120:123], v[172:175], v[120:123]
    v_mfma_f32_16x16x32_bf16 v[92:95], a[124:127], v[168:171], v[92:95]
    v_mfma_f32_16x16x32_bf16 v[124:127], a[124:127], v[172:175], v[124:127]
    s_waitcnt lgkmcnt(0)
    v_mfma_f32_16x16x32_bf16 v[128:131], a[64:67], a[128:131], 0
    ds_read_b64_tr_b16 a[96:97], v188 offset:8192
    v_exp_f32 v144, v144
    v_mfma_f32_16x16x32_bf16 v[128:131], a[68:71], a[132:135], v[128:131]
    v_exp_f32 v145, v145
    v_mfma_f32_16x16x32_bf16 v[128:131], a[72:75], a[136:139], v[128:131]
    ds_read_b64_tr_b16 a[98:99], v188 offset:12288
    v_exp_f32 v146, v146
    v_mfma_f32_16x16x32_bf16 v[128:131], a[76:79], a[140:143], v[128:131]
    v_exp_f32 v147, v147
    v_mfma_f32_16x16x32_bf16 v[136:139], a[64:67], a[144:147], 0
    ds_read_b64_tr_b16 a[100:101], v189 offset:8192
    v_exp_f32 v148, v148
    v_mfma_f32_16x16x32_bf16 v[136:139], a[68:71], a[148:151], v[136:139]
    v_exp_f32 v149, v149
    v_cvt_pk_bf16_f32 v168, v144, v145
    v_mfma_f32_16x16x32_bf16 v[136:139], a[72:75], a[152:155], v[136:139]
    ds_read_b64_tr_b16 a[102:103], v189 offset:12288
    v_cvt_pk_bf16_f32 v169, v146, v147
    v_mfma_f32_16x16x32_bf16 v[136:139], a[76:79], a[156:159], v[136:139]
    v_exp_f32 v150, v150
    v_mfma_f32_16x16x32_bf16 v[132:135], a[80:83], a[128:131], 0
    ds_read_b64_tr_b16 a[104:105], v190 offset:8192
    v_cvt_pk_bf16_f32 v170, v148, v149
    v_mfma_f32_16x16x32_bf16 v[132:135], a[84:87], a[132:135], v[132:135]
    v_exp_f32 v151, v151
    v_mfma_f32_16x16x32_bf16 v[132:135], a[88:91], a[136:139], v[132:135]
    ds_read_b64_tr_b16 a[106:107], v190 offset:12288
    v_cvt_pk_bf16_f32 v171, v150, v151
    v_mfma_f32_16x16x32_bf16 v[132:135], a[92:95], a[140:143], v[132:135]
    v_exp_f32 v152, v152
    v_mfma_f32_16x16x32_bf16 v[140:143], a[80:83], a[144:147], 0
    ds_read_b64_tr_b16 a[108:109], v191 offset:8192
    v_mfma_f32_16x16x32_bf16 v[140:143], a[84:87], a[148:151], v[140:143]
    v_exp_f32 v153, v153
    v_mfma_f32_16x16x32_bf16 v[140:143], a[88:91], a[152:155], v[140:143]
    ds_read_b64_tr_b16 a[110:111], v191 offset:12288
    v_cvt_pk_bf16_f32 v172, v152, v153
    v_mfma_f32_16x16x32_bf16 v[140:143], a[92:95], a[156:159], v[140:143]
    v_exp_f32 v154, v154
    v_mfma_f32_16x16x32_bf16 v[176:179], v[242:245], v[160:163], v[176:179]
    ds_read_b64_tr_b16 a[112:113], v192 offset:8192
    v_mfma_f32_16x16x32_bf16 v[184:187], v[242:245], v[164:167], v[184:187]
    ds_read_b64_tr_b16 a[114:115], v192 offset:12288
    s_waitcnt lgkmcnt(6)
    v_mfma_f32_16x16x32_bf16 v[0:3], a[96:99], v[160:163], v[0:3]
    buffer_load_dwordx4 v200, s[20:23], s29 offen offset:2048 nt lds
    v_mfma_f32_16x16x32_bf16 v[32:35], a[96:99], v[164:167], v[32:35]
    ds_read_b64_tr_b16 a[116:117], v193 offset:8192
    v_mfma_f32_16x16x32_bf16 v[4:7], a[100:103], v[160:163], v[4:7]
    ds_read_b64_tr_b16 a[118:119], v193 offset:12288
    v_mfma_f32_16x16x32_bf16 v[36:39], a[100:103], v[164:167], v[36:39]
    s_waitcnt lgkmcnt(4)
    v_mfma_f32_16x16x32_bf16 v[8:11], a[104:107], v[160:163], v[8:11]
    ds_read_b64_tr_b16 a[120:121], v194 offset:8192
    v_mfma_f32_16x16x32_bf16 v[40:43], a[104:107], v[164:167], v[40:43]
    ds_read_b64_tr_b16 a[122:123], v194 offset:12288
    v_mfma_f32_16x16x32_bf16 v[12:15], a[108:111], v[160:163], v[12:15]
    v_exp_f32 v155, v155
    v_mfma_f32_16x16x32_bf16 v[44:47], a[108:111], v[164:167], v[44:47]
    ds_read_b64_tr_b16 a[124:125], v195 offset:8192
    s_waitcnt lgkmcnt(3)
    v_mfma_f32_16x16x32_bf16 v[16:19], a[112:115], v[160:163], v[16:19]
    ds_read_b64_tr_b16 a[126:127], v195 offset:12288
    v_cvt_pk_bf16_f32 v173, v154, v155
    v_mfma_f32_16x16x32_bf16 v[48:51], a[112:115], v[164:167], v[48:51]
    v_exp_f32 v156, v156
    v_mfma_f32_16x16x32_bf16 v[20:23], a[116:119], v[160:163], v[20:23]
    v_exp_f32 v157, v157
    v_mfma_f32_16x16x32_bf16 v[52:55], a[116:119], v[164:167], v[52:55]
    v_cvt_pk_bf16_f32 v174, v156, v157
    s_waitcnt lgkmcnt(0)
    v_mfma_f32_16x16x32_bf16 v[24:27], a[120:123], v[160:163], v[24:27]
    v_exp_f32 v158, v158
    v_mfma_f32_16x16x32_bf16 v[56:59], a[120:123], v[164:167], v[56:59]
    v_exp_f32 v159, v159
    v_mfma_f32_16x16x32_bf16 v[28:31], a[124:127], v[160:163], v[28:31]
    v_cvt_pk_bf16_f32 v175, v158, v159
    v_mfma_f32_16x16x32_bf16 v[60:63], a[124:127], v[164:167], v[60:63]
    v_mfma_f32_16x16x32_bf16 v[144:147], a[64:67], a[160:163], 0
    v_exp_f32 v128, v128
    v_mfma_f32_16x16x32_bf16 v[144:147], a[68:71], a[164:167], v[144:147]
    v_exp_f32 v129, v129
    v_mfma_f32_16x16x32_bf16 v[144:147], a[72:75], a[168:171], v[144:147]
    v_exp_f32 v130, v130
    v_mfma_f32_16x16x32_bf16 v[144:147], a[76:79], a[172:175], v[144:147]
    v_exp_f32 v131, v131
    v_mfma_f32_16x16x32_bf16 v[152:155], a[64:67], a[176:179], 0
    v_exp_f32 v132, v132
    v_cvt_pk_bf16_f32 v160, v128, v129
    v_mfma_f32_16x16x32_bf16 v[152:155], a[68:71], a[180:183], v[152:155]
    v_exp_f32 v133, v133
    v_mfma_f32_16x16x32_bf16 v[152:155], a[72:75], a[184:187], v[152:155]
    ds_read_b128 a[64:67], v180 offset:24576
    v_cvt_pk_bf16_f32 v161, v130, v131
    v_mfma_f32_16x16x32_bf16 v[152:155], a[76:79], a[188:191], v[152:155]
    v_exp_f32 v134, v134
    v_mfma_f32_16x16x32_bf16 v[148:151], a[80:83], a[160:163], 0
    ds_read_b128 a[68:71], v181 offset:24576
    v_cvt_pk_bf16_f32 v162, v132, v133
    v_mfma_f32_16x16x32_bf16 v[148:151], a[84:87], a[164:167], v[148:151]
    s_add_u32 s39, s52, 8192
    buffer_store_dwordx4 a[228:231], v203, s[24:27], s39 offen offset:1024 sc0 sc1 nt
    v_mfma_f32_16x16x32_bf16 v[148:151], a[88:91], a[168:171], v[148:151]
    ds_read_b128 a[72:75], v182 offset:24576
    v_mfma_f32_16x16x32_bf16 v[148:151], a[92:95], a[172:175], v[148:151]
    v_exp_f32 v135, v135
    v_mfma_f32_16x16x32_bf16 v[156:159], a[80:83], a[176:179], 0
    ds_read_b128 a[76:79], v183 offset:24576
    v_cvt_pk_bf16_f32 v163, v134, v135
    v_mfma_f32_16x16x32_bf16 v[156:159], a[84:87], a[180:183], v[156:159]
    v_exp_f32 v136, v136
    v_mfma_f32_16x16x32_bf16 v[156:159], a[88:91], a[184:187], v[156:159]
    ds_read_b128 a[80:83], v180 offset:28672
    v_mfma_f32_16x16x32_bf16 v[156:159], a[92:95], a[188:191], v[156:159]
    v_exp_f32 v137, v137
    v_mfma_f32_16x16x32_bf16 v[222:225], v[242:245], v[168:171], v[222:225]
    ds_read_b128 a[84:87], v181 offset:28672
    v_cvt_pk_bf16_f32 v164, v136, v137
    v_mfma_f32_16x16x32_bf16 v[246:249], v[242:245], v[172:175], v[246:249]
    v_exp_f32 v138, v138
    v_mfma_f32_16x16x32_bf16 v[64:67], a[96:99], v[168:171], v[64:67]
    ds_read_b128 a[88:91], v182 offset:28672
    v_mfma_f32_16x16x32_bf16 v[96:99], a[96:99], v[172:175], v[96:99]
    v_exp_f32 v139, v139
    v_mfma_f32_16x16x32_bf16 v[68:71], a[100:103], v[168:171], v[68:71]
    ds_read_b128 a[92:95], v183 offset:28672
    v_cvt_pk_bf16_f32 v165, v138, v139
    v_mfma_f32_16x16x32_bf16 v[100:103], a[100:103], v[172:175], v[100:103]
    v_exp_f32 v140, v140
    v_mfma_f32_16x16x32_bf16 v[72:75], a[104:107], v[168:171], v[72:75]
    v_exp_f32 v141, v141
    v_mfma_f32_16x16x32_bf16 v[104:107], a[104:107], v[172:175], v[104:107]
    v_exp_f32 v142, v142
    v_mfma_f32_16x16x32_bf16 v[76:79], a[108:111], v[168:171], v[76:79]
    v_exp_f32 v143, v143
    v_mfma_f32_16x16x32_bf16 v[108:111], a[108:111], v[172:175], v[108:111]
    v_cvt_pk_bf16_f32 v166, v140, v141
    v_cvt_pk_bf16_f32 v167, v142, v143
    v_mfma_f32_16x16x32_bf16 v[80:83], a[112:115], v[168:171], v[80:83]
    v_mfma_f32_16x16x32_bf16 v[112:115], a[112:115], v[172:175], v[112:115]
    buffer_load_dwordx4 v201, s[20:23], s29 offen offset:3072 nt lds
    s_add_u32 s29, s29, 16384
    v_mfma_f32_16x16x32_bf16 v[84:87], a[116:119], v[168:171], v[84:87]
    v_mfma_f32_16x16x32_bf16 v[116:119], a[116:119], v[172:175], v[116:119]
    v_mfma_f32_16x16x32_bf16 v[88:91], a[120:123], v[168:171], v[88:91]
    v_mfma_f32_16x16x32_bf16 v[120:123], a[120:123], v[172:175], v[120:123]
    v_mfma_f32_16x16x32_bf16 v[92:95], a[124:127], v[168:171], v[92:95]
    v_mfma_f32_16x16x32_bf16 v[124:127], a[124:127], v[172:175], v[124:127]
    s_waitcnt lgkmcnt(0)
    v_mfma_f32_16x16x32_bf16 v[128:131], a[64:67], a[128:131], 0
    s_waitcnt vmcnt(16)
    s_barrier
    ds_read_b64_tr_b16 a[96:97], v188 offset:16384
    v_mfma_f32_16x16x32_bf16 v[128:131], a[68:71], a[132:135], v[128:131]
    v_exp_f32 v144, v144
    v_mfma_f32_16x16x32_bf16 v[128:131], a[72:75], a[136:139], v[128:131]
    ds_read_b64_tr_b16 a[98:99], v188 offset:20480
    v_exp_f32 v145, v145
    v_mfma_f32_16x16x32_bf16 v[128:131], a[76:79], a[140:143], v[128:131]
    v_exp_f32 v146, v146
    v_mfma_f32_16x16x32_bf16 v[136:139], a[64:67], a[144:147], 0
    ds_read_b64_tr_b16 a[100:101], v189 offset:16384
    v_exp_f32 v147, v147
    v_mfma_f32_16x16x32_bf16 v[136:139], a[68:71], a[148:151], v[136:139]
    v_exp_f32 v148, v148
    v_cvt_pk_bf16_f32 v168, v144, v145
    v_mfma_f32_16x16x32_bf16 v[136:139], a[72:75], a[152:155], v[136:139]
    ds_read_b64_tr_b16 a[102:103], v189 offset:20480
    v_cvt_pk_bf16_f32 v169, v146, v147
    v_mfma_f32_16x16x32_bf16 v[136:139], a[76:79], a[156:159], v[136:139]
    v_exp_f32 v149, v149
    v_mfma_f32_16x16x32_bf16 v[132:135], a[80:83], a[128:131], 0
    ds_read_b64_tr_b16 a[104:105], v190 offset:16384
    v_cvt_pk_bf16_f32 v170, v148, v149
    v_mfma_f32_16x16x32_bf16 v[132:135], a[84:87], a[132:135], v[132:135]
    v_exp_f32 v150, v150
    v_mfma_f32_16x16x32_bf16 v[132:135], a[88:91], a[136:139], v[132:135]
    ds_read_b64_tr_b16 a[106:107], v190 offset:20480
    v_mfma_f32_16x16x32_bf16 v[132:135], a[92:95], a[140:143], v[132:135]
    v_exp_f32 v151, v151
    v_mfma_f32_16x16x32_bf16 v[140:143], a[80:83], a[144:147], 0
    ds_read_b64_tr_b16 a[108:109], v191 offset:16384
    v_cvt_pk_bf16_f32 v171, v150, v151
    v_mfma_f32_16x16x32_bf16 v[140:143], a[84:87], a[148:151], v[140:143]
    v_exp_f32 v152, v152
    v_mfma_f32_16x16x32_bf16 v[140:143], a[88:91], a[152:155], v[140:143]
    ds_read_b64_tr_b16 a[110:111], v191 offset:20480
    v_mfma_f32_16x16x32_bf16 v[140:143], a[92:95], a[156:159], v[140:143]
    v_exp_f32 v153, v153
    v_mfma_f32_16x16x32_bf16 v[176:179], v[242:245], v[160:163], v[176:179]
    ds_read_b64_tr_b16 a[112:113], v192 offset:16384
    v_cvt_pk_bf16_f32 v172, v152, v153
    v_mfma_f32_16x16x32_bf16 v[184:187], v[242:245], v[164:167], v[184:187]
    ds_read_b64_tr_b16 a[114:115], v192 offset:20480
    s_waitcnt lgkmcnt(6)
    v_mfma_f32_16x16x32_bf16 v[0:3], a[96:99], v[160:163], v[0:3]
    v_exp_f32 v154, v154
    v_mfma_f32_16x16x32_bf16 v[32:35], a[96:99], v[164:167], v[32:35]
    ds_read_b64_tr_b16 a[116:117], v193 offset:16384
    v_mfma_f32_16x16x32_bf16 v[4:7], a[100:103], v[160:163], v[4:7]
    ds_read_b64_tr_b16 a[118:119], v193 offset:20480
    v_mfma_f32_16x16x32_bf16 v[36:39], a[100:103], v[164:167], v[36:39]
    s_waitcnt lgkmcnt(4)
    v_mfma_f32_16x16x32_bf16 v[8:11], a[104:107], v[160:163], v[8:11]
    ds_read_b64_tr_b16 a[120:121], v194 offset:16384
    v_mfma_f32_16x16x32_bf16 v[40:43], a[104:107], v[164:167], v[40:43]
    ds_read_b64_tr_b16 a[122:123], v194 offset:20480
    v_mfma_f32_16x16x32_bf16 v[12:15], a[108:111], v[160:163], v[12:15]
    v_exp_f32 v155, v155
    v_mfma_f32_16x16x32_bf16 v[44:47], a[108:111], v[164:167], v[44:47]
    ds_read_b64_tr_b16 a[124:125], v195 offset:16384
    s_waitcnt lgkmcnt(3)
    v_mfma_f32_16x16x32_bf16 v[16:19], a[112:115], v[160:163], v[16:19]
    ds_read_b64_tr_b16 a[126:127], v195 offset:20480
    v_cvt_pk_bf16_f32 v173, v154, v155
    v_mfma_f32_16x16x32_bf16 v[48:51], a[112:115], v[164:167], v[48:51]
    v_exp_f32 v156, v156
    v_mfma_f32_16x16x32_bf16 v[20:23], a[116:119], v[160:163], v[20:23]
    v_exp_f32 v157, v157
    v_mfma_f32_16x16x32_bf16 v[52:55], a[116:119], v[164:167], v[52:55]
    v_cvt_pk_bf16_f32 v174, v156, v157
    s_waitcnt lgkmcnt(0)
    v_mfma_f32_16x16x32_bf16 v[24:27], a[120:123], v[160:163], v[24:27]
    v_exp_f32 v158, v158
    v_mfma_f32_16x16x32_bf16 v[56:59], a[120:123], v[164:167], v[56:59]
    v_exp_f32 v159, v159
    v_mfma_f32_16x16x32_bf16 v[28:31], a[124:127], v[160:163], v[28:31]
    v_cvt_pk_bf16_f32 v175, v158, v159
    v_mfma_f32_16x16x32_bf16 v[60:63], a[124:127], v[164:167], v[60:63]
    v_mfma_f32_16x16x32_bf16 v[144:147], a[64:67], a[160:163], 0
    v_exp_f32 v128, v128
    v_mfma_f32_16x16x32_bf16 v[144:147], a[68:71], a[164:167], v[144:147]
    v_exp_f32 v129, v129
    v_mfma_f32_16x16x32_bf16 v[144:147], a[72:75], a[168:171], v[144:147]
    v_exp_f32 v130, v130
    v_mfma_f32_16x16x32_bf16 v[144:147], a[76:79], a[172:175], v[144:147]
    v_exp_f32 v131, v131
    v_mfma_f32_16x16x32_bf16 v[152:155], a[64:67], a[176:179], 0
    v_exp_f32 v132, v132
    v_cvt_pk_bf16_f32 v160, v128, v129
    v_mfma_f32_16x16x32_bf16 v[152:155], a[68:71], a[180:183], v[152:155]
    v_exp_f32 v133, v133
    v_mfma_f32_16x16x32_bf16 v[152:155], a[72:75], a[184:187], v[152:155]
    ds_read_b128 a[64:67], v180 offset:32768
    v_cvt_pk_bf16_f32 v161, v130, v131
    v_mfma_f32_16x16x32_bf16 v[152:155], a[76:79], a[188:191], v[152:155]
    v_exp_f32 v134, v134
    v_mfma_f32_16x16x32_bf16 v[148:151], a[80:83], a[160:163], 0
    ds_read_b128 a[68:71], v181 offset:32768
    v_cvt_pk_bf16_f32 v162, v132, v133
    v_mfma_f32_16x16x32_bf16 v[148:151], a[84:87], a[164:167], v[148:151]
    v_exp_f32 v135, v135
    v_mfma_f32_16x16x32_bf16 v[148:151], a[88:91], a[168:171], v[148:151]
    ds_read_b128 a[72:75], v182 offset:32768
    v_cvt_pk_bf16_f32 v163, v134, v135
    v_mfma_f32_16x16x32_bf16 v[148:151], a[92:95], a[172:175], v[148:151]
    v_exp_f32 v136, v136
    v_mfma_f32_16x16x32_bf16 v[156:159], a[80:83], a[176:179], 0
    ds_read_b128 a[76:79], v183 offset:32768
    v_mfma_f32_16x16x32_bf16 v[156:159], a[84:87], a[180:183], v[156:159]
    v_exp_f32 v137, v137
    v_mfma_f32_16x16x32_bf16 v[156:159], a[88:91], a[184:187], v[156:159]
    ds_read_b128 a[80:83], v180 offset:36864
    v_cvt_pk_bf16_f32 v164, v136, v137
    v_mfma_f32_16x16x32_bf16 v[156:159], a[92:95], a[188:191], v[156:159]
    v_exp_f32 v138, v138
    v_mfma_f32_16x16x32_bf16 v[222:225], v[242:245], v[168:171], v[222:225]
    ds_read_b128 a[84:87], v181 offset:36864
    v_mfma_f32_16x16x32_bf16 v[246:249], v[242:245], v[172:175], v[246:249]
    v_exp_f32 v139, v139
    v_mfma_f32_16x16x32_bf16 v[64:67], a[96:99], v[168:171], v[64:67]
    ds_read_b128 a[88:91], v182 offset:36864
    v_cvt_pk_bf16_f32 v165, v138, v139
    v_mfma_f32_16x16x32_bf16 v[96:99], a[96:99], v[172:175], v[96:99]
    v_exp_f32 v140, v140
    v_mfma_f32_16x16x32_bf16 v[68:71], a[100:103], v[168:171], v[68:71]
    ds_read_b128 a[92:95], v183 offset:36864
    v_mfma_f32_16x16x32_bf16 v[100:103], a[100:103], v[172:175], v[100:103]
    s_add_u32 s39, s52, 8192
    buffer_store_dwordx4 a[232:235], v202, s[24:27], s39 offen offset:2048 sc0 sc1 nt
    v_mfma_f32_16x16x32_bf16 v[72:75], a[104:107], v[168:171], v[72:75]
    v_exp_f32 v141, v141
    v_mfma_f32_16x16x32_bf16 v[104:107], a[104:107], v[172:175], v[104:107]
    v_exp_f32 v142, v142
    v_mfma_f32_16x16x32_bf16 v[76:79], a[108:111], v[168:171], v[76:79]
    v_exp_f32 v143, v143
    v_mfma_f32_16x16x32_bf16 v[108:111], a[108:111], v[172:175], v[108:111]
    v_cvt_pk_bf16_f32 v166, v140, v141
    v_cvt_pk_bf16_f32 v167, v142, v143
    v_mfma_f32_16x16x32_bf16 v[80:83], a[112:115], v[168:171], v[80:83]
    v_mfma_f32_16x16x32_bf16 v[112:115], a[112:115], v[172:175], v[112:115]
    v_mfma_f32_16x16x32_bf16 v[84:87], a[116:119], v[168:171], v[84:87]
    v_mfma_f32_16x16x32_bf16 v[116:119], a[116:119], v[172:175], v[116:119]
    v_mfma_f32_16x16x32_bf16 v[88:91], a[120:123], v[168:171], v[88:91]
    v_mfma_f32_16x16x32_bf16 v[120:123], a[120:123], v[172:175], v[120:123]
    v_mfma_f32_16x16x32_bf16 v[92:95], a[124:127], v[168:171], v[92:95]
    v_mfma_f32_16x16x32_bf16 v[124:127], a[124:127], v[172:175], v[124:127]
    s_waitcnt lgkmcnt(0)
    v_mfma_f32_16x16x32_bf16 v[128:131], a[64:67], a[128:131], 0
    ds_read_b64_tr_b16 a[96:97], v188 offset:24576
    v_exp_f32 v144, v144
    v_mfma_f32_16x16x32_bf16 v[128:131], a[68:71], a[132:135], v[128:131]
    v_exp_f32 v145, v145
    v_mfma_f32_16x16x32_bf16 v[128:131], a[72:75], a[136:139], v[128:131]
    ds_read_b64_tr_b16 a[98:99], v188 offset:28672
    v_exp_f32 v146, v146
    v_mfma_f32_16x16x32_bf16 v[128:131], a[76:79], a[140:143], v[128:131]
    v_exp_f32 v147, v147
    v_mfma_f32_16x16x32_bf16 v[136:139], a[64:67], a[144:147], 0
    ds_read_b64_tr_b16 a[100:101], v189 offset:24576
    v_cvt_pk_bf16_f32 v168, v144, v145
    v_mfma_f32_16x16x32_bf16 v[136:139], a[68:71], a[148:151], v[136:139]
    v_exp_f32 v148, v148
    v_mfma_f32_16x16x32_bf16 v[136:139], a[72:75], a[152:155], v[136:139]
    ds_read_b64_tr_b16 a[102:103], v189 offset:28672
    v_cvt_pk_bf16_f32 v169, v146, v147
    v_mfma_f32_16x16x32_bf16 v[136:139], a[76:79], a[156:159], v[136:139]
    v_exp_f32 v149, v149
    v_mfma_f32_16x16x32_bf16 v[132:135], a[80:83], a[128:131], 0
    ds_read_b64_tr_b16 a[104:105], v190 offset:24576
    v_cvt_pk_bf16_f32 v170, v148, v149
    v_mfma_f32_16x16x32_bf16 v[132:135], a[84:87], a[132:135], v[132:135]
    v_exp_f32 v150, v150
    v_mfma_f32_16x16x32_bf16 v[132:135], a[88:91], a[136:139], v[132:135]
    ds_read_b64_tr_b16 a[106:107], v190 offset:28672
    v_mfma_f32_16x16x32_bf16 v[132:135], a[92:95], a[140:143], v[132:135]
    v_exp_f32 v151, v151
    v_mfma_f32_16x16x32_bf16 v[140:143], a[80:83], a[144:147], 0
    ds_read_b64_tr_b16 a[108:109], v191 offset:24576
    v_cvt_pk_bf16_f32 v171, v150, v151
    v_mfma_f32_16x16x32_bf16 v[140:143], a[84:87], a[148:151], v[140:143]
    v_exp_f32 v152, v152
    v_mfma_f32_16x16x32_bf16 v[140:143], a[88:91], a[152:155], v[140:143]
    ds_read_b64_tr_b16 a[110:111], v191 offset:28672
    v_mfma_f32_16x16x32_bf16 v[140:143], a[92:95], a[156:159], v[140:143]
    v_exp_f32 v153, v153
    v_mfma_f32_16x16x32_bf16 v[176:179], v[242:245], v[160:163], v[176:179]
    ds_read_b64_tr_b16 a[112:113], v192 offset:24576
    v_cvt_pk_bf16_f32 v172, v152, v153
    v_mfma_f32_16x16x32_bf16 v[184:187], v[242:245], v[164:167], v[184:187]
    ds_read_b64_tr_b16 a[114:115], v192 offset:28672
    s_waitcnt lgkmcnt(6)
    v_mfma_f32_16x16x32_bf16 v[0:3], a[96:99], v[160:163], v[0:3]
    v_exp_f32 v154, v154
    v_mfma_f32_16x16x32_bf16 v[32:35], a[96:99], v[164:167], v[32:35]
    ds_read_b64_tr_b16 a[116:117], v193 offset:24576
    v_mfma_f32_16x16x32_bf16 v[4:7], a[100:103], v[160:163], v[4:7]
    ds_read_b64_tr_b16 a[118:119], v193 offset:28672
    v_mfma_f32_16x16x32_bf16 v[36:39], a[100:103], v[164:167], v[36:39]
    s_waitcnt lgkmcnt(4)
    v_mfma_f32_16x16x32_bf16 v[8:11], a[104:107], v[160:163], v[8:11]
    ds_read_b64_tr_b16 a[120:121], v194 offset:24576
    v_mfma_f32_16x16x32_bf16 v[40:43], a[104:107], v[164:167], v[40:43]
    ds_read_b64_tr_b16 a[122:123], v194 offset:28672
    v_mfma_f32_16x16x32_bf16 v[12:15], a[108:111], v[160:163], v[12:15]
    v_exp_f32 v155, v155
    v_mfma_f32_16x16x32_bf16 v[44:47], a[108:111], v[164:167], v[44:47]
    ds_read_b64_tr_b16 a[124:125], v195 offset:24576
    s_waitcnt lgkmcnt(3)
    v_mfma_f32_16x16x32_bf16 v[16:19], a[112:115], v[160:163], v[16:19]
    ds_read_b64_tr_b16 a[126:127], v195 offset:28672
    v_cvt_pk_bf16_f32 v173, v154, v155
    v_mfma_f32_16x16x32_bf16 v[48:51], a[112:115], v[164:167], v[48:51]
    v_exp_f32 v156, v156
    v_mfma_f32_16x16x32_bf16 v[20:23], a[116:119], v[160:163], v[20:23]
    v_exp_f32 v157, v157
    v_mfma_f32_16x16x32_bf16 v[52:55], a[116:119], v[164:167], v[52:55]
    v_cvt_pk_bf16_f32 v174, v156, v157
    s_waitcnt lgkmcnt(0)
    v_mfma_f32_16x16x32_bf16 v[24:27], a[120:123], v[160:163], v[24:27]
    v_exp_f32 v158, v158
    v_mfma_f32_16x16x32_bf16 v[56:59], a[120:123], v[164:167], v[56:59]
    v_exp_f32 v159, v159
    v_mfma_f32_16x16x32_bf16 v[28:31], a[124:127], v[160:163], v[28:31]
    v_cvt_pk_bf16_f32 v175, v158, v159
    v_mfma_f32_16x16x32_bf16 v[60:63], a[124:127], v[164:167], v[60:63]
    v_mfma_f32_16x16x32_bf16 v[144:147], a[64:67], a[160:163], 0
    v_exp_f32 v128, v128
    v_mfma_f32_16x16x32_bf16 v[144:147], a[68:71], a[164:167], v[144:147]
    v_exp_f32 v129, v129
    v_mfma_f32_16x16x32_bf16 v[144:147], a[72:75], a[168:171], v[144:147]
    v_exp_f32 v130, v130
    v_mfma_f32_16x16x32_bf16 v[144:147], a[76:79], a[172:175], v[144:147]
    v_exp_f32 v131, v131
    v_mfma_f32_16x16x32_bf16 v[152:155], a[64:67], a[176:179], 0
    v_exp_f32 v132, v132
    v_cvt_pk_bf16_f32 v160, v128, v129
    v_mfma_f32_16x16x32_bf16 v[152:155], a[68:71], a[180:183], v[152:155]
    v_exp_f32 v133, v133
    v_mfma_f32_16x16x32_bf16 v[152:155], a[72:75], a[184:187], v[152:155]
    ds_read_b128 a[64:67], v180 offset:40960
    v_cvt_pk_bf16_f32 v161, v130, v131
    v_mfma_f32_16x16x32_bf16 v[152:155], a[76:79], a[188:191], v[152:155]
    v_exp_f32 v134, v134
    v_mfma_f32_16x16x32_bf16 v[148:151], a[80:83], a[160:163], 0
    ds_read_b128 a[68:71], v181 offset:40960
    v_cvt_pk_bf16_f32 v162, v132, v133
    v_mfma_f32_16x16x32_bf16 v[148:151], a[84:87], a[164:167], v[148:151]
    v_exp_f32 v135, v135
    v_mfma_f32_16x16x32_bf16 v[148:151], a[88:91], a[168:171], v[148:151]
    ds_read_b128 a[72:75], v182 offset:40960
    v_cvt_pk_bf16_f32 v163, v134, v135
    v_mfma_f32_16x16x32_bf16 v[148:151], a[92:95], a[172:175], v[148:151]
    v_exp_f32 v136, v136
    v_mfma_f32_16x16x32_bf16 v[156:159], a[80:83], a[176:179], 0
    ds_read_b128 a[76:79], v183 offset:40960
    v_mfma_f32_16x16x32_bf16 v[156:159], a[84:87], a[180:183], v[156:159]
    v_exp_f32 v137, v137
    v_mfma_f32_16x16x32_bf16 v[156:159], a[88:91], a[184:187], v[156:159]
    ds_read_b128 a[80:83], v180 offset:45056
    v_cvt_pk_bf16_f32 v164, v136, v137
    v_mfma_f32_16x16x32_bf16 v[156:159], a[92:95], a[188:191], v[156:159]
    v_exp_f32 v138, v138
    v_mfma_f32_16x16x32_bf16 v[222:225], v[242:245], v[168:171], v[222:225]
    ds_read_b128 a[84:87], v181 offset:45056
    v_mfma_f32_16x16x32_bf16 v[246:249], v[242:245], v[172:175], v[246:249]
    v_exp_f32 v139, v139
    v_mfma_f32_16x16x32_bf16 v[64:67], a[96:99], v[168:171], v[64:67]
    ds_read_b128 a[88:91], v182 offset:45056
    v_cvt_pk_bf16_f32 v165, v138, v139
    v_mfma_f32_16x16x32_bf16 v[96:99], a[96:99], v[172:175], v[96:99]
    v_exp_f32 v140, v140
    v_mfma_f32_16x16x32_bf16 v[68:71], a[100:103], v[168:171], v[68:71]
    ds_read_b128 a[92:95], v183 offset:45056
    v_mfma_f32_16x16x32_bf16 v[100:103], a[100:103], v[172:175], v[100:103]
    s_add_u32 s39, s52, 8192
    buffer_store_dwordx4 a[236:239], v203, s[24:27], s39 offen offset:3072 sc0 sc1 nt
    v_mfma_f32_16x16x32_bf16 v[72:75], a[104:107], v[168:171], v[72:75]
    v_exp_f32 v141, v141
    v_mfma_f32_16x16x32_bf16 v[104:107], a[104:107], v[172:175], v[104:107]
    v_exp_f32 v142, v142
    v_mfma_f32_16x16x32_bf16 v[76:79], a[108:111], v[168:171], v[76:79]
    v_exp_f32 v143, v143
    v_mfma_f32_16x16x32_bf16 v[108:111], a[108:111], v[172:175], v[108:111]
    v_cvt_pk_bf16_f32 v166, v140, v141
    v_cvt_pk_bf16_f32 v167, v142, v143
    v_mfma_f32_16x16x32_bf16 v[80:83], a[112:115], v[168:171], v[80:83]
    v_mfma_f32_16x16x32_bf16 v[112:115], a[112:115], v[172:175], v[112:115]
    v_mfma_f32_16x16x32_bf16 v[84:87], a[116:119], v[168:171], v[84:87]
    v_mfma_f32_16x16x32_bf16 v[116:119], a[116:119], v[172:175], v[116:119]
    v_mfma_f32_16x16x32_bf16 v[88:91], a[120:123], v[168:171], v[88:91]
    v_mfma_f32_16x16x32_bf16 v[120:123], a[120:123], v[172:175], v[120:123]
    v_mfma_f32_16x16x32_bf16 v[92:95], a[124:127], v[168:171], v[92:95]
    v_mfma_f32_16x16x32_bf16 v[124:127], a[124:127], v[172:175], v[124:127]
    s_waitcnt lgkmcnt(0)
    v_mfma_f32_16x16x32_bf16 v[128:131], a[64:67], a[128:131], 0
    s_waitcnt vmcnt(8)
    s_barrier
    ds_read_b64_tr_b16 a[96:97], v188 offset:32768
    v_mfma_f32_16x16x32_bf16 v[128:131], a[68:71], a[132:135], v[128:131]
    v_exp_f32 v144, v144
    v_mfma_f32_16x16x32_bf16 v[128:131], a[72:75], a[136:139], v[128:131]
    ds_read_b64_tr_b16 a[98:99], v188 offset:36864
    v_exp_f32 v145, v145
    v_mfma_f32_16x16x32_bf16 v[128:131], a[76:79], a[140:143], v[128:131]
    v_exp_f32 v146, v146
    v_mfma_f32_16x16x32_bf16 v[136:139], a[64:67], a[144:147], 0
    ds_read_b64_tr_b16 a[100:101], v189 offset:32768
    v_exp_f32 v147, v147
    v_mfma_f32_16x16x32_bf16 v[136:139], a[68:71], a[148:151], v[136:139]
    v_exp_f32 v148, v148
    v_cvt_pk_bf16_f32 v168, v144, v145
    v_mfma_f32_16x16x32_bf16 v[136:139], a[72:75], a[152:155], v[136:139]
    ds_read_b64_tr_b16 a[102:103], v189 offset:36864
    v_cvt_pk_bf16_f32 v169, v146, v147
    v_mfma_f32_16x16x32_bf16 v[136:139], a[76:79], a[156:159], v[136:139]
    v_exp_f32 v149, v149
    v_mfma_f32_16x16x32_bf16 v[132:135], a[80:83], a[128:131], 0
    ds_read_b64_tr_b16 a[104:105], v190 offset:32768
    v_cvt_pk_bf16_f32 v170, v148, v149
    v_mfma_f32_16x16x32_bf16 v[132:135], a[84:87], a[132:135], v[132:135]
    v_exp_f32 v150, v150
    v_mfma_f32_16x16x32_bf16 v[132:135], a[88:91], a[136:139], v[132:135]
    ds_read_b64_tr_b16 a[106:107], v190 offset:36864
    v_mfma_f32_16x16x32_bf16 v[132:135], a[92:95], a[140:143], v[132:135]
    v_exp_f32 v151, v151
    v_mfma_f32_16x16x32_bf16 v[140:143], a[80:83], a[144:147], 0
    ds_read_b64_tr_b16 a[108:109], v191 offset:32768
    v_cvt_pk_bf16_f32 v171, v150, v151
    v_mfma_f32_16x16x32_bf16 v[140:143], a[84:87], a[148:151], v[140:143]
    v_exp_f32 v152, v152
    v_mfma_f32_16x16x32_bf16 v[140:143], a[88:91], a[152:155], v[140:143]
    ds_read_b64_tr_b16 a[110:111], v191 offset:36864
    v_mfma_f32_16x16x32_bf16 v[140:143], a[92:95], a[156:159], v[140:143]
    v_exp_f32 v153, v153
    v_mfma_f32_16x16x32_bf16 v[176:179], v[242:245], v[160:163], v[176:179]
    ds_read_b64_tr_b16 a[112:113], v192 offset:32768
    v_cvt_pk_bf16_f32 v172, v152, v153
    v_mfma_f32_16x16x32_bf16 v[184:187], v[242:245], v[164:167], v[184:187]
    ds_read_b64_tr_b16 a[114:115], v192 offset:36864
    s_waitcnt lgkmcnt(6)
    v_mfma_f32_16x16x32_bf16 v[0:3], a[96:99], v[160:163], v[0:3]
    v_exp_f32 v154, v154
    v_mfma_f32_16x16x32_bf16 v[32:35], a[96:99], v[164:167], v[32:35]
    ds_read_b64_tr_b16 a[116:117], v193 offset:32768
    v_mfma_f32_16x16x32_bf16 v[4:7], a[100:103], v[160:163], v[4:7]
    ds_read_b64_tr_b16 a[118:119], v193 offset:36864
    v_mfma_f32_16x16x32_bf16 v[36:39], a[100:103], v[164:167], v[36:39]
    s_waitcnt lgkmcnt(4)
    v_mfma_f32_16x16x32_bf16 v[8:11], a[104:107], v[160:163], v[8:11]
    ds_read_b64_tr_b16 a[120:121], v194 offset:32768
    v_mfma_f32_16x16x32_bf16 v[40:43], a[104:107], v[164:167], v[40:43]
    ds_read_b64_tr_b16 a[122:123], v194 offset:36864
    v_mfma_f32_16x16x32_bf16 v[12:15], a[108:111], v[160:163], v[12:15]
    v_exp_f32 v155, v155
    v_mfma_f32_16x16x32_bf16 v[44:47], a[108:111], v[164:167], v[44:47]
    ds_read_b64_tr_b16 a[124:125], v195 offset:32768
    s_waitcnt lgkmcnt(3)
    v_mfma_f32_16x16x32_bf16 v[16:19], a[112:115], v[160:163], v[16:19]
    ds_read_b64_tr_b16 a[126:127], v195 offset:36864
    v_cvt_pk_bf16_f32 v173, v154, v155
    v_mfma_f32_16x16x32_bf16 v[48:51], a[112:115], v[164:167], v[48:51]
    v_exp_f32 v156, v156
    v_mfma_f32_16x16x32_bf16 v[20:23], a[116:119], v[160:163], v[20:23]
    v_exp_f32 v157, v157
    v_mfma_f32_16x16x32_bf16 v[52:55], a[116:119], v[164:167], v[52:55]
    v_cvt_pk_bf16_f32 v174, v156, v157
    s_waitcnt lgkmcnt(0)
    v_mfma_f32_16x16x32_bf16 v[24:27], a[120:123], v[160:163], v[24:27]
    v_exp_f32 v158, v158
    v_mfma_f32_16x16x32_bf16 v[56:59], a[120:123], v[164:167], v[56:59]
    v_exp_f32 v159, v159
    v_mfma_f32_16x16x32_bf16 v[28:31], a[124:127], v[160:163], v[28:31]
    v_cvt_pk_bf16_f32 v175, v158, v159
    v_mfma_f32_16x16x32_bf16 v[60:63], a[124:127], v[164:167], v[60:63]
    v_mfma_f32_16x16x32_bf16 v[144:147], a[64:67], a[160:163], 0
    v_exp_f32 v128, v128
    v_mfma_f32_16x16x32_bf16 v[144:147], a[68:71], a[164:167], v[144:147]
    v_exp_f32 v129, v129
    v_mfma_f32_16x16x32_bf16 v[144:147], a[72:75], a[168:171], v[144:147]
    v_exp_f32 v130, v130
    v_mfma_f32_16x16x32_bf16 v[144:147], a[76:79], a[172:175], v[144:147]
    v_exp_f32 v131, v131
    v_mfma_f32_16x16x32_bf16 v[152:155], a[64:67], a[176:179], 0
    v_exp_f32 v132, v132
    v_cvt_pk_bf16_f32 v160, v128, v129
    v_mfma_f32_16x16x32_bf16 v[152:155], a[68:71], a[180:183], v[152:155]
    v_exp_f32 v133, v133
    v_mfma_f32_16x16x32_bf16 v[152:155], a[72:75], a[184:187], v[152:155]
    ds_read_b128 a[64:67], v180 offset:49152
    v_cvt_pk_bf16_f32 v161, v130, v131
    v_mfma_f32_16x16x32_bf16 v[152:155], a[76:79], a[188:191], v[152:155]
    v_exp_f32 v134, v134
    v_mfma_f32_16x16x32_bf16 v[148:151], a[80:83], a[160:163], 0
    ds_read_b128 a[68:71], v181 offset:49152
    v_cvt_pk_bf16_f32 v162, v132, v133
    v_mfma_f32_16x16x32_bf16 v[148:151], a[84:87], a[164:167], v[148:151]
    v_exp_f32 v135, v135
    v_mfma_f32_16x16x32_bf16 v[148:151], a[88:91], a[168:171], v[148:151]
    ds_read_b128 a[72:75], v182 offset:49152
    v_cvt_pk_bf16_f32 v163, v134, v135
    v_mfma_f32_16x16x32_bf16 v[148:151], a[92:95], a[172:175], v[148:151]
    v_exp_f32 v136, v136
    v_mfma_f32_16x16x32_bf16 v[156:159], a[80:83], a[176:179], 0
    ds_read_b128 a[76:79], v183 offset:49152
    v_mfma_f32_16x16x32_bf16 v[156:159], a[84:87], a[180:183], v[156:159]
    v_exp_f32 v137, v137
    v_mfma_f32_16x16x32_bf16 v[156:159], a[88:91], a[184:187], v[156:159]
    ds_read_b128 a[80:83], v180 offset:53248
    v_cvt_pk_bf16_f32 v164, v136, v137
    v_mfma_f32_16x16x32_bf16 v[156:159], a[92:95], a[188:191], v[156:159]
    v_exp_f32 v138, v138
    v_mfma_f32_16x16x32_bf16 v[222:225], v[242:245], v[168:171], v[222:225]
    ds_read_b128 a[84:87], v181 offset:53248
    v_mfma_f32_16x16x32_bf16 v[246:249], v[242:245], v[172:175], v[246:249]
    v_exp_f32 v139, v139
    v_mfma_f32_16x16x32_bf16 v[64:67], a[96:99], v[168:171], v[64:67]
    ds_read_b128 a[88:91], v182 offset:53248
    v_cvt_pk_bf16_f32 v165, v138, v139
    v_mfma_f32_16x16x32_bf16 v[96:99], a[96:99], v[172:175], v[96:99]
    v_exp_f32 v140, v140
    v_mfma_f32_16x16x32_bf16 v[68:71], a[100:103], v[168:171], v[68:71]
    ds_read_b128 a[92:95], v183 offset:53248
    v_mfma_f32_16x16x32_bf16 v[100:103], a[100:103], v[172:175], v[100:103]
    s_add_u32 s39, s52, 12288
    buffer_store_dwordx4 a[240:243], v202, s[24:27], s39 offen offset:0 sc0 sc1 nt
    v_mfma_f32_16x16x32_bf16 v[72:75], a[104:107], v[168:171], v[72:75]
    v_exp_f32 v141, v141
    v_mfma_f32_16x16x32_bf16 v[104:107], a[104:107], v[172:175], v[104:107]
    v_exp_f32 v142, v142
    v_mfma_f32_16x16x32_bf16 v[76:79], a[108:111], v[168:171], v[76:79]
    v_exp_f32 v143, v143
    v_mfma_f32_16x16x32_bf16 v[108:111], a[108:111], v[172:175], v[108:111]
    v_cvt_pk_bf16_f32 v166, v140, v141
    v_cvt_pk_bf16_f32 v167, v142, v143
    v_mfma_f32_16x16x32_bf16 v[80:83], a[112:115], v[168:171], v[80:83]
    v_mfma_f32_16x16x32_bf16 v[112:115], a[112:115], v[172:175], v[112:115]
    v_mfma_f32_16x16x32_bf16 v[84:87], a[116:119], v[168:171], v[84:87]
    v_mfma_f32_16x16x32_bf16 v[116:119], a[116:119], v[172:175], v[116:119]
    v_mfma_f32_16x16x32_bf16 v[88:91], a[120:123], v[168:171], v[88:91]
    v_mfma_f32_16x16x32_bf16 v[120:123], a[120:123], v[172:175], v[120:123]
    v_mfma_f32_16x16x32_bf16 v[92:95], a[124:127], v[168:171], v[92:95]
    v_mfma_f32_16x16x32_bf16 v[124:127], a[124:127], v[172:175], v[124:127]
    s_waitcnt lgkmcnt(0)
    v_mfma_f32_16x16x32_bf16 v[128:131], a[64:67], a[128:131], 0
    ds_read_b64_tr_b16 a[96:97], v188 offset:40960
    v_exp_f32 v144, v144
    v_mfma_f32_16x16x32_bf16 v[128:131], a[68:71], a[132:135], v[128:131]
    v_exp_f32 v145, v145
    v_mfma_f32_16x16x32_bf16 v[128:131], a[72:75], a[136:139], v[128:131]
    ds_read_b64_tr_b16 a[98:99], v188 offset:45056
    v_exp_f32 v146, v146
    v_mfma_f32_16x16x32_bf16 v[128:131], a[76:79], a[140:143], v[128:131]
    v_exp_f32 v147, v147
    v_mfma_f32_16x16x32_bf16 v[136:139], a[64:67], a[144:147], 0
    ds_read_b64_tr_b16 a[100:101], v189 offset:40960
    v_cvt_pk_bf16_f32 v168, v144, v145
    v_mfma_f32_16x16x32_bf16 v[136:139], a[68:71], a[148:151], v[136:139]
    v_exp_f32 v148, v148
    v_mfma_f32_16x16x32_bf16 v[136:139], a[72:75], a[152:155], v[136:139]
    ds_read_b64_tr_b16 a[102:103], v189 offset:45056
    v_cvt_pk_bf16_f32 v169, v146, v147
    v_mfma_f32_16x16x32_bf16 v[136:139], a[76:79], a[156:159], v[136:139]
    v_exp_f32 v149, v149
    v_mfma_f32_16x16x32_bf16 v[132:135], a[80:83], a[128:131], 0
    ds_read_b64_tr_b16 a[104:105], v190 offset:40960
    v_cvt_pk_bf16_f32 v170, v148, v149
    v_mfma_f32_16x16x32_bf16 v[132:135], a[84:87], a[132:135], v[132:135]
    v_exp_f32 v150, v150
    v_mfma_f32_16x16x32_bf16 v[132:135], a[88:91], a[136:139], v[132:135]
    ds_read_b64_tr_b16 a[106:107], v190 offset:45056
    v_mfma_f32_16x16x32_bf16 v[132:135], a[92:95], a[140:143], v[132:135]
    v_exp_f32 v151, v151
    v_mfma_f32_16x16x32_bf16 v[140:143], a[80:83], a[144:147], 0
    ds_read_b64_tr_b16 a[108:109], v191 offset:40960
    v_cvt_pk_bf16_f32 v171, v150, v151
    v_mfma_f32_16x16x32_bf16 v[140:143], a[84:87], a[148:151], v[140:143]
    v_exp_f32 v152, v152
    v_mfma_f32_16x16x32_bf16 v[140:143], a[88:91], a[152:155], v[140:143]
    ds_read_b64_tr_b16 a[110:111], v191 offset:45056
    v_mfma_f32_16x16x32_bf16 v[140:143], a[92:95], a[156:159], v[140:143]
    v_exp_f32 v153, v153
    v_mfma_f32_16x16x32_bf16 v[176:179], v[242:245], v[160:163], v[176:179]
    ds_read_b64_tr_b16 a[112:113], v192 offset:40960
    v_cvt_pk_bf16_f32 v172, v152, v153
    v_mfma_f32_16x16x32_bf16 v[184:187], v[242:245], v[164:167], v[184:187]
    ds_read_b64_tr_b16 a[114:115], v192 offset:45056
    s_waitcnt lgkmcnt(6)
    v_mfma_f32_16x16x32_bf16 v[0:3], a[96:99], v[160:163], v[0:3]
    v_exp_f32 v154, v154
    v_mfma_f32_16x16x32_bf16 v[32:35], a[96:99], v[164:167], v[32:35]
    ds_read_b64_tr_b16 a[116:117], v193 offset:40960
    v_mfma_f32_16x16x32_bf16 v[4:7], a[100:103], v[160:163], v[4:7]
    ds_read_b64_tr_b16 a[118:119], v193 offset:45056
    v_mfma_f32_16x16x32_bf16 v[36:39], a[100:103], v[164:167], v[36:39]
    s_waitcnt lgkmcnt(4)
    v_mfma_f32_16x16x32_bf16 v[8:11], a[104:107], v[160:163], v[8:11]
    ds_read_b64_tr_b16 a[120:121], v194 offset:40960
    v_mfma_f32_16x16x32_bf16 v[40:43], a[104:107], v[164:167], v[40:43]
    ds_read_b64_tr_b16 a[122:123], v194 offset:45056
    v_mfma_f32_16x16x32_bf16 v[12:15], a[108:111], v[160:163], v[12:15]
    v_exp_f32 v155, v155
    v_mfma_f32_16x16x32_bf16 v[44:47], a[108:111], v[164:167], v[44:47]
    ds_read_b64_tr_b16 a[124:125], v195 offset:40960
    s_waitcnt lgkmcnt(3)
    v_mfma_f32_16x16x32_bf16 v[16:19], a[112:115], v[160:163], v[16:19]
    ds_read_b64_tr_b16 a[126:127], v195 offset:45056
    v_cvt_pk_bf16_f32 v173, v154, v155
    v_mfma_f32_16x16x32_bf16 v[48:51], a[112:115], v[164:167], v[48:51]
    v_exp_f32 v156, v156
    v_mfma_f32_16x16x32_bf16 v[20:23], a[116:119], v[160:163], v[20:23]
    v_exp_f32 v157, v157
    v_mfma_f32_16x16x32_bf16 v[52:55], a[116:119], v[164:167], v[52:55]
    v_cvt_pk_bf16_f32 v174, v156, v157
    s_waitcnt lgkmcnt(0)
    v_mfma_f32_16x16x32_bf16 v[24:27], a[120:123], v[160:163], v[24:27]
    v_exp_f32 v158, v158
    v_mfma_f32_16x16x32_bf16 v[56:59], a[120:123], v[164:167], v[56:59]
    v_exp_f32 v159, v159
    v_mfma_f32_16x16x32_bf16 v[28:31], a[124:127], v[160:163], v[28:31]
    v_cvt_pk_bf16_f32 v175, v158, v159
    v_mfma_f32_16x16x32_bf16 v[60:63], a[124:127], v[164:167], v[60:63]
    v_mfma_f32_16x16x32_bf16 v[144:147], a[64:67], a[160:163], 0
    v_exp_f32 v128, v128
    v_mfma_f32_16x16x32_bf16 v[144:147], a[68:71], a[164:167], v[144:147]
    v_exp_f32 v129, v129
    v_mfma_f32_16x16x32_bf16 v[144:147], a[72:75], a[168:171], v[144:147]
    v_exp_f32 v130, v130
    v_mfma_f32_16x16x32_bf16 v[144:147], a[76:79], a[172:175], v[144:147]
    v_exp_f32 v131, v131
    v_mfma_f32_16x16x32_bf16 v[152:155], a[64:67], a[176:179], 0
    v_exp_f32 v132, v132
    v_cvt_pk_bf16_f32 v160, v128, v129
    v_mfma_f32_16x16x32_bf16 v[152:155], a[68:71], a[180:183], v[152:155]
    v_exp_f32 v133, v133
    v_mfma_f32_16x16x32_bf16 v[152:155], a[72:75], a[184:187], v[152:155]
    ds_read_b128 a[64:67], v180 offset:57344
    v_cvt_pk_bf16_f32 v161, v130, v131
    v_mfma_f32_16x16x32_bf16 v[152:155], a[76:79], a[188:191], v[152:155]
    v_exp_f32 v134, v134
    v_mfma_f32_16x16x32_bf16 v[148:151], a[80:83], a[160:163], 0
    ds_read_b128 a[68:71], v181 offset:57344
    v_cvt_pk_bf16_f32 v162, v132, v133
    v_mfma_f32_16x16x32_bf16 v[148:151], a[84:87], a[164:167], v[148:151]
    v_exp_f32 v135, v135
    v_mfma_f32_16x16x32_bf16 v[148:151], a[88:91], a[168:171], v[148:151]
    ds_read_b128 a[72:75], v182 offset:57344
    v_cvt_pk_bf16_f32 v163, v134, v135
    v_mfma_f32_16x16x32_bf16 v[148:151], a[92:95], a[172:175], v[148:151]
    v_exp_f32 v136, v136
    v_mfma_f32_16x16x32_bf16 v[156:159], a[80:83], a[176:179], 0
    ds_read_b128 a[76:79], v183 offset:57344
    v_mfma_f32_16x16x32_bf16 v[156:159], a[84:87], a[180:183], v[156:159]
    v_exp_f32 v137, v137
    v_mfma_f32_16x16x32_bf16 v[156:159], a[88:91], a[184:187], v[156:159]
    ds_read_b128 a[80:83], v180 offset:61440
    v_cvt_pk_bf16_f32 v164, v136, v137
    v_mfma_f32_16x16x32_bf16 v[156:159], a[92:95], a[188:191], v[156:159]
    v_exp_f32 v138, v138
    v_mfma_f32_16x16x32_bf16 v[222:225], v[242:245], v[168:171], v[222:225]
    ds_read_b128 a[84:87], v181 offset:61440
    v_mfma_f32_16x16x32_bf16 v[246:249], v[242:245], v[172:175], v[246:249]
    v_exp_f32 v139, v139
    v_mfma_f32_16x16x32_bf16 v[64:67], a[96:99], v[168:171], v[64:67]
    ds_read_b128 a[88:91], v182 offset:61440
    v_cvt_pk_bf16_f32 v165, v138, v139
    v_mfma_f32_16x16x32_bf16 v[96:99], a[96:99], v[172:175], v[96:99]
    v_exp_f32 v140, v140
    v_mfma_f32_16x16x32_bf16 v[68:71], a[100:103], v[168:171], v[68:71]
    ds_read_b128 a[92:95], v183 offset:61440
    v_mfma_f32_16x16x32_bf16 v[100:103], a[100:103], v[172:175], v[100:103]
    s_add_u32 s39, s52, 12288
    buffer_store_dwordx4 a[244:247], v203, s[24:27], s39 offen offset:1024 sc0 sc1 nt
    v_mfma_f32_16x16x32_bf16 v[72:75], a[104:107], v[168:171], v[72:75]
    v_exp_f32 v141, v141
    v_mfma_f32_16x16x32_bf16 v[104:107], a[104:107], v[172:175], v[104:107]
    v_exp_f32 v142, v142
    v_mfma_f32_16x16x32_bf16 v[76:79], a[108:111], v[168:171], v[76:79]
    v_exp_f32 v143, v143
    v_mfma_f32_16x16x32_bf16 v[108:111], a[108:111], v[172:175], v[108:111]
    v_cvt_pk_bf16_f32 v166, v140, v141
    v_cvt_pk_bf16_f32 v167, v142, v143
    v_mfma_f32_16x16x32_bf16 v[80:83], a[112:115], v[168:171], v[80:83]
    v_mfma_f32_16x16x32_bf16 v[112:115], a[112:115], v[172:175], v[112:115]
    v_mfma_f32_16x16x32_bf16 v[84:87], a[116:119], v[168:171], v[84:87]
    v_mfma_f32_16x16x32_bf16 v[116:119], a[116:119], v[172:175], v[116:119]
    v_mfma_f32_16x16x32_bf16 v[88:91], a[120:123], v[168:171], v[88:91]
    v_mfma_f32_16x16x32_bf16 v[120:123], a[120:123], v[172:175], v[120:123]
    v_mfma_f32_16x16x32_bf16 v[92:95], a[124:127], v[168:171], v[92:95]
    v_mfma_f32_16x16x32_bf16 v[124:127], a[124:127], v[172:175], v[124:127]
    s_waitcnt lgkmcnt(0)
    v_mfma_f32_16x16x32_bf16 v[128:131], a[64:67], a[128:131], 0
    s_waitcnt vmcnt(4)
    s_barrier
    ds_read_b64_tr_b16 a[96:97], v188 offset:49152
    v_mfma_f32_16x16x32_bf16 v[128:131], a[68:71], a[132:135], v[128:131]
    v_exp_f32 v144, v144
    v_mfma_f32_16x16x32_bf16 v[128:131], a[72:75], a[136:139], v[128:131]
    ds_read_b64_tr_b16 a[98:99], v188 offset:53248
    v_exp_f32 v145, v145
    v_mfma_f32_16x16x32_bf16 v[128:131], a[76:79], a[140:143], v[128:131]
    v_exp_f32 v146, v146
    v_mfma_f32_16x16x32_bf16 v[136:139], a[64:67], a[144:147], 0
    ds_read_b64_tr_b16 a[100:101], v189 offset:49152
    v_exp_f32 v147, v147
    v_mfma_f32_16x16x32_bf16 v[136:139], a[68:71], a[148:151], v[136:139]
    v_exp_f32 v148, v148
    v_cvt_pk_bf16_f32 v168, v144, v145
    v_mfma_f32_16x16x32_bf16 v[136:139], a[72:75], a[152:155], v[136:139]
    ds_read_b64_tr_b16 a[102:103], v189 offset:53248
    v_cvt_pk_bf16_f32 v169, v146, v147
    v_mfma_f32_16x16x32_bf16 v[136:139], a[76:79], a[156:159], v[136:139]
    v_exp_f32 v149, v149
    v_mfma_f32_16x16x32_bf16 v[132:135], a[80:83], a[128:131], 0
    ds_read_b64_tr_b16 a[104:105], v190 offset:49152
    v_cvt_pk_bf16_f32 v170, v148, v149
    v_mfma_f32_16x16x32_bf16 v[132:135], a[84:87], a[132:135], v[132:135]
    v_exp_f32 v150, v150
    v_mfma_f32_16x16x32_bf16 v[132:135], a[88:91], a[136:139], v[132:135]
    ds_read_b64_tr_b16 a[106:107], v190 offset:53248
    v_mfma_f32_16x16x32_bf16 v[132:135], a[92:95], a[140:143], v[132:135]
    v_exp_f32 v151, v151
    v_mfma_f32_16x16x32_bf16 v[140:143], a[80:83], a[144:147], 0
    ds_read_b64_tr_b16 a[108:109], v191 offset:49152
    v_cvt_pk_bf16_f32 v171, v150, v151
    v_mfma_f32_16x16x32_bf16 v[140:143], a[84:87], a[148:151], v[140:143]
    v_exp_f32 v152, v152
    v_mfma_f32_16x16x32_bf16 v[140:143], a[88:91], a[152:155], v[140:143]
    ds_read_b64_tr_b16 a[110:111], v191 offset:53248
    v_mfma_f32_16x16x32_bf16 v[140:143], a[92:95], a[156:159], v[140:143]
    v_exp_f32 v153, v153
    v_mfma_f32_16x16x32_bf16 v[176:179], v[242:245], v[160:163], v[176:179]
    ds_read_b64_tr_b16 a[112:113], v192 offset:49152
    v_cvt_pk_bf16_f32 v172, v152, v153
    v_mfma_f32_16x16x32_bf16 v[184:187], v[242:245], v[164:167], v[184:187]
    ds_read_b64_tr_b16 a[114:115], v192 offset:53248
    s_waitcnt lgkmcnt(6)
    v_mfma_f32_16x16x32_bf16 v[0:3], a[96:99], v[160:163], v[0:3]
    v_exp_f32 v154, v154
    v_mfma_f32_16x16x32_bf16 v[32:35], a[96:99], v[164:167], v[32:35]
    ds_read_b64_tr_b16 a[116:117], v193 offset:49152
    v_mfma_f32_16x16x32_bf16 v[4:7], a[100:103], v[160:163], v[4:7]
    ds_read_b64_tr_b16 a[118:119], v193 offset:53248
    v_mfma_f32_16x16x32_bf16 v[36:39], a[100:103], v[164:167], v[36:39]
    s_waitcnt lgkmcnt(4)
    v_mfma_f32_16x16x32_bf16 v[8:11], a[104:107], v[160:163], v[8:11]
    ds_read_b64_tr_b16 a[120:121], v194 offset:49152
    v_mfma_f32_16x16x32_bf16 v[40:43], a[104:107], v[164:167], v[40:43]
    ds_read_b64_tr_b16 a[122:123], v194 offset:53248
    v_mfma_f32_16x16x32_bf16 v[12:15], a[108:111], v[160:163], v[12:15]
    v_exp_f32 v155, v155
    v_mfma_f32_16x16x32_bf16 v[44:47], a[108:111], v[164:167], v[44:47]
    ds_read_b64_tr_b16 a[124:125], v195 offset:49152
    s_waitcnt lgkmcnt(3)
    v_mfma_f32_16x16x32_bf16 v[16:19], a[112:115], v[160:163], v[16:19]
    ds_read_b64_tr_b16 a[126:127], v195 offset:53248
    v_cvt_pk_bf16_f32 v173, v154, v155
    v_mfma_f32_16x16x32_bf16 v[48:51], a[112:115], v[164:167], v[48:51]
    v_exp_f32 v156, v156
    v_mfma_f32_16x16x32_bf16 v[20:23], a[116:119], v[160:163], v[20:23]
    v_exp_f32 v157, v157
    v_mfma_f32_16x16x32_bf16 v[52:55], a[116:119], v[164:167], v[52:55]
    v_cvt_pk_bf16_f32 v174, v156, v157
    s_waitcnt lgkmcnt(0)
    v_mfma_f32_16x16x32_bf16 v[24:27], a[120:123], v[160:163], v[24:27]
    v_exp_f32 v158, v158
    v_mfma_f32_16x16x32_bf16 v[56:59], a[120:123], v[164:167], v[56:59]
    v_exp_f32 v159, v159
    v_mfma_f32_16x16x32_bf16 v[28:31], a[124:127], v[160:163], v[28:31]
    v_cvt_pk_bf16_f32 v175, v158, v159
    v_mfma_f32_16x16x32_bf16 v[60:63], a[124:127], v[164:167], v[60:63]
    v_mfma_f32_16x16x32_bf16 v[144:147], a[64:67], a[160:163], 0
    v_exp_f32 v128, v128
    v_mfma_f32_16x16x32_bf16 v[144:147], a[68:71], a[164:167], v[144:147]
    v_exp_f32 v129, v129
    v_mfma_f32_16x16x32_bf16 v[144:147], a[72:75], a[168:171], v[144:147]
    v_exp_f32 v130, v130
    v_mfma_f32_16x16x32_bf16 v[144:147], a[76:79], a[172:175], v[144:147]
    v_exp_f32 v131, v131
    v_mfma_f32_16x16x32_bf16 v[152:155], a[64:67], a[176:179], 0
    v_exp_f32 v132, v132
    v_cvt_pk_bf16_f32 v160, v128, v129
    v_mfma_f32_16x16x32_bf16 v[152:155], a[68:71], a[180:183], v[152:155]
    v_exp_f32 v133, v133
    v_mfma_f32_16x16x32_bf16 v[152:155], a[72:75], a[184:187], v[152:155]
    v_exp_f32 v134, v134
    v_cvt_pk_bf16_f32 v161, v130, v131
    v_mfma_f32_16x16x32_bf16 v[152:155], a[76:79], a[188:191], v[152:155]
    v_exp_f32 v135, v135
    v_mfma_f32_16x16x32_bf16 v[148:151], a[80:83], a[160:163], 0
    v_exp_f32 v136, v136
    v_cvt_pk_bf16_f32 v162, v132, v133
    v_mfma_f32_16x16x32_bf16 v[148:151], a[84:87], a[164:167], v[148:151]
    v_exp_f32 v137, v137
    v_mfma_f32_16x16x32_bf16 v[148:151], a[88:91], a[168:171], v[148:151]
    v_exp_f32 v138, v138
    v_cvt_pk_bf16_f32 v163, v134, v135
    v_mfma_f32_16x16x32_bf16 v[148:151], a[92:95], a[172:175], v[148:151]
    v_exp_f32 v139, v139
    v_mfma_f32_16x16x32_bf16 v[156:159], a[80:83], a[176:179], 0
    v_exp_f32 v140, v140
    v_cvt_pk_bf16_f32 v164, v136, v137
    v_mfma_f32_16x16x32_bf16 v[156:159], a[84:87], a[180:183], v[156:159]
    v_exp_f32 v141, v141
    v_mfma_f32_16x16x32_bf16 v[156:159], a[88:91], a[184:187], v[156:159]
    v_exp_f32 v142, v142
    v_cvt_pk_bf16_f32 v165, v138, v139
    v_mfma_f32_16x16x32_bf16 v[156:159], a[92:95], a[188:191], v[156:159]
    v_exp_f32 v143, v143
    v_mfma_f32_16x16x32_bf16 v[222:225], v[242:245], v[168:171], v[222:225]
    v_cvt_pk_bf16_f32 v166, v140, v141
    v_cvt_pk_bf16_f32 v167, v142, v143
    v_mfma_f32_16x16x32_bf16 v[246:249], v[242:245], v[172:175], v[246:249]
    v_mfma_f32_16x16x32_bf16 v[64:67], a[96:99], v[168:171], v[64:67]
    v_mfma_f32_16x16x32_bf16 v[96:99], a[96:99], v[172:175], v[96:99]
    v_mfma_f32_16x16x32_bf16 v[68:71], a[100:103], v[168:171], v[68:71]
    v_mfma_f32_16x16x32_bf16 v[100:103], a[100:103], v[172:175], v[100:103]
    s_add_u32 s39, s52, 12288
    buffer_store_dwordx4 a[248:251], v202, s[24:27], s39 offen offset:2048 sc0 sc1 nt
    v_mfma_f32_16x16x32_bf16 v[72:75], a[104:107], v[168:171], v[72:75]
    v_mfma_f32_16x16x32_bf16 v[104:107], a[104:107], v[172:175], v[104:107]
    v_mfma_f32_16x16x32_bf16 v[76:79], a[108:111], v[168:171], v[76:79]
    v_mfma_f32_16x16x32_bf16 v[108:111], a[108:111], v[172:175], v[108:111]
    v_mfma_f32_16x16x32_bf16 v[80:83], a[112:115], v[168:171], v[80:83]
    v_mfma_f32_16x16x32_bf16 v[112:115], a[112:115], v[172:175], v[112:115]
    v_mfma_f32_16x16x32_bf16 v[84:87], a[116:119], v[168:171], v[84:87]
    v_mfma_f32_16x16x32_bf16 v[116:119], a[116:119], v[172:175], v[116:119]
    v_mfma_f32_16x16x32_bf16 v[88:91], a[120:123], v[168:171], v[88:91]
    v_mfma_f32_16x16x32_bf16 v[120:123], a[120:123], v[172:175], v[120:123]
    v_mfma_f32_16x16x32_bf16 v[92:95], a[124:127], v[168:171], v[92:95]
    v_mfma_f32_16x16x32_bf16 v[124:127], a[124:127], v[172:175], v[124:127]
    ds_read_b64_tr_b16 a[96:97], v188 offset:57344
    v_exp_f32 v144, v144
    v_exp_f32 v145, v145
    ds_read_b64_tr_b16 a[98:99], v188 offset:61440
    v_exp_f32 v146, v146
    v_exp_f32 v147, v147
    ds_read_b64_tr_b16 a[100:101], v189 offset:57344
    v_cvt_pk_bf16_f32 v168, v144, v145
    v_exp_f32 v148, v148
    ds_read_b64_tr_b16 a[102:103], v189 offset:61440
    v_cvt_pk_bf16_f32 v169, v146, v147
    v_exp_f32 v149, v149
    ds_read_b64_tr_b16 a[104:105], v190 offset:57344
    v_cvt_pk_bf16_f32 v170, v148, v149
    v_exp_f32 v150, v150
    ds_read_b64_tr_b16 a[106:107], v190 offset:61440
    v_exp_f32 v151, v151
    ds_read_b64_tr_b16 a[108:109], v191 offset:57344
    v_cvt_pk_bf16_f32 v171, v150, v151
    v_exp_f32 v152, v152
    ds_read_b64_tr_b16 a[110:111], v191 offset:61440
    v_exp_f32 v153, v153
    v_mfma_f32_16x16x32_bf16 v[176:179], v[242:245], v[160:163], v[176:179]
    ds_read_b64_tr_b16 a[112:113], v192 offset:57344
    v_cvt_pk_bf16_f32 v172, v152, v153
    v_mfma_f32_16x16x32_bf16 v[184:187], v[242:245], v[164:167], v[184:187]
    ds_read_b64_tr_b16 a[114:115], v192 offset:61440
    s_waitcnt lgkmcnt(6)
    v_mfma_f32_16x16x32_bf16 v[0:3], a[96:99], v[160:163], v[0:3]
    v_exp_f32 v154, v154
    v_mfma_f32_16x16x32_bf16 v[32:35], a[96:99], v[164:167], v[32:35]
    ds_read_b64_tr_b16 a[116:117], v193 offset:57344
    v_mfma_f32_16x16x32_bf16 v[4:7], a[100:103], v[160:163], v[4:7]
    ds_read_b64_tr_b16 a[118:119], v193 offset:61440
    v_mfma_f32_16x16x32_bf16 v[36:39], a[100:103], v[164:167], v[36:39]
    s_waitcnt lgkmcnt(4)
    v_mfma_f32_16x16x32_bf16 v[8:11], a[104:107], v[160:163], v[8:11]
    ds_read_b64_tr_b16 a[120:121], v194 offset:57344
    v_mfma_f32_16x16x32_bf16 v[40:43], a[104:107], v[164:167], v[40:43]
    ds_read_b64_tr_b16 a[122:123], v194 offset:61440
    v_mfma_f32_16x16x32_bf16 v[12:15], a[108:111], v[160:163], v[12:15]
    v_exp_f32 v155, v155
    v_mfma_f32_16x16x32_bf16 v[44:47], a[108:111], v[164:167], v[44:47]
    ds_read_b64_tr_b16 a[124:125], v195 offset:57344
    s_waitcnt lgkmcnt(3)
    v_mfma_f32_16x16x32_bf16 v[16:19], a[112:115], v[160:163], v[16:19]
    ds_read_b64_tr_b16 a[126:127], v195 offset:61440
    v_cvt_pk_bf16_f32 v173, v154, v155
    v_mfma_f32_16x16x32_bf16 v[48:51], a[112:115], v[164:167], v[48:51]
    v_exp_f32 v156, v156
    v_mfma_f32_16x16x32_bf16 v[20:23], a[116:119], v[160:163], v[20:23]
    v_exp_f32 v157, v157
    v_mfma_f32_16x16x32_bf16 v[52:55], a[116:119], v[164:167], v[52:55]
    v_cvt_pk_bf16_f32 v174, v156, v157
    s_waitcnt lgkmcnt(0)
    v_mfma_f32_16x16x32_bf16 v[24:27], a[120:123], v[160:163], v[24:27]
    v_exp_f32 v158, v158
    v_mfma_f32_16x16x32_bf16 v[56:59], a[120:123], v[164:167], v[56:59]
    v_exp_f32 v159, v159
    v_mfma_f32_16x16x32_bf16 v[28:31], a[124:127], v[160:163], v[28:31]
    v_cvt_pk_bf16_f32 v175, v158, v159
    v_mfma_f32_16x16x32_bf16 v[60:63], a[124:127], v[164:167], v[60:63]
    v_cmp_nle_f32 vcc, s48, v176
    s_mov_b64 s[42:43], vcc
    v_cmp_nge_f32 vcc, s49, v176
    s_or_b64 s[42:43], s[42:43], vcc
    v_cmp_nle_f32 vcc, s48, v184
    s_or_b64 s[42:43], s[42:43], vcc
    v_cmp_nge_f32 vcc, s49, v184
    s_or_b64 s[42:43], s[42:43], vcc
    s_cselect_b32 s42, 2, 0
    s_or_b32 s50, s50, s42
    v_rcp_f32 v218, v176
    v_rcp_f32 v220, v184
    v_pk_mul_f32 v[0:1], v[0:1], v[218:219] op_sel_hi:[1,0]
    v_pk_mul_f32 v[2:3], v[2:3], v[218:219] op_sel_hi:[1,0]
    v_pk_mul_f32 v[4:5], v[4:5], v[218:219] op_sel_hi:[1,0]
    v_pk_mul_f32 v[6:7], v[6:7], v[218:219] op_sel_hi:[1,0]
    v_pk_mul_f32 v[8:9], v[8:9], v[218:219] op_sel_hi:[1,0]
    v_pk_mul_f32 v[10:11], v[10:11], v[218:219] op_sel_hi:[1,0]
    v_pk_mul_f32 v[12:13], v[12:13], v[218:219] op_sel_hi:[1,0]
    v_pk_mul_f32 v[14:15], v[14:15], v[218:219] op_sel_hi:[1,0]
    v_cvt_pk_bf16_f32 v0, v0, v1
    v_cvt_pk_bf16_f32 v1, v2, v3
    v_cvt_pk_bf16_f32 v2, v4, v5
    v_cvt_pk_bf16_f32 v3, v6, v7
    v_cvt_pk_bf16_f32 v4, v8, v9
    v_cvt_pk_bf16_f32 v5, v10, v11
    v_cvt_pk_bf16_f32 v6, v12, v13
    v_cvt_pk_bf16_f32 v7, v14, v15
    ds_write_b64 v206, v[0:1] offset:0
    ds_write_b64 v207, v[2:3] offset:0
    ds_write_b64 v208, v[4:5] offset:0
    ds_write_b64 v209, v[6:7] offset:0
    v_mfma_f32_16x16x32_bf16 v[226:229], v[242:245], v[0:3], 0
    v_mfma_f32_16x16x32_bf16 v[226:229], v[242:245], v[4:7], v[226:229]
    v_pk_mul_f32 v[16:17], v[16:17], v[218:219] op_sel_hi:[1,0]
    v_pk_mul_f32 v[18:19], v[18:19], v[218:219] op_sel_hi:[1,0]
    v_pk_mul_f32 v[20:21], v[20:21], v[218:219] op_sel_hi:[1,0]
    v_pk_mul_f32 v[22:23], v[22:23], v[218:219] op_sel_hi:[1,0]
    v_pk_mul_f32 v[24:25], v[24:25], v[218:219] op_sel_hi:[1,0]
    v_pk_mul_f32 v[26:27], v[26:27], v[218:219] op_sel_hi:[1,0]
    v_pk_mul_f32 v[28:29], v[28:29], v[218:219] op_sel_hi:[1,0]
    v_pk_mul_f32 v[30:31], v[30:31], v[218:219] op_sel_hi:[1,0]
    v_cvt_pk_bf16_f32 v16, v16, v17
    v_cvt_pk_bf16_f32 v17, v18, v19
    v_cvt_pk_bf16_f32 v18, v20, v21
    v_cvt_pk_bf16_f32 v19, v22, v23
    v_cvt_pk_bf16_f32 v20, v24, v25
    v_cvt_pk_bf16_f32 v21, v26, v27
    v_cvt_pk_bf16_f32 v22, v28, v29
    v_cvt_pk_bf16_f32 v23, v30, v31
    ds_write_b64 v210, v[16:17] offset:0
    ds_write_b64 v211, v[18:19] offset:0
    v_mfma_f32_16x16x32_bf16 v[222:225], v[242:245], v[168:171], v[222:225]
    ds_write_b64 v212, v[20:21] offset:0
    ds_write_b64 v213, v[22:23] offset:0
    v_mfma_f32_16x16x32_bf16 v[246:249], v[242:245], v[172:175], v[246:249]
    v_mfma_f32_16x16x32_bf16 v[226:229], v[242:245], v[16:19], v[226:229]
    v_mfma_f32_16x16x32_bf16 v[226:229], v[242:245], v[20:23], v[226:229]
    v_pk_mul_f32 v[32:33], v[32:33], v[220:221] op_sel_hi:[1,0]
    v_pk_mul_f32 v[34:35], v[34:35], v[220:221] op_sel_hi:[1,0]
    v_pk_mul_f32 v[36:37], v[36:37], v[220:221] op_sel_hi:[1,0]
    v_pk_mul_f32 v[38:39], v[38:39], v[220:221] op_sel_hi:[1,0]
    v_pk_mul_f32 v[40:41], v[40:41], v[220:221] op_sel_hi:[1,0]
    v_pk_mul_f32 v[42:43], v[42:43], v[220:221] op_sel_hi:[1,0]
    v_mfma_f32_16x16x32_bf16 v[64:67], a[96:99], v[168:171], v[64:67]
    v_pk_mul_f32 v[44:45], v[44:45], v[220:221] op_sel_hi:[1,0]
    v_pk_mul_f32 v[46:47], v[46:47], v[220:221] op_sel_hi:[1,0]
    v_cvt_pk_bf16_f32 v32, v32, v33
    v_mfma_f32_16x16x32_bf16 v[96:99], a[96:99], v[172:175], v[96:99]
    v_cvt_pk_bf16_f32 v33, v34, v35
    v_cvt_pk_bf16_f32 v34, v36, v37
    v_cvt_pk_bf16_f32 v35, v38, v39
    v_cvt_pk_bf16_f32 v36, v40, v41
    v_mfma_f32_16x16x32_bf16 v[68:71], a[100:103], v[168:171], v[68:71]
    v_cvt_pk_bf16_f32 v37, v42, v43
    v_cvt_pk_bf16_f32 v38, v44, v45
    v_cvt_pk_bf16_f32 v39, v46, v47
    v_mfma_f32_16x16x32_bf16 v[100:103], a[100:103], v[172:175], v[100:103]
    s_add_u32 s39, s52, 12288
    buffer_store_dwordx4 a[252:255], v203, s[24:27], s39 offen offset:3072 sc0 sc1 nt
    ds_write_b64 v206, v[32:33] offset:4096
    ds_write_b64 v207, v[34:35] offset:4096
    v_mfma_f32_16x16x32_bf16 v[72:75], a[104:107], v[168:171], v[72:75]
    ds_write_b64 v208, v[36:37] offset:4096
    ds_write_b64 v209, v[38:39] offset:4096
    v_mfma_f32_16x16x32_bf16 v[104:107], a[104:107], v[172:175], v[104:107]
    v_mfma_f32_16x16x32_bf16 v[226:229], v[242:245], v[32:35], v[226:229]
    v_mfma_f32_16x16x32_bf16 v[226:229], v[242:245], v[36:39], v[226:229]
    v_pk_mul_f32 v[48:49], v[48:49], v[220:221] op_sel_hi:[1,0]
    v_pk_mul_f32 v[50:51], v[50:51], v[220:221] op_sel_hi:[1,0]
    v_pk_mul_f32 v[52:53], v[52:53], v[220:221] op_sel_hi:[1,0]
    v_pk_mul_f32 v[54:55], v[54:55], v[220:221] op_sel_hi:[1,0]
    v_mfma_f32_16x16x32_bf16 v[76:79], a[108:111], v[168:171], v[76:79]
    v_pk_mul_f32 v[56:57], v[56:57], v[220:221] op_sel_hi:[1,0]
    v_pk_mul_f32 v[58:59], v[58:59], v[220:221] op_sel_hi:[1,0]
    v_pk_mul_f32 v[60:61], v[60:61], v[220:221] op_sel_hi:[1,0]
    v_mfma_f32_16x16x32_bf16 v[108:111], a[108:111], v[172:175], v[108:111]
    v_pk_mul_f32 v[62:63], v[62:63], v[220:221] op_sel_hi:[1,0]
    v_cvt_pk_bf16_f32 v48, v48, v49
    v_cvt_pk_bf16_f32 v49, v50, v51
    v_cvt_pk_bf16_f32 v50, v52, v53
    v_mfma_f32_16x16x32_bf16 v[80:83], a[112:115], v[168:171], v[80:83]
    v_cvt_pk_bf16_f32 v51, v54, v55
    v_cvt_pk_bf16_f32 v52, v56, v57
    v_cvt_pk_bf16_f32 v53, v58, v59
    v_mfma_f32_16x16x32_bf16 v[112:115], a[112:115], v[172:175], v[112:115]
    v_cvt_pk_bf16_f32 v54, v60, v61
    v_cvt_pk_bf16_f32 v55, v62, v63
    v_mfma_f32_16x16x32_bf16 v[84:87], a[116:119], v[168:171], v[84:87]
    ds_write_b64 v210, v[48:49] offset:4096
    ds_write_b64 v211, v[50:51] offset:4096
    v_mfma_f32_16x16x32_bf16 v[116:119], a[116:119], v[172:175], v[116:119]
    ds_write_b64 v212, v[52:53] offset:4096
    ds_write_b64 v213, v[54:55] offset:4096
    v_mfma_f32_16x16x32_bf16 v[88:91], a[120:123], v[168:171], v[88:91]
    v_mfma_f32_16x16x32_bf16 v[226:229], v[242:245], v[48:51], v[226:229]
    v_mfma_f32_16x16x32_bf16 v[226:229], v[242:245], v[52:55], v[226:229]
    v_cmp_nle_f32 vcc, s48, v222
    v_mfma_f32_16x16x32_bf16 v[120:123], a[120:123], v[172:175], v[120:123]
    s_mov_b64 s[42:43], vcc
    v_cmp_nge_f32 vcc, s49, v222
    v_mfma_f32_16x16x32_bf16 v[92:95], a[124:127], v[168:171], v[92:95]
    s_or_b64 s[42:43], s[42:43], vcc
    v_cmp_nle_f32 vcc, s48, v246
    v_mfma_f32_16x16x32_bf16 v[124:127], a[124:127], v[172:175], v[124:127]
    s_or_b64 s[42:43], s[42:43], vcc
    v_cmp_nge_f32 vcc, s49, v246
    s_or_b64 s[42:43], s[42:43], vcc
    s_cselect_b32 s42, 2, 0
    s_or_b32 s50, s50, s42
    v_rcp_f32 v234, v222
    v_rcp_f32 v236, v246
    v_cmp_class_f32 vcc, v226, v250
    s_cmp_lg_u64 vcc, 0
    s_cselect_b32 s42, 2, 0
    s_or_b32 s50, s50, s42
    ds_read_b128 a[192:195], v205 offset:0
    ds_read_b128 a[196:199], v205 offset:1024
    ds_read_b128 a[200:203], v205 offset:2048
    ds_read_b128 a[204:207], v205 offset:3072
    ds_read_b128 a[208:211], v205 offset:4096
    ds_read_b128 a[212:215], v205 offset:5120
    ds_read_b128 a[216:219], v205 offset:6144
    ds_read_b128 a[220:223], v205 offset:7168
    v_pk_mul_f32 v[64:65], v[64:65], v[234:235] op_sel_hi:[1,0]
    v_pk_mul_f32 v[66:67], v[66:67], v[234:235] op_sel_hi:[1,0]
    v_pk_mul_f32 v[68:69], v[68:69], v[234:235] op_sel_hi:[1,0]
    v_pk_mul_f32 v[70:71], v[70:71], v[234:235] op_sel_hi:[1,0]
    v_pk_mul_f32 v[72:73], v[72:73], v[234:235] op_sel_hi:[1,0]
    v_pk_mul_f32 v[74:75], v[74:75], v[234:235] op_sel_hi:[1,0]
    v_pk_mul_f32 v[76:77], v[76:77], v[234:235] op_sel_hi:[1,0]
    v_pk_mul_f32 v[78:79], v[78:79], v[234:235] op_sel_hi:[1,0]
    s_add_u32 s39, s52, 65536
    v_cvt_pk_bf16_f32 v64, v64, v65
    v_cvt_pk_bf16_f32 v65, v66, v67
    v_cvt_pk_bf16_f32 v66, v68, v69
    v_cvt_pk_bf16_f32 v67, v70, v71
    v_cvt_pk_bf16_f32 v68, v72, v73
    v_cvt_pk_bf16_f32 v69, v74, v75
    v_cvt_pk_bf16_f32 v70, v76, v77
    v_cvt_pk_bf16_f32 v71, v78, v79
    s_waitcnt lgkmcnt(7)
    buffer_store_dwordx4 a[192:195], v202, s[24:27], s39 offen offset:0 sc0 sc1 nt
    ds_write_b64 v206, v[64:65] offset:0
    ds_write_b64 v207, v[66:67] offset:0
    ds_write_b64 v208, v[68:69] offset:0
    ds_write_b64 v209, v[70:71] offset:0
    v_mfma_f32_16x16x32_bf16 v[230:233], v[242:245], v[64:67], 0
    v_mfma_f32_16x16x32_bf16 v[230:233], v[242:245], v[68:71], v[230:233]
    v_pk_mul_f32 v[80:81], v[80:81], v[234:235] op_sel_hi:[1,0]
    v_pk_mul_f32 v[82:83], v[82:83], v[234:235] op_sel_hi:[1,0]
    s_waitcnt lgkmcnt(10)
    buffer_store_dwordx4 a[196:199], v203, s[24:27], s39 offen offset:1024 sc0 sc1 nt
    v_pk_mul_f32 v[84:85], v[84:85], v[234:235] op_sel_hi:[1,0]
    v_pk_mul_f32 v[86:87], v[86:87], v[234:235] op_sel_hi:[1,0]
    v_pk_mul_f32 v[88:89], v[88:89], v[234:235] op_sel_hi:[1,0]
    v_pk_mul_f32 v[90:91], v[90:91], v[234:235] op_sel_hi:[1,0]
    v_pk_mul_f32 v[92:93], v[92:93], v[234:235] op_sel_hi:[1,0]
    v_pk_mul_f32 v[94:95], v[94:95], v[234:235] op_sel_hi:[1,0]
    v_cvt_pk_bf16_f32 v80, v80, v81
    v_cvt_pk_bf16_f32 v81, v82, v83
    s_waitcnt lgkmcnt(9)
    buffer_store_dwordx4 a[200:203], v202, s[24:27], s39 offen offset:2048 sc0 sc1 nt
    v_cvt_pk_bf16_f32 v82, v84, v85
    v_cvt_pk_bf16_f32 v83, v86, v87
    v_cvt_pk_bf16_f32 v84, v88, v89
    v_cvt_pk_bf16_f32 v85, v90, v91
    v_cvt_pk_bf16_f32 v86, v92, v93
    v_cvt_pk_bf16_f32 v87, v94, v95
    ds_write_b64 v210, v[80:81] offset:0
    ds_write_b64 v211, v[82:83] offset:0
    s_waitcnt lgkmcnt(10)
    buffer_store_dwordx4 a[204:207], v203, s[24:27], s39 offen offset:3072 sc0 sc1 nt
    ds_write_b64 v212, v[84:85] offset:0
    ds_write_b64 v213, v[86:87] offset:0
    v_mfma_f32_16x16x32_bf16 v[230:233], v[242:245], v[80:83], v[230:233]
    v_mfma_f32_16x16x32_bf16 v[230:233], v[242:245], v[84:87], v[230:233]
    v_pk_mul_f32 v[96:97], v[96:97], v[236:237] op_sel_hi:[1,0]
    v_pk_mul_f32 v[98:99], v[98:99], v[236:237] op_sel_hi:[1,0]
    v_pk_mul_f32 v[100:101], v[100:101], v[236:237] op_sel_hi:[1,0]
    v_pk_mul_f32 v[102:103], v[102:103], v[236:237] op_sel_hi:[1,0]
    s_add_u32 s39, s52, 69632
    v_pk_mul_f32 v[104:105], v[104:105], v[236:237] op_sel_hi:[1,0]
    v_pk_mul_f32 v[106:107], v[106:107], v[236:237] op_sel_hi:[1,0]
    v_pk_mul_f32 v[108:109], v[108:109], v[236:237] op_sel_hi:[1,0]
    v_pk_mul_f32 v[110:111], v[110:111], v[236:237] op_sel_hi:[1,0]
    v_cvt_pk_bf16_f32 v96, v96, v97
    v_cvt_pk_bf16_f32 v97, v98, v99
    v_cvt_pk_bf16_f32 v98, v100, v101
    v_cvt_pk_bf16_f32 v99, v102, v103
    s_waitcnt lgkmcnt(11)
    buffer_store_dwordx4 a[208:211], v202, s[24:27], s39 offen offset:0 sc0 sc1 nt
    v_cvt_pk_bf16_f32 v100, v104, v105
    v_cvt_pk_bf16_f32 v101, v106, v107
    v_cvt_pk_bf16_f32 v102, v108, v109
    v_cvt_pk_bf16_f32 v103, v110, v111
    ds_write_b64 v206, v[96:97] offset:4096
    ds_write_b64 v207, v[98:99] offset:4096
    ds_write_b64 v208, v[100:101] offset:4096
    ds_write_b64 v209, v[102:103] offset:4096
    s_waitcnt lgkmcnt(14)
    buffer_store_dwordx4 a[212:215], v203, s[24:27], s39 offen offset:1024 sc0 sc1 nt
    v_mfma_f32_16x16x32_bf16 v[230:233], v[242:245], v[96:99], v[230:233]
    v_mfma_f32_16x16x32_bf16 v[230:233], v[242:245], v[100:103], v[230:233]
    v_pk_mul_f32 v[112:113], v[112:113], v[236:237] op_sel_hi:[1,0]
    v_pk_mul_f32 v[114:115], v[114:115], v[236:237] op_sel_hi:[1,0]
    v_pk_mul_f32 v[116:117], v[116:117], v[236:237] op_sel_hi:[1,0]
    v_pk_mul_f32 v[118:119], v[118:119], v[236:237] op_sel_hi:[1,0]
    v_pk_mul_f32 v[120:121], v[120:121], v[236:237] op_sel_hi:[1,0]
    v_pk_mul_f32 v[122:123], v[122:123], v[236:237] op_sel_hi:[1,0]
    s_waitcnt lgkmcnt(13)
    buffer_store_dwordx4 a[216:219], v202, s[24:27], s39 offen offset:2048 sc0 sc1 nt
    v_pk_mul_f32 v[124:125], v[124:125], v[236:237] op_sel_hi:[1,0]
    v_pk_mul_f32 v[126:127], v[126:127], v[236:237] op_sel_hi:[1,0]
    v_cvt_pk_bf16_f32 v112, v112, v113
    v_cvt_pk_bf16_f32 v113, v114, v115
    v_cvt_pk_bf16_f32 v114, v116, v117
    v_cvt_pk_bf16_f32 v115, v118, v119
    v_cvt_pk_bf16_f32 v116, v120, v121
    v_cvt_pk_bf16_f32 v117, v122, v123
    s_waitcnt lgkmcnt(12)
    buffer_store_dwordx4 a[220:223], v203, s[24:27], s39 offen offset:3072 sc0 sc1 nt
    v_cvt_pk_bf16_f32 v118, v124, v125
    v_cvt_pk_bf16_f32 v119, v126, v127
    ds_write_b64 v210, v[112:113] offset:4096
    ds_write_b64 v211, v[114:115] offset:4096
    ds_write_b64 v212, v[116:117] offset:4096
    ds_write_b64 v213, v[118:119] offset:4096
    v_mfma_f32_16x16x32_bf16 v[230:233], v[242:245], v[112:115], v[230:233]
    v_mfma_f32_16x16x32_bf16 v[230:233], v[242:245], v[116:119], v[230:233]
    ds_read_b128 a[224:227], v205 offset:0
    ds_read_b128 a[228:231], v205 offset:1024
    ds_read_b128 a[232:235], v205 offset:2048
    ds_read_b128 a[236:239], v205 offset:3072
    ds_read_b128 a[240:243], v205 offset:4096
    ds_read_b128 a[244:247], v205 offset:5120
    ds_read_b128 a[248:251], v205 offset:6144
    ds_read_b128 a[252:255], v205 offset:7168
    v_cmp_class_f32 vcc, v230, v250
    s_cmp_lg_u64 vcc, 0
    s_cselect_b32 s42, 2, 0
    s_or_b32 s50, s50, s42
    s_add_u32 s39, s52, 73728
    s_waitcnt lgkmcnt(7)
    buffer_store_dwordx4 a[224:227], v202, s[24:27], s39 offen offset:0 sc0 sc1 nt
    s_waitcnt lgkmcnt(6)
    buffer_store_dwordx4 a[228:231], v203, s[24:27], s39 offen offset:1024 sc0 sc1 nt
    s_waitcnt lgkmcnt(5)
    buffer_store_dwordx4 a[232:235], v202, s[24:27], s39 offen offset:2048 sc0 sc1 nt
    s_waitcnt lgkmcnt(4)
    buffer_store_dwordx4 a[236:239], v203, s[24:27], s39 offen offset:3072 sc0 sc1 nt
    s_add_u32 s39, s52, 77824
    s_waitcnt lgkmcnt(3)
    buffer_store_dwordx4 a[240:243], v202, s[24:27], s39 offen offset:0 sc0 sc1 nt
    s_waitcnt lgkmcnt(2)
    buffer_store_dwordx4 a[244:247], v203, s[24:27], s39 offen offset:1024 sc0 sc1 nt
    s_waitcnt lgkmcnt(1)
    buffer_store_dwordx4 a[248:251], v202, s[24:27], s39 offen offset:2048 sc0 sc1 nt
    s_waitcnt lgkmcnt(0)
    buffer_store_dwordx4 a[252:255], v203, s[24:27], s39 offen offset:3072 sc0 sc1 nt
L_done:
L_codeend:
    s_cmp_eq_u32 s50, 0
    s_cbranch_scc0 L_fb_start
    s_endpgm
L_fb_start:
    s_waitcnt vmcnt(0) lgkmcnt(0)
    v_subrev_u32 v226, s30, v196
    v_subrev_u32 v227, s30, v197
    v_subrev_u32 v228, s30, v198
    v_subrev_u32 v229, s30, v199
    v_subrev_u32 v230, s30, v200
    v_subrev_u32 v231, s30, v201
    s_sub_u32 s38, s36, 0x10000
    v_add_u32 v232, s38, v188
    v_add_u32 v233, s38, v189
    v_add_u32 v234, s38, v190
    v_add_u32 v235, s38, v191
    v_add_u32 v236, s38, v192
    v_add_u32 v237, s38, v193
    v_add_u32 v238, s38, v194
    v_add_u32 v239, s38, v195
    s_mov_b32 s32, 0
    s_bitcmp1_b32 s50, 0
    s_cbranch_scc1 L_fb_head
L_fb_second:
    v_accvgpr_mov_b32 a0, a128
    v_accvgpr_mov_b32 a1, a129
    v_accvgpr_mov_b32 a2, a130
    v_accvgpr_mov_b32 a3, a131
    v_accvgpr_mov_b32 a4, a132
    v_accvgpr_mov_b32 a5, a133
    v_accvgpr_mov_b32 a6, a134
    v_accvgpr_mov_b32 a7, a135
    v_accvgpr_mov_b32 a8, a136
    v_accvgpr_mov_b32 a9, a137
    v_accvgpr_mov_b32 a10, a138
    v_accvgpr_mov_b32 a11, a139
    v_accvgpr_mov_b32 a12, a140
    v_accvgpr_mov_b32 a13, a141
    v_accvgpr_mov_b32 a14, a142
    v_accvgpr_mov_b32 a15, a143
    v_accvgpr_mov_b32 a16, a144
    v_accvgpr_mov_b32 a17, a145
    v_accvgpr_mov_b32 a18, a146
    v_accvgpr_mov_b32 a19, a147
    v_accvgpr_mov_b32 a20, a148
    v_accvgpr_mov_b32 a21, a149
    v_accvgpr_mov_b32 a22, a150
    v_accvgpr_mov_b32 a23, a151
    v_accvgpr_mov_b32 a24, a152
    v_accvgpr_mov_b32 a25, a153
    v_accvgpr_mov_b32 a26, a154
    v_accvgpr_mov_b32 a27, a155
    v_accvgpr_mov_b32 a28, a156
    v_accvgpr_mov_b32 a29, a157
    v_accvgpr_mov_b32 a30, a158
    v_accvgpr_mov_b32 a31, a159
    v_accvgpr_mov_b32 a32, a160
    v_accvgpr_mov_b32 a33, a161
    v_accvgpr_mov_b32 a34, a162
    v_accvgpr_mov_b32 a35, a163
    v_accvgpr_mov_b32 a36, a164
    v_accvgpr_mov_b32 a37, a165
    v_accvgpr_mov_b32 a38, a166
    v_accvgpr_mov_b32 a39, a167
    v_accvgpr_mov_b32 a40, a168
    v_accvgpr_mov_b32 a41, a169
    v_accvgpr_mov_b32 a42, a170
    v_accvgpr_mov_b32 a43, a171
    v_accvgpr_mov_b32 a44, a172
    v_accvgpr_mov_b32 a45, a173
    v_accvgpr_mov_b32 a46, a174
    v_accvgpr_mov_b32 a47, a175
    v_accvgpr_mov_b32 a48, a176
    v_accvgpr_mov_b32 a49, a177
    v_accvgpr_mov_b32 a50, a178
    v_accvgpr_mov_b32 a51, a179
    v_accvgpr_mov_b32 a52, a180
    v_accvgpr_mov_b32 a53, a181
    v_accvgpr_mov_b32 a54, a182
    v_accvgpr_mov_b32 a55, a183
    v_accvgpr_mov_b32 a56, a184
    v_accvgpr_mov_b32 a57, a185
    v_accvgpr_mov_b32 a58, a186
    v_accvgpr_mov_b32 a59, a187
    v_accvgpr_mov_b32 a60, a188
    v_accvgpr_mov_b32 a61, a189
    v_accvgpr_mov_b32 a62, a190
    v_accvgpr_mov_b32 a63, a191
    s_mov_b32 s32, 1
    s_add_u32 s52, s52, 65536
L_fb_head:
    v_mov_b32 v240, 0xff000000
    v_mov_b32 v176, 0
    v_mov_b32 v241, 0xff000000
    v_mov_b32 v177, 0
    v_mov_b32 v242, 0xff000000
    v_mov_b32 v178, 0
    v_mov_b32 v243, 0xff000000
    v_mov_b32 v179, 0
    v_mov_b32 v0, 0
    v_mov_b32 v1, 0
    v_mov_b32 v2, 0
    v_mov_b32 v3, 0
    v_mov_b32 v4, 0
    v_mov_b32 v5, 0
    v_mov_b32 v6, 0
    v_mov_b32 v7, 0
    v_mov_b32 v8, 0
    v_mov_b32 v9, 0
    v_mov_b32 v10, 0
    v_mov_b32 v11, 0
    v_mov_b32 v12, 0
    v_mov_b32 v13, 0
    v_mov_b32 v14, 0
    v_mov_b32 v15, 0
    v_mov_b32 v16, 0
    v_mov_b32 v17, 0
    v_mov_b32 v18, 0
    v_mov_b32 v19, 0
    v_mov_b32 v20, 0
    v_mov_b32 v21, 0
    v_mov_b32 v22, 0
    v_mov_b32 v23, 0
    v_mov_b32 v24, 0
    v_mov_b32 v25, 0
    v_mov_b32 v26, 0
    v_mov_b32 v27, 0
    v_mov_b32 v28, 0
    v_mov_b32 v29, 0
    v_mov_b32 v30, 0
    v_mov_b32 v31, 0
    v_mov_b32 v32, 0
    v_mov_b32 v33, 0
    v_mov_b32 v34, 0
    v_mov_b32 v35, 0
    v_mov_b32 v36, 0
    v_mov_b32 v37, 0
    v_mov_b32 v38, 0
    v_mov_b32 v39, 0
    v_mov_b32 v40, 0
    v_mov_b32 v41, 0
    v_mov_b32 v42, 0
    v_mov_b32 v43, 0
    v_mov_b32 v44, 0
    v_mov_b32 v45, 0
    v_mov_b32 v46, 0
    v_mov_b32 v47, 0
    v_mov_b32 v48, 0
    v_mov_b32 v49, 0
    v_mov_b32 v50, 0
    v_mov_b32 v51, 0
    v_mov_b32 v52, 0
    v_mov_b32 v53, 0
    v_mov_b32 v54, 0
    v_mov_b32 v55, 0
    v_mov_b32 v56, 0
    v_mov_b32 v57, 0
    v_mov_b32 v58, 0
    v_mov_b32 v59, 0
    v_mov_b32 v60, 0
    v_mov_b32 v61, 0
    v_mov_b32 v62, 0
    v_mov_b32 v63, 0
    v_mov_b32 v64, 0
    v_mov_b32 v65, 0
    v_mov_b32 v66, 0
    v_mov_b32 v67, 0
    v_mov_b32 v68, 0
    v_mov_b32 v69, 0
    v_mov_b32 v70, 0
    v_mov_b32 v71, 0
    v_mov_b32 v72, 0
    v_mov_b32 v73, 0
    v_mov_b32 v74, 0
    v_mov_b32 v75, 0
    v_mov_b32 v76, 0
    v_mov_b32 v77, 0
    v_mov_b32 v78, 0
    v_mov_b32 v79, 0
    v_mov_b32 v80, 0
    v_mov_b32 v81, 0
    v_mov_b32 v82, 0
    v_mov_b32 v83, 0
    v_mov_b32 v84, 0
    v_mov_b32 v85, 0
    v_mov_b32 v86, 0
    v_mov_b32 v87, 0
    v_mov_b32 v88, 0
    v_mov_b32 v89, 0
    v_mov_b32 v90, 0
    v_mov_b32 v91, 0
    v_mov_b32 v92, 0
    v_mov_b32 v93, 0
    v_mov_b32 v94, 0
    v_mov_b32 v95, 0
    v_mov_b32 v96, 0
    v_mov_b32 v97, 0
    v_mov_b32 v98, 0
    v_mov_b32 v99, 0
    v_mov_b32 v100, 0
    v_mov_b32 v101, 0
    v_mov_b32 v102, 0
    v_mov_b32 v103, 0
    v_mov_b32 v104, 0
    v_mov_b32 v105, 0
    v_mov_b32 v106, 0
    v_mov_b32 v107, 0
    v_mov_b32 v108, 0
    v_mov_b32 v109, 0
    v_mov_b32 v110, 0
    v_mov_b32 v111, 0
    v_mov_b32 v112, 0
    v_mov_b32 v113, 0
    v_mov_b32 v114, 0
    v_mov_b32 v115, 0
    v_mov_b32 v116, 0
    v_mov_b32 v117, 0
    v_mov_b32 v118, 0
    v_mov_b32 v119, 0
    v_mov_b32 v120, 0
    v_mov_b32 v121, 0
    v_mov_b32 v122, 0
    v_mov_b32 v123, 0
    v_mov_b32 v124, 0
    v_mov_b32 v125, 0
    v_mov_b32 v126, 0
    v_mov_b32 v127, 0
    s_lshl_b32 s42, s32, 18
    s_mov_b32 s43, 0
L_fb_loop:
    s_add_u32 m0, s36, 0
    s_add_u32 s38, s42, 0
    buffer_load_dwordx4 v226, s[16:19], s38 offen offset:0 lds
    buffer_load_dwordx4 v227, s[16:19], s38 offen offset:1024 lds
    buffer_load_dwordx4 v228, s[16:19], s38 offen offset:2048 lds
    buffer_load_dwordx4 v229, s[16:19], s38 offen offset:3072 lds
    s_add_u32 m0, s36, 4096
    s_add_u32 s38, s42, 4096
    buffer_load_dwordx4 v226, s[16:19], s38 offen offset:0 lds
    buffer_load_dwordx4 v227, s[16:19], s38 offen offset:1024 lds
    buffer_load_dwordx4 v228, s[16:19], s38 offen offset:2048 lds
    buffer_load_dwordx4 v229, s[16:19], s38 offen offset:3072 lds
    s_waitcnt vmcnt(0)
    ds_read_b128 a[64:67], v214 offset:0
    ds_read_b128 a[68:71], v215 offset:0
    ds_read_b128 a[72:75], v216 offset:0
    ds_read_b128 a[76:79], v217 offset:0
    ds_read_b128 a[80:83], v214 offset:4096
    ds_read_b128 a[84:87], v215 offset:4096
    ds_read_b128 a[88:91], v216 offset:4096
    ds_read_b128 a[92:95], v217 offset:4096
    s_waitcnt lgkmcnt(0)
    s_add_u32 m0, s36, 0
    s_add_u32 s38, s42, 0
    buffer_load_dwordx4 v230, s[20:23], s38 offen offset:0 lds
    buffer_load_dwordx4 v231, s[20:23], s38 offen offset:1024 lds
    buffer_load_dwordx4 v230, s[20:23], s38 offen offset:2048 lds
    buffer_load_dwordx4 v231, s[20:23], s38 offen offset:3072 lds
    s_add_u32 m0, s36, 4096
    s_add_u32 s38, s42, 4096
    buffer_load_dwordx4 v230, s[20:23], s38 offen offset:0 lds
    buffer_load_dwordx4 v231, s[20:23], s38 offen offset:1024 lds
    buffer_load_dwordx4 v230, s[20:23], s38 offen offset:2048 lds
    buffer_load_dwordx4 v231, s[20:23], s38 offen offset:3072 lds
    v_mfma_f32_16x16x32_bf16 v[128:131], a[64:67], a[0:3], 0
    v_mfma_f32_16x16x32_bf16 v[128:131], a[68:71], a[4:7], v[128:131]
    v_mfma_f32_16x16x32_bf16 v[128:131], a[72:75], a[8:11], v[128:131]
    v_mfma_f32_16x16x32_bf16 v[128:131], a[76:79], a[12:15], v[128:131]
    v_mfma_f32_16x16x32_bf16 v[136:139], a[64:67], a[16:19], 0
    v_mfma_f32_16x16x32_bf16 v[136:139], a[68:71], a[20:23], v[136:139]
    v_mfma_f32_16x16x32_bf16 v[136:139], a[72:75], a[24:27], v[136:139]
    v_mfma_f32_16x16x32_bf16 v[136:139], a[76:79], a[28:31], v[136:139]
    v_mfma_f32_16x16x32_bf16 v[132:135], a[80:83], a[0:3], 0
    v_mfma_f32_16x16x32_bf16 v[132:135], a[84:87], a[4:7], v[132:135]
    v_mfma_f32_16x16x32_bf16 v[132:135], a[88:91], a[8:11], v[132:135]
    v_mfma_f32_16x16x32_bf16 v[132:135], a[92:95], a[12:15], v[132:135]
    v_mfma_f32_16x16x32_bf16 v[140:143], a[80:83], a[16:19], 0
    v_mfma_f32_16x16x32_bf16 v[140:143], a[84:87], a[20:23], v[140:143]
    v_mfma_f32_16x16x32_bf16 v[140:143], a[88:91], a[24:27], v[140:143]
    v_mfma_f32_16x16x32_bf16 v[140:143], a[92:95], a[28:31], v[140:143]
    v_mfma_f32_16x16x32_bf16 v[144:147], a[64:67], a[32:35], 0
    v_mfma_f32_16x16x32_bf16 v[144:147], a[68:71], a[36:39], v[144:147]
    v_mfma_f32_16x16x32_bf16 v[144:147], a[72:75], a[40:43], v[144:147]
    v_mfma_f32_16x16x32_bf16 v[144:147], a[76:79], a[44:47], v[144:147]
    v_mfma_f32_16x16x32_bf16 v[152:155], a[64:67], a[48:51], 0
    v_mfma_f32_16x16x32_bf16 v[152:155], a[68:71], a[52:55], v[152:155]
    v_mfma_f32_16x16x32_bf16 v[152:155], a[72:75], a[56:59], v[152:155]
    v_mfma_f32_16x16x32_bf16 v[152:155], a[76:79], a[60:63], v[152:155]
    v_mfma_f32_16x16x32_bf16 v[148:151], a[80:83], a[32:35], 0
    v_mfma_f32_16x16x32_bf16 v[148:151], a[84:87], a[36:39], v[148:151]
    v_mfma_f32_16x16x32_bf16 v[148:151], a[88:91], a[40:43], v[148:151]
    v_mfma_f32_16x16x32_bf16 v[148:151], a[92:95], a[44:47], v[148:151]
    v_mfma_f32_16x16x32_bf16 v[156:159], a[80:83], a[48:51], 0
    v_mfma_f32_16x16x32_bf16 v[156:159], a[84:87], a[52:55], v[156:159]
    v_mfma_f32_16x16x32_bf16 v[156:159], a[88:91], a[56:59], v[156:159]
    v_mfma_f32_16x16x32_bf16 v[156:159], a[92:95], a[60:63], v[156:159]
    v_max3_f32 v244, v128, v129, v240
    v_max3_f32 v244, v130, v131, v244
    v_max3_f32 v244, v132, v133, v244
    v_max3_f32 v244, v134, v135, v244
    v_mov_b32 v246, v244
    s_nop 1
    v_permlane16_swap_b32 v246, v244
    v_max_f32 v244, v244, v246
    v_mov_b32 v246, v244
    s_nop 1
    v_permlane32_swap_b32 v246, v244
    v_max_f32 v244, v244, v246
    v_sub_f32 v245, v240, v244
    v_exp_f32 v245, v245
    v_mov_b32 v240, v244
    v_mul_f32 v176, v176, v245
    v_mul_f32 v0, v0, v245
    v_mul_f32 v1, v1, v245
    v_mul_f32 v2, v2, v245
    v_mul_f32 v3, v3, v245
    v_mul_f32 v4, v4, v245
    v_mul_f32 v5, v5, v245
    v_mul_f32 v6, v6, v245
    v_mul_f32 v7, v7, v245
    v_mul_f32 v8, v8, v245
    v_mul_f32 v9, v9, v245
    v_mul_f32 v10, v10, v245
    v_mul_f32 v11, v11, v245
    v_mul_f32 v12, v12, v245
    v_mul_f32 v13, v13, v245
    v_mul_f32 v14, v14, v245
    v_mul_f32 v15, v15, v245
    v_mul_f32 v16, v16, v245
    v_mul_f32 v17, v17, v245
    v_mul_f32 v18, v18, v245
    v_mul_f32 v19, v19, v245
    v_mul_f32 v20, v20, v245
    v_mul_f32 v21, v21, v245
    v_mul_f32 v22, v22, v245
    v_mul_f32 v23, v23, v245
    v_mul_f32 v24, v24, v245
    v_mul_f32 v25, v25, v245
    v_mul_f32 v26, v26, v245
    v_mul_f32 v27, v27, v245
    v_mul_f32 v28, v28, v245
    v_mul_f32 v29, v29, v245
    v_mul_f32 v30, v30, v245
    v_mul_f32 v31, v31, v245
    v_sub_f32 v128, v128, v244
    v_exp_f32 v128, v128
    v_sub_f32 v129, v129, v244
    v_exp_f32 v129, v129
    v_sub_f32 v130, v130, v244
    v_exp_f32 v130, v130
    v_sub_f32 v131, v131, v244
    v_exp_f32 v131, v131
    v_sub_f32 v132, v132, v244
    v_exp_f32 v132, v132
    v_sub_f32 v133, v133, v244
    v_exp_f32 v133, v133
    v_sub_f32 v134, v134, v244
    v_exp_f32 v134, v134
    v_sub_f32 v135, v135, v244
    v_exp_f32 v135, v135
    v_add_f32 v176, v176, v128
    v_add_f32 v176, v176, v129
    v_add_f32 v176, v176, v130
    v_add_f32 v176, v176, v131
    v_add_f32 v176, v176, v132
    v_add_f32 v176, v176, v133
    v_add_f32 v176, v176, v134
    v_add_f32 v176, v176, v135
    v_max3_f32 v244, v136, v137, v241
    v_max3_f32 v244, v138, v139, v244
    v_max3_f32 v244, v140, v141, v244
    v_max3_f32 v244, v142, v143, v244
    v_mov_b32 v246, v244
    s_nop 1
    v_permlane16_swap_b32 v246, v244
    v_max_f32 v244, v244, v246
    v_mov_b32 v246, v244
    s_nop 1
    v_permlane32_swap_b32 v246, v244
    v_max_f32 v244, v244, v246
    v_sub_f32 v245, v241, v244
    v_exp_f32 v245, v245
    v_mov_b32 v241, v244
    v_mul_f32 v177, v177, v245
    v_mul_f32 v32, v32, v245
    v_mul_f32 v33, v33, v245
    v_mul_f32 v34, v34, v245
    v_mul_f32 v35, v35, v245
    v_mul_f32 v36, v36, v245
    v_mul_f32 v37, v37, v245
    v_mul_f32 v38, v38, v245
    v_mul_f32 v39, v39, v245
    v_mul_f32 v40, v40, v245
    v_mul_f32 v41, v41, v245
    v_mul_f32 v42, v42, v245
    v_mul_f32 v43, v43, v245
    v_mul_f32 v44, v44, v245
    v_mul_f32 v45, v45, v245
    v_mul_f32 v46, v46, v245
    v_mul_f32 v47, v47, v245
    v_mul_f32 v48, v48, v245
    v_mul_f32 v49, v49, v245
    v_mul_f32 v50, v50, v245
    v_mul_f32 v51, v51, v245
    v_mul_f32 v52, v52, v245
    v_mul_f32 v53, v53, v245
    v_mul_f32 v54, v54, v245
    v_mul_f32 v55, v55, v245
    v_mul_f32 v56, v56, v245
    v_mul_f32 v57, v57, v245
    v_mul_f32 v58, v58, v245
    v_mul_f32 v59, v59, v245
    v_mul_f32 v60, v60, v245
    v_mul_f32 v61, v61, v245
    v_mul_f32 v62, v62, v245
    v_mul_f32 v63, v63, v245
    v_sub_f32 v136, v136, v244
    v_exp_f32 v136, v136
    v_sub_f32 v137, v137, v244
    v_exp_f32 v137, v137
    v_sub_f32 v138, v138, v244
    v_exp_f32 v138, v138
    v_sub_f32 v139, v139, v244
    v_exp_f32 v139, v139
    v_sub_f32 v140, v140, v244
    v_exp_f32 v140, v140
    v_sub_f32 v141, v141, v244
    v_exp_f32 v141, v141
    v_sub_f32 v142, v142, v244
    v_exp_f32 v142, v142
    v_sub_f32 v143, v143, v244
    v_exp_f32 v143, v143
    v_add_f32 v177, v177, v136
    v_add_f32 v177, v177, v137
    v_add_f32 v177, v177, v138
    v_add_f32 v177, v177, v139
    v_add_f32 v177, v177, v140
    v_add_f32 v177, v177, v141
    v_add_f32 v177, v177, v142
    v_add_f32 v177, v177, v143
    v_cvt_pk_bf16_f32 v160, v128, v129
    v_cvt_pk_bf16_f32 v161, v130, v131
    v_cvt_pk_bf16_f32 v162, v132, v133
    v_cvt_pk_bf16_f32 v163, v134, v135
    v_cvt_pk_bf16_f32 v164, v136, v137
    v_cvt_pk_bf16_f32 v165, v138, v139
    v_cvt_pk_bf16_f32 v166, v140, v141
    v_cvt_pk_bf16_f32 v167, v142, v143
    v_max3_f32 v244, v144, v145, v242
    v_max3_f32 v244, v146, v147, v244
    v_max3_f32 v244, v148, v149, v244
    v_max3_f32 v244, v150, v151, v244
    v_mov_b32 v246, v244
    s_nop 1
    v_permlane16_swap_b32 v246, v244
    v_max_f32 v244, v244, v246
    v_mov_b32 v246, v244
    s_nop 1
    v_permlane32_swap_b32 v246, v244
    v_max_f32 v244, v244, v246
    v_sub_f32 v245, v242, v244
    v_exp_f32 v245, v245
    v_mov_b32 v242, v244
    v_mul_f32 v178, v178, v245
    v_mul_f32 v64, v64, v245
    v_mul_f32 v65, v65, v245
    v_mul_f32 v66, v66, v245
    v_mul_f32 v67, v67, v245
    v_mul_f32 v68, v68, v245
    v_mul_f32 v69, v69, v245
    v_mul_f32 v70, v70, v245
    v_mul_f32 v71, v71, v245
    v_mul_f32 v72, v72, v245
    v_mul_f32 v73, v73, v245
    v_mul_f32 v74, v74, v245
    v_mul_f32 v75, v75, v245
    v_mul_f32 v76, v76, v245
    v_mul_f32 v77, v77, v245
    v_mul_f32 v78, v78, v245
    v_mul_f32 v79, v79, v245
    v_mul_f32 v80, v80, v245
    v_mul_f32 v81, v81, v245
    v_mul_f32 v82, v82, v245
    v_mul_f32 v83, v83, v245
    v_mul_f32 v84, v84, v245
    v_mul_f32 v85, v85, v245
    v_mul_f32 v86, v86, v245
    v_mul_f32 v87, v87, v245
    v_mul_f32 v88, v88, v245
    v_mul_f32 v89, v89, v245
    v_mul_f32 v90, v90, v245
    v_mul_f32 v91, v91, v245
    v_mul_f32 v92, v92, v245
    v_mul_f32 v93, v93, v245
    v_mul_f32 v94, v94, v245
    v_mul_f32 v95, v95, v245
    v_sub_f32 v144, v144, v244
    v_exp_f32 v144, v144
    v_sub_f32 v145, v145, v244
    v_exp_f32 v145, v145
    v_sub_f32 v146, v146, v244
    v_exp_f32 v146, v146
    v_sub_f32 v147, v147, v244
    v_exp_f32 v147, v147
    v_sub_f32 v148, v148, v244
    v_exp_f32 v148, v148
    v_sub_f32 v149, v149, v244
    v_exp_f32 v149, v149
    v_sub_f32 v150, v150, v244
    v_exp_f32 v150, v150
    v_sub_f32 v151, v151, v244
    v_exp_f32 v151, v151
    v_add_f32 v178, v178, v144
    v_add_f32 v178, v178, v145
    v_add_f32 v178, v178, v146
    v_add_f32 v178, v178, v147
    v_add_f32 v178, v178, v148
    v_add_f32 v178, v178, v149
    v_add_f32 v178, v178, v150
    v_add_f32 v178, v178, v151
    v_max3_f32 v244, v152, v153, v243
    v_max3_f32 v244, v154, v155, v244
    v_max3_f32 v244, v156, v157, v244
    v_max3_f32 v244, v158, v159, v244
    v_mov_b32 v246, v244
    s_nop 1
    v_permlane16_swap_b32 v246, v244
    v_max_f32 v244, v244, v246
    v_mov_b32 v246, v244
    s_nop 1
    v_permlane32_swap_b32 v246, v244
    v_max_f32 v244, v244, v246
    v_sub_f32 v245, v243, v244
    v_exp_f32 v245, v245
    v_mov_b32 v243, v244
    v_mul_f32 v179, v179, v245
    v_mul_f32 v96, v96, v245
    v_mul_f32 v97, v97, v245
    v_mul_f32 v98, v98, v245
    v_mul_f32 v99, v99, v245
    v_mul_f32 v100, v100, v245
    v_mul_f32 v101, v101, v245
    v_mul_f32 v102, v102, v245
    v_mul_f32 v103, v103, v245
    v_mul_f32 v104, v104, v245
    v_mul_f32 v105, v105, v245
    v_mul_f32 v106, v106, v245
    v_mul_f32 v107, v107, v245
    v_mul_f32 v108, v108, v245
    v_mul_f32 v109, v109, v245
    v_mul_f32 v110, v110, v245
    v_mul_f32 v111, v111, v245
    v_mul_f32 v112, v112, v245
    v_mul_f32 v113, v113, v245
    v_mul_f32 v114, v114, v245
    v_mul_f32 v115, v115, v245
    v_mul_f32 v116, v116, v245
    v_mul_f32 v117, v117, v245
    v_mul_f32 v118, v118, v245
    v_mul_f32 v119, v119, v245
    v_mul_f32 v120, v120, v245
    v_mul_f32 v121, v121, v245
    v_mul_f32 v122, v122, v245
    v_mul_f32 v123, v123, v245
    v_mul_f32 v124, v124, v245
    v_mul_f32 v125, v125, v245
    v_mul_f32 v126, v126, v245
    v_mul_f32 v127, v127, v245
    v_sub_f32 v152, v152, v244
    v_exp_f32 v152, v152
    v_sub_f32 v153, v153, v244
    v_exp_f32 v153, v153
    v_sub_f32 v154, v154, v244
    v_exp_f32 v154, v154
    v_sub_f32 v155, v155, v244
    v_exp_f32 v155, v155
    v_sub_f32 v156, v156, v244
    v_exp_f32 v156, v156
    v_sub_f32 v157, v157, v244
    v_exp_f32 v157, v157
    v_sub_f32 v158, v158, v244
    v_exp_f32 v158, v158
    v_sub_f32 v159, v159, v244
    v_exp_f32 v159, v159
    v_add_f32 v179, v179, v152
    v_add_f32 v179, v179, v153
    v_add_f32 v179, v179, v154
    v_add_f32 v179, v179, v155
    v_add_f32 v179, v179, v156
    v_add_f32 v179, v179, v157
    v_add_f32 v179, v179, v158
    v_add_f32 v179, v179, v159
    v_cvt_pk_bf16_f32 v168, v144, v145
    v_cvt_pk_bf16_f32 v169, v146, v147
    v_cvt_pk_bf16_f32 v170, v148, v149
    v_cvt_pk_bf16_f32 v171, v150, v151
    v_cvt_pk_bf16_f32 v172, v152, v153
    v_cvt_pk_bf16_f32 v173, v154, v155
    v_cvt_pk_bf16_f32 v174, v156, v157
    v_cvt_pk_bf16_f32 v175, v158, v159
    s_waitcnt vmcnt(0)
    ds_read_b64_tr_b16 a[96:97], v232 offset:0
    ds_read_b64_tr_b16 a[98:99], v232 offset:4096
    ds_read_b64_tr_b16 a[100:101], v233 offset:0
    ds_read_b64_tr_b16 a[102:103], v233 offset:4096
    ds_read_b64_tr_b16 a[104:105], v234 offset:0
    ds_read_b64_tr_b16 a[106:107], v234 offset:4096
    ds_read_b64_tr_b16 a[108:109], v235 offset:0
    ds_read_b64_tr_b16 a[110:111], v235 offset:4096
    ds_read_b64_tr_b16 a[112:113], v236 offset:0
    ds_read_b64_tr_b16 a[114:115], v236 offset:4096
    ds_read_b64_tr_b16 a[116:117], v237 offset:0
    ds_read_b64_tr_b16 a[118:119], v237 offset:4096
    ds_read_b64_tr_b16 a[120:121], v238 offset:0
    ds_read_b64_tr_b16 a[122:123], v238 offset:4096
    ds_read_b64_tr_b16 a[124:125], v239 offset:0
    ds_read_b64_tr_b16 a[126:127], v239 offset:4096
    s_waitcnt lgkmcnt(0)
    v_mfma_f32_16x16x32_bf16 v[0:3], a[96:99], v[160:163], v[0:3]
    v_mfma_f32_16x16x32_bf16 v[32:35], a[96:99], v[164:167], v[32:35]
    v_mfma_f32_16x16x32_bf16 v[4:7], a[100:103], v[160:163], v[4:7]
    v_mfma_f32_16x16x32_bf16 v[36:39], a[100:103], v[164:167], v[36:39]
    v_mfma_f32_16x16x32_bf16 v[8:11], a[104:107], v[160:163], v[8:11]
    v_mfma_f32_16x16x32_bf16 v[40:43], a[104:107], v[164:167], v[40:43]
    v_mfma_f32_16x16x32_bf16 v[12:15], a[108:111], v[160:163], v[12:15]
    v_mfma_f32_16x16x32_bf16 v[44:47], a[108:111], v[164:167], v[44:47]
    v_mfma_f32_16x16x32_bf16 v[16:19], a[112:115], v[160:163], v[16:19]
    v_mfma_f32_16x16x32_bf16 v[48:51], a[112:115], v[164:167], v[48:51]
    v_mfma_f32_16x16x32_bf16 v[20:23], a[116:119], v[160:163], v[20:23]
    v_mfma_f32_16x16x32_bf16 v[52:55], a[116:119], v[164:167], v[52:55]
    v_mfma_f32_16x16x32_bf16 v[24:27], a[120:123], v[160:163], v[24:27]
    v_mfma_f32_16x16x32_bf16 v[56:59], a[120:123], v[164:167], v[56:59]
    v_mfma_f32_16x16x32_bf16 v[28:31], a[124:127], v[160:163], v[28:31]
    v_mfma_f32_16x16x32_bf16 v[60:63], a[124:127], v[164:167], v[60:63]
    v_mfma_f32_16x16x32_bf16 v[64:67], a[96:99], v[168:171], v[64:67]
    v_mfma_f32_16x16x32_bf16 v[96:99], a[96:99], v[172:175], v[96:99]
    v_mfma_f32_16x16x32_bf16 v[68:71], a[100:103], v[168:171], v[68:71]
    v_mfma_f32_16x16x32_bf16 v[100:103], a[100:103], v[172:175], v[100:103]
    v_mfma_f32_16x16x32_bf16 v[72:75], a[104:107], v[168:171], v[72:75]
    v_mfma_f32_16x16x32_bf16 v[104:107], a[104:107], v[172:175], v[104:107]
    v_mfma_f32_16x16x32_bf16 v[76:79], a[108:111], v[168:171], v[76:79]
    v_mfma_f32_16x16x32_bf16 v[108:111], a[108:111], v[172:175], v[108:111]
    v_mfma_f32_16x16x32_bf16 v[80:83], a[112:115], v[168:171], v[80:83]
    v_mfma_f32_16x16x32_bf16 v[112:115], a[112:115], v[172:175], v[112:115]
    v_mfma_f32_16x16x32_bf16 v[84:87], a[116:119], v[168:171], v[84:87]
    v_mfma_f32_16x16x32_bf16 v[116:119], a[116:119], v[172:175], v[116:119]
    v_mfma_f32_16x16x32_bf16 v[88:91], a[120:123], v[168:171], v[88:91]
    v_mfma_f32_16x16x32_bf16 v[120:123], a[120:123], v[172:175], v[120:123]
    v_mfma_f32_16x16x32_bf16 v[92:95], a[124:127], v[168:171], v[92:95]
    v_mfma_f32_16x16x32_bf16 v[124:127], a[124:127], v[172:175], v[124:127]
    s_add_u32 s42, s42, 8192
    s_add_u32 s43, s43, 1
    s_cmp_lt_u32 s43, 32
    s_nop 15
    s_cbranch_scc1 L_fb_loop
    v_mov_b32 v222, v176
    v_mov_b32 v223, v177
    s_nop 0
    v_permlane16_swap_b32 v222, v176
    v_permlane16_swap_b32 v223, v177
    v_add_f32 v176, v176, v222
    v_add_f32 v177, v177, v223
    v_mov_b32 v222, v176
    v_mov_b32 v223, v177
    s_nop 0
    v_permlane32_swap_b32 v222, v176
    v_permlane32_swap_b32 v223, v177
    v_add_f32 v176, v176, v222
    v_add_f32 v177, v177, v223
    v_rcp_f32 v218, v176
    v_rcp_f32 v219, v177
    v_mul_f32 v0, v0, v218
    v_mul_f32 v1, v1, v218
    v_mul_f32 v2, v2, v218
    v_mul_f32 v3, v3, v218
    v_mul_f32 v4, v4, v218
    v_mul_f32 v5, v5, v218
    v_mul_f32 v6, v6, v218
    v_mul_f32 v7, v7, v218
    v_mul_f32 v8, v8, v218
    v_mul_f32 v9, v9, v218
    v_mul_f32 v10, v10, v218
    v_mul_f32 v11, v11, v218
    v_mul_f32 v12, v12, v218
    v_mul_f32 v13, v13, v218
    v_mul_f32 v14, v14, v218
    v_mul_f32 v15, v15, v218
    v_cvt_pk_bf16_f32 v0, v0, v1
    v_cvt_pk_bf16_f32 v1, v2, v3
    v_cvt_pk_bf16_f32 v2, v4, v5
    v_cvt_pk_bf16_f32 v3, v6, v7
    v_cvt_pk_bf16_f32 v4, v8, v9
    v_cvt_pk_bf16_f32 v5, v10, v11
    v_cvt_pk_bf16_f32 v6, v12, v13
    v_cvt_pk_bf16_f32 v7, v14, v15
    ds_write_b64 v206, v[0:1] offset:0
    ds_write_b64 v207, v[2:3] offset:0
    ds_write_b64 v208, v[4:5] offset:0
    ds_write_b64 v209, v[6:7] offset:0
    v_mul_f32 v16, v16, v218
    v_mul_f32 v17, v17, v218
    v_mul_f32 v18, v18, v218
    v_mul_f32 v19, v19, v218
    v_mul_f32 v20, v20, v218
    v_mul_f32 v21, v21, v218
    v_mul_f32 v22, v22, v218
    v_mul_f32 v23, v23, v218
    v_mul_f32 v24, v24, v218
    v_mul_f32 v25, v25, v218
    v_mul_f32 v26, v26, v218
    v_mul_f32 v27, v27, v218
    v_mul_f32 v28, v28, v218
    v_mul_f32 v29, v29, v218
    v_mul_f32 v30, v30, v218
    v_mul_f32 v31, v31, v218
    v_cvt_pk_bf16_f32 v16, v16, v17
    v_cvt_pk_bf16_f32 v17, v18, v19
    v_cvt_pk_bf16_f32 v18, v20, v21
    v_cvt_pk_bf16_f32 v19, v22, v23
    v_cvt_pk_bf16_f32 v20, v24, v25
    v_cvt_pk_bf16_f32 v21, v26, v27
    v_cvt_pk_bf16_f32 v22, v28, v29
    v_cvt_pk_bf16_f32 v23, v30, v31
    ds_write_b64 v210, v[16:17] offset:0
    ds_write_b64 v211, v[18:19] offset:0
    ds_write_b64 v212, v[20:21] offset:0
    ds_write_b64 v213, v[22:23] offset:0
    v_mul_f32 v32, v32, v219
    v_mul_f32 v33, v33, v219
    v_mul_f32 v34, v34, v219
    v_mul_f32 v35, v35, v219
    v_mul_f32 v36, v36, v219
    v_mul_f32 v37, v37, v219
    v_mul_f32 v38, v38, v219
    v_mul_f32 v39, v39, v219
    v_mul_f32 v40, v40, v219
    v_mul_f32 v41, v41, v219
    v_mul_f32 v42, v42, v219
    v_mul_f32 v43, v43, v219
    v_mul_f32 v44, v44, v219
    v_mul_f32 v45, v45, v219
    v_mul_f32 v46, v46, v219
    v_mul_f32 v47, v47, v219
    v_cvt_pk_bf16_f32 v32, v32, v33
    v_cvt_pk_bf16_f32 v33, v34, v35
    v_cvt_pk_bf16_f32 v34, v36, v37
    v_cvt_pk_bf16_f32 v35, v38, v39
    v_cvt_pk_bf16_f32 v36, v40, v41
    v_cvt_pk_bf16_f32 v37, v42, v43
    v_cvt_pk_bf16_f32 v38, v44, v45
    v_cvt_pk_bf16_f32 v39, v46, v47
    ds_write_b64 v206, v[32:33] offset:4096
    ds_write_b64 v207, v[34:35] offset:4096
    ds_write_b64 v208, v[36:37] offset:4096
    ds_write_b64 v209, v[38:39] offset:4096
    v_mul_f32 v48, v48, v219
    v_mul_f32 v49, v49, v219
    v_mul_f32 v50, v50, v219
    v_mul_f32 v51, v51, v219
    v_mul_f32 v52, v52, v219
    v_mul_f32 v53, v53, v219
    v_mul_f32 v54, v54, v219
    v_mul_f32 v55, v55, v219
    v_mul_f32 v56, v56, v219
    v_mul_f32 v57, v57, v219
    v_mul_f32 v58, v58, v219
    v_mul_f32 v59, v59, v219
    v_mul_f32 v60, v60, v219
    v_mul_f32 v61, v61, v219
    v_mul_f32 v62, v62, v219
    v_mul_f32 v63, v63, v219
    v_cvt_pk_bf16_f32 v48, v48, v49
    v_cvt_pk_bf16_f32 v49, v50, v51
    v_cvt_pk_bf16_f32 v50, v52, v53
    v_cvt_pk_bf16_f32 v51, v54, v55
    v_cvt_pk_bf16_f32 v52, v56, v57
    v_cvt_pk_bf16_f32 v53, v58, v59
    v_cvt_pk_bf16_f32 v54, v60, v61
    v_cvt_pk_bf16_f32 v55, v62, v63
    ds_write_b64 v210, v[48:49] offset:4096
    ds_write_b64 v211, v[50:51] offset:4096
    ds_write_b64 v212, v[52:53] offset:4096
    ds_write_b64 v213, v[54:55] offset:4096
    ds_read_b128 a[192:195], v205 offset:0
    ds_read_b128 a[196:199], v205 offset:1024
    ds_read_b128 a[200:203], v205 offset:2048
    ds_read_b128 a[204:207], v205 offset:3072
    ds_read_b128 a[208:211], v205 offset:4096
    ds_read_b128 a[212:215], v205 offset:5120
    ds_read_b128 a[216:219], v205 offset:6144
    ds_read_b128 a[220:223], v205 offset:7168
    s_add_u32 s39, s52, 0
    s_waitcnt lgkmcnt(7)
    buffer_store_dwordx4 a[192:195], v202, s[24:27], s39 offen offset:0 sc0 sc1 nt
    s_waitcnt lgkmcnt(6)
    buffer_store_dwordx4 a[196:199], v203, s[24:27], s39 offen offset:1024 sc0 sc1 nt
    s_waitcnt lgkmcnt(5)
    buffer_store_dwordx4 a[200:203], v202, s[24:27], s39 offen offset:2048 sc0 sc1 nt
    s_waitcnt lgkmcnt(4)
    buffer_store_dwordx4 a[204:207], v203, s[24:27], s39 offen offset:3072 sc0 sc1 nt
    s_add_u32 s39, s52, 4096
    s_waitcnt lgkmcnt(3)
    buffer_store_dwordx4 a[208:211], v202, s[24:27], s39 offen offset:0 sc0 sc1 nt
    s_waitcnt lgkmcnt(2)
    buffer_store_dwordx4 a[212:215], v203, s[24:27], s39 offen offset:1024 sc0 sc1 nt
    s_waitcnt lgkmcnt(1)
    buffer_store_dwordx4 a[216:219], v202, s[24:27], s39 offen offset:2048 sc0 sc1 nt
    s_waitcnt lgkmcnt(0)
    buffer_store_dwordx4 a[220:223], v203, s[24:27], s39 offen offset:3072 sc0 sc1 nt
    v_mov_b32 v224, v178
    v_mov_b32 v225, v179
    s_nop 0
    v_permlane16_swap_b32 v224, v178
    v_permlane16_swap_b32 v225, v179
    v_add_f32 v178, v178, v224
    v_add_f32 v179, v179, v225
    v_mov_b32 v224, v178
    v_mov_b32 v225, v179
    s_nop 0
    v_permlane32_swap_b32 v224, v178
    v_permlane32_swap_b32 v225, v179
    v_add_f32 v178, v178, v224
    v_add_f32 v179, v179, v225
    v_rcp_f32 v220, v178
    v_rcp_f32 v221, v179
    v_mul_f32 v64, v64, v220
    v_mul_f32 v65, v65, v220
    v_mul_f32 v66, v66, v220
    v_mul_f32 v67, v67, v220
    v_mul_f32 v68, v68, v220
    v_mul_f32 v69, v69, v220
    v_mul_f32 v70, v70, v220
    v_mul_f32 v71, v71, v220
    v_mul_f32 v72, v72, v220
    v_mul_f32 v73, v73, v220
    v_mul_f32 v74, v74, v220
    v_mul_f32 v75, v75, v220
    v_mul_f32 v76, v76, v220
    v_mul_f32 v77, v77, v220
    v_mul_f32 v78, v78, v220
    v_mul_f32 v79, v79, v220
    v_cvt_pk_bf16_f32 v64, v64, v65
    v_cvt_pk_bf16_f32 v65, v66, v67
    v_cvt_pk_bf16_f32 v66, v68, v69
    v_cvt_pk_bf16_f32 v67, v70, v71
    v_cvt_pk_bf16_f32 v68, v72, v73
    v_cvt_pk_bf16_f32 v69, v74, v75
    v_cvt_pk_bf16_f32 v70, v76, v77
    v_cvt_pk_bf16_f32 v71, v78, v79
    ds_write_b64 v206, v[64:65] offset:0
    ds_write_b64 v207, v[66:67] offset:0
    ds_write_b64 v208, v[68:69] offset:0
    ds_write_b64 v209, v[70:71] offset:0
    v_mul_f32 v80, v80, v220
    v_mul_f32 v81, v81, v220
    v_mul_f32 v82, v82, v220
    v_mul_f32 v83, v83, v220
    v_mul_f32 v84, v84, v220
    v_mul_f32 v85, v85, v220
    v_mul_f32 v86, v86, v220
    v_mul_f32 v87, v87, v220
    v_mul_f32 v88, v88, v220
    v_mul_f32 v89, v89, v220
    v_mul_f32 v90, v90, v220
    v_mul_f32 v91, v91, v220
    v_mul_f32 v92, v92, v220
    v_mul_f32 v93, v93, v220
    v_mul_f32 v94, v94, v220
    v_mul_f32 v95, v95, v220
    v_cvt_pk_bf16_f32 v80, v80, v81
    v_cvt_pk_bf16_f32 v81, v82, v83
    v_cvt_pk_bf16_f32 v82, v84, v85
    v_cvt_pk_bf16_f32 v83, v86, v87
    v_cvt_pk_bf16_f32 v84, v88, v89
    v_cvt_pk_bf16_f32 v85, v90, v91
    v_cvt_pk_bf16_f32 v86, v92, v93
    v_cvt_pk_bf16_f32 v87, v94, v95
    ds_write_b64 v210, v[80:81] offset:0
    ds_write_b64 v211, v[82:83] offset:0
    ds_write_b64 v212, v[84:85] offset:0
    ds_write_b64 v213, v[86:87] offset:0
    v_mul_f32 v96, v96, v221
    v_mul_f32 v97, v97, v221
    v_mul_f32 v98, v98, v221
    v_mul_f32 v99, v99, v221
    v_mul_f32 v100, v100, v221
    v_mul_f32 v101, v101, v221
    v_mul_f32 v102, v102, v221
    v_mul_f32 v103, v103, v221
    v_mul_f32 v104, v104, v221
    v_mul_f32 v105, v105, v221
    v_mul_f32 v106, v106, v221
    v_mul_f32 v107, v107, v221
    v_mul_f32 v108, v108, v221
    v_mul_f32 v109, v109, v221
    v_mul_f32 v110, v110, v221
    v_mul_f32 v111, v111, v221
    v_cvt_pk_bf16_f32 v96, v96, v97
    v_cvt_pk_bf16_f32 v97, v98, v99
    v_cvt_pk_bf16_f32 v98, v100, v101
    v_cvt_pk_bf16_f32 v99, v102, v103
    v_cvt_pk_bf16_f32 v100, v104, v105
    v_cvt_pk_bf16_f32 v101, v106, v107
    v_cvt_pk_bf16_f32 v102, v108, v109
    v_cvt_pk_bf16_f32 v103, v110, v111
    ds_write_b64 v206, v[96:97] offset:4096
    ds_write_b64 v207, v[98:99] offset:4096
    ds_write_b64 v208, v[100:101] offset:4096
    ds_write_b64 v209, v[102:103] offset:4096
    v_mul_f32 v112, v112, v221
    v_mul_f32 v113, v113, v221
    v_mul_f32 v114, v114, v221
    v_mul_f32 v115, v115, v221
    v_mul_f32 v116, v116, v221
    v_mul_f32 v117, v117, v221
    v_mul_f32 v118, v118, v221
    v_mul_f32 v119, v119, v221
    v_mul_f32 v120, v120, v221
    v_mul_f32 v121, v121, v221
    v_mul_f32 v122, v122, v221
    v_mul_f32 v123, v123, v221
    v_mul_f32 v124, v124, v221
    v_mul_f32 v125, v125, v221
    v_mul_f32 v126, v126, v221
    v_mul_f32 v127, v127, v221
    v_cvt_pk_bf16_f32 v112, v112, v113
    v_cvt_pk_bf16_f32 v113, v114, v115
    v_cvt_pk_bf16_f32 v114, v116, v117
    v_cvt_pk_bf16_f32 v115, v118, v119
    v_cvt_pk_bf16_f32 v116, v120, v121
    v_cvt_pk_bf16_f32 v117, v122, v123
    v_cvt_pk_bf16_f32 v118, v124, v125
    v_cvt_pk_bf16_f32 v119, v126, v127
    ds_write_b64 v210, v[112:113] offset:4096
    ds_write_b64 v211, v[114:115] offset:4096
    ds_write_b64 v212, v[116:117] offset:4096
    ds_write_b64 v213, v[118:119] offset:4096
    ds_read_b128 a[192:195], v205 offset:0
    ds_read_b128 a[196:199], v205 offset:1024
    ds_read_b128 a[200:203], v205 offset:2048
    ds_read_b128 a[204:207], v205 offset:3072
    ds_read_b128 a[208:211], v205 offset:4096
    ds_read_b128 a[212:215], v205 offset:5120
    ds_read_b128 a[216:219], v205 offset:6144
    ds_read_b128 a[220:223], v205 offset:7168
    s_add_u32 s39, s52, 8192
    s_waitcnt lgkmcnt(7)
    buffer_store_dwordx4 a[192:195], v202, s[24:27], s39 offen offset:0 sc0 sc1 nt
    s_waitcnt lgkmcnt(6)
    buffer_store_dwordx4 a[196:199], v203, s[24:27], s39 offen offset:1024 sc0 sc1 nt
    s_waitcnt lgkmcnt(5)
    buffer_store_dwordx4 a[200:203], v202, s[24:27], s39 offen offset:2048 sc0 sc1 nt
    s_waitcnt lgkmcnt(4)
    buffer_store_dwordx4 a[204:207], v203, s[24:27], s39 offen offset:3072 sc0 sc1 nt
    s_add_u32 s39, s52, 12288
    s_waitcnt lgkmcnt(3)
    buffer_store_dwordx4 a[208:211], v202, s[24:27], s39 offen offset:0 sc0 sc1 nt
    s_waitcnt lgkmcnt(2)
    buffer_store_dwordx4 a[212:215], v203, s[24:27], s39 offen offset:1024 sc0 sc1 nt
    s_waitcnt lgkmcnt(1)
    buffer_store_dwordx4 a[216:219], v202, s[24:27], s39 offen offset:2048 sc0 sc1 nt
    s_waitcnt lgkmcnt(0)
    buffer_store_dwordx4 a[220:223], v203, s[24:27], s39 offen offset:3072 sc0 sc1 nt
    s_waitcnt vmcnt(0) lgkmcnt(0)
    s_cmp_eq_u32 s32, 1
    s_cbranch_scc1 L_end
    s_bitcmp1_b32 s50, 1
    s_cbranch_scc1 L_fb_second
L_end:
    s_endpgm
.section .rodata,"a"
.p2align 6
.amdhsa_kernel standalone__gqa_softmax__near_ridge_kernel
  .amdhsa_next_free_vgpr 512
  .amdhsa_next_free_sgpr 102
  .amdhsa_accum_offset 256
  .amdhsa_group_segment_fixed_size 0
  .amdhsa_kernarg_size 48
  .amdhsa_user_sgpr_count 2
  .amdhsa_user_sgpr_kernarg_segment_ptr 1
  .amdhsa_system_sgpr_workgroup_id_x 1
.end_amdhsa_kernel
```
